```python
import torch

def _softmax(x, axis=-1):
    return torch.softmax(x, dim=axis)

def _gelu(x):
    return torch.nn.functional.gelu(x, approximate='tanh')

def _silu(x):
    return torch.nn.functional.silu(x)

def _sigmoid(x):
    return torch.sigmoid(x)

def _layernorm(x, axis=-1, eps=1e-05):
    m = x.mean(dim=axis, keepdim=True)
    v = x.var(dim=axis, keepdim=True, unbiased=False)
    return (x - m) / torch.sqrt(v + eps)

def _scatter_add(tgt, idx, src, axis=0):
    return tgt.clone().index_add_(axis, idx, src)

def _segment_sum(src, seg, n):
    out = torch.zeros((n,) + src.shape[1:], dtype=src.dtype)
    return out.index_add_(0, seg, src)

def _pad(x, pw):
    flat = tuple((v for pair in reversed(pw) for v in pair))
    return torch.nn.functional.pad(x, flat)
kernel_name = 'concat_heads__memory_aug_recurrent_mem_tr__linear_attn_block__prompt'

def setup_inputs():

    _w = lambda a: (lambda t: t.to(torch.bfloat16) if t.is_floating_point() else t)(torch.as_tensor(a))

    def _A_setup():
        B, S, Dm = (1, 2048, 640)
        H, Dh = (32, 128)
        M, seg = (8, 32)
        seg = min(seg, S)
        S = S // seg * seg
        return {'x': _w((lambda *s: torch.randn(*s, dtype=torch.bfloat16) * 0.05)(B, S, Dm)), 'mem0': _w((lambda *s: torch.randn(*s, dtype=torch.bfloat16) * 0.8)(B, M, Dm)), 'Wq': _w((lambda *s: torch.randn(*s, dtype=torch.bfloat16) * 1.6)(Dm, H, Dh) * Dm ** (-0.5)), 'Wk': _w((lambda *s: torch.randn(*s, dtype=torch.bfloat16) * 1.6)(Dm, H, Dh) * Dm ** (-0.5)), 'Wv': _w((lambda *s: torch.randn(*s, dtype=torch.bfloat16) * 0.8)(Dm, H, Dh) * Dm ** (-0.5)), 'Wo': _w((lambda *s: torch.randn(*s, dtype=torch.bfloat16) * 0.8)(H, Dh, Dm) * (H * Dh) ** (-0.5)), 'seg_len': seg}
    _A_in = _A_setup()

    def _B_setup():
        B, S, D = (1, 2048, 640)
        return {'x': _w((lambda *s: torch.randn(*s, dtype=torch.bfloat16) * 0.05)(B, S, D)), 'wqkv': _w((lambda *s: torch.randn(*s, dtype=torch.bfloat16) * 1.6)(D, 3 * D)), 'wo': _w((lambda *s: torch.randn(*s, dtype=torch.bfloat16) * 0.1)(D, D))}
    _B_in = _B_setup()
    return {'A_x': _A_in['x'], 'A_mem0': _A_in['mem0'], 'A_Wq': _A_in['Wq'], 'A_Wk': _A_in['Wk'], 'A_Wv': _A_in['Wv'], 'A_Wo': _A_in['Wo'], 'A_seg_len': _A_in['seg_len'], 'B_x': _B_in['x'], 'B_wqkv': _B_in['wqkv'], 'B_wo': _B_in['wo']}

def reference(A_x, A_mem0, A_Wq, A_Wk, A_Wv, A_Wo, A_seg_len, B_x, B_wqkv, B_wo):

    def _A_ref(x, mem0, Wq, Wk, Wv, Wo, seg_len):
        B, S, Dm = x.shape
        H, Dh = (Wq.shape[1], Wq.shape[2])
        M = mem0.shape[1]
        scale = Dh ** (-0.5)
        n_seg = S // seg_len
        L = M + seg_len
        idx = torch.arange(L)
        mask = (idx[:, None] < M) | (idx[:, None] >= idx[None, :])
        mem = mem0
        outs = []
        for s in range(n_seg):
            xs = x[:, s * seg_len:(s + 1) * seg_len, :].clone()
            h = torch.concatenate([mem, xs], axis=1)
            q = torch.einsum('btd,dhe->bhte', h, Wq)
            k = torch.einsum('btd,dhe->bhte', h, Wk)
            v = torch.einsum('btd,dhe->bhte', h, Wv)
            scores = torch.einsum('bhqe,bhke->bhqk', q, k) * scale
            scores = torch.where(mask[None, None], scores, -1000000000.0)
            p = _softmax(scores, axis=-1)
            o = torch.einsum('bhqk,bhke->bhqe', p, v)
            o = torch.einsum('bhte,hed->btd', o, Wo)
            mem = o[:, :M, :].clone()
            outs.append(o[:, M:, :])
        return torch.concatenate(outs, axis=1)

    def _B_ref(x, wqkv, wo):
        B, S, D = x.shape
        H = 32
        Dh = D // H
        qkv = (lambda x, *d: x.permute(*d))((x @ wqkv).reshape(B, S, 3, H, Dh), 2, 0, 3, 1, 4)
        q, k, v = (qkv[0], qkv[1], qkv[2])
        phi = lambda t: torch.where(t > 0, t + 1, torch.exp(t)) + 1e-06
        pq, pk = (phi(q), phi(k))
        kv = torch.einsum('bhsd,bhse->bhde', pk, v)
        z = torch.einsum('bhsd->bhd', pk)
        num = torch.einsum('bhqd,bhde->bhqe', pq, kv)
        den = torch.einsum('bhqd,bhd->bhq', pq, z)[..., None] + 1e-06
        o = num / den
        return (lambda x, *d: x.permute(*d))(o, 0, 2, 1, 3).reshape(B, S, D) @ wo
    a = _A_ref(A_x, A_mem0, A_Wq, A_Wk, A_Wv, A_Wo, A_seg_len)
    b = _B_ref(B_x, B_wqkv, B_wo)
    return torch.concatenate([a, b], axis=-1)
```

```asm
; @launch grid=(256,1,1) block=(512,1,1) lds=163840
.amdgcn_target "amdgcn-amd-amdhsa--gfx950"
.text
.globl concat_heads__memory_aug_recurrent_mem_tr__linear_attn_block__prompt_kernel
.p2align 8
.type concat_heads__memory_aug_recurrent_mem_tr__linear_attn_block__prompt_kernel,@function
concat_heads__memory_aug_recurrent_mem_tr__linear_attn_block__prompt_kernel:
  s_cmp_ge_u32 s2, 256
  s_cbranch_scc1 L_end
  s_load_dwordx16 s[64:79], s[0:1], 0
  s_load_dwordx8 s[80:87], s[0:1], 64
  s_load_dwordx2 s[88:89], s[0:1], 96
  v_lshrrev_b32 v1, 6, v0
  s_getreg_b32 s6, hwreg(HW_REG_XCC_ID)
  v_readfirstlane_b32 s3, v1
  s_and_b32 s6, s6, 7
  v_and_b32 v1, 63, v0
  s_waitcnt lgkmcnt(0)
  s_mov_b32 s8, s88
  s_and_b32 s9, s89, 0xffff
  s_mov_b32 s10, 268435456
  s_mov_b32 s11, 0x20000
  s_mov_b32 s12, s86
  s_and_b32 s13, s87, 0xffff
  s_mov_b32 s14, 256
  s_mov_b32 s15, 0x20000
  v_mov_b32 v4, 0
  v_mov_b32 v5, 0
  v_mov_b32 v6, 0
  v_mov_b32 v7, 0
  s_lshl_b32 s24, s2, 8
  v_lshlrev_b32 v2, 4, v0
  v_mov_b32 v3, 1073741824
  v_cmp_gt_u32 vcc, 16, v0
  s_nop 1
  v_cndmask_b32 v3, v3, v2, vcc
  buffer_store_dwordx4 v[4:7], v3, s[8:11], s24 offen sc1
  v_mov_b32 v8, -1
  v_mov_b32 v9, -1
  v_mov_b32 v10, -1
  v_mov_b32 v11, -1
  s_mul_i32 s25, s2, 13952
  s_add_u32 s25, s25, 65536
  buffer_store_dwordx4 v[8:11], v2, s[8:11], s25 offen sc1
  v_mov_b32 v3, 1073741824
  v_cmp_gt_u32 vcc, 360, v0
  v_add_u32 v12, 8192, v2
  s_nop 0
  v_cndmask_b32 v3, v3, v12, vcc
  buffer_store_dwordx4 v[8:11], v3, s[8:11], s25 offen sc1
  s_mul_i32 s25, s2, 3072
  s_add_u32 s25, s25, 117440512
  v_mov_b32 v3, 1073741824
  v_cmp_gt_u32 vcc, 192, v0
  s_nop 1
  v_cndmask_b32 v3, v3, v2, vcc
  buffer_store_dwordx4 v[8:11], v3, s[8:11], s25 offen sc1
  v_mov_b32 v3, 163824
  v_mov_b32 v13, 0
  ds_write_b32 v3, v13
  s_waitcnt vmcnt(0) lgkmcnt(0)
  s_barrier
  s_lshr_b32 s7, s2, 3
  s_mov_b32 s5, 0
  s_mov_b32 s98, 0
  s_cmp_eq_u32 s3, 0
  s_cbranch_scc0 L_dispatch
  s_sub_u32 s24, s6, s2
  s_and_b32 s24, s24, 7
  s_lshl_b32 s24, s24, 2
  v_mov_b32 v2, 1
  v_mov_b32 v3, s24
  s_mov_b64 exec, 1
  buffer_atomic_add v2, v3, s[12:15], 0 offen
  s_mov_b64 exec, -1
  s_branch L_dispatch
L_restart:
  s_waitcnt vmcnt(0) lgkmcnt(0)
  s_barrier
  s_getreg_b32 s6, hwreg(HW_REG_XCC_ID)
  s_and_b32 s6, s6, 7
  s_mov_b32 s98, 1
  s_mov_b32 s12, s86
  s_and_b32 s13, s87, 0xffff
  s_mov_b32 s14, 256
  s_mov_b32 s15, 0x20000
  s_cmp_eq_u32 s3, 0
  s_cbranch_scc0 L_reg_done
  v_mov_b32 v2, 1
  s_lshl_b32 s24, s6, 2
  s_add_u32 s24, s24, 32
  v_mov_b32 v3, s24
  s_mov_b64 exec, 1
  buffer_atomic_add v2, v3, s[12:15], 0 offen sc0
  s_waitcnt vmcnt(0)
  s_mov_b64 exec, -1
  s_nop 0
  v_readfirstlane_b32 s7, v2
  v_and_b32 v3, 7, v1
  v_lshlrev_b32 v3, 2, v3
  s_mov_b32 s26, 0
L_reg_poll:
  buffer_load_dword v4, v3, s[12:15], 0 offen offset:32 sc1
  s_waitcnt vmcnt(0)
  s_mov_b32 s24, 0
  s_mov_b32 s25, 0
  v_readlane_b32 s27, v4, 0
  s_nop 0
  s_add_u32 s24, s24, s27
  s_xor_b32 s27, s27, 32
  s_or_b32 s25, s25, s27
  v_readlane_b32 s27, v4, 1
  s_nop 0
  s_add_u32 s24, s24, s27
  s_xor_b32 s27, s27, 32
  s_or_b32 s25, s25, s27
  v_readlane_b32 s27, v4, 2
  s_nop 0
  s_add_u32 s24, s24, s27
  s_xor_b32 s27, s27, 32
  s_or_b32 s25, s25, s27
  v_readlane_b32 s27, v4, 3
  s_nop 0
  s_add_u32 s24, s24, s27
  s_xor_b32 s27, s27, 32
  s_or_b32 s25, s25, s27
  v_readlane_b32 s27, v4, 4
  s_nop 0
  s_add_u32 s24, s24, s27
  s_xor_b32 s27, s27, 32
  s_or_b32 s25, s25, s27
  v_readlane_b32 s27, v4, 5
  s_nop 0
  s_add_u32 s24, s24, s27
  s_xor_b32 s27, s27, 32
  s_or_b32 s25, s25, s27
  v_readlane_b32 s27, v4, 6
  s_nop 0
  s_add_u32 s24, s24, s27
  s_xor_b32 s27, s27, 32
  s_or_b32 s25, s25, s27
  v_readlane_b32 s27, v4, 7
  s_nop 0
  s_add_u32 s24, s24, s27
  s_xor_b32 s27, s27, 32
  s_or_b32 s25, s25, s27
  s_cmp_ge_u32 s24, 256
  s_cbranch_scc1 L_reg_all
  s_add_u32 s26, s26, 1
  s_cmp_ge_u32 s26, 0x40000
  s_cbranch_scc1 L_reg_all
  s_sleep 4
  s_branch L_reg_poll
L_reg_all:
  s_mov_b32 s5, 0
  s_cmp_eq_u32 s25, 0
  s_cbranch_scc1 L_reg_fast
  v_mov_b32 v2, 1
  v_mov_b32 v3, 64
  s_mov_b64 exec, 1
  buffer_atomic_add v2, v3, s[12:15], 0 offen sc0
  s_waitcnt vmcnt(0)
  s_mov_b64 exec, -1
  s_nop 0
  v_readfirstlane_b32 s24, v2
  s_nop 1
  s_lshr_b32 s6, s24, 5
  s_and_b32 s7, s24, 31
  s_mov_b32 s5, 1
L_reg_fast:
  v_mov_b32 v4, s6
  v_mov_b32 v5, s7
  v_mov_b32 v6, s5
  v_mov_b32 v7, 0
  v_mov_b32 v3, 0
  ds_write_b128 v3, v[4:7]
  s_waitcnt lgkmcnt(0)
L_reg_done:
  s_barrier
  v_mov_b32 v3, 0
  ds_read_b128 v[4:7], v3
  s_waitcnt lgkmcnt(0)
  v_readfirstlane_b32 s6, v4
  v_readfirstlane_b32 s7, v5
  v_readfirstlane_b32 s5, v6
  s_nop 3
  s_barrier
L_dispatch:
  s_cmp_lt_u32 s6, 4
  s_cbranch_scc1 L_chain
  s_cmp_eq_u32 s6, 6
  s_cbranch_scc1 L_m_qa
  s_cmp_eq_u32 s6, 7
  s_cbranch_scc1 L_m_b
  s_cmp_lt_u32 s7, 20
  s_cbranch_scc1 L_m_out
  s_cmp_eq_u32 s6, 5
  s_cbranch_scc1 L_m_5q
  s_cmp_lt_u32 s7, 28
  s_cbranch_scc1 L_m_attx
  s_add_u32 s4, s7, 4
  s_branch L_qkv
L_m_attx:
  s_sub_u32 s4, s7, 20
  s_branch L_attx
L_m_5q:
  s_add_u32 s4, s7, 16
  s_branch L_qkv
L_m_out:
  s_sub_u32 s4, s6, 4
  s_mul_i32 s4, s4, 20
  s_add_u32 s4, s4, s7
  s_branch L_out
L_m_b:
  s_mov_b32 s4, s7
  s_branch L_b
L_m_qa:
  s_mov_b32 s4, s7
  s_branch L_qkv
L_chain:
  s_lshr_b32 s26, s7, 2
  s_and_b32 s25, s7, 3
  s_lshl_b32 s24, s6, 3
  s_add_u32 s24, s24, s26
  s_mov_b32 s27, 0
  s_mov_b32 s28, 0
  s_cmp_eq_u32 s3, 7
  s_cbranch_scc1 L_ch_w7
  s_cmp_ge_u32 s3, 4
  s_cbranch_scc1 L_ch_red
  s_lshr_b32 s33, s3, 1
  s_and_b32 s34, s3, 1
  s_cmp_eq_u32 s34, 0
  s_cselect_b32 s12, s68, s70
  s_cselect_b32 s13, s69, s71
  s_and_b32 s13, s13, 0xffff
  s_mov_b32 s14, 5242880
  s_mov_b32 s15, 0x20000
  s_mov_b32 s16, s72
  s_and_b32 s17, s73, 0xffff
  s_mov_b32 s18, 5242880
  s_mov_b32 s19, 0x20000
  s_mov_b32 s20, s74
  s_and_b32 s21, s75, 0xffff
  s_mov_b32 s22, 5242880
  s_mov_b32 s23, 0x20000
  v_lshrrev_b32 v16, 1, v1
  v_and_b32 v17, 1, v1
  v_lshlrev_b32 v18, 13, v16
  v_lshl_or_b32 v18, v17, 4, v18
  v_mul_u32_u24 v19, 1280, v16
  v_lshl_or_b32 v19, v17, 4, v19
  v_lshrrev_b32 v16, 2, v1
  v_and_b32 v17, 3, v1
  v_lshlrev_b32 v30, 13, v16
  v_lshl_or_b32 v30, v17, 4, v30
  v_mul_u32_u24 v31, 1280, v16
  v_lshl_or_b32 v31, v17, 4, v31
  s_lshl_b32 s29, s24, 8
  s_lshl_b32 s30, s25, 6
  s_add_u32 s29, s29, s30
  s_mul_i32 s30, s33, 2621440
  s_add_u32 s29, s29, s30
  s_lshl_b32 s31, s34, 5
  s_add_u32 s31, s31, s29
  s_add_u32 s30, s29, 0
  buffer_load_dwordx4 v[136:139], v30, s[12:15], s30 offen
  s_add_u32 s30, s29, 131072
  buffer_load_dwordx4 v[140:143], v30, s[12:15], s30 offen
  s_add_u32 s30, s29, 262144
  buffer_load_dwordx4 v[176:179], v30, s[12:15], s30 offen
  s_add_u32 s30, s29, 393216
  buffer_load_dwordx4 v[180:183], v30, s[12:15], s30 offen
  s_add_u32 s30, s29, 524288
  buffer_load_dwordx4 v[144:147], v30, s[12:15], s30 offen
  s_add_u32 s30, s29, 655360
  buffer_load_dwordx4 v[148:151], v30, s[12:15], s30 offen
  s_add_u32 s30, s29, 786432
  buffer_load_dwordx4 v[184:187], v30, s[12:15], s30 offen
  s_add_u32 s30, s29, 917504
  buffer_load_dwordx4 v[188:191], v30, s[12:15], s30 offen
  s_add_u32 s30, s29, 1048576
  buffer_load_dwordx4 v[152:155], v30, s[12:15], s30 offen
  s_add_u32 s30, s29, 1179648
  buffer_load_dwordx4 v[156:159], v30, s[12:15], s30 offen
  s_add_u32 s30, s29, 1310720
  buffer_load_dwordx4 v[192:195], v30, s[12:15], s30 offen
  s_add_u32 s30, s29, 1441792
  buffer_load_dwordx4 v[196:199], v30, s[12:15], s30 offen
  s_add_u32 s30, s29, 1572864
  buffer_load_dwordx4 v[160:163], v30, s[12:15], s30 offen
  s_add_u32 s30, s29, 1703936
  buffer_load_dwordx4 v[164:167], v30, s[12:15], s30 offen
  s_add_u32 s30, s29, 1835008
  buffer_load_dwordx4 v[200:203], v30, s[12:15], s30 offen
  s_add_u32 s30, s29, 1966080
  buffer_load_dwordx4 v[204:207], v30, s[12:15], s30 offen
  s_add_u32 s30, s29, 2097152
  buffer_load_dwordx4 v[168:171], v30, s[12:15], s30 offen
  s_add_u32 s30, s29, 2228224
  buffer_load_dwordx4 v[172:175], v30, s[12:15], s30 offen
  s_add_u32 s30, s29, 2359296
  buffer_load_dwordx4 v[208:211], v30, s[12:15], s30 offen
  s_add_u32 s30, s29, 2490368
  buffer_load_dwordx4 v[212:215], v30, s[12:15], s30 offen
  s_add_u32 s30, s31, 0
  buffer_load_dwordx4 v[216:219], v18, s[16:19], s30 offen
  s_add_u32 s30, s31, 262144
  buffer_load_dwordx4 v[220:223], v18, s[16:19], s30 offen
  s_add_u32 s30, s31, 524288
  buffer_load_dwordx4 v[224:227], v18, s[16:19], s30 offen
  s_add_u32 s30, s31, 786432
  buffer_load_dwordx4 v[228:231], v18, s[16:19], s30 offen
  s_add_u32 s30, s31, 1048576
  buffer_load_dwordx4 v[232:235], v18, s[16:19], s30 offen
  s_add_u32 s30, s31, 1310720
  buffer_load_dwordx4 v[236:239], v18, s[16:19], s30 offen
  s_add_u32 s30, s31, 1572864
  buffer_load_dwordx4 v[240:243], v18, s[16:19], s30 offen
  s_add_u32 s30, s31, 1835008
  buffer_load_dwordx4 v[244:247], v18, s[16:19], s30 offen
  s_add_u32 s30, s31, 2097152
  buffer_load_dwordx4 v[248:251], v18, s[16:19], s30 offen
  s_add_u32 s30, s31, 2359296
  buffer_load_dwordx4 v[252:255], v18, s[16:19], s30 offen
  s_lshl_b32 s29, s3, 1
  s_add_u32 s29, s29, 2
  s_cmp_eq_u32 s3, 0
  s_cselect_b32 s44, 0, s29
  s_add_u32 s29, s3, 2
  s_cmp_lt_u32 s3, 2
  s_cselect_b32 s45, s29, s44
  s_mul_i32 s30, s24, 163840
  s_mul_i32 s31, s25, 320
  s_add_u32 s30, s30, s31
  s_lshl_b32 s31, s44, 5
  s_add_u32 s31, s31, s30
  s_add_u32 s32, s3, 0
  s_and_b32 s32, s32, 3
  s_mul_i32 s32, s32, 40960
  s_add_u32 s32, s32, s31
  buffer_load_dwordx4 v[88:91], v31, s[20:23], s32 offen
  s_add_u32 s32, s32, 20480
  buffer_load_dwordx4 v[104:107], v31, s[20:23], s32 offen
  s_add_u32 s32, s3, 1
  s_and_b32 s32, s32, 3
  s_mul_i32 s32, s32, 40960
  s_add_u32 s32, s32, s31
  buffer_load_dwordx4 v[92:95], v31, s[20:23], s32 offen
  s_add_u32 s32, s32, 20480
  buffer_load_dwordx4 v[108:111], v31, s[20:23], s32 offen
  s_add_u32 s32, s3, 2
  s_and_b32 s32, s32, 3
  s_mul_i32 s32, s32, 40960
  s_add_u32 s32, s32, s31
  buffer_load_dwordx4 v[96:99], v31, s[20:23], s32 offen
  s_add_u32 s32, s32, 20480
  buffer_load_dwordx4 v[112:115], v31, s[20:23], s32 offen
  s_add_u32 s32, s3, 3
  s_and_b32 s32, s32, 3
  s_mul_i32 s32, s32, 40960
  s_add_u32 s32, s32, s31
  buffer_load_dwordx4 v[100:103], v31, s[20:23], s32 offen
  s_add_u32 s32, s32, 20480
  buffer_load_dwordx4 v[116:119], v31, s[20:23], s32 offen
  s_lshl_b32 s31, s45, 5
  s_add_u32 s31, s31, s30
  s_add_u32 s32, s3, 0
  s_and_b32 s32, s32, 3
  s_mul_i32 s32, s32, 40960
  s_add_u32 s32, s32, s31
  buffer_load_dwordx4 v[120:123], v19, s[20:23], s32 offen
  s_add_u32 s32, s3, 1
  s_and_b32 s32, s32, 3
  s_mul_i32 s32, s32, 40960
  s_add_u32 s32, s32, s31
  buffer_load_dwordx4 v[124:127], v19, s[20:23], s32 offen
  s_add_u32 s32, s3, 2
  s_and_b32 s32, s32, 3
  s_mul_i32 s32, s32, 40960
  s_add_u32 s32, s32, s31
  buffer_load_dwordx4 v[128:131], v19, s[20:23], s32 offen
  s_add_u32 s32, s3, 3
  s_and_b32 s32, s32, 3
  s_mul_i32 s32, s32, 40960
  s_add_u32 s32, s32, s31
  buffer_load_dwordx4 v[132:135], v19, s[20:23], s32 offen
  v_and_b32 v20, 15, v1
  v_lshrrev_b32 v21, 4, v1
  v_and_b32 v22, 7, v1
  v_bfe_u32 v29, v1, 3, 1
  v_lshlrev_b32 v12, 4, v1
  v_lshlrev_b32 v23, 9, v29
  v_lshl_add_u32 v23, v21, 7, v23
  v_lshl_add_u32 v2, v22, 4, v23
  v_lshlrev_b32 v23, 7, v21
  v_lshl_add_u32 v3, v22, 4, v23
  v_and_b32 v24, 1, v21
  v_lshlrev_b32 v23, 8, v24
  v_lshl_add_u32 v23, v20, 4, v23
  v_add_u32 v4, 1024, v23
  s_lshl_b32 s29, s34, 12
  s_lshl_b32 s30, s33, 11
  s_add_u32 s29, s29, s30
  v_lshrrev_b32 v25, 1, v21
  v_lshlrev_b32 v23, 10, v25
  v_lshl_add_u32 v23, v24, 8, v23
  v_lshl_add_u32 v23, v20, 2, v23
  v_add_u32 v5, s29, v23
  s_lshl_b32 s29, s34, 9
  s_add_u32 s29, s29, s30
  s_add_u32 s29, s29, 8192
  v_lshlrev_b32 v23, 10, v25
  v_lshl_add_u32 v23, v24, 4, v23
  v_lshl_add_u32 v23, v20, 5, v23
  v_add_u32 v6, s29, v23
  s_lshl_b32 s29, s3, 10
  s_add_u32 s29, s29, 12288
  v_add_u32 v7, s29, v12
  v_lshlrev_b32 v9, 2, v1
  s_lshl_b32 s29, s3, 8
  s_add_u32 s29, s29, 16384
  v_add_u32 v8, s29, v9
  s_lshl_b32 s29, s3, 11
  s_add_u32 s29, s29, 28672
  v_add_u32 v10, s29, v12
  s_lshl_b32 s29, s3, 10
  s_add_u32 s29, s29, 24576
  v_add_u32 v11, s29, v12
  s_mul_i32 s30, s24, 20480
  s_add_u32 s30, s30, 1015808
  s_mul_i32 s29, s25, 5120
  s_add_u32 s30, s30, s29
  s_lshl_b32 s29, s44, 9
  s_add_u32 s39, s30, s29
  s_add_u32 s37, s30, 1024
  v_lshlrev_b32 v23, 8, v21
  v_lshl_add_u32 v23, v22, 4, v23
  s_lshl_b32 s29, s3, 7
  v_add_u32 v13, s29, v23
  s_add_u32 s29, s3, 1
  s_and_b32 s29, s29, 3
  s_lshl_b32 s29, s29, 10
  s_add_u32 s29, s29, 24576
  v_add_u32 v14, s29, v12
  s_add_u32 s29, s3, 2
  s_and_b32 s29, s29, 3
  s_lshl_b32 s29, s29, 10
  s_add_u32 s29, s29, 24576
  v_add_u32 v15, s29, v12
  s_add_u32 s29, s3, 3
  s_and_b32 s29, s29, 3
  s_lshl_b32 s29, s29, 10
  s_add_u32 s29, s29, 24576
  v_add_u32 v71, s29, v12
  v_lshrrev_b32 v23, 5, v1
  v_lshlrev_b32 v23, 9, v23
  v_lshl_add_u32 v24, v22, 6, v23
  v_bfe_u32 v25, v1, 3, 2
  v_lshl_add_u32 v24, v25, 4, v24
  v_lshl_add_u32 v25, v20, 5, v23
  v_bfe_u32 v26, v1, 4, 1
  v_lshl_add_u32 v25, v26, 4, v25
  s_cmp_eq_u32 s3, 2
  s_cselect_b64 vcc, -1, 0
  s_min_u32 s29, s3, 2
  s_lshl_b32 s29, s29, 12
  v_cndmask_b32 v24, v24, v25, vcc
  v_add_u32 v68, s29, v24
  v_mov_b32 v69, 1073741824
  s_cmp_lt_u32 s3, 3
  s_cselect_b64 s[46:47], -1, 0
  v_cmp_gt_u32 vcc, 32, v1
  s_nop 1
  s_and_b64 vcc, vcc, s[46:47]
  s_nop 1
  v_cndmask_b32 v69, v69, v12, vcc
  s_mul_i32 s38, s24, 6144
  s_mul_i32 s29, s25, 1536
  s_add_u32 s38, s38, s29
  s_lshl_b32 s29, s3, 9
  s_add_u32 s38, s38, s29
  s_add_u32 s38, s38, 229376
  s_mov_b32 s40, 0x00ff00ff
  s_mov_b32 s41, 0x00ff00ff
  s_mov_b32 s62, -1
  s_mov_b32 s63, 0
  s_lshl_b32 s29, s3, 12
  s_add_u32 s29, s29, 81920
  v_add_u32 v24, s29, v12
  v_bfe_u32 v25, v1, 2, 2
  v_lshrrev_b32 v26, 1, v25
  v_lshlrev_b32 v26, 5, v26
  v_and_b32 v27, 1, v25
  v_add_u32 v26, v26, v27
  v_and_b32 v27, 1, v21
  v_lshl_add_u32 v26, v27, 4, v26
  v_lshrrev_b32 v27, 1, v21
  v_lshl_add_u32 v26, v27, 2, v26
  v_and_b32 v27, 3, v1
  v_lshlrev_b32 v32, 6, v26
  v_lshl_add_u32 v32, v27, 3, v32
  v_add_u32 v32, s29, v32
  v_lshlrev_b32 v26, 5, v26
  v_lshl_add_u32 v26, v27, 3, v26
  v_add_u32 v26, s29, v26
  v_lshl_add_u32 v28, v21, 2, v25
  v_lshlrev_b32 v33, 6, v28
  v_lshl_add_u32 v33, v27, 3, v33
  v_add_u32 v33, s29, v33
  v_lshlrev_b32 v28, 5, v28
  v_lshl_add_u32 v28, v27, 3, v28
  v_add_u32 v28, s29, v28
  s_waitcnt vmcnt(38)
  ds_write_b128 v24, v[136:139] offset:0
  ds_write_b128 v24, v[140:143] offset:1024
  ds_write_b128 v24, v[176:179] offset:2048
  ds_write_b128 v24, v[180:183] offset:3072
  ds_read_b64_tr_b16 v[136:137], v32 offset:0
  ds_read_b64_tr_b16 v[138:139], v32 offset:128
  ds_read_b64_tr_b16 v[140:141], v32 offset:512
  ds_read_b64_tr_b16 v[142:143], v32 offset:640
  ds_read_b64_tr_b16 v[176:177], v32 offset:32
  ds_read_b64_tr_b16 v[178:179], v32 offset:160
  ds_read_b64_tr_b16 v[180:181], v32 offset:544
  ds_read_b64_tr_b16 v[182:183], v32 offset:672
  s_waitcnt vmcnt(34)
  ds_write_b128 v24, v[144:147] offset:0
  ds_write_b128 v24, v[148:151] offset:1024
  ds_write_b128 v24, v[184:187] offset:2048
  ds_write_b128 v24, v[188:191] offset:3072
  ds_read_b64_tr_b16 v[144:145], v32 offset:0
  ds_read_b64_tr_b16 v[146:147], v32 offset:128
  ds_read_b64_tr_b16 v[148:149], v32 offset:512
  ds_read_b64_tr_b16 v[150:151], v32 offset:640
  ds_read_b64_tr_b16 v[184:185], v32 offset:32
  ds_read_b64_tr_b16 v[186:187], v32 offset:160
  ds_read_b64_tr_b16 v[188:189], v32 offset:544
  ds_read_b64_tr_b16 v[190:191], v32 offset:672
  s_waitcnt vmcnt(30)
  ds_write_b128 v24, v[152:155] offset:0
  ds_write_b128 v24, v[156:159] offset:1024
  ds_write_b128 v24, v[192:195] offset:2048
  ds_write_b128 v24, v[196:199] offset:3072
  ds_read_b64_tr_b16 v[152:153], v32 offset:0
  ds_read_b64_tr_b16 v[154:155], v32 offset:128
  ds_read_b64_tr_b16 v[156:157], v32 offset:512
  ds_read_b64_tr_b16 v[158:159], v32 offset:640
  ds_read_b64_tr_b16 v[192:193], v32 offset:32
  ds_read_b64_tr_b16 v[194:195], v32 offset:160
  ds_read_b64_tr_b16 v[196:197], v32 offset:544
  ds_read_b64_tr_b16 v[198:199], v32 offset:672
  s_waitcnt vmcnt(26)
  ds_write_b128 v24, v[160:163] offset:0
  ds_write_b128 v24, v[164:167] offset:1024
  ds_write_b128 v24, v[200:203] offset:2048
  ds_write_b128 v24, v[204:207] offset:3072
  ds_read_b64_tr_b16 v[160:161], v32 offset:0
  ds_read_b64_tr_b16 v[162:163], v32 offset:128
  ds_read_b64_tr_b16 v[164:165], v32 offset:512
  ds_read_b64_tr_b16 v[166:167], v32 offset:640
  ds_read_b64_tr_b16 v[200:201], v32 offset:32
  ds_read_b64_tr_b16 v[202:203], v32 offset:160
  ds_read_b64_tr_b16 v[204:205], v32 offset:544
  ds_read_b64_tr_b16 v[206:207], v32 offset:672
  s_waitcnt vmcnt(22)
  ds_write_b128 v24, v[168:171] offset:0
  ds_write_b128 v24, v[172:175] offset:1024
  ds_write_b128 v24, v[208:211] offset:2048
  ds_write_b128 v24, v[212:215] offset:3072
  ds_read_b64_tr_b16 v[168:169], v32 offset:0
  ds_read_b64_tr_b16 v[170:171], v32 offset:128
  ds_read_b64_tr_b16 v[172:173], v32 offset:512
  ds_read_b64_tr_b16 v[174:175], v32 offset:640
  ds_read_b64_tr_b16 v[208:209], v32 offset:32
  ds_read_b64_tr_b16 v[210:211], v32 offset:160
  ds_read_b64_tr_b16 v[212:213], v32 offset:544
  ds_read_b64_tr_b16 v[214:215], v32 offset:672
  s_waitcnt vmcnt(20)
  ds_write_b128 v24, v[216:219]
  ds_write_b128 v24, v[220:223] offset:1024
  ds_read_b64_tr_b16 v[216:217], v26 offset:0
  ds_read_b64_tr_b16 v[218:219], v26 offset:64
  ds_read_b64_tr_b16 v[220:221], v26 offset:256
  ds_read_b64_tr_b16 v[222:223], v26 offset:320
  s_waitcnt vmcnt(18)
  ds_write_b128 v24, v[224:227]
  ds_write_b128 v24, v[228:231] offset:1024
  ds_read_b64_tr_b16 v[224:225], v26 offset:0
  ds_read_b64_tr_b16 v[226:227], v26 offset:64
  ds_read_b64_tr_b16 v[228:229], v26 offset:256
  ds_read_b64_tr_b16 v[230:231], v26 offset:320
  s_waitcnt vmcnt(16)
  ds_write_b128 v24, v[232:235]
  ds_write_b128 v24, v[236:239] offset:1024
  ds_read_b64_tr_b16 v[232:233], v26 offset:0
  ds_read_b64_tr_b16 v[234:235], v26 offset:64
  ds_read_b64_tr_b16 v[236:237], v26 offset:256
  ds_read_b64_tr_b16 v[238:239], v26 offset:320
  s_waitcnt vmcnt(14)
  ds_write_b128 v24, v[240:243]
  ds_write_b128 v24, v[244:247] offset:1024
  ds_read_b64_tr_b16 v[240:241], v26 offset:0
  ds_read_b64_tr_b16 v[242:243], v26 offset:64
  ds_read_b64_tr_b16 v[244:245], v26 offset:256
  ds_read_b64_tr_b16 v[246:247], v26 offset:320
  s_waitcnt vmcnt(12)
  ds_write_b128 v24, v[248:251]
  ds_write_b128 v24, v[252:255] offset:1024
  ds_read_b64_tr_b16 v[248:249], v26 offset:0
  ds_read_b64_tr_b16 v[250:251], v26 offset:64
  ds_read_b64_tr_b16 v[252:253], v26 offset:256
  ds_read_b64_tr_b16 v[254:255], v26 offset:320
  s_waitcnt vmcnt(10)
  ds_write_b128 v24, v[88:91]
  ds_write_b128 v24, v[104:107] offset:1024
  ds_read_b64_tr_b16 v[88:89], v33 offset:0
  ds_read_b64_tr_b16 v[90:91], v33 offset:1024
  ds_read_b64_tr_b16 v[104:105], v33 offset:32
  ds_read_b64_tr_b16 v[106:107], v33 offset:1056
  s_waitcnt vmcnt(8)
  ds_write_b128 v24, v[92:95]
  ds_write_b128 v24, v[108:111] offset:1024
  ds_read_b64_tr_b16 v[92:93], v33 offset:0
  ds_read_b64_tr_b16 v[94:95], v33 offset:1024
  ds_read_b64_tr_b16 v[108:109], v33 offset:32
  ds_read_b64_tr_b16 v[110:111], v33 offset:1056
  s_waitcnt vmcnt(6)
  ds_write_b128 v24, v[96:99]
  ds_write_b128 v24, v[112:115] offset:1024
  ds_read_b64_tr_b16 v[96:97], v33 offset:0
  ds_read_b64_tr_b16 v[98:99], v33 offset:1024
  ds_read_b64_tr_b16 v[112:113], v33 offset:32
  ds_read_b64_tr_b16 v[114:115], v33 offset:1056
  s_waitcnt vmcnt(4)
  ds_write_b128 v24, v[100:103]
  ds_write_b128 v24, v[116:119] offset:1024
  ds_read_b64_tr_b16 v[100:101], v33 offset:0
  ds_read_b64_tr_b16 v[102:103], v33 offset:1024
  ds_read_b64_tr_b16 v[116:117], v33 offset:32
  ds_read_b64_tr_b16 v[118:119], v33 offset:1056
  s_waitcnt vmcnt(3)
  ds_write_b128 v24, v[120:123]
  ds_read_b64_tr_b16 v[120:121], v28
  ds_read_b64_tr_b16 v[122:123], v28 offset:512
  s_waitcnt vmcnt(2)
  ds_write_b128 v24, v[124:127]
  ds_read_b64_tr_b16 v[124:125], v28
  ds_read_b64_tr_b16 v[126:127], v28 offset:512
  s_waitcnt vmcnt(1)
  ds_write_b128 v24, v[128:131]
  ds_read_b64_tr_b16 v[128:129], v28
  ds_read_b64_tr_b16 v[130:131], v28 offset:512
  s_waitcnt vmcnt(0)
  ds_write_b128 v24, v[132:135]
  ds_read_b64_tr_b16 v[132:133], v28
  ds_read_b64_tr_b16 v[134:135], v28 offset:512
  v_mov_b32 v0, 0x44444444
  v_mov_b32 v24, 0xeeeeeeee
  v_cmp_gt_u32 vcc, 8, v20
  s_nop 1
  v_cndmask_b32 v0, v24, v0, vcc
  s_mul_i32 s35, s6, 10240
  s_mul_i32 s29, s33, 5120
  s_add_u32 s35, s35, s29
  s_add_u32 s35, s35, 65536
  s_mul_i32 s36, s24, 6144
  s_mul_i32 s29, s3, 1536
  s_add_u32 s36, s36, s29
  s_add_u32 s36, s36, 229376
  s_waitcnt lgkmcnt(0)
  s_barrier
  s_cmp_eq_u32 s98, 0
  s_cbranch_scc0 L_chA_vc
  v_mov_b32 v16, 163824
  ds_read_b32 v17, v16
  s_waitcnt lgkmcnt(0)
  v_readfirstlane_b32 s32, v17
  s_nop 0
  s_cmp_eq_u32 s32, 2
  s_cbranch_scc1 L_restart
L_chA_vc:
  s_mov_b32 s42, 0x3e0293ee
  s_mov_b32 s43, 0x42200000
  s_cmp_eq_u32 s5, 0
  s_cbranch_scc0 L_chA1_loop
L_chA0_loop:
  s_and_b32 s29, s27, 3
  s_mul_i32 s29, s29, 40960
  s_add_u32 s29, s29, s35
  s_add_u32 s30, s29, 4096
  v_mov_b32 v36, 0
  v_mov_b32 v37, 0
  v_mov_b32 v38, 0
  v_mov_b32 v39, 0
  v_mov_b32 v40, 0
  v_mov_b32 v41, 0
  v_mov_b32 v42, 0
  v_mov_b32 v43, 0
  v_mov_b32 v44, 0
  v_mov_b32 v45, 0
  v_mov_b32 v46, 0
  v_mov_b32 v47, 0
  s_barrier
  s_sleep 2
  buffer_load_dwordx4 v[16:19], v2, s[8:11], s29 offen offset:0 sc1
  buffer_load_dwordx4 v[20:23], v2, s[8:11], s29 offen offset:1024 sc1
  buffer_load_dwordx4 v[24:27], v2, s[8:11], s29 offen offset:2048 sc1
  buffer_load_dwordx4 v[28:31], v2, s[8:11], s29 offen offset:3072 sc1
  buffer_load_dwordx4 v[32:35], v2, s[8:11], s30 offen sc1
  s_waitcnt vmcnt(4)
  v_max_u32 v48, v16, v18
  v_cmp_eq_u32 vcc, -1, v48
  s_cbranch_vccnz L_chA0_ms0
L_chA0_mf0:
  s_waitcnt vmcnt(3)
  v_max_u32 v48, v20, v22
  v_cmp_eq_u32 vcc, -1, v48
  v_smfmac_f32_16x16x64_bf16 v[36:39], v[16:19], v[136:143], v0
  v_smfmac_f32_16x16x64_bf16 v[40:43], v[16:19], v[176:183], v0
  v_smfmac_f32_16x16x64_bf16 v[44:47], v[16:19], v[216:223], v0
  s_cbranch_vccnz L_chA0_ms1
L_chA0_mf1:
  s_waitcnt vmcnt(2)
  v_max_u32 v48, v24, v26
  v_cmp_eq_u32 vcc, -1, v48
  v_smfmac_f32_16x16x64_bf16 v[36:39], v[20:23], v[144:151], v0
  v_smfmac_f32_16x16x64_bf16 v[40:43], v[20:23], v[184:191], v0
  v_smfmac_f32_16x16x64_bf16 v[44:47], v[20:23], v[224:231], v0
  s_cbranch_vccnz L_chA0_ms2
L_chA0_mf2:
  s_waitcnt vmcnt(1)
  v_max_u32 v48, v28, v30
  v_cmp_eq_u32 vcc, -1, v48
  v_smfmac_f32_16x16x64_bf16 v[36:39], v[24:27], v[152:159], v0
  v_smfmac_f32_16x16x64_bf16 v[40:43], v[24:27], v[192:199], v0
  v_smfmac_f32_16x16x64_bf16 v[44:47], v[24:27], v[232:239], v0
  s_cbranch_vccnz L_chA0_ms3
L_chA0_mf3:
  s_waitcnt vmcnt(0)
  v_max_u32 v48, v32, v34
  v_cmp_eq_u32 vcc, -1, v48
  v_smfmac_f32_16x16x64_bf16 v[36:39], v[28:31], v[160:167], v0
  v_smfmac_f32_16x16x64_bf16 v[40:43], v[28:31], v[200:207], v0
  v_smfmac_f32_16x16x64_bf16 v[44:47], v[28:31], v[240:247], v0
  s_cbranch_vccnz L_chA0_ms4
L_chA0_mf4:
  v_smfmac_f32_16x16x64_bf16 v[36:39], v[32:35], v[168:175], v0
  v_smfmac_f32_16x16x64_bf16 v[40:43], v[32:35], v[208:215], v0
  v_smfmac_f32_16x16x64_bf16 v[44:47], v[32:35], v[248:255], v0
  s_and_b32 s29, s27, 3
  s_mul_i32 s29, s29, 196608
  s_add_u32 s29, s29, s36
  s_and_b32 s31, s27, 3
  s_mul_i32 s31, s31, 196608
  s_add_u32 s31, s31, s38
  ds_write2_b32 v5, v36, v37 offset0:0 offset1:16
  ds_write2_b32 v5, v38, v39 offset0:32 offset1:48
  ds_write2_b32 v5, v40, v41 offset0:128 offset1:144
  ds_write2_b32 v5, v42, v43 offset0:160 offset1:176
  ds_write_b128 v6, v[44:47]
  s_waitcnt lgkmcnt(0)
  s_barrier
  ds_read_b128 v[48:51], v68 offset:0
  ds_read_b128 v[52:55], v68 offset:1024
  ds_read_b128 v[56:59], v68 offset:2048
  ds_read_b128 v[60:63], v68 offset:3072
  s_waitcnt lgkmcnt(2)
  v_pk_add_f32 v[48:49], v[48:49], v[52:53]
  v_pk_add_f32 v[50:51], v[50:51], v[54:55]
  s_waitcnt lgkmcnt(0)
  v_pk_add_f32 v[56:57], v[56:57], v[60:61]
  v_pk_add_f32 v[58:59], v[58:59], v[62:63]
  v_pk_add_f32 v[48:49], v[48:49], v[56:57]
  v_pk_add_f32 v[50:51], v[50:51], v[58:59]
  v_cvt_pk_bf16_f32 v64, v48, v49
  v_cvt_pk_bf16_f32 v65, v50, v51
  s_nop 1
  v_permlane32_swap_b32 v64, v66
  v_permlane32_swap_b32 v65, v67
  buffer_store_dwordx4 v[64:67], v69, s[8:11], s31 offen
  s_cmp_eq_u32 s27, 63
  s_cbranch_scc1 L_chA_exit
  ds_read_b128 v[80:83], v10
  ds_read_b128 v[84:87], v10 offset:1024
  ds_read_b128 v[72:75], v10 offset:8192
  ds_read_b128 v[76:79], v10 offset:9216
  v_mov_b32 v28, 0x3f803f80
  v_mov_b32 v29, 0x3f803f80
  v_mov_b32 v30, 0x3f803f80
  v_mov_b32 v31, 0x3f803f80
  s_sleep 3
  buffer_load_dwordx4 v[16:19], v3, s[8:11], s29 offen sc1
  buffer_load_dwordx4 v[20:23], v3, s[8:11], s29 offen offset:512 sc1
  buffer_load_dwordx4 v[24:27], v4, s[8:11], s29 offen sc1
L_chA0_qw:
  s_waitcnt vmcnt(1)
  v_max3_u32 v48, v16, v18, v20
  v_max_u32 v48, v48, v22
  v_cmp_eq_u32 vcc, -1, v48
  s_waitcnt lgkmcnt(0)
  v_mfma_f32_16x16x32_bf16 v[36:39], v[80:83], v[16:19], 0
  v_mfma_f32_16x16x32_bf16 v[40:43], v[84:87], v[16:19], 0
  v_mfma_f32_16x16x32_bf16 v[44:47], v[20:23], v[16:19], 0
  s_cbranch_vccnz L_chA0_qs
L_chA0_qok:
  s_nop 3
  v_cndmask_b32 v36, v40, v36, s[40:41]
  v_cndmask_b32 v37, v41, v37, s[40:41]
  v_cndmask_b32 v38, v42, v38, s[40:41]
  v_cndmask_b32 v39, v43, v39, s[40:41]
  v_cndmask_b32 v44, v45, v44, s[40:41]
  v_cndmask_b32 v46, v47, v46, s[40:41]
  ds_write_b128 v7, v[36:39]
  v_cndmask_b32 v44, v46, v44, s[62:63]
  ds_write_b32 v8, v44
  s_waitcnt lgkmcnt(0)
  s_barrier
  ds_read_b128 v[48:51], v12 offset:12288
  ds_read_b128 v[52:55], v12 offset:13312
  ds_read_b128 v[56:59], v12 offset:14336
  ds_read_b128 v[60:63], v12 offset:15360
  ds_read_b32 v64, v9 offset:16384
  ds_read_b32 v65, v9 offset:16640
  ds_read_b32 v66, v9 offset:16896
  ds_read_b32 v67, v9 offset:17152
  s_waitcnt vmcnt(0)
  v_max_u32 v32, v24, v26
  v_cmp_eq_u32 s[64:65], -1, v32
  s_waitcnt lgkmcnt(6)
  v_pk_add_f32 v[48:49], v[48:49], v[52:53]
  v_pk_add_f32 v[50:51], v[50:51], v[54:55]
  s_waitcnt lgkmcnt(4)
  v_pk_add_f32 v[56:57], v[56:57], v[60:61]
  v_pk_add_f32 v[58:59], v[58:59], v[62:63]
  s_waitcnt lgkmcnt(0)
  v_pk_add_f32 v[64:65], v[64:65], v[66:67]
  v_pk_add_f32 v[48:49], v[48:49], v[56:57]
  v_pk_add_f32 v[50:51], v[50:51], v[58:59]
  v_add_f32 v64, v64, v65
  v_pk_mul_f32 v[48:49], v[48:49], s[42:43] op_sel_hi:[1,0]
  v_pk_mul_f32 v[50:51], v[50:51], s[42:43] op_sel_hi:[1,0]
  v_mul_f32 v64, s42, v64
  v_mov_b32 v57, 0
  v_max3_f32 v67, |v48|, |v49|, |v50|
  v_max3_f32 v67, v67, |v51|, |v64|
  v_cmp_lt_f32 vcc, s43, v67
  v_exp_f32 v32, v48
  v_exp_f32 v33, v49
  v_exp_f32 v34, v50
  v_exp_f32 v35, v51
  s_or_b64 vcc, vcc, s[64:65]
  v_exp_f32 v65, v64
  s_cbranch_vccnz L_chA0_smax
L_chA0_smaxd:
  v_cvt_pk_bf16_f32 v52, v32, v33
  v_cvt_pk_bf16_f32 v53, v34, v35
  v_mov_b32_dpp v66, v65 row_ror:8 row_mask:0xf bank_mask:0xf
  v_mov_b32_dpp v54, v52 row_ror:8 row_mask:0xf bank_mask:0xf
  v_mov_b32_dpp v55, v53 row_ror:8 row_mask:0xf bank_mask:0xf
  v_cvt_pk_bf16_f32 v56, v65, v66
  s_nop 0
  v_mfma_f32_16x16x32_bf16 v[36:39], v[72:75], v[52:55], 0
  v_permlane32_swap_b32 v56, v57
  v_mfma_f32_16x16x32_bf16 v[40:43], v[76:79], v[52:55], 0
  v_mfma_f32_16x16x32_bf16 v[44:47], v[28:31], v[52:55], 0
  v_mfma_f32_16x16x16_bf16 v[36:39], v[24:25], v[56:57], v[36:39]
  v_mfma_f32_16x16x16_bf16 v[40:43], v[26:27], v[56:57], v[40:43]
  v_mfma_f32_16x16x16_bf16 v[44:47], v[28:29], v[56:57], v[44:47]
  s_nop 2
  v_cvt_pk_bf16_f32 v60, v36, v37
  v_cvt_pk_bf16_f32 v61, v38, v39
  v_cvt_pk_bf16_f32 v62, v40, v41
  v_cvt_pk_bf16_f32 v63, v42, v43
  ds_write_b128 v11, v[60:63]
  s_and_b32 s29, s27, 3
  s_mul_i32 s29, s29, 655360
  s_add_u32 s29, s29, s39
  v_rcp_f32 v58, v44
  s_and_b32 s30, s27, 3
  s_mul_i32 s30, s30, 655360
  s_add_u32 s30, s30, s37
  v_mfma_f32_16x16x32_bf16 v[44:47], v[120:123], v[60:63], 0
  v_mfma_f32_16x16x32_bf16 v[36:39], v[88:91], v[60:63], 0
  v_mfma_f32_16x16x32_bf16 v[40:43], v[104:107], v[60:63], 0
  s_waitcnt lgkmcnt(0)
  s_barrier
  ds_read_b128 v[16:19], v14
  ds_read_b128 v[20:23], v15
  ds_read_b128 v[24:27], v71
  s_waitcnt lgkmcnt(2)
  v_mfma_f32_16x16x32_bf16 v[44:47], v[124:127], v[16:19], v[44:47]
  v_mfma_f32_16x16x32_bf16 v[36:39], v[92:95], v[16:19], v[36:39]
  v_mfma_f32_16x16x32_bf16 v[40:43], v[108:111], v[16:19], v[40:43]
  s_waitcnt lgkmcnt(1)
  v_mfma_f32_16x16x32_bf16 v[44:47], v[128:131], v[20:23], v[44:47]
  v_mfma_f32_16x16x32_bf16 v[36:39], v[96:99], v[20:23], v[36:39]
  v_mfma_f32_16x16x32_bf16 v[40:43], v[112:115], v[20:23], v[40:43]
  s_waitcnt lgkmcnt(0)
  v_mfma_f32_16x16x32_bf16 v[44:47], v[132:135], v[24:27], v[44:47]
  v_mfma_f32_16x16x32_bf16 v[36:39], v[100:103], v[24:27], v[36:39]
  v_mfma_f32_16x16x32_bf16 v[40:43], v[116:119], v[24:27], v[40:43]
  s_cmp_ge_u32 s3, 2
  s_cbranch_scc1 L_chA0_nosingle2
  s_mov_b64 exec, s[40:41]
  v_pk_mul_f32 v[44:45], v[44:45], v[58:59] op_sel_hi:[1,0]
  v_pk_mul_f32 v[46:47], v[46:47], v[58:59] op_sel_hi:[1,0]
  buffer_store_dwordx4 v[44:47], v13, s[8:11], s30 offen
  s_mov_b64 exec, -1
  s_nop 0
L_chA0_nosingle:
  v_mov_b32_dpp v36, v40 row_ror:8 row_mask:0xf bank_mask:0xc
  v_mov_b32_dpp v37, v41 row_ror:8 row_mask:0xf bank_mask:0xc
  v_mov_b32_dpp v38, v42 row_ror:8 row_mask:0xf bank_mask:0xc
  v_mov_b32_dpp v39, v43 row_ror:8 row_mask:0xf bank_mask:0xc
  v_pk_mul_f32 v[36:37], v[36:37], v[58:59] op_sel_hi:[1,0]
  v_pk_mul_f32 v[38:39], v[38:39], v[58:59] op_sel_hi:[1,0]
  buffer_store_dwordx4 v[36:39], v12, s[8:11], s29 offen
  s_barrier
  s_barrier
  s_add_u32 s27, s27, 1
  s_branch L_chA0_loop
L_chA0_ms0:
  buffer_load_dwordx4 v[16:19], v2, s[8:11], s29 offen offset:0 sc1
  buffer_load_dwordx4 v[20:23], v2, s[8:11], s29 offen offset:1024 sc1
  buffer_load_dwordx4 v[24:27], v2, s[8:11], s29 offen offset:2048 sc1
  buffer_load_dwordx4 v[28:31], v2, s[8:11], s29 offen offset:3072 sc1
  buffer_load_dwordx4 v[32:35], v2, s[8:11], s30 offen sc1
L_chA0_mr0:
  s_add_u32 s28, s28, 1
  s_cmp_ge_u32 s28, 262144
  s_cbranch_scc1 L_chA0_mf0
  s_waitcnt vmcnt(0)
  v_max_u32 v48, v16, v18
  v_cmp_eq_u32 vcc, -1, v48
  s_cbranch_vccz L_chA0_mf0
  buffer_load_dwordx4 v[16:19], v2, s[8:11], s29 offen offset:0 sc1
  s_branch L_chA0_mr0
L_chA0_ms1:
  buffer_load_dwordx4 v[20:23], v2, s[8:11], s29 offen offset:1024 sc1
  buffer_load_dwordx4 v[24:27], v2, s[8:11], s29 offen offset:2048 sc1
  buffer_load_dwordx4 v[28:31], v2, s[8:11], s29 offen offset:3072 sc1
  buffer_load_dwordx4 v[32:35], v2, s[8:11], s30 offen sc1
L_chA0_mr1:
  s_add_u32 s28, s28, 1
  s_cmp_ge_u32 s28, 262144
  s_cbranch_scc1 L_chA0_mf1
  s_waitcnt vmcnt(0)
  v_max_u32 v48, v20, v22
  v_cmp_eq_u32 vcc, -1, v48
  s_cbranch_vccz L_chA0_mf1
  buffer_load_dwordx4 v[20:23], v2, s[8:11], s29 offen offset:1024 sc1
  s_branch L_chA0_mr1
L_chA0_ms2:
  buffer_load_dwordx4 v[24:27], v2, s[8:11], s29 offen offset:2048 sc1
  buffer_load_dwordx4 v[28:31], v2, s[8:11], s29 offen offset:3072 sc1
  buffer_load_dwordx4 v[32:35], v2, s[8:11], s30 offen sc1
L_chA0_mr2:
  s_add_u32 s28, s28, 1
  s_cmp_ge_u32 s28, 262144
  s_cbranch_scc1 L_chA0_mf2
  s_waitcnt vmcnt(0)
  v_max_u32 v48, v24, v26
  v_cmp_eq_u32 vcc, -1, v48
  s_cbranch_vccz L_chA0_mf2
  buffer_load_dwordx4 v[24:27], v2, s[8:11], s29 offen offset:2048 sc1
  s_branch L_chA0_mr2
L_chA0_ms3:
  buffer_load_dwordx4 v[28:31], v2, s[8:11], s29 offen offset:3072 sc1
  buffer_load_dwordx4 v[32:35], v2, s[8:11], s30 offen sc1
L_chA0_mr3:
  s_add_u32 s28, s28, 1
  s_cmp_ge_u32 s28, 262144
  s_cbranch_scc1 L_chA0_mf3
  s_waitcnt vmcnt(0)
  v_max_u32 v48, v28, v30
  v_cmp_eq_u32 vcc, -1, v48
  s_cbranch_vccz L_chA0_mf3
  buffer_load_dwordx4 v[28:31], v2, s[8:11], s29 offen offset:3072 sc1
  s_branch L_chA0_mr3
L_chA0_ms4:
  buffer_load_dwordx4 v[32:35], v2, s[8:11], s30 offen sc1
L_chA0_mr4:
  s_add_u32 s28, s28, 1
  s_cmp_ge_u32 s28, 262144
  s_cbranch_scc1 L_chA0_mf4
  s_waitcnt vmcnt(0)
  v_max_u32 v48, v32, v34
  v_cmp_eq_u32 vcc, -1, v48
  s_cbranch_vccz L_chA0_mf4
  buffer_load_dwordx4 v[32:35], v2, s[8:11], s30 offen sc1
  s_branch L_chA0_mr4
L_chA0_nosingle2:
  s_nop 5
  s_branch L_chA0_nosingle
L_chA0_qs:
  s_add_u32 s28, s28, 1
  s_cmp_ge_u32 s28, 262144
  s_cbranch_scc1 L_chA0_qok
  buffer_load_dwordx4 v[16:19], v3, s[8:11], s29 offen sc1
  buffer_load_dwordx4 v[20:23], v3, s[8:11], s29 offen offset:512 sc1
  buffer_load_dwordx4 v[24:27], v4, s[8:11], s29 offen sc1
  s_branch L_chA0_qw
L_chA0_smax:
L_chA0_vs:
  v_max_u32 v66, v24, v26
  v_cmp_eq_u32 vcc, -1, v66
  s_cbranch_vccz L_chA0_vok
  s_add_u32 s28, s28, 1
  s_cmp_ge_u32 s28, 262144
  s_cbranch_scc1 L_chA0_vok
  s_and_b32 s29, s27, 3
  s_mul_i32 s29, s29, 196608
  s_add_u32 s29, s29, s36
  buffer_load_dwordx4 v[24:27], v4, s[8:11], s29 offen sc1
  s_waitcnt vmcnt(0)
  s_branch L_chA0_vs
L_chA0_vok:
  v_max3_f32 v67, |v48|, |v49|, |v50|
  v_max3_f32 v67, v67, |v51|, |v64|
  v_cmp_lt_f32 vcc, s43, v67
  s_cbranch_vccz L_chA0_smaxd
  v_max3_f32 v67, v48, v49, v50
  v_max3_f32 v67, v67, v51, v64
  s_nop 1
  v_max_f32_dpp v67, v67, v67 row_ror:8 row_mask:0xf bank_mask:0xf
  v_mov_b32 v66, v67
  s_nop 1
  v_permlane16_swap_b32 v67, v66
  v_max_f32 v67, v67, v66
  v_mov_b32 v66, v67
  s_nop 1
  v_permlane32_swap_b32 v67, v66
  v_max_f32 v67, v67, v66
  v_sub_f32 v32, v48, v67
  v_sub_f32 v33, v49, v67
  v_sub_f32 v34, v50, v67
  v_sub_f32 v35, v51, v67
  v_sub_f32 v65, v64, v67
  v_exp_f32 v32, v32
  v_exp_f32 v33, v33
  v_exp_f32 v34, v34
  v_exp_f32 v35, v35
  v_exp_f32 v65, v65
  s_nop 1
  s_branch L_chA0_smaxd
L_chA1_loop:
  s_and_b32 s29, s27, 3
  s_mul_i32 s29, s29, 40960
  s_add_u32 s29, s29, s35
  s_add_u32 s30, s29, 4096
  v_mov_b32 v36, 0
  v_mov_b32 v37, 0
  v_mov_b32 v38, 0
  v_mov_b32 v39, 0
  v_mov_b32 v40, 0
  v_mov_b32 v41, 0
  v_mov_b32 v42, 0
  v_mov_b32 v43, 0
  v_mov_b32 v44, 0
  v_mov_b32 v45, 0
  v_mov_b32 v46, 0
  v_mov_b32 v47, 0
  s_barrier
  s_sleep 2
  buffer_load_dwordx4 v[16:19], v2, s[8:11], s29 offen offset:0 sc1
  buffer_load_dwordx4 v[20:23], v2, s[8:11], s29 offen offset:1024 sc1
  buffer_load_dwordx4 v[24:27], v2, s[8:11], s29 offen offset:2048 sc1
  buffer_load_dwordx4 v[28:31], v2, s[8:11], s29 offen offset:3072 sc1
  buffer_load_dwordx4 v[32:35], v2, s[8:11], s30 offen sc1
  s_waitcnt vmcnt(4)
  v_max_u32 v48, v16, v18
  v_cmp_eq_u32 vcc, -1, v48
  s_cbranch_vccnz L_chA1_ms0
L_chA1_mf0:
  s_waitcnt vmcnt(3)
  v_max_u32 v48, v20, v22
  v_cmp_eq_u32 vcc, -1, v48
  v_smfmac_f32_16x16x64_bf16 v[36:39], v[16:19], v[136:143], v0
  v_smfmac_f32_16x16x64_bf16 v[40:43], v[16:19], v[176:183], v0
  v_smfmac_f32_16x16x64_bf16 v[44:47], v[16:19], v[216:223], v0
  s_cbranch_vccnz L_chA1_ms1
L_chA1_mf1:
  s_waitcnt vmcnt(2)
  v_max_u32 v48, v24, v26
  v_cmp_eq_u32 vcc, -1, v48
  v_smfmac_f32_16x16x64_bf16 v[36:39], v[20:23], v[144:151], v0
  v_smfmac_f32_16x16x64_bf16 v[40:43], v[20:23], v[184:191], v0
  v_smfmac_f32_16x16x64_bf16 v[44:47], v[20:23], v[224:231], v0
  s_cbranch_vccnz L_chA1_ms2
L_chA1_mf2:
  s_waitcnt vmcnt(1)
  v_max_u32 v48, v28, v30
  v_cmp_eq_u32 vcc, -1, v48
  v_smfmac_f32_16x16x64_bf16 v[36:39], v[24:27], v[152:159], v0
  v_smfmac_f32_16x16x64_bf16 v[40:43], v[24:27], v[192:199], v0
  v_smfmac_f32_16x16x64_bf16 v[44:47], v[24:27], v[232:239], v0
  s_cbranch_vccnz L_chA1_ms3
L_chA1_mf3:
  s_waitcnt vmcnt(0)
  v_max_u32 v48, v32, v34
  v_cmp_eq_u32 vcc, -1, v48
  v_smfmac_f32_16x16x64_bf16 v[36:39], v[28:31], v[160:167], v0
  v_smfmac_f32_16x16x64_bf16 v[40:43], v[28:31], v[200:207], v0
  v_smfmac_f32_16x16x64_bf16 v[44:47], v[28:31], v[240:247], v0
  s_cbranch_vccnz L_chA1_ms4
L_chA1_mf4:
  v_smfmac_f32_16x16x64_bf16 v[36:39], v[32:35], v[168:175], v0
  v_smfmac_f32_16x16x64_bf16 v[40:43], v[32:35], v[208:215], v0
  v_smfmac_f32_16x16x64_bf16 v[44:47], v[32:35], v[248:255], v0
  s_and_b32 s29, s27, 3
  s_mul_i32 s29, s29, 196608
  s_add_u32 s29, s29, s36
  s_and_b32 s31, s27, 3
  s_mul_i32 s31, s31, 196608
  s_add_u32 s31, s31, s38
  ds_write2_b32 v5, v36, v37 offset0:0 offset1:16
  ds_write2_b32 v5, v38, v39 offset0:32 offset1:48
  ds_write2_b32 v5, v40, v41 offset0:128 offset1:144
  ds_write2_b32 v5, v42, v43 offset0:160 offset1:176
  ds_write_b128 v6, v[44:47]
  s_waitcnt lgkmcnt(0)
  s_barrier
  ds_read_b128 v[48:51], v68 offset:0
  ds_read_b128 v[52:55], v68 offset:1024
  ds_read_b128 v[56:59], v68 offset:2048
  ds_read_b128 v[60:63], v68 offset:3072
  s_waitcnt lgkmcnt(2)
  v_pk_add_f32 v[48:49], v[48:49], v[52:53]
  v_pk_add_f32 v[50:51], v[50:51], v[54:55]
  s_waitcnt lgkmcnt(0)
  v_pk_add_f32 v[56:57], v[56:57], v[60:61]
  v_pk_add_f32 v[58:59], v[58:59], v[62:63]
  v_pk_add_f32 v[48:49], v[48:49], v[56:57]
  v_pk_add_f32 v[50:51], v[50:51], v[58:59]
  v_cvt_pk_bf16_f32 v64, v48, v49
  v_cvt_pk_bf16_f32 v65, v50, v51
  s_nop 1
  v_permlane32_swap_b32 v64, v66
  v_permlane32_swap_b32 v65, v67
  buffer_store_dwordx4 v[64:67], v69, s[8:11], s31 offen sc1
  s_cmp_eq_u32 s27, 63
  s_cbranch_scc1 L_chA_exit
  ds_read_b128 v[80:83], v10
  ds_read_b128 v[84:87], v10 offset:1024
  ds_read_b128 v[72:75], v10 offset:8192
  ds_read_b128 v[76:79], v10 offset:9216
  v_mov_b32 v28, 0x3f803f80
  v_mov_b32 v29, 0x3f803f80
  v_mov_b32 v30, 0x3f803f80
  v_mov_b32 v31, 0x3f803f80
  s_sleep 3
  buffer_load_dwordx4 v[16:19], v3, s[8:11], s29 offen sc1
  buffer_load_dwordx4 v[20:23], v3, s[8:11], s29 offen offset:512 sc1
  buffer_load_dwordx4 v[24:27], v4, s[8:11], s29 offen sc1
L_chA1_qw:
  s_waitcnt vmcnt(1)
  v_max3_u32 v48, v16, v18, v20
  v_max_u32 v48, v48, v22
  v_cmp_eq_u32 vcc, -1, v48
  s_waitcnt lgkmcnt(0)
  v_mfma_f32_16x16x32_bf16 v[36:39], v[80:83], v[16:19], 0
  v_mfma_f32_16x16x32_bf16 v[40:43], v[84:87], v[16:19], 0
  v_mfma_f32_16x16x32_bf16 v[44:47], v[20:23], v[16:19], 0
  s_cbranch_vccnz L_chA1_qs
L_chA1_qok:
  s_nop 3
  v_cndmask_b32 v36, v40, v36, s[40:41]
  v_cndmask_b32 v37, v41, v37, s[40:41]
  v_cndmask_b32 v38, v42, v38, s[40:41]
  v_cndmask_b32 v39, v43, v39, s[40:41]
  v_cndmask_b32 v44, v45, v44, s[40:41]
  v_cndmask_b32 v46, v47, v46, s[40:41]
  ds_write_b128 v7, v[36:39]
  v_cndmask_b32 v44, v46, v44, s[62:63]
  ds_write_b32 v8, v44
  s_waitcnt lgkmcnt(0)
  s_barrier
  ds_read_b128 v[48:51], v12 offset:12288
  ds_read_b128 v[52:55], v12 offset:13312
  ds_read_b128 v[56:59], v12 offset:14336
  ds_read_b128 v[60:63], v12 offset:15360
  ds_read_b32 v64, v9 offset:16384
  ds_read_b32 v65, v9 offset:16640
  ds_read_b32 v66, v9 offset:16896
  ds_read_b32 v67, v9 offset:17152
  s_waitcnt vmcnt(0)
  v_max_u32 v32, v24, v26
  v_cmp_eq_u32 s[64:65], -1, v32
  s_waitcnt lgkmcnt(6)
  v_pk_add_f32 v[48:49], v[48:49], v[52:53]
  v_pk_add_f32 v[50:51], v[50:51], v[54:55]
  s_waitcnt lgkmcnt(4)
  v_pk_add_f32 v[56:57], v[56:57], v[60:61]
  v_pk_add_f32 v[58:59], v[58:59], v[62:63]
  s_waitcnt lgkmcnt(0)
  v_pk_add_f32 v[64:65], v[64:65], v[66:67]
  v_pk_add_f32 v[48:49], v[48:49], v[56:57]
  v_pk_add_f32 v[50:51], v[50:51], v[58:59]
  v_add_f32 v64, v64, v65
  v_pk_mul_f32 v[48:49], v[48:49], s[42:43] op_sel_hi:[1,0]
  v_pk_mul_f32 v[50:51], v[50:51], s[42:43] op_sel_hi:[1,0]
  v_mul_f32 v64, s42, v64
  v_mov_b32 v57, 0
  v_max3_f32 v67, |v48|, |v49|, |v50|
  v_max3_f32 v67, v67, |v51|, |v64|
  v_cmp_lt_f32 vcc, s43, v67
  v_exp_f32 v32, v48
  v_exp_f32 v33, v49
  v_exp_f32 v34, v50
  v_exp_f32 v35, v51
  s_or_b64 vcc, vcc, s[64:65]
  v_exp_f32 v65, v64
  s_cbranch_vccnz L_chA1_smax
L_chA1_smaxd:
  v_cvt_pk_bf16_f32 v52, v32, v33
  v_cvt_pk_bf16_f32 v53, v34, v35
  v_mov_b32_dpp v66, v65 row_ror:8 row_mask:0xf bank_mask:0xf
  v_mov_b32_dpp v54, v52 row_ror:8 row_mask:0xf bank_mask:0xf
  v_mov_b32_dpp v55, v53 row_ror:8 row_mask:0xf bank_mask:0xf
  v_cvt_pk_bf16_f32 v56, v65, v66
  s_nop 0
  v_mfma_f32_16x16x32_bf16 v[36:39], v[72:75], v[52:55], 0
  v_permlane32_swap_b32 v56, v57
  v_mfma_f32_16x16x32_bf16 v[40:43], v[76:79], v[52:55], 0
  v_mfma_f32_16x16x32_bf16 v[44:47], v[28:31], v[52:55], 0
  v_mfma_f32_16x16x16_bf16 v[36:39], v[24:25], v[56:57], v[36:39]
  v_mfma_f32_16x16x16_bf16 v[40:43], v[26:27], v[56:57], v[40:43]
  v_mfma_f32_16x16x16_bf16 v[44:47], v[28:29], v[56:57], v[44:47]
  s_nop 2
  v_cvt_pk_bf16_f32 v60, v36, v37
  v_cvt_pk_bf16_f32 v61, v38, v39
  v_cvt_pk_bf16_f32 v62, v40, v41
  v_cvt_pk_bf16_f32 v63, v42, v43
  ds_write_b128 v11, v[60:63]
  s_and_b32 s29, s27, 3
  s_mul_i32 s29, s29, 655360
  s_add_u32 s29, s29, s39
  v_rcp_f32 v58, v44
  s_and_b32 s30, s27, 3
  s_mul_i32 s30, s30, 655360
  s_add_u32 s30, s30, s37
  v_mfma_f32_16x16x32_bf16 v[44:47], v[120:123], v[60:63], 0
  v_mfma_f32_16x16x32_bf16 v[36:39], v[88:91], v[60:63], 0
  v_mfma_f32_16x16x32_bf16 v[40:43], v[104:107], v[60:63], 0
  s_waitcnt lgkmcnt(0)
  s_barrier
  ds_read_b128 v[16:19], v14
  ds_read_b128 v[20:23], v15
  ds_read_b128 v[24:27], v71
  s_waitcnt lgkmcnt(2)
  v_mfma_f32_16x16x32_bf16 v[44:47], v[124:127], v[16:19], v[44:47]
  v_mfma_f32_16x16x32_bf16 v[36:39], v[92:95], v[16:19], v[36:39]
  v_mfma_f32_16x16x32_bf16 v[40:43], v[108:111], v[16:19], v[40:43]
  s_waitcnt lgkmcnt(1)
  v_mfma_f32_16x16x32_bf16 v[44:47], v[128:131], v[20:23], v[44:47]
  v_mfma_f32_16x16x32_bf16 v[36:39], v[96:99], v[20:23], v[36:39]
  v_mfma_f32_16x16x32_bf16 v[40:43], v[112:115], v[20:23], v[40:43]
  s_waitcnt lgkmcnt(0)
  v_mfma_f32_16x16x32_bf16 v[44:47], v[132:135], v[24:27], v[44:47]
  v_mfma_f32_16x16x32_bf16 v[36:39], v[100:103], v[24:27], v[36:39]
  v_mfma_f32_16x16x32_bf16 v[40:43], v[116:119], v[24:27], v[40:43]
  s_cmp_ge_u32 s3, 2
  s_cbranch_scc1 L_chA1_nosingle2
  s_mov_b64 exec, s[40:41]
  v_pk_mul_f32 v[44:45], v[44:45], v[58:59] op_sel_hi:[1,0]
  v_pk_mul_f32 v[46:47], v[46:47], v[58:59] op_sel_hi:[1,0]
  buffer_store_dwordx4 v[44:47], v13, s[8:11], s30 offen sc1
  s_mov_b64 exec, -1
  s_nop 0
L_chA1_nosingle:
  v_mov_b32_dpp v36, v40 row_ror:8 row_mask:0xf bank_mask:0xc
  v_mov_b32_dpp v37, v41 row_ror:8 row_mask:0xf bank_mask:0xc
  v_mov_b32_dpp v38, v42 row_ror:8 row_mask:0xf bank_mask:0xc
  v_mov_b32_dpp v39, v43 row_ror:8 row_mask:0xf bank_mask:0xc
  v_pk_mul_f32 v[36:37], v[36:37], v[58:59] op_sel_hi:[1,0]
  v_pk_mul_f32 v[38:39], v[38:39], v[58:59] op_sel_hi:[1,0]
  buffer_store_dwordx4 v[36:39], v12, s[8:11], s29 offen sc1
  s_barrier
  s_barrier
  s_add_u32 s27, s27, 1
  s_branch L_chA1_loop
L_chA1_ms0:
  buffer_load_dwordx4 v[16:19], v2, s[8:11], s29 offen offset:0 sc1
  buffer_load_dwordx4 v[20:23], v2, s[8:11], s29 offen offset:1024 sc1
  buffer_load_dwordx4 v[24:27], v2, s[8:11], s29 offen offset:2048 sc1
  buffer_load_dwordx4 v[28:31], v2, s[8:11], s29 offen offset:3072 sc1
  buffer_load_dwordx4 v[32:35], v2, s[8:11], s30 offen sc1
L_chA1_mr0:
  s_add_u32 s28, s28, 1
  s_cmp_ge_u32 s28, 262144
  s_cbranch_scc1 L_chA1_mf0
  s_waitcnt vmcnt(0)
  v_max_u32 v48, v16, v18
  v_cmp_eq_u32 vcc, -1, v48
  s_cbranch_vccz L_chA1_mf0
  buffer_load_dwordx4 v[16:19], v2, s[8:11], s29 offen offset:0 sc1
  s_branch L_chA1_mr0
L_chA1_ms1:
  buffer_load_dwordx4 v[20:23], v2, s[8:11], s29 offen offset:1024 sc1
  buffer_load_dwordx4 v[24:27], v2, s[8:11], s29 offen offset:2048 sc1
  buffer_load_dwordx4 v[28:31], v2, s[8:11], s29 offen offset:3072 sc1
  buffer_load_dwordx4 v[32:35], v2, s[8:11], s30 offen sc1
L_chA1_mr1:
  s_add_u32 s28, s28, 1
  s_cmp_ge_u32 s28, 262144
  s_cbranch_scc1 L_chA1_mf1
  s_waitcnt vmcnt(0)
  v_max_u32 v48, v20, v22
  v_cmp_eq_u32 vcc, -1, v48
  s_cbranch_vccz L_chA1_mf1
  buffer_load_dwordx4 v[20:23], v2, s[8:11], s29 offen offset:1024 sc1
  s_branch L_chA1_mr1
L_chA1_ms2:
  buffer_load_dwordx4 v[24:27], v2, s[8:11], s29 offen offset:2048 sc1
  buffer_load_dwordx4 v[28:31], v2, s[8:11], s29 offen offset:3072 sc1
  buffer_load_dwordx4 v[32:35], v2, s[8:11], s30 offen sc1
L_chA1_mr2:
  s_add_u32 s28, s28, 1
  s_cmp_ge_u32 s28, 262144
  s_cbranch_scc1 L_chA1_mf2
  s_waitcnt vmcnt(0)
  v_max_u32 v48, v24, v26
  v_cmp_eq_u32 vcc, -1, v48
  s_cbranch_vccz L_chA1_mf2
  buffer_load_dwordx4 v[24:27], v2, s[8:11], s29 offen offset:2048 sc1
  s_branch L_chA1_mr2
L_chA1_ms3:
  buffer_load_dwordx4 v[28:31], v2, s[8:11], s29 offen offset:3072 sc1
  buffer_load_dwordx4 v[32:35], v2, s[8:11], s30 offen sc1
L_chA1_mr3:
  s_add_u32 s28, s28, 1
  s_cmp_ge_u32 s28, 262144
  s_cbranch_scc1 L_chA1_mf3
  s_waitcnt vmcnt(0)
  v_max_u32 v48, v28, v30
  v_cmp_eq_u32 vcc, -1, v48
  s_cbranch_vccz L_chA1_mf3
  buffer_load_dwordx4 v[28:31], v2, s[8:11], s29 offen offset:3072 sc1
  s_branch L_chA1_mr3
L_chA1_ms4:
  buffer_load_dwordx4 v[32:35], v2, s[8:11], s30 offen sc1
L_chA1_mr4:
  s_add_u32 s28, s28, 1
  s_cmp_ge_u32 s28, 262144
  s_cbranch_scc1 L_chA1_mf4
  s_waitcnt vmcnt(0)
  v_max_u32 v48, v32, v34
  v_cmp_eq_u32 vcc, -1, v48
  s_cbranch_vccz L_chA1_mf4
  buffer_load_dwordx4 v[32:35], v2, s[8:11], s30 offen sc1
  s_branch L_chA1_mr4
L_chA1_nosingle2:
  s_nop 5
  s_branch L_chA1_nosingle
L_chA1_qs:
  s_add_u32 s28, s28, 1
  s_cmp_ge_u32 s28, 262144
  s_cbranch_scc1 L_chA1_qok
  buffer_load_dwordx4 v[16:19], v3, s[8:11], s29 offen sc1
  buffer_load_dwordx4 v[20:23], v3, s[8:11], s29 offen offset:512 sc1
  buffer_load_dwordx4 v[24:27], v4, s[8:11], s29 offen sc1
  s_branch L_chA1_qw
L_chA1_smax:
L_chA1_vs:
  v_max_u32 v66, v24, v26
  v_cmp_eq_u32 vcc, -1, v66
  s_cbranch_vccz L_chA1_vok
  s_add_u32 s28, s28, 1
  s_cmp_ge_u32 s28, 262144
  s_cbranch_scc1 L_chA1_vok
  s_and_b32 s29, s27, 3
  s_mul_i32 s29, s29, 196608
  s_add_u32 s29, s29, s36
  buffer_load_dwordx4 v[24:27], v4, s[8:11], s29 offen sc1
  s_waitcnt vmcnt(0)
  s_branch L_chA1_vs
L_chA1_vok:
  v_max3_f32 v67, |v48|, |v49|, |v50|
  v_max3_f32 v67, v67, |v51|, |v64|
  v_cmp_lt_f32 vcc, s43, v67
  s_cbranch_vccz L_chA1_smaxd
  v_max3_f32 v67, v48, v49, v50
  v_max3_f32 v67, v67, v51, v64
  s_nop 1
  v_max_f32_dpp v67, v67, v67 row_ror:8 row_mask:0xf bank_mask:0xf
  v_mov_b32 v66, v67
  s_nop 1
  v_permlane16_swap_b32 v67, v66
  v_max_f32 v67, v67, v66
  v_mov_b32 v66, v67
  s_nop 1
  v_permlane32_swap_b32 v67, v66
  v_max_f32 v67, v67, v66
  v_sub_f32 v32, v48, v67
  v_sub_f32 v33, v49, v67
  v_sub_f32 v34, v50, v67
  v_sub_f32 v35, v51, v67
  v_sub_f32 v65, v64, v67
  v_exp_f32 v32, v32
  v_exp_f32 v33, v33
  v_exp_f32 v34, v34
  v_exp_f32 v35, v35
  v_exp_f32 v65, v65
  s_nop 1
  s_branch L_chA1_smaxd
L_chA_exit:
  s_endpgm
L_ch_red:
  s_sub_u32 s33, s3, 4
  v_lshlrev_b32 v4, 4, v1
  s_lshl_b32 s29, s33, 12
  v_lshrrev_b32 v10, 5, v1
  v_lshlrev_b32 v10, 9, v10
  v_and_b32 v11, 7, v1
  v_lshl_add_u32 v12, v11, 6, v10
  v_bfe_u32 v11, v1, 3, 2
  v_lshl_add_u32 v12, v11, 4, v12
  v_and_b32 v11, 15, v1
  v_lshl_add_u32 v13, v11, 5, v10
  v_bfe_u32 v11, v1, 4, 1
  v_lshl_add_u32 v13, v11, 4, v13
  s_cmp_eq_u32 s33, 2
  s_cselect_b64 vcc, -1, 0
  s_nop 1
  v_cndmask_b32 v12, v12, v13, vcc
  v_add_u32 v2, s29, v12
  v_mov_b32 v3, 1073741824
  v_cmp_gt_u32 vcc, 32, v1
  s_nop 1
  v_cndmask_b32 v3, v3, v4, vcc
  s_mul_i32 s34, s24, 6144
  s_mul_i32 s29, s25, 1536
  s_add_u32 s34, s34, s29
  s_lshl_b32 s29, s33, 9
  s_add_u32 s34, s34, s29
  s_add_u32 s34, s34, 229376
  s_lshl_b32 s35, s24, 11
  s_lshl_b32 s29, s25, 9
  s_add_u32 s35, s35, s29
  s_cmp_eq_u32 s33, 2
  s_mov_b32 s30, 71303168
  s_cselect_b32 s29, 75497472, s30
  s_add_u32 s35, s35, s29
  s_lshl_b32 s36, s24, 6
  s_lshl_b32 s29, s25, 2
  s_add_u32 s36, s36, s29
  s_lshl_b32 s29, s33, 4
  s_add_u32 s36, s36, s29
  s_add_u32 s36, s36, 8176
  v_mov_b32 v5, 1073741824
  v_cmp_eq_u32 vcc, 0, v1
  v_mov_b32 v10, s36
  s_nop 0
  v_cndmask_b32 v5, v5, v10, vcc
  s_sub_u32 s29, s7, 20
  s_cmp_lt_u32 s7, 20
  s_cselect_b32 s29, s7, s29
  s_mul_i32 s37, s6, 163840
  s_lshl_b32 s29, s29, 10
  s_add_u32 s37, s37, s29
  s_add_u32 s37, s37, 1015808
  s_lshr_b32 s31, s29, 10
  s_lshr_b32 s30, s31, 3
  s_lshl_b32 s30, s30, 14
  s_and_b32 s38, s31, 7
  s_lshl_b32 s38, s38, 10
  s_add_u32 s38, s38, s30
  s_mul_i32 s30, s6, 49152
  s_add_u32 s38, s38, s30
  s_add_u32 s38, s38, 117440512
  s_mul_i32 s39, s24, 20480
  s_mul_i32 s29, s25, 5120
  s_add_u32 s39, s39, s29
  s_add_u32 s39, s39, 1015808
  s_lshl_b32 s40, s24, 13
  s_cmp_eq_u32 s33, 2
  s_mov_b32 s30, 4194304
  s_cselect_b32 s29, 20971520, s30
  s_add_u32 s40, s40, s29
  s_cselect_b32 s29, 32, 0
  s_cmp_eq_u32 s33, 2
  s_cselect_b32 s29, 32, 0
  s_add_u32 s29, s29, s24
  s_lshl_b32 s29, s29, 6
  s_add_u32 s29, s29, 0
  v_and_b32 v10, 3, v1
  v_lshl_add_u32 v6, v10, 2, s29
  s_sub_u32 s29, s33, 1
  s_lshl_b32 s29, s29, 13
  s_add_u32 s29, s29, 28672
  v_add_u32 v7, s29, v4
  v_mov_b32 v8, -1
  v_mov_b32 v9, -1
  v_mov_b32 v10, -1
  v_mov_b32 v11, -1
  s_mov_b32 s41, 0
  s_cmp_eq_u32 s33, 0
  s_cbranch_scc1 L_chR_init
  s_cmp_eq_u32 s98, 0
  s_cbranch_scc0 L_chR_vw_ok
  v_mov_b32 v14, 163824
L_chR_vw:
  ds_read_b32 v15, v14
  s_waitcnt lgkmcnt(0)
  v_readfirstlane_b32 s32, v15
  s_nop 0
  s_cmp_eq_u32 s32, 2
  s_cbranch_scc1 L_chR_init
  s_cmp_eq_u32 s32, 1
  s_cbranch_scc1 L_chR_vw_ok
  s_sleep 2
  s_add_u32 s28, s28, 1
  s_cmp_lt_u32 s28, 262144
  s_cbranch_scc1 L_chR_vw
L_chR_vw_ok:
  s_mov_b32 s31, 1
  s_cmp_ge_u32 s41, s31
  s_cbranch_scc1 L_chR_kv0_ok
L_chR_kv0:
  buffer_load_dword v16, v6, s[8:11], 0 offen sc1
  s_waitcnt vmcnt(0)
  v_readlane_b32 s48, v16, 0
  v_readlane_b32 s49, v16, 1
  v_readlane_b32 s50, v16, 2
  v_readlane_b32 s51, v16, 3
  s_min_u32 s48, s48, s49
  s_min_u32 s50, s50, s51
  s_min_u32 s41, s48, s50
  s_cmp_ge_u32 s41, s31
  s_cbranch_scc1 L_chR_kv0_ok
  s_sleep 2
  s_add_u32 s28, s28, 1
  s_cmp_lt_u32 s28, 262144
  s_cbranch_scc1 L_chR_kv0
L_chR_kv0_ok:
  buffer_load_dwordx4 v[96:99], v4, s[8:11], s40 offen offset:0 sc1
  buffer_load_dwordx4 v[100:103], v4, s[8:11], s40 offen offset:1024 sc1
  buffer_load_dwordx4 v[104:107], v4, s[8:11], s40 offen offset:2048 sc1
  buffer_load_dwordx4 v[108:111], v4, s[8:11], s40 offen offset:3072 sc1
  s_add_u32 s40, s40, 4096
  buffer_load_dwordx4 v[112:115], v4, s[8:11], s40 offen offset:0 sc1
  buffer_load_dwordx4 v[116:119], v4, s[8:11], s40 offen offset:1024 sc1
  buffer_load_dwordx4 v[120:123], v4, s[8:11], s40 offen offset:2048 sc1
  buffer_load_dwordx4 v[124:127], v4, s[8:11], s40 offen offset:3072 sc1
  s_add_u32 s40, s40, 258048
  s_waitcnt vmcnt(0)
  ds_write_b128 v7, v[96:99] offset:0
  ds_write_b128 v7, v[100:103] offset:1024
  ds_write_b128 v7, v[104:107] offset:2048
  ds_write_b128 v7, v[108:111] offset:3072
  ds_write_b128 v7, v[112:115] offset:4096
  ds_write_b128 v7, v[116:119] offset:5120
  ds_write_b128 v7, v[120:123] offset:6144
  ds_write_b128 v7, v[124:127] offset:7168
  s_waitcnt lgkmcnt(0)
L_chR_init:
  s_barrier
  s_cmp_eq_u32 s98, 0
  s_cbranch_scc0 L_chR_vc
  v_mov_b32 v14, 163824
  ds_read_b32 v15, v14
  s_waitcnt lgkmcnt(0)
  v_readfirstlane_b32 s32, v15
  s_nop 0
  s_cmp_eq_u32 s32, 2
  s_cbranch_scc1 L_restart
L_chR_vc:
  s_cmp_eq_u32 s33, 0
  s_cbranch_scc1 L_ch_w4
  s_mul_i32 s42, s24, 6144
  s_mul_i32 s29, s25, 1536
  s_add_u32 s42, s42, s29
  s_add_u32 s42, s42, 229376
  s_mov_b32 s43, 0
  s_cmp_eq_u32 s5, 0
  s_cbranch_scc0 L_chR1_loop
L_chR0_loop:
  s_barrier
  s_cmp_eq_u32 s43, 0
  s_cbranch_scc1 L_chR0_nokv
  s_waitcnt vmcnt(0)
  ds_write_b128 v7, v[96:99] offset:0
  ds_write_b128 v7, v[100:103] offset:1024
  ds_write_b128 v7, v[104:107] offset:2048
  ds_write_b128 v7, v[108:111] offset:3072
  ds_write_b128 v7, v[112:115] offset:4096
  ds_write_b128 v7, v[116:119] offset:5120
  ds_write_b128 v7, v[120:123] offset:6144
  ds_write_b128 v7, v[124:127] offset:7168
  s_waitcnt lgkmcnt(0)
L_chR0_nokv:
  s_barrier
  s_cmp_eq_u32 s27, 63
  s_cbranch_scc1 L_chR_last
  s_barrier
  ds_read_b128 v[16:19], v2 offset:0
  ds_read_b128 v[20:23], v2 offset:1024
  ds_read_b128 v[24:27], v2 offset:2048
  ds_read_b128 v[28:31], v2 offset:3072
  s_waitcnt lgkmcnt(2)
  v_pk_add_f32 v[16:17], v[16:17], v[20:21]
  v_pk_add_f32 v[18:19], v[18:19], v[22:23]
  s_waitcnt lgkmcnt(0)
  v_pk_add_f32 v[24:25], v[24:25], v[28:29]
  v_pk_add_f32 v[26:27], v[26:27], v[30:31]
  v_pk_add_f32 v[16:17], v[16:17], v[24:25]
  v_pk_add_f32 v[18:19], v[18:19], v[26:27]
  v_cvt_pk_bf16_f32 v32, v16, v17
  v_cvt_pk_bf16_f32 v33, v18, v19
  s_nop 1
  v_permlane32_swap_b32 v32, v34
  v_permlane32_swap_b32 v33, v35
  s_lshl_b32 s31, s27, 16
  s_add_u32 s31, s31, s35
  s_barrier
  s_barrier
  s_barrier
  s_add_u32 s30, s27, 2
  s_cmp_ge_u32 s41, s30
  s_cbranch_scc1 L_chR0_kv_ok
L_chR0_kv:
  buffer_load_dword v16, v6, s[8:11], 0 offen sc1
  s_waitcnt vmcnt(0)
  v_readlane_b32 s48, v16, 0
  v_readlane_b32 s49, v16, 1
  v_readlane_b32 s50, v16, 2
  v_readlane_b32 s51, v16, 3
  s_min_u32 s48, s48, s49
  s_min_u32 s50, s50, s51
  s_min_u32 s41, s48, s50
  s_cmp_ge_u32 s41, s30
  s_cbranch_scc1 L_chR0_kv_ok
  s_sleep 2
  s_add_u32 s28, s28, 1
  s_cmp_lt_u32 s28, 262144
  s_cbranch_scc1 L_chR0_kv
L_chR0_kv_ok:
  buffer_load_dwordx4 v[96:99], v4, s[8:11], s40 offen offset:0 sc1
  buffer_load_dwordx4 v[100:103], v4, s[8:11], s40 offen offset:1024 sc1
  buffer_load_dwordx4 v[104:107], v4, s[8:11], s40 offen offset:2048 sc1
  buffer_load_dwordx4 v[108:111], v4, s[8:11], s40 offen offset:3072 sc1
  s_add_u32 s40, s40, 4096
  buffer_load_dwordx4 v[112:115], v4, s[8:11], s40 offen offset:0 sc1
  buffer_load_dwordx4 v[116:119], v4, s[8:11], s40 offen offset:1024 sc1
  buffer_load_dwordx4 v[120:123], v4, s[8:11], s40 offen offset:2048 sc1
  buffer_load_dwordx4 v[124:127], v4, s[8:11], s40 offen offset:3072 sc1
  s_add_u32 s40, s40, 258048
  buffer_store_dwordx4 v[32:35], v3, s[8:11], s31 offen sc1
  s_cmp_eq_u32 s33, 1
  s_cbranch_scc0 L_chR0_noreset
  s_add_u32 s30, s27, 0xffffffff
  s_and_b32 s30, s30, 3
  s_mul_i32 s30, s30, 655360
  s_add_u32 s30, s30, s39
  buffer_store_dwordx4 v[8:11], v4, s[8:11], s30 offen offset:0
  buffer_store_dwordx4 v[8:11], v4, s[8:11], s30 offen offset:1024
  buffer_store_dwordx4 v[8:11], v4, s[8:11], s30 offen offset:2048
  buffer_store_dwordx4 v[8:11], v4, s[8:11], s30 offen offset:3072
  s_add_u32 s30, s30, 4096
  buffer_store_dwordx4 v[8:11], v4, s[8:11], s30 offen
  s_branch L_chR0_b3
L_chR0_noreset:
  s_add_u32 s30, s27, 0xffffffff
  s_and_b32 s30, s30, 3
  s_mul_i32 s30, s30, 196608
  s_add_u32 s30, s30, s42
  buffer_store_dwordx4 v[8:11], v4, s[8:11], s30 offen
  buffer_store_dwordx4 v[8:11], v3, s[8:11], s30 offen offset:1024
L_chR0_b3:
  s_mov_b32 s43, 1
  s_add_u32 s27, s27, 1
  s_branch L_chR0_loop
L_chR1_loop:
  s_barrier
  s_cmp_eq_u32 s43, 0
  s_cbranch_scc1 L_chR1_nokv
  s_waitcnt vmcnt(0)
  ds_write_b128 v7, v[96:99] offset:0
  ds_write_b128 v7, v[100:103] offset:1024
  ds_write_b128 v7, v[104:107] offset:2048
  ds_write_b128 v7, v[108:111] offset:3072
  ds_write_b128 v7, v[112:115] offset:4096
  ds_write_b128 v7, v[116:119] offset:5120
  ds_write_b128 v7, v[120:123] offset:6144
  ds_write_b128 v7, v[124:127] offset:7168
  s_waitcnt lgkmcnt(0)
L_chR1_nokv:
  s_barrier
  s_cmp_eq_u32 s27, 63
  s_cbranch_scc1 L_chR_last
  s_barrier
  ds_read_b128 v[16:19], v2 offset:0
  ds_read_b128 v[20:23], v2 offset:1024
  ds_read_b128 v[24:27], v2 offset:2048
  ds_read_b128 v[28:31], v2 offset:3072
  s_waitcnt lgkmcnt(2)
  v_pk_add_f32 v[16:17], v[16:17], v[20:21]
  v_pk_add_f32 v[18:19], v[18:19], v[22:23]
  s_waitcnt lgkmcnt(0)
  v_pk_add_f32 v[24:25], v[24:25], v[28:29]
  v_pk_add_f32 v[26:27], v[26:27], v[30:31]
  v_pk_add_f32 v[16:17], v[16:17], v[24:25]
  v_pk_add_f32 v[18:19], v[18:19], v[26:27]
  v_cvt_pk_bf16_f32 v32, v16, v17
  v_cvt_pk_bf16_f32 v33, v18, v19
  s_nop 1
  v_permlane32_swap_b32 v32, v34
  v_permlane32_swap_b32 v33, v35
  s_lshl_b32 s31, s27, 16
  s_add_u32 s31, s31, s35
  s_barrier
  s_barrier
  s_barrier
  s_add_u32 s30, s27, 2
  s_cmp_ge_u32 s41, s30
  s_cbranch_scc1 L_chR1_kv_ok
L_chR1_kv:
  buffer_load_dword v16, v6, s[8:11], 0 offen sc1
  s_waitcnt vmcnt(0)
  v_readlane_b32 s48, v16, 0
  v_readlane_b32 s49, v16, 1
  v_readlane_b32 s50, v16, 2
  v_readlane_b32 s51, v16, 3
  s_min_u32 s48, s48, s49
  s_min_u32 s50, s50, s51
  s_min_u32 s41, s48, s50
  s_cmp_ge_u32 s41, s30
  s_cbranch_scc1 L_chR1_kv_ok
  s_sleep 2
  s_add_u32 s28, s28, 1
  s_cmp_lt_u32 s28, 262144
  s_cbranch_scc1 L_chR1_kv
L_chR1_kv_ok:
  buffer_load_dwordx4 v[96:99], v4, s[8:11], s40 offen offset:0 sc1
  buffer_load_dwordx4 v[100:103], v4, s[8:11], s40 offen offset:1024 sc1
  buffer_load_dwordx4 v[104:107], v4, s[8:11], s40 offen offset:2048 sc1
  buffer_load_dwordx4 v[108:111], v4, s[8:11], s40 offen offset:3072 sc1
  s_add_u32 s40, s40, 4096
  buffer_load_dwordx4 v[112:115], v4, s[8:11], s40 offen offset:0 sc1
  buffer_load_dwordx4 v[116:119], v4, s[8:11], s40 offen offset:1024 sc1
  buffer_load_dwordx4 v[120:123], v4, s[8:11], s40 offen offset:2048 sc1
  buffer_load_dwordx4 v[124:127], v4, s[8:11], s40 offen offset:3072 sc1
  s_add_u32 s40, s40, 258048
  buffer_store_dwordx4 v[32:35], v3, s[8:11], s31 offen sc1
  s_cmp_eq_u32 s33, 1
  s_cbranch_scc0 L_chR1_noreset
  s_add_u32 s30, s27, 0xffffffff
  s_and_b32 s30, s30, 3
  s_mul_i32 s30, s30, 655360
  s_add_u32 s30, s30, s39
  buffer_store_dwordx4 v[8:11], v4, s[8:11], s30 offen offset:0 sc1
  buffer_store_dwordx4 v[8:11], v4, s[8:11], s30 offen offset:1024 sc1
  buffer_store_dwordx4 v[8:11], v4, s[8:11], s30 offen offset:2048 sc1
  buffer_store_dwordx4 v[8:11], v4, s[8:11], s30 offen offset:3072 sc1
  s_add_u32 s30, s30, 4096
  buffer_store_dwordx4 v[8:11], v4, s[8:11], s30 offen sc1
  s_branch L_chR1_b3
L_chR1_noreset:
  s_add_u32 s30, s27, 0xffffffff
  s_and_b32 s30, s30, 3
  s_mul_i32 s30, s30, 196608
  s_add_u32 s30, s30, s42
  buffer_store_dwordx4 v[8:11], v4, s[8:11], s30 offen sc1
  buffer_store_dwordx4 v[8:11], v3, s[8:11], s30 offen offset:1024 sc1
L_chR1_b3:
  s_mov_b32 s43, 1
  s_add_u32 s27, s27, 1
  s_branch L_chR1_loop
L_chR_last:
  ds_read_b128 v[16:19], v2 offset:0
  ds_read_b128 v[20:23], v2 offset:1024
  ds_read_b128 v[24:27], v2 offset:2048
  ds_read_b128 v[28:31], v2 offset:3072
  s_waitcnt lgkmcnt(2)
  v_pk_add_f32 v[16:17], v[16:17], v[20:21]
  v_pk_add_f32 v[18:19], v[18:19], v[22:23]
  s_waitcnt lgkmcnt(0)
  v_pk_add_f32 v[24:25], v[24:25], v[28:29]
  v_pk_add_f32 v[26:27], v[26:27], v[30:31]
  v_pk_add_f32 v[16:17], v[16:17], v[24:25]
  v_pk_add_f32 v[18:19], v[18:19], v[26:27]
  v_cvt_pk_bf16_f32 v32, v16, v17
  v_cvt_pk_bf16_f32 v33, v18, v19
  s_nop 1
  v_permlane32_swap_b32 v32, v34
  v_permlane32_swap_b32 v33, v35
  s_lshl_b32 s31, s27, 16
  s_add_u32 s31, s31, s35
  buffer_store_dwordx4 v[32:35], v3, s[8:11], s31 offen sc1
  s_waitcnt vmcnt(0)
  v_mov_b32 v36, 64
  buffer_store_dword v36, v5, s[8:11], 0 offen sc1
  s_endpgm
L_ch_w4:
  v_lshrrev_b32 v10, 4, v1
  v_lshlrev_b32 v10, 7, v10
  v_and_b32 v11, 7, v1
  v_lshl_add_u32 v10, v11, 4, v10
  v_and_b32 v13, 8, v1
  v_mov_b32 v12, 1073741824
  v_cmp_eq_u32 vcc, 0, v13
  s_nop 1
  v_cndmask_b32 v12, v12, v10, vcc
  s_cmp_lt_u32 s7, 20
  s_cselect_b64 vcc, -1, 0
  v_mov_b32 v11, 1073741824
  v_cndmask_b32 v7, v11, v4, vcc
  v_cndmask_b32 v12, v11, v12, vcc
  s_mul_i32 s43, s6, 10240
  s_lshl_b32 s29, s7, 9
  s_add_u32 s43, s43, s29
  s_add_u32 s43, s43, 65536
  s_sub_u32 s29, s7, 20
  s_cmp_lt_u32 s7, 20
  s_cselect_b32 s29, s7, s29
  s_lshr_b32 s30, s29, 3
  s_lshl_b32 s30, s30, 14
  s_and_b32 s42, s29, 7
  s_lshl_b32 s42, s42, 10
  s_add_u32 s42, s42, s30
  s_add_u32 s42, s42, 117440512
  v_mov_b32 v14, 15360
L_ch4_ph:
  buffer_load_dword v15, v14, s[8:11], 0 offen sc1
  s_waitcnt vmcnt(0)
  v_readfirstlane_b32 s29, v15
  s_nop 0
  s_cmp_lg_u32 s29, 0
  s_cbranch_scc1 L_ch4_ph_ok
  s_sleep 4
  s_add_u32 s28, s28, 1
  s_cmp_lt_u32 s28, 262144
  s_cbranch_scc1 L_ch4_ph
L_ch4_ph_ok:
  s_sub_u32 s29, s29, 1
  s_and_b32 s29, s29, 1
  s_lshl_b32 s29, s29, 13
  s_add_u32 s42, s42, s29
  s_add_u32 s38, s38, s29
  v_cmp_gt_u32 vcc, 20, v1
  v_mul_u32_u24 v10, 512, v1
  v_mov_b32 v11, 0
  v_cndmask_b32 v10, v11, v10, vcc
  v_add_u32 v13, 496, v10
  s_mul_i32 s44, s6, 10240
  s_add_u32 s44, s44, 65536
  s_mov_b32 s45, 8
  s_cmp_eq_u32 s5, 0
  s_cbranch_scc0 L_ch41_loop
L_ch40_loop:
  s_barrier
  s_and_b32 s29, s27, 3
  s_mul_i32 s29, s29, 655360
  s_add_u32 s29, s29, s37
  s_add_u32 s48, s29, 0
  s_add_u32 s49, s29, 20480
  s_add_u32 s50, s29, 40960
  s_add_u32 s51, s29, 61440
  s_add_u32 s52, s29, 81920
  s_add_u32 s53, s29, 102400
  s_add_u32 s54, s29, 122880
  s_add_u32 s55, s29, 143360
  s_and_b32 s29, s27, 3
  s_mul_i32 s29, s29, 196608
  s_add_u32 s29, s29, s38
  s_and_b32 s30, s27, 3
  s_mul_i32 s30, s30, 196608
  s_add_u32 s30, s30, s42
  s_add_u32 s31, s27, 0x1
  s_and_b32 s31, s31, 3
  s_mul_i32 s31, s31, 40960
  s_add_u32 s31, s31, s43
  s_add_u32 s32, s27, 0x1
  s_and_b32 s32, s32, 3
  s_mul_i32 s32, s32, 40960
  s_add_u32 s32, s32, s44
  s_barrier
  s_cmp_eq_u32 s27, 63
  s_cbranch_scc1 L_ch4_end
  s_barrier
  s_barrier
  s_barrier
  s_sleep 4
  buffer_load_dwordx4 v[16:19], v4, s[8:11], s48 offen sc1
  buffer_load_dwordx4 v[20:23], v4, s[8:11], s49 offen sc1
  buffer_load_dwordx4 v[24:27], v4, s[8:11], s50 offen sc1
  buffer_load_dwordx4 v[28:31], v4, s[8:11], s51 offen sc1
  buffer_load_dwordx4 v[32:35], v4, s[8:11], s52 offen sc1
  buffer_load_dwordx4 v[36:39], v4, s[8:11], s53 offen sc1
  buffer_load_dwordx4 v[40:43], v4, s[8:11], s54 offen sc1
  buffer_load_dwordx4 v[44:47], v4, s[8:11], s55 offen sc1
L_ch40_p1w:
  s_waitcnt vmcnt(0)
  v_max3_u32 v50, v16, v20, v24
  v_max3_u32 v51, v28, v32, v36
  v_max3_u32 v50, v50, v40, v44
  v_max_u32 v50, v50, v51
  v_cmp_eq_u32 vcc, -1, v50
  v_pk_add_f32 v[16:17], v[16:17], v[20:21]
  v_pk_add_f32 v[18:19], v[18:19], v[22:23]
  v_pk_add_f32 v[24:25], v[24:25], v[28:29]
  v_pk_add_f32 v[26:27], v[26:27], v[30:31]
  v_pk_add_f32 v[32:33], v[32:33], v[36:37]
  v_pk_add_f32 v[34:35], v[34:35], v[38:39]
  v_pk_add_f32 v[40:41], v[40:41], v[44:45]
  v_pk_add_f32 v[42:43], v[42:43], v[46:47]
  v_pk_add_f32 v[16:17], v[16:17], v[24:25]
  v_pk_add_f32 v[18:19], v[18:19], v[26:27]
  v_pk_add_f32 v[32:33], v[32:33], v[40:41]
  v_pk_add_f32 v[34:35], v[34:35], v[42:43]
  v_pk_add_f32 v[16:17], v[16:17], v[32:33]
  v_pk_add_f32 v[18:19], v[18:19], v[34:35]
  s_cbranch_vccnz L_ch40_p1s
L_ch40_p1ok:
  buffer_store_dwordx4 v[16:19], v7, s[8:11], s29 offen sc1
L_ch40_r1skip:
  s_barrier
  s_add_u32 s48, s30, 0
  s_add_u32 s49, s30, 49152
  s_add_u32 s50, s30, 98304
  s_add_u32 s51, s30, 147456
  s_sleep 8
  buffer_load_dwordx4 v[20:23], v4, s[8:11], s48 offen sc1
  buffer_load_dwordx4 v[24:27], v4, s[8:11], s49 offen sc1
  buffer_load_dwordx4 v[28:31], v4, s[8:11], s50 offen sc1
  buffer_load_dwordx4 v[32:35], v4, s[8:11], s51 offen sc1
L_ch40_p2w:
  s_waitcnt vmcnt(0)
  v_max3_u32 v50, v20, v24, v28
  v_max_u32 v50, v50, v32
  v_cmp_eq_u32 vcc, -1, v50
  v_pk_add_f32 v[20:21], v[20:21], v[24:25]
  v_pk_add_f32 v[22:23], v[22:23], v[26:27]
  v_pk_add_f32 v[28:29], v[28:29], v[32:33]
  v_pk_add_f32 v[30:31], v[30:31], v[34:35]
  v_pk_add_f32 v[20:21], v[20:21], v[28:29]
  v_pk_add_f32 v[22:23], v[22:23], v[30:31]
  v_cvt_pk_bf16_f32 v36, v20, v21
  v_cvt_pk_bf16_f32 v37, v22, v23
  s_cbranch_vccnz L_ch40_p2s
L_ch40_p2ok:
  s_nop 0
  v_mov_b32_dpp v38, v36 row_ror:8 row_mask:0xf bank_mask:0xf
  v_mov_b32_dpp v39, v37 row_ror:8 row_mask:0xf bank_mask:0xf
  buffer_store_dwordx4 v[36:39], v12, s[8:11], s31 offen
L_ch40_next:
  s_add_u32 s27, s27, 1
  s_branch L_ch40_loop
L_ch40_p1s:
  s_add_u32 s28, s28, 1
  s_cmp_ge_u32 s28, 262144
  s_cbranch_scc1 L_ch40_p1ok
  buffer_load_dwordx4 v[16:19], v4, s[8:11], s48 offen sc1
  buffer_load_dwordx4 v[20:23], v4, s[8:11], s49 offen sc1
  buffer_load_dwordx4 v[24:27], v4, s[8:11], s50 offen sc1
  buffer_load_dwordx4 v[28:31], v4, s[8:11], s51 offen sc1
  buffer_load_dwordx4 v[32:35], v4, s[8:11], s52 offen sc1
  buffer_load_dwordx4 v[36:39], v4, s[8:11], s53 offen sc1
  buffer_load_dwordx4 v[40:43], v4, s[8:11], s54 offen sc1
  buffer_load_dwordx4 v[44:47], v4, s[8:11], s55 offen sc1
  s_branch L_ch40_p1w
L_ch40_p2s:
  s_add_u32 s28, s28, 1
  s_cmp_ge_u32 s28, 262144
  s_cbranch_scc1 L_ch40_p2ok
  buffer_load_dwordx4 v[20:23], v4, s[8:11], s48 offen sc1
  buffer_load_dwordx4 v[24:27], v4, s[8:11], s49 offen sc1
  buffer_load_dwordx4 v[28:31], v4, s[8:11], s50 offen sc1
  buffer_load_dwordx4 v[32:35], v4, s[8:11], s51 offen sc1
  s_branch L_ch40_p2w
L_ch41_loop:
  s_barrier
  s_and_b32 s29, s27, 3
  s_mul_i32 s29, s29, 655360
  s_add_u32 s29, s29, s37
  s_add_u32 s48, s29, 0
  s_add_u32 s49, s29, 20480
  s_add_u32 s50, s29, 40960
  s_add_u32 s51, s29, 61440
  s_add_u32 s52, s29, 81920
  s_add_u32 s53, s29, 102400
  s_add_u32 s54, s29, 122880
  s_add_u32 s55, s29, 143360
  s_and_b32 s29, s27, 3
  s_mul_i32 s29, s29, 196608
  s_add_u32 s29, s29, s38
  s_and_b32 s30, s27, 3
  s_mul_i32 s30, s30, 196608
  s_add_u32 s30, s30, s42
  s_add_u32 s31, s27, 0x1
  s_and_b32 s31, s31, 3
  s_mul_i32 s31, s31, 40960
  s_add_u32 s31, s31, s43
  s_add_u32 s32, s27, 0x1
  s_and_b32 s32, s32, 3
  s_mul_i32 s32, s32, 40960
  s_add_u32 s32, s32, s44
  s_barrier
  s_cmp_eq_u32 s27, 63
  s_cbranch_scc1 L_ch4_end
  s_barrier
  s_barrier
  s_barrier
  s_sleep 4
  buffer_load_dwordx4 v[16:19], v4, s[8:11], s48 offen sc1
  buffer_load_dwordx4 v[20:23], v4, s[8:11], s49 offen sc1
  buffer_load_dwordx4 v[24:27], v4, s[8:11], s50 offen sc1
  buffer_load_dwordx4 v[28:31], v4, s[8:11], s51 offen sc1
  buffer_load_dwordx4 v[32:35], v4, s[8:11], s52 offen sc1
  buffer_load_dwordx4 v[36:39], v4, s[8:11], s53 offen sc1
  buffer_load_dwordx4 v[40:43], v4, s[8:11], s54 offen sc1
  buffer_load_dwordx4 v[44:47], v4, s[8:11], s55 offen sc1
L_ch41_p1w:
  s_waitcnt vmcnt(0)
  v_max3_u32 v50, v16, v20, v24
  v_max3_u32 v51, v28, v32, v36
  v_max3_u32 v50, v50, v40, v44
  v_max_u32 v50, v50, v51
  v_cmp_eq_u32 vcc, -1, v50
  v_pk_add_f32 v[16:17], v[16:17], v[20:21]
  v_pk_add_f32 v[18:19], v[18:19], v[22:23]
  v_pk_add_f32 v[24:25], v[24:25], v[28:29]
  v_pk_add_f32 v[26:27], v[26:27], v[30:31]
  v_pk_add_f32 v[32:33], v[32:33], v[36:37]
  v_pk_add_f32 v[34:35], v[34:35], v[38:39]
  v_pk_add_f32 v[40:41], v[40:41], v[44:45]
  v_pk_add_f32 v[42:43], v[42:43], v[46:47]
  v_pk_add_f32 v[16:17], v[16:17], v[24:25]
  v_pk_add_f32 v[18:19], v[18:19], v[26:27]
  v_pk_add_f32 v[32:33], v[32:33], v[40:41]
  v_pk_add_f32 v[34:35], v[34:35], v[42:43]
  v_pk_add_f32 v[16:17], v[16:17], v[32:33]
  v_pk_add_f32 v[18:19], v[18:19], v[34:35]
  s_cbranch_vccnz L_ch41_p1s
L_ch41_p1ok:
  buffer_store_dwordx4 v[16:19], v7, s[8:11], s29 offen sc1
L_ch41_r1skip:
  s_barrier
  s_add_u32 s48, s30, 0
  s_add_u32 s49, s30, 49152
  s_add_u32 s50, s30, 98304
  s_add_u32 s51, s30, 147456
  s_sleep 8
  buffer_load_dwordx4 v[20:23], v4, s[8:11], s48 offen sc1
  buffer_load_dwordx4 v[24:27], v4, s[8:11], s49 offen sc1
  buffer_load_dwordx4 v[28:31], v4, s[8:11], s50 offen sc1
  buffer_load_dwordx4 v[32:35], v4, s[8:11], s51 offen sc1
L_ch41_p2w:
  s_waitcnt vmcnt(0)
  v_max3_u32 v50, v20, v24, v28
  v_max_u32 v50, v50, v32
  v_cmp_eq_u32 vcc, -1, v50
  v_pk_add_f32 v[20:21], v[20:21], v[24:25]
  v_pk_add_f32 v[22:23], v[22:23], v[26:27]
  v_pk_add_f32 v[28:29], v[28:29], v[32:33]
  v_pk_add_f32 v[30:31], v[30:31], v[34:35]
  v_pk_add_f32 v[20:21], v[20:21], v[28:29]
  v_pk_add_f32 v[22:23], v[22:23], v[30:31]
  v_cvt_pk_bf16_f32 v36, v20, v21
  v_cvt_pk_bf16_f32 v37, v22, v23
  s_cbranch_vccnz L_ch41_p2s
L_ch41_p2ok:
  s_nop 0
  v_mov_b32_dpp v38, v36 row_ror:8 row_mask:0xf bank_mask:0xf
  v_mov_b32_dpp v39, v37 row_ror:8 row_mask:0xf bank_mask:0xf
  buffer_store_dwordx4 v[36:39], v12, s[8:11], s31 offen sc1
L_ch41_next:
  s_add_u32 s27, s27, 1
  s_branch L_ch41_loop
L_ch41_p1s:
  s_add_u32 s28, s28, 1
  s_cmp_ge_u32 s28, 262144
  s_cbranch_scc1 L_ch41_p1ok
  buffer_load_dwordx4 v[16:19], v4, s[8:11], s48 offen sc1
  buffer_load_dwordx4 v[20:23], v4, s[8:11], s49 offen sc1
  buffer_load_dwordx4 v[24:27], v4, s[8:11], s50 offen sc1
  buffer_load_dwordx4 v[28:31], v4, s[8:11], s51 offen sc1
  buffer_load_dwordx4 v[32:35], v4, s[8:11], s52 offen sc1
  buffer_load_dwordx4 v[36:39], v4, s[8:11], s53 offen sc1
  buffer_load_dwordx4 v[40:43], v4, s[8:11], s54 offen sc1
  buffer_load_dwordx4 v[44:47], v4, s[8:11], s55 offen sc1
  s_branch L_ch41_p1w
L_ch41_p2s:
  s_add_u32 s28, s28, 1
  s_cmp_ge_u32 s28, 262144
  s_cbranch_scc1 L_ch41_p2ok
  buffer_load_dwordx4 v[20:23], v4, s[8:11], s48 offen sc1
  buffer_load_dwordx4 v[24:27], v4, s[8:11], s49 offen sc1
  buffer_load_dwordx4 v[28:31], v4, s[8:11], s50 offen sc1
  buffer_load_dwordx4 v[32:35], v4, s[8:11], s51 offen sc1
  s_branch L_ch41_p2w
L_ch4_end:
  s_endpgm
L_ch_w7:
  v_lshlrev_b32 v2, 4, v1
  v_lshrrev_b32 v10, 4, v1
  v_lshlrev_b32 v10, 7, v10
  v_and_b32 v11, 7, v1
  v_lshl_add_u32 v10, v11, 4, v10
  v_and_b32 v12, 8, v1
  v_mov_b32 v3, 1073741824
  v_cmp_eq_u32 vcc, 0, v12
  s_nop 1
  v_cndmask_b32 v3, v3, v10, vcc
  s_mul_i32 s33, s6, 10240
  s_lshl_b32 s29, s7, 9
  s_add_u32 s33, s33, s29
  s_add_u32 s33, s33, 65536
  s_sub_u32 s29, s7, 20
  s_cmp_lt_u32 s7, 20
  s_cselect_b32 s29, s7, s29
  s_lshr_b32 s30, s29, 3
  s_lshl_b32 s30, s30, 14
  s_and_b32 s35, s29, 7
  s_lshl_b32 s35, s35, 10
  s_add_u32 s35, s35, s30
  s_add_u32 s29, s29, 12
  s_lshr_b32 s30, s29, 3
  s_lshl_b32 s30, s30, 14
  s_and_b32 s37, s29, 7
  s_lshl_b32 s37, s37, 10
  s_add_u32 s37, s37, s30
  s_mul_i32 s29, s6, 49152
  s_add_u32 s29, s29, 117440512
  s_add_u32 s35, s35, s29
  s_add_u32 s37, s37, s29
  s_cmp_eq_u32 s98, 0
  s_cbranch_scc0 L_ch7_voted
  s_mov_b32 s56, s86
  s_and_b32 s57, s87, 0xffff
  s_mov_b32 s58, 256
  s_mov_b32 s59, 0x20000
  s_mov_b32 s63, 0
  v_mov_b32 v17, 128
  buffer_load_dword v16, v17, s[56:59], 0 offen sc1
  s_sleep 32
  buffer_load_dword v16, v17, s[56:59], 0 offen sc1
  s_sleep 32
  buffer_load_dword v16, v17, s[56:59], 0 offen sc1
  s_sleep 32
  buffer_load_dword v16, v17, s[56:59], 0 offen sc1
  s_sleep 32
  buffer_load_dword v16, v17, s[56:59], 0 offen sc1
  s_sleep 32
  buffer_load_dword v16, v17, s[56:59], 0 offen sc1
  s_waitcnt vmcnt(0)
L_ch7_vote:
  v_readfirstlane_b32 s60, v16
  s_nop 0
  s_cmp_eq_u32 s60, 1
  s_cbranch_scc1 L_ch7_vote_all
  s_cmp_eq_u32 s60, 2
  s_cbranch_scc1 L_ch7_bad
  s_add_u32 s63, s63, 1
  s_cmp_ge_u32 s63, 0x40000
  s_cbranch_scc1 L_ch7_bad
  s_sleep 4
  buffer_load_dword v16, v17, s[56:59], 0 offen sc1
  s_waitcnt vmcnt(0)
  s_branch L_ch7_vote
L_ch7_vote_all:
  v_mov_b32 v16, 1
  v_mov_b32 v17, 163824
  ds_write_b32 v17, v16
  s_branch L_ch7_voted
L_ch7_bad:
  v_mov_b32 v16, 2
  v_mov_b32 v17, 163824
  ds_write_b32 v17, v16
  s_waitcnt lgkmcnt(0)
  s_branch L_ch7_nom0
L_ch7_voted:
  v_mov_b32 v14, 15360
L_ch7_ph:
  buffer_load_dword v15, v14, s[8:11], 0 offen sc1
  s_waitcnt vmcnt(0)
  v_readfirstlane_b32 s29, v15
  s_nop 0
  s_cmp_lg_u32 s29, 0
  s_cbranch_scc1 L_ch7_ph_ok
  s_sleep 4
  s_add_u32 s28, s28, 1
  s_cmp_lt_u32 s28, 262144
  s_cbranch_scc1 L_ch7_ph
L_ch7_ph_ok:
  s_sub_u32 s29, s29, 1
  s_and_b32 s29, s29, 1
  s_lshl_b32 s29, s29, 13
  s_add_u32 s35, s35, s29
  s_add_u32 s37, s37, s29
  s_lshl_b32 s29, s6, 6
  s_add_u32 s29, s29, 14336
  v_mov_b32 v4, 1073741824
  v_cmp_eq_u32 vcc, 0, v1
  v_mov_b32 v10, s29
  s_nop 0
  v_cndmask_b32 v4, v4, v10, vcc
  v_mov_b32 v8, -1
  v_mov_b32 v9, -1
  v_mov_b32 v10, -1
  v_mov_b32 v11, -1
  s_cmp_ge_u32 s7, 20
  s_cbranch_scc1 L_ch7_nom0
  s_mov_b32 s12, s66
  s_and_b32 s13, s67, 0xffff
  s_mov_b32 s14, 10240
  s_mov_b32 s15, 0x20000
  v_and_b32 v12, 7, v1
  v_mul_u32_u24 v12, 1280, v12
  v_bfe_u32 v13, v1, 3, 1
  v_lshl_add_u32 v12, v13, 5, v12
  v_lshrrev_b32 v13, 4, v1
  v_lshl_add_u32 v12, v13, 3, v12
  s_lshl_b32 s29, s7, 6
  buffer_load_dwordx2 v[12:13], v12, s[12:15], s29 offen
  s_waitcnt vmcnt(0)
  v_mov_b32_dpp v14, v12 row_ror:8 row_mask:0xf bank_mask:0xf
  v_mov_b32_dpp v15, v13 row_ror:8 row_mask:0xf bank_mask:0xf
  s_cmp_eq_u32 s5, 0
  s_cbranch_scc0 L_ch7_m0s
  buffer_store_dwordx4 v[12:15], v3, s[8:11], s33 offen
  s_branch L_ch7_nom0
L_ch7_m0s:
  buffer_store_dwordx4 v[12:15], v3, s[8:11], s33 offen sc1
L_ch7_nom0:
  s_waitcnt lgkmcnt(0)
  s_barrier
  s_cmp_eq_u32 s98, 0
  s_cbranch_scc0 L_ch7_vc
  v_mov_b32 v14, 163824
  ds_read_b32 v15, v14
  s_waitcnt lgkmcnt(0)
  v_readfirstlane_b32 s32, v15
  s_nop 0
  s_cmp_eq_u32 s32, 2
  s_cbranch_scc1 L_restart
L_ch7_vc:
  s_cmp_eq_u32 s5, 0
  s_cbranch_scc0 L_ch71_loop
L_ch70_loop:
  s_barrier
  s_waitcnt vmcnt(0)
  s_barrier
  s_cmp_eq_u32 s27, 63
  s_cbranch_scc1 L_ch7_end
  s_barrier
  s_barrier
  s_barrier
  s_barrier
  s_cmp_ge_u32 s7, 20
  s_cbranch_scc1 L_ch70_b3
  s_cmp_eq_u32 s27, 0
  s_cbranch_scc1 L_ch70_b3
  s_add_u32 s29, s27, 0xffffffff
  s_and_b32 s29, s29, 3
  s_mul_i32 s29, s29, 40960
  s_add_u32 s29, s29, s33
  buffer_store_dwordx4 v[8:11], v3, s[8:11], s29 offen
L_ch70_b3:
  s_cmp_lt_u32 s7, 20
  s_cbranch_scc1 L_ch70_win
  s_cmp_lt_u32 s27, 2
  s_cbranch_scc1 L_ch70_win
  s_cmp_eq_u32 s7, 31
  s_cbranch_scc0 L_ch70_nxp
  s_sub_u32 s29, s27, 1
  v_mov_b32 v36, s29
  buffer_store_dword v36, v4, s[8:11], 0 offen sc1
L_ch70_nxp:
  s_add_u32 s29, s27, 0xfffffffe
  s_and_b32 s29, s29, 3
  s_mul_i32 s29, s29, 196608
  s_add_u32 s29, s29, s35
  buffer_store_dwordx4 v[8:11], v2, s[8:11], s29 offen sc1
  s_cmp_lt_u32 s7, 28
  s_cbranch_scc0 L_ch70_win
  s_add_u32 s29, s27, 0xfffffffe
  s_and_b32 s29, s29, 3
  s_mul_i32 s29, s29, 196608
  s_add_u32 s29, s29, s37
  buffer_store_dwordx4 v[8:11], v2, s[8:11], s29 offen sc1
L_ch70_win:
  s_add_u32 s27, s27, 1
  s_branch L_ch70_loop
L_ch71_loop:
  s_barrier
  s_waitcnt vmcnt(0)
  s_barrier
  s_cmp_eq_u32 s27, 63
  s_cbranch_scc1 L_ch7_end
  s_barrier
  s_barrier
  s_barrier
  s_barrier
  s_cmp_ge_u32 s7, 20
  s_cbranch_scc1 L_ch71_b3
  s_cmp_eq_u32 s27, 0
  s_cbranch_scc1 L_ch71_b3
  s_add_u32 s29, s27, 0xffffffff
  s_and_b32 s29, s29, 3
  s_mul_i32 s29, s29, 40960
  s_add_u32 s29, s29, s33
  buffer_store_dwordx4 v[8:11], v3, s[8:11], s29 offen sc1
L_ch71_b3:
  s_cmp_lt_u32 s7, 20
  s_cbranch_scc1 L_ch71_win
  s_cmp_lt_u32 s27, 2
  s_cbranch_scc1 L_ch71_win
  s_cmp_eq_u32 s7, 31
  s_cbranch_scc0 L_ch71_nxp
  s_sub_u32 s29, s27, 1
  v_mov_b32 v36, s29
  buffer_store_dword v36, v4, s[8:11], 0 offen sc1
L_ch71_nxp:
  s_add_u32 s29, s27, 0xfffffffe
  s_and_b32 s29, s29, 3
  s_mul_i32 s29, s29, 196608
  s_add_u32 s29, s29, s35
  buffer_store_dwordx4 v[8:11], v2, s[8:11], s29 offen sc1
  s_cmp_lt_u32 s7, 28
  s_cbranch_scc0 L_ch71_win
  s_add_u32 s29, s27, 0xfffffffe
  s_and_b32 s29, s29, 3
  s_mul_i32 s29, s29, 196608
  s_add_u32 s29, s29, s37
  buffer_store_dwordx4 v[8:11], v2, s[8:11], s29 offen sc1
L_ch71_win:
  s_add_u32 s27, s27, 1
  s_branch L_ch71_loop
L_ch7_end:
  s_cmp_eq_u32 s7, 31
  s_cbranch_scc0 L_ch7_end2
  v_mov_b32 v36, 62
  buffer_store_dword v36, v4, s[8:11], 0 offen sc1
L_ch7_end2:
  s_endpgm
L_qkv:
  s_cmp_lt_u32 s4, 32
  s_cbranch_scc1 L_qkv_now
L_qkv_now:
  s_cmp_eq_u32 s98, 0
  s_cbranch_scc0 L_qkv_vote0_skip
  s_cmp_eq_u32 s3, 0
  s_cbranch_scc0 L_qkv_vote0_w
  s_mov_b32 s56, s86
  s_and_b32 s57, s87, 0xffff
  s_mov_b32 s58, 256
  s_mov_b32 s59, 0x20000
  s_mov_b32 s63, 0
  v_mov_b32 v26, 128
  buffer_load_dword v25, v26, s[56:59], 0 offen sc1
  s_waitcnt vmcnt(0)
L_qkv_vote0:
  v_readfirstlane_b32 s60, v25
  s_nop 0
  s_cmp_eq_u32 s60, 1
  s_cbranch_scc1 L_qkv_vote0_all
  s_cmp_eq_u32 s60, 2
  s_cbranch_scc1 L_qkv_vote0_bad
  s_add_u32 s63, s63, 1
  s_cmp_ge_u32 s63, 0x40000
  s_cbranch_scc1 L_qkv_vote0_bad
  s_sleep 8
  buffer_load_dword v25, v26, s[56:59], 0 offen sc1
  s_waitcnt vmcnt(0)
  s_branch L_qkv_vote0
L_qkv_vote0_all:
  v_mov_b32 v25, 1
  s_branch L_qkv_vote0_pub
L_qkv_vote0_bad:
  v_mov_b32 v25, 2
L_qkv_vote0_pub:
  v_mov_b32 v26, 163824
  ds_write_b32 v26, v25
  s_waitcnt lgkmcnt(0)
L_qkv_vote0_w:
  s_barrier
  v_mov_b32 v26, 163824
  ds_read_b32 v25, v26
  s_waitcnt lgkmcnt(0)
  v_readfirstlane_b32 s60, v25
  s_nop 0
  s_cmp_eq_u32 s60, 2
  s_cbranch_scc1 L_restart
L_qkv_vote0_skip:
L_qkv_nolate:
  s_lshr_b32 s24, s4, 4
  s_and_b32 s25, s4, 15
  s_lshl_b32 s25, s25, 1
  s_lshr_b32 s28, s3, 2
  s_add_u32 s25, s25, s28
  s_and_b32 s26, s3, 3
  s_cmp_eq_u32 s24, 0
  s_cselect_b32 s16, s70, s72
  s_cselect_b32 s17, s71, s73
  s_cmp_eq_u32 s24, 2
  s_cselect_b32 s16, s68, s16
  s_cselect_b32 s17, s69, s17
  s_and_b32 s17, s17, 0xffff
  s_mov_b32 s18, 5242880
  s_mov_b32 s19, 0x20000
  s_mov_b32 s12, s64
  s_and_b32 s13, s65, 0xffff
  s_mov_b32 s14, 2621440
  s_mov_b32 s15, 0x20000
  s_mov_b32 s56, s86
  s_and_b32 s57, s87, 0xffff
  s_mov_b32 s58, 256
  s_mov_b32 s59, 0x20000
  s_mov_b32 s63, 0
  v_mov_b32 v26, 128
  v_mov_b32 v25, 0
  v_lshrrev_b32 v18, 3, v1
  v_lshlrev_b32 v18, 13, v18
  v_and_b32 v19, 7, v1
  v_lshl_or_b32 v18, v19, 4, v18
  s_lshl_b32 s28, s25, 8
  s_and_b32 s29, s26, 2
  s_lshl_b32 s29, s29, 6
  s_add_u32 s28, s28, s29
  s_and_b32 s29, s3, 1
  s_mul_i32 s29, s29, 131072
  s_add_u32 s28, s28, s29
  buffer_load_dwordx4 v[96:99], v18, s[16:19], s28 offen
  s_add_u32 s28, s28, 65536
  buffer_load_dwordx4 v[100:103], v18, s[16:19], s28 offen
  s_add_u32 s28, s28, 196608
  buffer_load_dwordx4 v[104:107], v18, s[16:19], s28 offen
  s_add_u32 s28, s28, 65536
  buffer_load_dwordx4 v[108:111], v18, s[16:19], s28 offen
  s_add_u32 s28, s28, 196608
  buffer_load_dwordx4 v[112:115], v18, s[16:19], s28 offen
  s_add_u32 s28, s28, 65536
  buffer_load_dwordx4 v[116:119], v18, s[16:19], s28 offen
  s_add_u32 s28, s28, 196608
  buffer_load_dwordx4 v[120:123], v18, s[16:19], s28 offen
  s_add_u32 s28, s28, 65536
  buffer_load_dwordx4 v[124:127], v18, s[16:19], s28 offen
  s_add_u32 s28, s28, 196608
  buffer_load_dwordx4 v[128:131], v18, s[16:19], s28 offen
  s_add_u32 s28, s28, 65536
  buffer_load_dwordx4 v[132:135], v18, s[16:19], s28 offen
  s_add_u32 s28, s28, 196608
  buffer_load_dwordx4 v[136:139], v18, s[16:19], s28 offen
  s_add_u32 s28, s28, 65536
  buffer_load_dwordx4 v[140:143], v18, s[16:19], s28 offen
  s_add_u32 s28, s28, 196608
  buffer_load_dwordx4 v[144:147], v18, s[16:19], s28 offen
  s_add_u32 s28, s28, 65536
  buffer_load_dwordx4 v[148:151], v18, s[16:19], s28 offen
  s_add_u32 s28, s28, 196608
  buffer_load_dwordx4 v[152:155], v18, s[16:19], s28 offen
  s_add_u32 s28, s28, 65536
  buffer_load_dwordx4 v[156:159], v18, s[16:19], s28 offen
  s_add_u32 s28, s28, 196608
  buffer_load_dwordx4 v[160:163], v18, s[16:19], s28 offen
  s_add_u32 s28, s28, 65536
  buffer_load_dwordx4 v[164:167], v18, s[16:19], s28 offen
  s_add_u32 s28, s28, 196608
  buffer_load_dwordx4 v[168:171], v18, s[16:19], s28 offen
  s_add_u32 s28, s28, 65536
  buffer_load_dwordx4 v[172:175], v18, s[16:19], s28 offen
  s_add_u32 s28, s28, 196608
  buffer_load_dwordx4 v[176:179], v18, s[16:19], s28 offen
  s_add_u32 s28, s28, 65536
  buffer_load_dwordx4 v[180:183], v18, s[16:19], s28 offen
  s_add_u32 s28, s28, 196608
  buffer_load_dwordx4 v[184:187], v18, s[16:19], s28 offen
  s_add_u32 s28, s28, 65536
  buffer_load_dwordx4 v[188:191], v18, s[16:19], s28 offen
  s_add_u32 s28, s28, 196608
  buffer_load_dwordx4 v[192:195], v18, s[16:19], s28 offen
  s_add_u32 s28, s28, 65536
  buffer_load_dwordx4 v[196:199], v18, s[16:19], s28 offen
  s_add_u32 s28, s28, 196608
  buffer_load_dwordx4 v[200:203], v18, s[16:19], s28 offen
  s_add_u32 s28, s28, 65536
  buffer_load_dwordx4 v[204:207], v18, s[16:19], s28 offen
  s_add_u32 s28, s28, 196608
  buffer_load_dwordx4 v[208:211], v18, s[16:19], s28 offen
  s_add_u32 s28, s28, 65536
  buffer_load_dwordx4 v[212:215], v18, s[16:19], s28 offen
  s_add_u32 s28, s28, 196608
  buffer_load_dwordx4 v[216:219], v18, s[16:19], s28 offen
  s_add_u32 s28, s28, 65536
  buffer_load_dwordx4 v[220:223], v18, s[16:19], s28 offen
  s_add_u32 s28, s28, 196608
  buffer_load_dwordx4 v[224:227], v18, s[16:19], s28 offen
  s_add_u32 s28, s28, 65536
  buffer_load_dwordx4 v[228:231], v18, s[16:19], s28 offen
  s_add_u32 s28, s28, 196608
  buffer_load_dwordx4 v[232:235], v18, s[16:19], s28 offen
  s_add_u32 s28, s28, 65536
  buffer_load_dwordx4 v[236:239], v18, s[16:19], s28 offen
  s_add_u32 s28, s28, 196608
  buffer_load_dwordx4 v[240:243], v18, s[16:19], s28 offen
  s_add_u32 s28, s28, 65536
  buffer_load_dwordx4 v[244:247], v18, s[16:19], s28 offen
  s_add_u32 s28, s28, 196608
  buffer_load_dwordx4 v[248:251], v18, s[16:19], s28 offen
  s_add_u32 s28, s28, 65536
  buffer_load_dwordx4 v[252:255], v18, s[16:19], s28 offen
  s_mul_i32 s29, s3, 320
  s_add_u32 s29, s29, 0
  v_add_u32 v20, s29, v1
  v_mul_u32_u24 v21, 52429, v20
  v_lshrrev_b32 v21, 22, v21
  v_mul_u32_u24 v22, 80, v21
  v_sub_u32 v22, v20, v22
  v_xor_b32 v23, v22, v21
  v_and_b32 v23, 15, v23
  v_and_b32 v22, 0x70, v22
  v_or_b32 v22, v22, v23
  v_mul_u32_u24 v21, 1280, v21
  v_lshl_add_u32 v2, v22, 4, v21
  s_mul_i32 s29, s3, 320
  s_add_u32 s29, s29, 64
  v_add_u32 v20, s29, v1
  v_mul_u32_u24 v21, 52429, v20
  v_lshrrev_b32 v21, 22, v21
  v_mul_u32_u24 v22, 80, v21
  v_sub_u32 v22, v20, v22
  v_xor_b32 v23, v22, v21
  v_and_b32 v23, 15, v23
  v_and_b32 v22, 0x70, v22
  v_or_b32 v22, v22, v23
  v_mul_u32_u24 v21, 1280, v21
  v_lshl_add_u32 v3, v22, 4, v21
  s_mul_i32 s29, s3, 320
  s_add_u32 s29, s29, 128
  v_add_u32 v20, s29, v1
  v_mul_u32_u24 v21, 52429, v20
  v_lshrrev_b32 v21, 22, v21
  v_mul_u32_u24 v22, 80, v21
  v_sub_u32 v22, v20, v22
  v_xor_b32 v23, v22, v21
  v_and_b32 v23, 15, v23
  v_and_b32 v22, 0x70, v22
  v_or_b32 v22, v22, v23
  v_mul_u32_u24 v21, 1280, v21
  v_lshl_add_u32 v4, v22, 4, v21
  s_mul_i32 s29, s3, 320
  s_add_u32 s29, s29, 192
  v_add_u32 v20, s29, v1
  v_mul_u32_u24 v21, 52429, v20
  v_lshrrev_b32 v21, 22, v21
  v_mul_u32_u24 v22, 80, v21
  v_sub_u32 v22, v20, v22
  v_xor_b32 v23, v22, v21
  v_and_b32 v23, 15, v23
  v_and_b32 v22, 0x70, v22
  v_or_b32 v22, v22, v23
  v_mul_u32_u24 v21, 1280, v21
  v_lshl_add_u32 v5, v22, 4, v21
  s_mul_i32 s29, s3, 320
  s_add_u32 s29, s29, 256
  v_add_u32 v20, s29, v1
  v_mul_u32_u24 v21, 52429, v20
  v_lshrrev_b32 v21, 22, v21
  v_mul_u32_u24 v22, 80, v21
  v_sub_u32 v22, v20, v22
  v_xor_b32 v23, v22, v21
  v_and_b32 v23, 15, v23
  v_and_b32 v22, 0x70, v22
  v_or_b32 v22, v22, v23
  v_mul_u32_u24 v21, 1280, v21
  v_lshl_add_u32 v6, v22, 4, v21
  s_mul_i32 s32, s3, 5120
  s_cmp_lt_u32 s24, 2
  s_cselect_b32 s33, 5, 0
  s_mul_i32 s30, s33, 40960
  s_add_u32 m0, s32, 0
  s_nop 0
  buffer_load_dwordx4 v2, s[12:15], s30 offen lds
  s_add_u32 m0, s32, 1024
  s_nop 0
  buffer_load_dwordx4 v3, s[12:15], s30 offen lds
  s_add_u32 m0, s32, 2048
  s_nop 0
  buffer_load_dwordx4 v4, s[12:15], s30 offen lds
  s_add_u32 m0, s32, 3072
  s_nop 0
  buffer_load_dwordx4 v5, s[12:15], s30 offen lds
  s_add_u32 m0, s32, 4096
  s_nop 0
  buffer_load_dwordx4 v6, s[12:15], s30 offen lds
  s_add_u32 s30, s30, 40960
  s_add_u32 m0, s32, 40960
  s_nop 0
  buffer_load_dwordx4 v2, s[12:15], s30 offen lds
  s_add_u32 m0, s32, 41984
  s_nop 0
  buffer_load_dwordx4 v3, s[12:15], s30 offen lds
  s_add_u32 m0, s32, 43008
  s_nop 0
  buffer_load_dwordx4 v4, s[12:15], s30 offen lds
  s_add_u32 m0, s32, 44032
  s_nop 0
  buffer_load_dwordx4 v5, s[12:15], s30 offen lds
  s_add_u32 m0, s32, 45056
  s_nop 0
  buffer_load_dwordx4 v6, s[12:15], s30 offen lds
  v_and_b32 v20, 15, v1
  v_lshrrev_b32 v21, 4, v1
  v_xor_b32 v21, v21, v20
  v_mul_u32_u24 v20, 1280, v20
  v_xor_b32 v22, 0, v21
  v_lshl_add_u32 v8, v22, 4, v20
  v_add_u32 v12, 81920, v8
  v_xor_b32 v22, 4, v21
  v_lshl_add_u32 v9, v22, 4, v20
  v_add_u32 v13, 81920, v9
  v_xor_b32 v22, 8, v21
  v_lshl_add_u32 v10, v22, 4, v20
  v_add_u32 v14, 81920, v10
  v_xor_b32 v22, 12, v21
  v_lshl_add_u32 v11, v22, 4, v20
  v_add_u32 v15, 81920, v11
  s_mul_i32 s28, s24, 16777216
  s_add_u32 s28, s28, 4194304
  s_lshl_b32 s29, s25, 13
  s_add_u32 s28, s28, s29
  s_lshl_b32 s29, s26, 11
  s_add_u32 s28, s28, s29
  v_lshl_add_u32 v16, v1, 4, s28
  s_lshl_b32 s28, s24, 5
  s_add_u32 s28, s28, s25
  s_lshl_b32 s28, s28, 6
  s_lshl_b32 s29, s26, 2
  s_add_u32 s28, s28, s29
  s_add_u32 s28, s28, 0
  v_mov_b32 v17, 1073741824
  v_cmp_eq_u32 vcc, 0, v1
  v_mov_b32 v20, s28
  s_nop 0
  v_cndmask_b32 v17, v17, v20, vcc
  s_lshr_b32 s28, s3, 1
  s_lshl_b32 s28, s28, 13
  s_add_u32 s28, s28, 122880
  s_and_b32 s29, s3, 1
  v_lshrrev_b32 v20, 3, v1
  v_bfe_u32 v21, v20, 1, 1
  v_lshlrev_b32 v21, 1, v21
  v_and_b32 v22, 7, v1
  v_xor_b32 v21, v21, v22
  v_lshlrev_b32 v20, 7, v20
  s_lshl_b32 s29, s29, 11
  s_add_u32 s29, s29, s28
  v_lshl_add_u32 v28, v21, 4, v20
  v_add_u32 v28, s29, v28
  v_xor_b32 v21, 4, v21
  v_lshl_add_u32 v29, v21, 4, v20
  v_add_u32 v29, s29, v29
  v_add_u32 v29, 1024, v29
  v_lshrrev_b32 v20, 4, v1
  v_bfe_u32 v21, v1, 2, 2
  v_lshl_add_u32 v22, v20, 3, v21
  v_lshlrev_b32 v22, 7, v22
  v_add_u32 v22, s28, v22
  v_and_b32 v23, 1, v1
  v_lshl_add_u32 v22, v23, 3, v22
  v_lshrrev_b32 v21, 1, v21
  v_lshlrev_b32 v21, 1, v21
  v_and_b32 v20, 1, v20
  v_lshl_or_b32 v21, v20, 2, v21
  v_bfe_u32 v23, v1, 1, 1
  s_and_b32 s29, s3, 1
  s_lshl_b32 s29, s29, 2
  v_or_b32 v23, s29, v23
  v_xor_b32 v27, v23, v21
  v_lshl_add_u32 v30, v27, 4, v22
  v_or_b32 v23, 2, v23
  v_xor_b32 v27, v23, v21
  v_lshl_add_u32 v31, v27, 4, v22
  s_waitcnt vmcnt(48)
  ds_write_b128 v28, v[96:99] offset:0
  ds_write_b128 v29, v[100:103] offset:0
  s_waitcnt lgkmcnt(0)
  s_barrier
  ds_read_b64_tr_b16 v[96:97], v30 offset:0
  ds_read_b64_tr_b16 v[98:99], v30 offset:512
  ds_read_b64_tr_b16 v[100:101], v31 offset:0
  ds_read_b64_tr_b16 v[102:103], v31 offset:512
  s_waitcnt vmcnt(46)
  ds_write_b128 v28, v[104:107] offset:4096
  ds_write_b128 v29, v[108:111] offset:4096
  s_waitcnt lgkmcnt(0)
  s_barrier
  ds_read_b64_tr_b16 v[104:105], v30 offset:4096
  ds_read_b64_tr_b16 v[106:107], v30 offset:4608
  ds_read_b64_tr_b16 v[108:109], v31 offset:4096
  ds_read_b64_tr_b16 v[110:111], v31 offset:4608
  s_waitcnt vmcnt(44)
  ds_write_b128 v28, v[112:115] offset:0
  ds_write_b128 v29, v[116:119] offset:0
  s_waitcnt lgkmcnt(0)
  s_barrier
  ds_read_b64_tr_b16 v[112:113], v30 offset:0
  ds_read_b64_tr_b16 v[114:115], v30 offset:512
  ds_read_b64_tr_b16 v[116:117], v31 offset:0
  ds_read_b64_tr_b16 v[118:119], v31 offset:512
  s_waitcnt vmcnt(42)
  ds_write_b128 v28, v[120:123] offset:4096
  ds_write_b128 v29, v[124:127] offset:4096
  s_waitcnt lgkmcnt(0)
  s_barrier
  ds_read_b64_tr_b16 v[120:121], v30 offset:4096
  ds_read_b64_tr_b16 v[122:123], v30 offset:4608
  ds_read_b64_tr_b16 v[124:125], v31 offset:4096
  ds_read_b64_tr_b16 v[126:127], v31 offset:4608
  s_waitcnt vmcnt(40)
  ds_write_b128 v28, v[128:131] offset:0
  ds_write_b128 v29, v[132:135] offset:0
  s_waitcnt lgkmcnt(0)
  s_barrier
  ds_read_b64_tr_b16 v[128:129], v30 offset:0
  ds_read_b64_tr_b16 v[130:131], v30 offset:512
  ds_read_b64_tr_b16 v[132:133], v31 offset:0
  ds_read_b64_tr_b16 v[134:135], v31 offset:512
  s_waitcnt vmcnt(38)
  ds_write_b128 v28, v[136:139] offset:4096
  ds_write_b128 v29, v[140:143] offset:4096
  s_waitcnt lgkmcnt(0)
  s_barrier
  ds_read_b64_tr_b16 v[136:137], v30 offset:4096
  ds_read_b64_tr_b16 v[138:139], v30 offset:4608
  ds_read_b64_tr_b16 v[140:141], v31 offset:4096
  ds_read_b64_tr_b16 v[142:143], v31 offset:4608
  s_waitcnt vmcnt(36)
  ds_write_b128 v28, v[144:147] offset:0
  ds_write_b128 v29, v[148:151] offset:0
  s_waitcnt lgkmcnt(0)
  s_barrier
  ds_read_b64_tr_b16 v[144:145], v30 offset:0
  ds_read_b64_tr_b16 v[146:147], v30 offset:512
  ds_read_b64_tr_b16 v[148:149], v31 offset:0
  ds_read_b64_tr_b16 v[150:151], v31 offset:512
  s_waitcnt vmcnt(34)
  ds_write_b128 v28, v[152:155] offset:4096
  ds_write_b128 v29, v[156:159] offset:4096
  s_waitcnt lgkmcnt(0)
  s_barrier
  ds_read_b64_tr_b16 v[152:153], v30 offset:4096
  ds_read_b64_tr_b16 v[154:155], v30 offset:4608
  ds_read_b64_tr_b16 v[156:157], v31 offset:4096
  ds_read_b64_tr_b16 v[158:159], v31 offset:4608
  s_waitcnt vmcnt(32)
  ds_write_b128 v28, v[160:163] offset:0
  ds_write_b128 v29, v[164:167] offset:0
  s_waitcnt lgkmcnt(0)
  s_barrier
  ds_read_b64_tr_b16 v[160:161], v30 offset:0
  ds_read_b64_tr_b16 v[162:163], v30 offset:512
  ds_read_b64_tr_b16 v[164:165], v31 offset:0
  ds_read_b64_tr_b16 v[166:167], v31 offset:512
  s_waitcnt vmcnt(30)
  ds_write_b128 v28, v[168:171] offset:4096
  ds_write_b128 v29, v[172:175] offset:4096
  s_waitcnt lgkmcnt(0)
  s_barrier
  ds_read_b64_tr_b16 v[168:169], v30 offset:4096
  ds_read_b64_tr_b16 v[170:171], v30 offset:4608
  ds_read_b64_tr_b16 v[172:173], v31 offset:4096
  ds_read_b64_tr_b16 v[174:175], v31 offset:4608
  s_waitcnt vmcnt(28)
  ds_write_b128 v28, v[176:179] offset:0
  ds_write_b128 v29, v[180:183] offset:0
  s_waitcnt lgkmcnt(0)
  s_barrier
  ds_read_b64_tr_b16 v[176:177], v30 offset:0
  ds_read_b64_tr_b16 v[178:179], v30 offset:512
  ds_read_b64_tr_b16 v[180:181], v31 offset:0
  ds_read_b64_tr_b16 v[182:183], v31 offset:512
  s_waitcnt vmcnt(26)
  ds_write_b128 v28, v[184:187] offset:4096
  ds_write_b128 v29, v[188:191] offset:4096
  s_waitcnt lgkmcnt(0)
  s_barrier
  ds_read_b64_tr_b16 v[184:185], v30 offset:4096
  ds_read_b64_tr_b16 v[186:187], v30 offset:4608
  ds_read_b64_tr_b16 v[188:189], v31 offset:4096
  ds_read_b64_tr_b16 v[190:191], v31 offset:4608
  s_waitcnt vmcnt(24)
  ds_write_b128 v28, v[192:195] offset:0
  ds_write_b128 v29, v[196:199] offset:0
  s_waitcnt lgkmcnt(0)
  s_barrier
  ds_read_b64_tr_b16 v[192:193], v30 offset:0
  ds_read_b64_tr_b16 v[194:195], v30 offset:512
  ds_read_b64_tr_b16 v[196:197], v31 offset:0
  ds_read_b64_tr_b16 v[198:199], v31 offset:512
  s_waitcnt vmcnt(22)
  ds_write_b128 v28, v[200:203] offset:4096
  ds_write_b128 v29, v[204:207] offset:4096
  s_waitcnt lgkmcnt(0)
  s_barrier
  ds_read_b64_tr_b16 v[200:201], v30 offset:4096
  ds_read_b64_tr_b16 v[202:203], v30 offset:4608
  ds_read_b64_tr_b16 v[204:205], v31 offset:4096
  ds_read_b64_tr_b16 v[206:207], v31 offset:4608
  s_waitcnt vmcnt(20)
  ds_write_b128 v28, v[208:211] offset:0
  ds_write_b128 v29, v[212:215] offset:0
  s_waitcnt lgkmcnt(0)
  s_barrier
  ds_read_b64_tr_b16 v[208:209], v30 offset:0
  ds_read_b64_tr_b16 v[210:211], v30 offset:512
  ds_read_b64_tr_b16 v[212:213], v31 offset:0
  ds_read_b64_tr_b16 v[214:215], v31 offset:512
  s_waitcnt vmcnt(18)
  ds_write_b128 v28, v[216:219] offset:4096
  ds_write_b128 v29, v[220:223] offset:4096
  s_waitcnt lgkmcnt(0)
  s_barrier
  ds_read_b64_tr_b16 v[216:217], v30 offset:4096
  ds_read_b64_tr_b16 v[218:219], v30 offset:4608
  ds_read_b64_tr_b16 v[220:221], v31 offset:4096
  ds_read_b64_tr_b16 v[222:223], v31 offset:4608
  s_waitcnt vmcnt(16)
  ds_write_b128 v28, v[224:227] offset:0
  ds_write_b128 v29, v[228:231] offset:0
  s_waitcnt lgkmcnt(0)
  s_barrier
  ds_read_b64_tr_b16 v[224:225], v30 offset:0
  ds_read_b64_tr_b16 v[226:227], v30 offset:512
  ds_read_b64_tr_b16 v[228:229], v31 offset:0
  ds_read_b64_tr_b16 v[230:231], v31 offset:512
  s_waitcnt vmcnt(14)
  ds_write_b128 v28, v[232:235] offset:4096
  ds_write_b128 v29, v[236:239] offset:4096
  s_waitcnt lgkmcnt(0)
  s_barrier
  ds_read_b64_tr_b16 v[232:233], v30 offset:4096
  ds_read_b64_tr_b16 v[234:235], v30 offset:4608
  ds_read_b64_tr_b16 v[236:237], v31 offset:4096
  ds_read_b64_tr_b16 v[238:239], v31 offset:4608
  s_waitcnt vmcnt(12)
  ds_write_b128 v28, v[240:243] offset:0
  ds_write_b128 v29, v[244:247] offset:0
  s_waitcnt lgkmcnt(0)
  s_barrier
  ds_read_b64_tr_b16 v[240:241], v30 offset:0
  ds_read_b64_tr_b16 v[242:243], v30 offset:512
  ds_read_b64_tr_b16 v[244:245], v31 offset:0
  ds_read_b64_tr_b16 v[246:247], v31 offset:512
  s_waitcnt vmcnt(10)
  ds_write_b128 v28, v[248:251] offset:4096
  ds_write_b128 v29, v[252:255] offset:4096
  s_waitcnt lgkmcnt(0)
  s_barrier
  ds_read_b64_tr_b16 v[248:249], v30 offset:4096
  ds_read_b64_tr_b16 v[250:251], v30 offset:4608
  ds_read_b64_tr_b16 v[252:253], v31 offset:4096
  ds_read_b64_tr_b16 v[254:255], v31 offset:4608
  s_waitcnt lgkmcnt(0) vmcnt(0)
  s_barrier
  ds_read_b128 v[56:59], v8 offset:0
  ds_read_b128 v[60:63], v8 offset:20480
  ds_read_b128 v[64:67], v9 offset:0
  ds_read_b128 v[68:71], v9 offset:20480
  s_mov_b32 s27, s33
  s_cmp_eq_u32 s24, 1
  s_cbranch_scc1 L_qkv_o1_loop
L_qkv_o0_loop:
  s_waitcnt lgkmcnt(3)
  v_mfma_f32_16x16x32_bf16 v[80:83], v[96:99], v[56:59], 0
  v_mfma_f32_16x16x32_bf16 v[84:87], v[100:103], v[56:59], 0
  ds_read_b128 v[72:75], v10 offset:0
  s_waitcnt lgkmcnt(3)
  v_mfma_f32_16x16x32_bf16 v[88:91], v[96:99], v[60:63], 0
  v_mfma_f32_16x16x32_bf16 v[92:95], v[100:103], v[60:63], 0
  ds_read_b128 v[76:79], v10 offset:20480
  s_waitcnt lgkmcnt(3)
  v_mfma_f32_16x16x32_bf16 v[80:83], v[104:107], v[64:67], v[80:83]
  v_mfma_f32_16x16x32_bf16 v[84:87], v[108:111], v[64:67], v[84:87]
  ds_read_b128 v[56:59], v11 offset:0
  s_waitcnt lgkmcnt(3)
  v_mfma_f32_16x16x32_bf16 v[88:91], v[104:107], v[68:71], v[88:91]
  v_mfma_f32_16x16x32_bf16 v[92:95], v[108:111], v[68:71], v[92:95]
  ds_read_b128 v[60:63], v11 offset:20480
  s_waitcnt lgkmcnt(3)
  v_mfma_f32_16x16x32_bf16 v[80:83], v[112:115], v[72:75], v[80:83]
  v_mfma_f32_16x16x32_bf16 v[84:87], v[116:119], v[72:75], v[84:87]
  ds_read_b128 v[64:67], v8 offset:256
  s_sub_u32 s28, s27, s33
  s_or_b32 s28, s28, s98
  s_cmp_eq_u32 s28, 0
  s_cbranch_scc0 L_qkv_o0a_nv
  buffer_load_dword v25, v26, s[56:59], 0 offen sc1
L_qkv_o0a_nv:
  s_waitcnt lgkmcnt(3)
  v_mfma_f32_16x16x32_bf16 v[88:91], v[112:115], v[76:79], v[88:91]
  v_mfma_f32_16x16x32_bf16 v[92:95], v[116:119], v[76:79], v[92:95]
  ds_read_b128 v[68:71], v8 offset:20736
  s_waitcnt lgkmcnt(3)
  v_mfma_f32_16x16x32_bf16 v[80:83], v[120:123], v[56:59], v[80:83]
  v_mfma_f32_16x16x32_bf16 v[84:87], v[124:127], v[56:59], v[84:87]
  ds_read_b128 v[72:75], v9 offset:256
  s_waitcnt lgkmcnt(3)
  v_mfma_f32_16x16x32_bf16 v[88:91], v[120:123], v[60:63], v[88:91]
  v_mfma_f32_16x16x32_bf16 v[92:95], v[124:127], v[60:63], v[92:95]
  ds_read_b128 v[76:79], v9 offset:20736
  s_waitcnt lgkmcnt(3)
  v_mfma_f32_16x16x32_bf16 v[80:83], v[128:131], v[64:67], v[80:83]
  v_mfma_f32_16x16x32_bf16 v[84:87], v[132:135], v[64:67], v[84:87]
  ds_read_b128 v[56:59], v10 offset:256
  s_waitcnt lgkmcnt(3)
  v_mfma_f32_16x16x32_bf16 v[88:91], v[128:131], v[68:71], v[88:91]
  v_mfma_f32_16x16x32_bf16 v[92:95], v[132:135], v[68:71], v[92:95]
  ds_read_b128 v[60:63], v10 offset:20736
  s_waitcnt lgkmcnt(3)
  v_mfma_f32_16x16x32_bf16 v[80:83], v[136:139], v[72:75], v[80:83]
  v_mfma_f32_16x16x32_bf16 v[84:87], v[140:143], v[72:75], v[84:87]
  ds_read_b128 v[64:67], v11 offset:256
  s_waitcnt lgkmcnt(3)
  v_mfma_f32_16x16x32_bf16 v[88:91], v[136:139], v[76:79], v[88:91]
  v_mfma_f32_16x16x32_bf16 v[92:95], v[140:143], v[76:79], v[92:95]
  ds_read_b128 v[68:71], v11 offset:20736
  s_waitcnt lgkmcnt(3)
  v_mfma_f32_16x16x32_bf16 v[80:83], v[144:147], v[56:59], v[80:83]
  v_mfma_f32_16x16x32_bf16 v[84:87], v[148:151], v[56:59], v[84:87]
  ds_read_b128 v[72:75], v8 offset:512
  s_waitcnt lgkmcnt(3)
  v_mfma_f32_16x16x32_bf16 v[88:91], v[144:147], v[60:63], v[88:91]
  v_mfma_f32_16x16x32_bf16 v[92:95], v[148:151], v[60:63], v[92:95]
  ds_read_b128 v[76:79], v8 offset:20992
  s_waitcnt lgkmcnt(3)
  v_mfma_f32_16x16x32_bf16 v[80:83], v[152:155], v[64:67], v[80:83]
  v_mfma_f32_16x16x32_bf16 v[84:87], v[156:159], v[64:67], v[84:87]
  ds_read_b128 v[56:59], v9 offset:512
  s_waitcnt lgkmcnt(3)
  v_mfma_f32_16x16x32_bf16 v[88:91], v[152:155], v[68:71], v[88:91]
  v_mfma_f32_16x16x32_bf16 v[92:95], v[156:159], v[68:71], v[92:95]
  ds_read_b128 v[60:63], v9 offset:20992
  s_waitcnt vmcnt(3)
  s_barrier
  s_add_u32 s30, s30, 40960
  s_waitcnt lgkmcnt(3)
  v_mfma_f32_16x16x32_bf16 v[80:83], v[160:163], v[72:75], v[80:83]
  v_mfma_f32_16x16x32_bf16 v[84:87], v[164:167], v[72:75], v[84:87]
  ds_read_b128 v[64:67], v10 offset:512
  s_cmp_ge_u32 s27, 62
  s_cbranch_scc1 L_qkv_o0a_nd16
  s_add_u32 m0, s32, 81920
  s_nop 0
  buffer_load_dwordx4 v2, s[12:15], s30 offen lds
L_qkv_o0a_nd16:
  s_waitcnt lgkmcnt(3)
  v_mfma_f32_16x16x32_bf16 v[88:91], v[160:163], v[76:79], v[88:91]
  v_mfma_f32_16x16x32_bf16 v[92:95], v[164:167], v[76:79], v[92:95]
  ds_read_b128 v[68:71], v10 offset:20992
  s_cmp_ge_u32 s27, 62
  s_cbranch_scc1 L_qkv_o0a_nd17
  s_add_u32 m0, s32, 82944
  s_nop 0
  buffer_load_dwordx4 v3, s[12:15], s30 offen lds
L_qkv_o0a_nd17:
  s_waitcnt lgkmcnt(3)
  v_mfma_f32_16x16x32_bf16 v[80:83], v[168:171], v[56:59], v[80:83]
  v_mfma_f32_16x16x32_bf16 v[84:87], v[172:175], v[56:59], v[84:87]
  ds_read_b128 v[72:75], v11 offset:512
  s_cmp_ge_u32 s27, 62
  s_cbranch_scc1 L_qkv_o0a_nd18
  s_add_u32 m0, s32, 83968
  s_nop 0
  buffer_load_dwordx4 v4, s[12:15], s30 offen lds
L_qkv_o0a_nd18:
  s_waitcnt lgkmcnt(3)
  v_mfma_f32_16x16x32_bf16 v[88:91], v[168:171], v[60:63], v[88:91]
  v_mfma_f32_16x16x32_bf16 v[92:95], v[172:175], v[60:63], v[92:95]
  ds_read_b128 v[76:79], v11 offset:20992
  s_cmp_ge_u32 s27, 62
  s_cbranch_scc1 L_qkv_o0a_nd19
  s_add_u32 m0, s32, 84992
  s_nop 0
  buffer_load_dwordx4 v5, s[12:15], s30 offen lds
L_qkv_o0a_nd19:
  s_waitcnt lgkmcnt(3)
  v_mfma_f32_16x16x32_bf16 v[80:83], v[176:179], v[64:67], v[80:83]
  v_mfma_f32_16x16x32_bf16 v[84:87], v[180:183], v[64:67], v[84:87]
  ds_read_b128 v[56:59], v8 offset:768
  s_cmp_ge_u32 s27, 62
  s_cbranch_scc1 L_qkv_o0a_nd20
  s_add_u32 m0, s32, 86016
  s_nop 0
  buffer_load_dwordx4 v6, s[12:15], s30 offen lds
L_qkv_o0a_nd20:
  s_waitcnt lgkmcnt(3)
  v_mfma_f32_16x16x32_bf16 v[88:91], v[176:179], v[68:71], v[88:91]
  v_mfma_f32_16x16x32_bf16 v[92:95], v[180:183], v[68:71], v[92:95]
  ds_read_b128 v[60:63], v8 offset:21248
  s_waitcnt lgkmcnt(3)
  v_mfma_f32_16x16x32_bf16 v[80:83], v[184:187], v[72:75], v[80:83]
  v_mfma_f32_16x16x32_bf16 v[84:87], v[188:191], v[72:75], v[84:87]
  ds_read_b128 v[64:67], v9 offset:768
  s_waitcnt lgkmcnt(3)
  v_mfma_f32_16x16x32_bf16 v[88:91], v[184:187], v[76:79], v[88:91]
  v_mfma_f32_16x16x32_bf16 v[92:95], v[188:191], v[76:79], v[92:95]
  ds_read_b128 v[68:71], v9 offset:21248
  s_waitcnt lgkmcnt(3)
  v_mfma_f32_16x16x32_bf16 v[80:83], v[192:195], v[56:59], v[80:83]
  v_mfma_f32_16x16x32_bf16 v[84:87], v[196:199], v[56:59], v[84:87]
  ds_read_b128 v[72:75], v10 offset:768
  s_waitcnt lgkmcnt(3)
  v_mfma_f32_16x16x32_bf16 v[88:91], v[192:195], v[60:63], v[88:91]
  v_mfma_f32_16x16x32_bf16 v[92:95], v[196:199], v[60:63], v[92:95]
  ds_read_b128 v[76:79], v10 offset:21248
  s_waitcnt lgkmcnt(3)
  v_mfma_f32_16x16x32_bf16 v[80:83], v[200:203], v[64:67], v[80:83]
  v_mfma_f32_16x16x32_bf16 v[84:87], v[204:207], v[64:67], v[84:87]
  ds_read_b128 v[56:59], v11 offset:768
  s_waitcnt lgkmcnt(3)
  v_mfma_f32_16x16x32_bf16 v[88:91], v[200:203], v[68:71], v[88:91]
  v_mfma_f32_16x16x32_bf16 v[92:95], v[204:207], v[68:71], v[92:95]
  ds_read_b128 v[60:63], v11 offset:21248
  s_waitcnt lgkmcnt(3)
  v_mfma_f32_16x16x32_bf16 v[80:83], v[208:211], v[72:75], v[80:83]
  v_mfma_f32_16x16x32_bf16 v[84:87], v[212:215], v[72:75], v[84:87]
  ds_read_b128 v[64:67], v8 offset:1024
  s_waitcnt lgkmcnt(3)
  v_mfma_f32_16x16x32_bf16 v[88:91], v[208:211], v[76:79], v[88:91]
  v_mfma_f32_16x16x32_bf16 v[92:95], v[212:215], v[76:79], v[92:95]
  ds_read_b128 v[68:71], v8 offset:21504
  s_waitcnt lgkmcnt(3)
  v_mfma_f32_16x16x32_bf16 v[80:83], v[216:219], v[56:59], v[80:83]
  v_mfma_f32_16x16x32_bf16 v[84:87], v[220:223], v[56:59], v[84:87]
  ds_read_b128 v[72:75], v9 offset:1024
  s_cmp_ge_u32 s27, 62
  s_cbranch_scc1 L_qkv_o0a_w0
  s_waitcnt vmcnt(5)
  s_branch L_qkv_o0a_w1
L_qkv_o0a_w0:
  s_waitcnt vmcnt(0)
L_qkv_o0a_w1:
  v_mov_b32 v27, 1073741824
  s_cmp_eq_u32 s27, s33
  s_cselect_b64 vcc, -1, 0
  v_mov_b32 v24, s27
  v_cndmask_b32 v27, v17, v27, vcc
  buffer_store_dword v24, v27, s[8:11], 0 offen sc1
  s_waitcnt lgkmcnt(3)
  v_mfma_f32_16x16x32_bf16 v[88:91], v[216:219], v[60:63], v[88:91]
  v_mfma_f32_16x16x32_bf16 v[92:95], v[220:223], v[60:63], v[92:95]
  ds_read_b128 v[76:79], v9 offset:21504
  s_waitcnt lgkmcnt(3)
  v_mfma_f32_16x16x32_bf16 v[80:83], v[224:227], v[64:67], v[80:83]
  v_mfma_f32_16x16x32_bf16 v[84:87], v[228:231], v[64:67], v[84:87]
  ds_read_b128 v[56:59], v10 offset:1024
  s_waitcnt lgkmcnt(3)
  v_mfma_f32_16x16x32_bf16 v[88:91], v[224:227], v[68:71], v[88:91]
  v_mfma_f32_16x16x32_bf16 v[92:95], v[228:231], v[68:71], v[92:95]
  ds_read_b128 v[60:63], v10 offset:21504
  s_waitcnt lgkmcnt(3)
  v_mfma_f32_16x16x32_bf16 v[80:83], v[232:235], v[72:75], v[80:83]
  v_mfma_f32_16x16x32_bf16 v[84:87], v[236:239], v[72:75], v[84:87]
  ds_read_b128 v[64:67], v11 offset:1024
  s_waitcnt lgkmcnt(3)
  v_mfma_f32_16x16x32_bf16 v[88:91], v[232:235], v[76:79], v[88:91]
  v_mfma_f32_16x16x32_bf16 v[92:95], v[236:239], v[76:79], v[92:95]
  ds_read_b128 v[68:71], v11 offset:21504
  s_waitcnt lgkmcnt(3)
  v_mfma_f32_16x16x32_bf16 v[80:83], v[240:243], v[56:59], v[80:83]
  v_mfma_f32_16x16x32_bf16 v[84:87], v[244:247], v[56:59], v[84:87]
  ds_read_b128 v[72:75], v8 offset:40960
  s_waitcnt lgkmcnt(3)
  v_mfma_f32_16x16x32_bf16 v[88:91], v[240:243], v[60:63], v[88:91]
  v_mfma_f32_16x16x32_bf16 v[92:95], v[244:247], v[60:63], v[92:95]
  ds_read_b128 v[76:79], v8 offset:61440
  s_waitcnt lgkmcnt(3)
  v_mfma_f32_16x16x32_bf16 v[80:83], v[248:251], v[64:67], v[80:83]
  v_mfma_f32_16x16x32_bf16 v[84:87], v[252:255], v[64:67], v[84:87]
  ds_read_b128 v[56:59], v9 offset:40960
  s_waitcnt lgkmcnt(3)
  v_mfma_f32_16x16x32_bf16 v[88:91], v[248:251], v[68:71], v[88:91]
  v_mfma_f32_16x16x32_bf16 v[92:95], v[252:255], v[68:71], v[92:95]
  ds_read_b128 v[60:63], v9 offset:61440
  s_sub_u32 s28, s27, s33
  s_or_b32 s28, s28, s98
  s_cmp_eq_u32 s28, 0
  s_cbranch_scc0 L_qkv_o0a_ne
L_qkv_o0a_vote:
  v_readfirstlane_b32 s60, v25
  s_nop 0
  s_cmp_eq_u32 s60, 1
  s_cbranch_scc1 L_qkv_o0a_vote_all
  s_cmp_eq_u32 s60, 2
  s_cbranch_scc1 L_restart
  s_add_u32 s63, s63, 1
  s_cmp_ge_u32 s63, 0x40000
  s_cbranch_scc1 L_restart
  s_sleep 4
  buffer_load_dword v25, v26, s[56:59], 0 offen sc1
  s_waitcnt vmcnt(0)
  s_branch L_qkv_o0a_vote
L_qkv_o0a_vote_all:
L_qkv_o0a_ne:
  s_lshl_b32 s31, s27, 18
  s_add_u32 s27, s27, 1
  s_nop 4
  v_cvt_pk_bf16_f32 v48, v80, v81
  v_cvt_pk_bf16_f32 v49, v82, v83
  v_cvt_pk_bf16_f32 v50, v84, v85
  v_cvt_pk_bf16_f32 v51, v86, v87
  v_cvt_pk_bf16_f32 v52, v88, v89
  v_cvt_pk_bf16_f32 v53, v90, v91
  v_cvt_pk_bf16_f32 v54, v92, v93
  v_cvt_pk_bf16_f32 v55, v94, v95
  buffer_store_dwordx4 v[48:51], v16, s[8:11], s31 offen sc1
  buffer_store_dwordx4 v[52:55], v16, s[8:11], s31 offen offset:1024 sc1
  s_add_u32 s28, s33, 1
  s_cmp_eq_u32 s27, s28
  s_cbranch_scc0 L_qkv_o0a_nf
  s_mov_b32 s63, 0
L_qkv_o0a_bw:
  buffer_load_dword v27, v17, s[8:11], 0 offen sc1
  s_waitcnt vmcnt(0)
  v_readfirstlane_b32 s29, v27
  s_nop 0
  s_cmp_ge_u32 s29, s33
  s_cbranch_scc1 L_qkv_o0a_bok
  s_sleep 4
  s_add_u32 s63, s63, 1
  s_cmp_lt_u32 s63, 0x40000
  s_cbranch_scc1 L_qkv_o0a_bw
L_qkv_o0a_bok:
  v_mov_b32 v24, s27
  buffer_store_dword v24, v17, s[8:11], 0 offen sc1
L_qkv_o0a_nf:
  s_cmp_ge_u32 s27, 64
  s_cbranch_scc1 L_qkv_exit
  s_waitcnt lgkmcnt(3)
  v_mfma_f32_16x16x32_bf16 v[80:83], v[96:99], v[72:75], 0
  v_mfma_f32_16x16x32_bf16 v[84:87], v[100:103], v[72:75], 0
  ds_read_b128 v[64:67], v10 offset:40960
  s_waitcnt lgkmcnt(3)
  v_mfma_f32_16x16x32_bf16 v[88:91], v[96:99], v[76:79], 0
  v_mfma_f32_16x16x32_bf16 v[92:95], v[100:103], v[76:79], 0
  ds_read_b128 v[68:71], v10 offset:61440
  s_waitcnt lgkmcnt(3)
  v_mfma_f32_16x16x32_bf16 v[80:83], v[104:107], v[56:59], v[80:83]
  v_mfma_f32_16x16x32_bf16 v[84:87], v[108:111], v[56:59], v[84:87]
  ds_read_b128 v[72:75], v11 offset:40960
  s_waitcnt lgkmcnt(3)
  v_mfma_f32_16x16x32_bf16 v[88:91], v[104:107], v[60:63], v[88:91]
  v_mfma_f32_16x16x32_bf16 v[92:95], v[108:111], v[60:63], v[92:95]
  ds_read_b128 v[76:79], v11 offset:61440
  s_waitcnt lgkmcnt(3)
  v_mfma_f32_16x16x32_bf16 v[80:83], v[112:115], v[64:67], v[80:83]
  v_mfma_f32_16x16x32_bf16 v[84:87], v[116:119], v[64:67], v[84:87]
  ds_read_b128 v[56:59], v8 offset:41216
  s_waitcnt lgkmcnt(3)
  v_mfma_f32_16x16x32_bf16 v[88:91], v[112:115], v[68:71], v[88:91]
  v_mfma_f32_16x16x32_bf16 v[92:95], v[116:119], v[68:71], v[92:95]
  ds_read_b128 v[60:63], v8 offset:61696
  s_waitcnt lgkmcnt(3)
  v_mfma_f32_16x16x32_bf16 v[80:83], v[120:123], v[72:75], v[80:83]
  v_mfma_f32_16x16x32_bf16 v[84:87], v[124:127], v[72:75], v[84:87]
  ds_read_b128 v[64:67], v9 offset:41216
  s_waitcnt lgkmcnt(3)
  v_mfma_f32_16x16x32_bf16 v[88:91], v[120:123], v[76:79], v[88:91]
  v_mfma_f32_16x16x32_bf16 v[92:95], v[124:127], v[76:79], v[92:95]
  ds_read_b128 v[68:71], v9 offset:61696
  s_waitcnt lgkmcnt(3)
  v_mfma_f32_16x16x32_bf16 v[80:83], v[128:131], v[56:59], v[80:83]
  v_mfma_f32_16x16x32_bf16 v[84:87], v[132:135], v[56:59], v[84:87]
  ds_read_b128 v[72:75], v10 offset:41216
  s_waitcnt lgkmcnt(3)
  v_mfma_f32_16x16x32_bf16 v[88:91], v[128:131], v[60:63], v[88:91]
  v_mfma_f32_16x16x32_bf16 v[92:95], v[132:135], v[60:63], v[92:95]
  ds_read_b128 v[76:79], v10 offset:61696
  s_waitcnt lgkmcnt(3)
  v_mfma_f32_16x16x32_bf16 v[80:83], v[136:139], v[64:67], v[80:83]
  v_mfma_f32_16x16x32_bf16 v[84:87], v[140:143], v[64:67], v[84:87]
  ds_read_b128 v[56:59], v11 offset:41216
  s_waitcnt lgkmcnt(3)
  v_mfma_f32_16x16x32_bf16 v[88:91], v[136:139], v[68:71], v[88:91]
  v_mfma_f32_16x16x32_bf16 v[92:95], v[140:143], v[68:71], v[92:95]
  ds_read_b128 v[60:63], v11 offset:61696
  s_waitcnt lgkmcnt(3)
  v_mfma_f32_16x16x32_bf16 v[80:83], v[144:147], v[72:75], v[80:83]
  v_mfma_f32_16x16x32_bf16 v[84:87], v[148:151], v[72:75], v[84:87]
  ds_read_b128 v[64:67], v8 offset:41472
  s_waitcnt lgkmcnt(3)
  v_mfma_f32_16x16x32_bf16 v[88:91], v[144:147], v[76:79], v[88:91]
  v_mfma_f32_16x16x32_bf16 v[92:95], v[148:151], v[76:79], v[92:95]
  ds_read_b128 v[68:71], v8 offset:61952
  s_waitcnt lgkmcnt(3)
  v_mfma_f32_16x16x32_bf16 v[80:83], v[152:155], v[56:59], v[80:83]
  v_mfma_f32_16x16x32_bf16 v[84:87], v[156:159], v[56:59], v[84:87]
  ds_read_b128 v[72:75], v9 offset:41472
  s_waitcnt lgkmcnt(3)
  v_mfma_f32_16x16x32_bf16 v[88:91], v[152:155], v[60:63], v[88:91]
  v_mfma_f32_16x16x32_bf16 v[92:95], v[156:159], v[60:63], v[92:95]
  ds_read_b128 v[76:79], v9 offset:61952
  s_waitcnt vmcnt(3)
  s_barrier
  s_add_u32 s30, s30, 40960
  s_waitcnt lgkmcnt(3)
  v_mfma_f32_16x16x32_bf16 v[80:83], v[160:163], v[64:67], v[80:83]
  v_mfma_f32_16x16x32_bf16 v[84:87], v[164:167], v[64:67], v[84:87]
  ds_read_b128 v[56:59], v10 offset:41472
  s_cmp_ge_u32 s27, 62
  s_cbranch_scc1 L_qkv_o0b_nd16
  s_add_u32 m0, s32, 0
  s_nop 0
  buffer_load_dwordx4 v2, s[12:15], s30 offen lds
L_qkv_o0b_nd16:
  s_waitcnt lgkmcnt(3)
  v_mfma_f32_16x16x32_bf16 v[88:91], v[160:163], v[68:71], v[88:91]
  v_mfma_f32_16x16x32_bf16 v[92:95], v[164:167], v[68:71], v[92:95]
  ds_read_b128 v[60:63], v10 offset:61952
  s_cmp_ge_u32 s27, 62
  s_cbranch_scc1 L_qkv_o0b_nd17
  s_add_u32 m0, s32, 1024
  s_nop 0
  buffer_load_dwordx4 v3, s[12:15], s30 offen lds
L_qkv_o0b_nd17:
  s_waitcnt lgkmcnt(3)
  v_mfma_f32_16x16x32_bf16 v[80:83], v[168:171], v[72:75], v[80:83]
  v_mfma_f32_16x16x32_bf16 v[84:87], v[172:175], v[72:75], v[84:87]
  ds_read_b128 v[64:67], v11 offset:41472
  s_cmp_ge_u32 s27, 62
  s_cbranch_scc1 L_qkv_o0b_nd18
  s_add_u32 m0, s32, 2048
  s_nop 0
  buffer_load_dwordx4 v4, s[12:15], s30 offen lds
L_qkv_o0b_nd18:
  s_waitcnt lgkmcnt(3)
  v_mfma_f32_16x16x32_bf16 v[88:91], v[168:171], v[76:79], v[88:91]
  v_mfma_f32_16x16x32_bf16 v[92:95], v[172:175], v[76:79], v[92:95]
  ds_read_b128 v[68:71], v11 offset:61952
  s_cmp_ge_u32 s27, 62
  s_cbranch_scc1 L_qkv_o0b_nd19
  s_add_u32 m0, s32, 3072
  s_nop 0
  buffer_load_dwordx4 v5, s[12:15], s30 offen lds
L_qkv_o0b_nd19:
  s_waitcnt lgkmcnt(3)
  v_mfma_f32_16x16x32_bf16 v[80:83], v[176:179], v[56:59], v[80:83]
  v_mfma_f32_16x16x32_bf16 v[84:87], v[180:183], v[56:59], v[84:87]
  ds_read_b128 v[72:75], v8 offset:41728
  s_cmp_ge_u32 s27, 62
  s_cbranch_scc1 L_qkv_o0b_nd20
  s_add_u32 m0, s32, 4096
  s_nop 0
  buffer_load_dwordx4 v6, s[12:15], s30 offen lds
L_qkv_o0b_nd20:
  s_waitcnt lgkmcnt(3)
  v_mfma_f32_16x16x32_bf16 v[88:91], v[176:179], v[60:63], v[88:91]
  v_mfma_f32_16x16x32_bf16 v[92:95], v[180:183], v[60:63], v[92:95]
  ds_read_b128 v[76:79], v8 offset:62208
  s_waitcnt lgkmcnt(3)
  v_mfma_f32_16x16x32_bf16 v[80:83], v[184:187], v[64:67], v[80:83]
  v_mfma_f32_16x16x32_bf16 v[84:87], v[188:191], v[64:67], v[84:87]
  ds_read_b128 v[56:59], v9 offset:41728
  s_waitcnt lgkmcnt(3)
  v_mfma_f32_16x16x32_bf16 v[88:91], v[184:187], v[68:71], v[88:91]
  v_mfma_f32_16x16x32_bf16 v[92:95], v[188:191], v[68:71], v[92:95]
  ds_read_b128 v[60:63], v9 offset:62208
  s_waitcnt lgkmcnt(3)
  v_mfma_f32_16x16x32_bf16 v[80:83], v[192:195], v[72:75], v[80:83]
  v_mfma_f32_16x16x32_bf16 v[84:87], v[196:199], v[72:75], v[84:87]
  ds_read_b128 v[64:67], v10 offset:41728
  s_waitcnt lgkmcnt(3)
  v_mfma_f32_16x16x32_bf16 v[88:91], v[192:195], v[76:79], v[88:91]
  v_mfma_f32_16x16x32_bf16 v[92:95], v[196:199], v[76:79], v[92:95]
  ds_read_b128 v[68:71], v10 offset:62208
  s_waitcnt lgkmcnt(3)
  v_mfma_f32_16x16x32_bf16 v[80:83], v[200:203], v[56:59], v[80:83]
  v_mfma_f32_16x16x32_bf16 v[84:87], v[204:207], v[56:59], v[84:87]
  ds_read_b128 v[72:75], v11 offset:41728
  s_waitcnt lgkmcnt(3)
  v_mfma_f32_16x16x32_bf16 v[88:91], v[200:203], v[60:63], v[88:91]
  v_mfma_f32_16x16x32_bf16 v[92:95], v[204:207], v[60:63], v[92:95]
  ds_read_b128 v[76:79], v11 offset:62208
  s_waitcnt lgkmcnt(3)
  v_mfma_f32_16x16x32_bf16 v[80:83], v[208:211], v[64:67], v[80:83]
  v_mfma_f32_16x16x32_bf16 v[84:87], v[212:215], v[64:67], v[84:87]
  ds_read_b128 v[56:59], v8 offset:41984
  s_waitcnt lgkmcnt(3)
  v_mfma_f32_16x16x32_bf16 v[88:91], v[208:211], v[68:71], v[88:91]
  v_mfma_f32_16x16x32_bf16 v[92:95], v[212:215], v[68:71], v[92:95]
  ds_read_b128 v[60:63], v8 offset:62464
  s_waitcnt lgkmcnt(3)
  v_mfma_f32_16x16x32_bf16 v[80:83], v[216:219], v[72:75], v[80:83]
  v_mfma_f32_16x16x32_bf16 v[84:87], v[220:223], v[72:75], v[84:87]
  ds_read_b128 v[64:67], v9 offset:41984
  s_cmp_ge_u32 s27, 62
  s_cbranch_scc1 L_qkv_o0b_w0
  s_waitcnt vmcnt(5)
  s_branch L_qkv_o0b_w1
L_qkv_o0b_w0:
  s_waitcnt vmcnt(0)
L_qkv_o0b_w1:
  v_mov_b32 v24, s27
  buffer_store_dword v24, v17, s[8:11], 0 offen sc1
  s_waitcnt lgkmcnt(3)
  v_mfma_f32_16x16x32_bf16 v[88:91], v[216:219], v[76:79], v[88:91]
  v_mfma_f32_16x16x32_bf16 v[92:95], v[220:223], v[76:79], v[92:95]
  ds_read_b128 v[68:71], v9 offset:62464
  s_waitcnt lgkmcnt(3)
  v_mfma_f32_16x16x32_bf16 v[80:83], v[224:227], v[56:59], v[80:83]
  v_mfma_f32_16x16x32_bf16 v[84:87], v[228:231], v[56:59], v[84:87]
  ds_read_b128 v[72:75], v10 offset:41984
  s_waitcnt lgkmcnt(3)
  v_mfma_f32_16x16x32_bf16 v[88:91], v[224:227], v[60:63], v[88:91]
  v_mfma_f32_16x16x32_bf16 v[92:95], v[228:231], v[60:63], v[92:95]
  ds_read_b128 v[76:79], v10 offset:62464
  s_waitcnt lgkmcnt(3)
  v_mfma_f32_16x16x32_bf16 v[80:83], v[232:235], v[64:67], v[80:83]
  v_mfma_f32_16x16x32_bf16 v[84:87], v[236:239], v[64:67], v[84:87]
  ds_read_b128 v[56:59], v11 offset:41984
  s_waitcnt lgkmcnt(3)
  v_mfma_f32_16x16x32_bf16 v[88:91], v[232:235], v[68:71], v[88:91]
  v_mfma_f32_16x16x32_bf16 v[92:95], v[236:239], v[68:71], v[92:95]
  ds_read_b128 v[60:63], v11 offset:62464
  s_waitcnt lgkmcnt(3)
  v_mfma_f32_16x16x32_bf16 v[80:83], v[240:243], v[72:75], v[80:83]
  v_mfma_f32_16x16x32_bf16 v[84:87], v[244:247], v[72:75], v[84:87]
  ds_read_b128 v[64:67], v12 offset:0
  s_waitcnt lgkmcnt(3)
  v_mfma_f32_16x16x32_bf16 v[88:91], v[240:243], v[76:79], v[88:91]
  v_mfma_f32_16x16x32_bf16 v[92:95], v[244:247], v[76:79], v[92:95]
  ds_read_b128 v[68:71], v12 offset:20480
  s_waitcnt lgkmcnt(3)
  v_mfma_f32_16x16x32_bf16 v[80:83], v[248:251], v[56:59], v[80:83]
  v_mfma_f32_16x16x32_bf16 v[84:87], v[252:255], v[56:59], v[84:87]
  ds_read_b128 v[72:75], v13 offset:0
  s_waitcnt lgkmcnt(3)
  v_mfma_f32_16x16x32_bf16 v[88:91], v[248:251], v[60:63], v[88:91]
  v_mfma_f32_16x16x32_bf16 v[92:95], v[252:255], v[60:63], v[92:95]
  ds_read_b128 v[76:79], v13 offset:20480
  s_lshl_b32 s31, s27, 18
  s_add_u32 s27, s27, 1
  s_nop 4
  v_cvt_pk_bf16_f32 v48, v80, v81
  v_cvt_pk_bf16_f32 v49, v82, v83
  v_cvt_pk_bf16_f32 v50, v84, v85
  v_cvt_pk_bf16_f32 v51, v86, v87
  v_cvt_pk_bf16_f32 v52, v88, v89
  v_cvt_pk_bf16_f32 v53, v90, v91
  v_cvt_pk_bf16_f32 v54, v92, v93
  v_cvt_pk_bf16_f32 v55, v94, v95
  buffer_store_dwordx4 v[48:51], v16, s[8:11], s31 offen sc1
  buffer_store_dwordx4 v[52:55], v16, s[8:11], s31 offen offset:1024 sc1
  s_cmp_ge_u32 s27, 64
  s_cbranch_scc1 L_qkv_exit
  s_waitcnt lgkmcnt(3)
  v_mfma_f32_16x16x32_bf16 v[80:83], v[96:99], v[64:67], 0
  v_mfma_f32_16x16x32_bf16 v[84:87], v[100:103], v[64:67], 0
  ds_read_b128 v[56:59], v14 offset:0
  s_waitcnt lgkmcnt(3)
  v_mfma_f32_16x16x32_bf16 v[88:91], v[96:99], v[68:71], 0
  v_mfma_f32_16x16x32_bf16 v[92:95], v[100:103], v[68:71], 0
  ds_read_b128 v[60:63], v14 offset:20480
  s_waitcnt lgkmcnt(3)
  v_mfma_f32_16x16x32_bf16 v[80:83], v[104:107], v[72:75], v[80:83]
  v_mfma_f32_16x16x32_bf16 v[84:87], v[108:111], v[72:75], v[84:87]
  ds_read_b128 v[64:67], v15 offset:0
  s_waitcnt lgkmcnt(3)
  v_mfma_f32_16x16x32_bf16 v[88:91], v[104:107], v[76:79], v[88:91]
  v_mfma_f32_16x16x32_bf16 v[92:95], v[108:111], v[76:79], v[92:95]
  ds_read_b128 v[68:71], v15 offset:20480
  s_waitcnt lgkmcnt(3)
  v_mfma_f32_16x16x32_bf16 v[80:83], v[112:115], v[56:59], v[80:83]
  v_mfma_f32_16x16x32_bf16 v[84:87], v[116:119], v[56:59], v[84:87]
  ds_read_b128 v[72:75], v12 offset:256
  s_waitcnt lgkmcnt(3)
  v_mfma_f32_16x16x32_bf16 v[88:91], v[112:115], v[60:63], v[88:91]
  v_mfma_f32_16x16x32_bf16 v[92:95], v[116:119], v[60:63], v[92:95]
  ds_read_b128 v[76:79], v12 offset:20736
  s_waitcnt lgkmcnt(3)
  v_mfma_f32_16x16x32_bf16 v[80:83], v[120:123], v[64:67], v[80:83]
  v_mfma_f32_16x16x32_bf16 v[84:87], v[124:127], v[64:67], v[84:87]
  ds_read_b128 v[56:59], v13 offset:256
  s_waitcnt lgkmcnt(3)
  v_mfma_f32_16x16x32_bf16 v[88:91], v[120:123], v[68:71], v[88:91]
  v_mfma_f32_16x16x32_bf16 v[92:95], v[124:127], v[68:71], v[92:95]
  ds_read_b128 v[60:63], v13 offset:20736
  s_waitcnt lgkmcnt(3)
  v_mfma_f32_16x16x32_bf16 v[80:83], v[128:131], v[72:75], v[80:83]
  v_mfma_f32_16x16x32_bf16 v[84:87], v[132:135], v[72:75], v[84:87]
  ds_read_b128 v[64:67], v14 offset:256
  s_waitcnt lgkmcnt(3)
  v_mfma_f32_16x16x32_bf16 v[88:91], v[128:131], v[76:79], v[88:91]
  v_mfma_f32_16x16x32_bf16 v[92:95], v[132:135], v[76:79], v[92:95]
  ds_read_b128 v[68:71], v14 offset:20736
  s_waitcnt lgkmcnt(3)
  v_mfma_f32_16x16x32_bf16 v[80:83], v[136:139], v[56:59], v[80:83]
  v_mfma_f32_16x16x32_bf16 v[84:87], v[140:143], v[56:59], v[84:87]
  ds_read_b128 v[72:75], v15 offset:256
  s_waitcnt lgkmcnt(3)
  v_mfma_f32_16x16x32_bf16 v[88:91], v[136:139], v[60:63], v[88:91]
  v_mfma_f32_16x16x32_bf16 v[92:95], v[140:143], v[60:63], v[92:95]
  ds_read_b128 v[76:79], v15 offset:20736
  s_waitcnt lgkmcnt(3)
  v_mfma_f32_16x16x32_bf16 v[80:83], v[144:147], v[64:67], v[80:83]
  v_mfma_f32_16x16x32_bf16 v[84:87], v[148:151], v[64:67], v[84:87]
  ds_read_b128 v[56:59], v12 offset:512
  s_waitcnt lgkmcnt(3)
  v_mfma_f32_16x16x32_bf16 v[88:91], v[144:147], v[68:71], v[88:91]
  v_mfma_f32_16x16x32_bf16 v[92:95], v[148:151], v[68:71], v[92:95]
  ds_read_b128 v[60:63], v12 offset:20992
  s_waitcnt lgkmcnt(3)
  v_mfma_f32_16x16x32_bf16 v[80:83], v[152:155], v[72:75], v[80:83]
  v_mfma_f32_16x16x32_bf16 v[84:87], v[156:159], v[72:75], v[84:87]
  ds_read_b128 v[64:67], v13 offset:512
  s_waitcnt lgkmcnt(3)
  v_mfma_f32_16x16x32_bf16 v[88:91], v[152:155], v[76:79], v[88:91]
  v_mfma_f32_16x16x32_bf16 v[92:95], v[156:159], v[76:79], v[92:95]
  ds_read_b128 v[68:71], v13 offset:20992
  s_waitcnt vmcnt(3)
  s_barrier
  s_add_u32 s30, s30, 40960
  s_waitcnt lgkmcnt(3)
  v_mfma_f32_16x16x32_bf16 v[80:83], v[160:163], v[56:59], v[80:83]
  v_mfma_f32_16x16x32_bf16 v[84:87], v[164:167], v[56:59], v[84:87]
  ds_read_b128 v[72:75], v14 offset:512
  s_cmp_ge_u32 s27, 62
  s_cbranch_scc1 L_qkv_o0c_nd16
  s_add_u32 m0, s32, 40960
  s_nop 0
  buffer_load_dwordx4 v2, s[12:15], s30 offen lds
L_qkv_o0c_nd16:
  s_waitcnt lgkmcnt(3)
  v_mfma_f32_16x16x32_bf16 v[88:91], v[160:163], v[60:63], v[88:91]
  v_mfma_f32_16x16x32_bf16 v[92:95], v[164:167], v[60:63], v[92:95]
  ds_read_b128 v[76:79], v14 offset:20992
  s_cmp_ge_u32 s27, 62
  s_cbranch_scc1 L_qkv_o0c_nd17
  s_add_u32 m0, s32, 41984
  s_nop 0
  buffer_load_dwordx4 v3, s[12:15], s30 offen lds
L_qkv_o0c_nd17:
  s_waitcnt lgkmcnt(3)
  v_mfma_f32_16x16x32_bf16 v[80:83], v[168:171], v[64:67], v[80:83]
  v_mfma_f32_16x16x32_bf16 v[84:87], v[172:175], v[64:67], v[84:87]
  ds_read_b128 v[56:59], v15 offset:512
  s_cmp_ge_u32 s27, 62
  s_cbranch_scc1 L_qkv_o0c_nd18
  s_add_u32 m0, s32, 43008
  s_nop 0
  buffer_load_dwordx4 v4, s[12:15], s30 offen lds
L_qkv_o0c_nd18:
  s_waitcnt lgkmcnt(3)
  v_mfma_f32_16x16x32_bf16 v[88:91], v[168:171], v[68:71], v[88:91]
  v_mfma_f32_16x16x32_bf16 v[92:95], v[172:175], v[68:71], v[92:95]
  ds_read_b128 v[60:63], v15 offset:20992
  s_cmp_ge_u32 s27, 62
  s_cbranch_scc1 L_qkv_o0c_nd19
  s_add_u32 m0, s32, 44032
  s_nop 0
  buffer_load_dwordx4 v5, s[12:15], s30 offen lds
L_qkv_o0c_nd19:
  s_waitcnt lgkmcnt(3)
  v_mfma_f32_16x16x32_bf16 v[80:83], v[176:179], v[72:75], v[80:83]
  v_mfma_f32_16x16x32_bf16 v[84:87], v[180:183], v[72:75], v[84:87]
  ds_read_b128 v[64:67], v12 offset:768
  s_cmp_ge_u32 s27, 62
  s_cbranch_scc1 L_qkv_o0c_nd20
  s_add_u32 m0, s32, 45056
  s_nop 0
  buffer_load_dwordx4 v6, s[12:15], s30 offen lds
L_qkv_o0c_nd20:
  s_waitcnt lgkmcnt(3)
  v_mfma_f32_16x16x32_bf16 v[88:91], v[176:179], v[76:79], v[88:91]
  v_mfma_f32_16x16x32_bf16 v[92:95], v[180:183], v[76:79], v[92:95]
  ds_read_b128 v[68:71], v12 offset:21248
  s_waitcnt lgkmcnt(3)
  v_mfma_f32_16x16x32_bf16 v[80:83], v[184:187], v[56:59], v[80:83]
  v_mfma_f32_16x16x32_bf16 v[84:87], v[188:191], v[56:59], v[84:87]
  ds_read_b128 v[72:75], v13 offset:768
  s_waitcnt lgkmcnt(3)
  v_mfma_f32_16x16x32_bf16 v[88:91], v[184:187], v[60:63], v[88:91]
  v_mfma_f32_16x16x32_bf16 v[92:95], v[188:191], v[60:63], v[92:95]
  ds_read_b128 v[76:79], v13 offset:21248
  s_waitcnt lgkmcnt(3)
  v_mfma_f32_16x16x32_bf16 v[80:83], v[192:195], v[64:67], v[80:83]
  v_mfma_f32_16x16x32_bf16 v[84:87], v[196:199], v[64:67], v[84:87]
  ds_read_b128 v[56:59], v14 offset:768
  s_waitcnt lgkmcnt(3)
  v_mfma_f32_16x16x32_bf16 v[88:91], v[192:195], v[68:71], v[88:91]
  v_mfma_f32_16x16x32_bf16 v[92:95], v[196:199], v[68:71], v[92:95]
  ds_read_b128 v[60:63], v14 offset:21248
  s_waitcnt lgkmcnt(3)
  v_mfma_f32_16x16x32_bf16 v[80:83], v[200:203], v[72:75], v[80:83]
  v_mfma_f32_16x16x32_bf16 v[84:87], v[204:207], v[72:75], v[84:87]
  ds_read_b128 v[64:67], v15 offset:768
  s_waitcnt lgkmcnt(3)
  v_mfma_f32_16x16x32_bf16 v[88:91], v[200:203], v[76:79], v[88:91]
  v_mfma_f32_16x16x32_bf16 v[92:95], v[204:207], v[76:79], v[92:95]
  ds_read_b128 v[68:71], v15 offset:21248
  s_waitcnt lgkmcnt(3)
  v_mfma_f32_16x16x32_bf16 v[80:83], v[208:211], v[56:59], v[80:83]
  v_mfma_f32_16x16x32_bf16 v[84:87], v[212:215], v[56:59], v[84:87]
  ds_read_b128 v[72:75], v12 offset:1024
  s_waitcnt lgkmcnt(3)
  v_mfma_f32_16x16x32_bf16 v[88:91], v[208:211], v[60:63], v[88:91]
  v_mfma_f32_16x16x32_bf16 v[92:95], v[212:215], v[60:63], v[92:95]
  ds_read_b128 v[76:79], v12 offset:21504
  s_waitcnt lgkmcnt(3)
  v_mfma_f32_16x16x32_bf16 v[80:83], v[216:219], v[64:67], v[80:83]
  v_mfma_f32_16x16x32_bf16 v[84:87], v[220:223], v[64:67], v[84:87]
  ds_read_b128 v[56:59], v13 offset:1024
  s_cmp_ge_u32 s27, 62
  s_cbranch_scc1 L_qkv_o0c_w0
  s_waitcnt vmcnt(5)
  s_branch L_qkv_o0c_w1
L_qkv_o0c_w0:
  s_waitcnt vmcnt(0)
L_qkv_o0c_w1:
  v_mov_b32 v24, s27
  buffer_store_dword v24, v17, s[8:11], 0 offen sc1
  s_waitcnt lgkmcnt(3)
  v_mfma_f32_16x16x32_bf16 v[88:91], v[216:219], v[68:71], v[88:91]
  v_mfma_f32_16x16x32_bf16 v[92:95], v[220:223], v[68:71], v[92:95]
  ds_read_b128 v[60:63], v13 offset:21504
  s_waitcnt lgkmcnt(3)
  v_mfma_f32_16x16x32_bf16 v[80:83], v[224:227], v[72:75], v[80:83]
  v_mfma_f32_16x16x32_bf16 v[84:87], v[228:231], v[72:75], v[84:87]
  ds_read_b128 v[64:67], v14 offset:1024
  s_waitcnt lgkmcnt(3)
  v_mfma_f32_16x16x32_bf16 v[88:91], v[224:227], v[76:79], v[88:91]
  v_mfma_f32_16x16x32_bf16 v[92:95], v[228:231], v[76:79], v[92:95]
  ds_read_b128 v[68:71], v14 offset:21504
  s_waitcnt lgkmcnt(3)
  v_mfma_f32_16x16x32_bf16 v[80:83], v[232:235], v[56:59], v[80:83]
  v_mfma_f32_16x16x32_bf16 v[84:87], v[236:239], v[56:59], v[84:87]
  ds_read_b128 v[72:75], v15 offset:1024
  s_waitcnt lgkmcnt(3)
  v_mfma_f32_16x16x32_bf16 v[88:91], v[232:235], v[60:63], v[88:91]
  v_mfma_f32_16x16x32_bf16 v[92:95], v[236:239], v[60:63], v[92:95]
  ds_read_b128 v[76:79], v15 offset:21504
  s_waitcnt lgkmcnt(3)
  v_mfma_f32_16x16x32_bf16 v[80:83], v[240:243], v[64:67], v[80:83]
  v_mfma_f32_16x16x32_bf16 v[84:87], v[244:247], v[64:67], v[84:87]
  ds_read_b128 v[56:59], v8 offset:0
  s_waitcnt lgkmcnt(3)
  v_mfma_f32_16x16x32_bf16 v[88:91], v[240:243], v[68:71], v[88:91]
  v_mfma_f32_16x16x32_bf16 v[92:95], v[244:247], v[68:71], v[92:95]
  ds_read_b128 v[60:63], v8 offset:20480
  s_waitcnt lgkmcnt(3)
  v_mfma_f32_16x16x32_bf16 v[80:83], v[248:251], v[72:75], v[80:83]
  v_mfma_f32_16x16x32_bf16 v[84:87], v[252:255], v[72:75], v[84:87]
  ds_read_b128 v[64:67], v9 offset:0
  s_waitcnt lgkmcnt(3)
  v_mfma_f32_16x16x32_bf16 v[88:91], v[248:251], v[76:79], v[88:91]
  v_mfma_f32_16x16x32_bf16 v[92:95], v[252:255], v[76:79], v[92:95]
  ds_read_b128 v[68:71], v9 offset:20480
  s_lshl_b32 s31, s27, 18
  s_add_u32 s27, s27, 1
  s_nop 4
  v_cvt_pk_bf16_f32 v48, v80, v81
  v_cvt_pk_bf16_f32 v49, v82, v83
  v_cvt_pk_bf16_f32 v50, v84, v85
  v_cvt_pk_bf16_f32 v51, v86, v87
  v_cvt_pk_bf16_f32 v52, v88, v89
  v_cvt_pk_bf16_f32 v53, v90, v91
  v_cvt_pk_bf16_f32 v54, v92, v93
  v_cvt_pk_bf16_f32 v55, v94, v95
  buffer_store_dwordx4 v[48:51], v16, s[8:11], s31 offen sc1
  buffer_store_dwordx4 v[52:55], v16, s[8:11], s31 offen offset:1024 sc1
  s_cmp_ge_u32 s27, 64
  s_cbranch_scc1 L_qkv_exit
  s_branch L_qkv_o0_loop
L_qkv_o1_loop:
  s_waitcnt lgkmcnt(3)
  v_mfma_f32_16x16x32_bf16 v[80:83], v[56:59], v[96:99], 0
  v_mfma_f32_16x16x32_bf16 v[84:87], v[56:59], v[100:103], 0
  ds_read_b128 v[72:75], v10 offset:0
  s_waitcnt lgkmcnt(3)
  v_mfma_f32_16x16x32_bf16 v[88:91], v[60:63], v[96:99], 0
  v_mfma_f32_16x16x32_bf16 v[92:95], v[60:63], v[100:103], 0
  ds_read_b128 v[76:79], v10 offset:20480
  s_waitcnt lgkmcnt(3)
  v_mfma_f32_16x16x32_bf16 v[80:83], v[64:67], v[104:107], v[80:83]
  v_mfma_f32_16x16x32_bf16 v[84:87], v[64:67], v[108:111], v[84:87]
  ds_read_b128 v[56:59], v11 offset:0
  s_waitcnt lgkmcnt(3)
  v_mfma_f32_16x16x32_bf16 v[88:91], v[68:71], v[104:107], v[88:91]
  v_mfma_f32_16x16x32_bf16 v[92:95], v[68:71], v[108:111], v[92:95]
  ds_read_b128 v[60:63], v11 offset:20480
  s_waitcnt lgkmcnt(3)
  v_mfma_f32_16x16x32_bf16 v[80:83], v[72:75], v[112:115], v[80:83]
  v_mfma_f32_16x16x32_bf16 v[84:87], v[72:75], v[116:119], v[84:87]
  ds_read_b128 v[64:67], v8 offset:256
  s_sub_u32 s28, s27, s33
  s_or_b32 s28, s28, s98
  s_cmp_eq_u32 s28, 0
  s_cbranch_scc0 L_qkv_o1a_nv
  buffer_load_dword v25, v26, s[56:59], 0 offen sc1
L_qkv_o1a_nv:
  s_waitcnt lgkmcnt(3)
  v_mfma_f32_16x16x32_bf16 v[88:91], v[76:79], v[112:115], v[88:91]
  v_mfma_f32_16x16x32_bf16 v[92:95], v[76:79], v[116:119], v[92:95]
  ds_read_b128 v[68:71], v8 offset:20736
  s_waitcnt lgkmcnt(3)
  v_mfma_f32_16x16x32_bf16 v[80:83], v[56:59], v[120:123], v[80:83]
  v_mfma_f32_16x16x32_bf16 v[84:87], v[56:59], v[124:127], v[84:87]
  ds_read_b128 v[72:75], v9 offset:256
  s_waitcnt lgkmcnt(3)
  v_mfma_f32_16x16x32_bf16 v[88:91], v[60:63], v[120:123], v[88:91]
  v_mfma_f32_16x16x32_bf16 v[92:95], v[60:63], v[124:127], v[92:95]
  ds_read_b128 v[76:79], v9 offset:20736
  s_waitcnt lgkmcnt(3)
  v_mfma_f32_16x16x32_bf16 v[80:83], v[64:67], v[128:131], v[80:83]
  v_mfma_f32_16x16x32_bf16 v[84:87], v[64:67], v[132:135], v[84:87]
  ds_read_b128 v[56:59], v10 offset:256
  s_waitcnt lgkmcnt(3)
  v_mfma_f32_16x16x32_bf16 v[88:91], v[68:71], v[128:131], v[88:91]
  v_mfma_f32_16x16x32_bf16 v[92:95], v[68:71], v[132:135], v[92:95]
  ds_read_b128 v[60:63], v10 offset:20736
  s_waitcnt lgkmcnt(3)
  v_mfma_f32_16x16x32_bf16 v[80:83], v[72:75], v[136:139], v[80:83]
  v_mfma_f32_16x16x32_bf16 v[84:87], v[72:75], v[140:143], v[84:87]
  ds_read_b128 v[64:67], v11 offset:256
  s_waitcnt lgkmcnt(3)
  v_mfma_f32_16x16x32_bf16 v[88:91], v[76:79], v[136:139], v[88:91]
  v_mfma_f32_16x16x32_bf16 v[92:95], v[76:79], v[140:143], v[92:95]
  ds_read_b128 v[68:71], v11 offset:20736
  s_waitcnt lgkmcnt(3)
  v_mfma_f32_16x16x32_bf16 v[80:83], v[56:59], v[144:147], v[80:83]
  v_mfma_f32_16x16x32_bf16 v[84:87], v[56:59], v[148:151], v[84:87]
  ds_read_b128 v[72:75], v8 offset:512
  s_waitcnt lgkmcnt(3)
  v_mfma_f32_16x16x32_bf16 v[88:91], v[60:63], v[144:147], v[88:91]
  v_mfma_f32_16x16x32_bf16 v[92:95], v[60:63], v[148:151], v[92:95]
  ds_read_b128 v[76:79], v8 offset:20992
  s_waitcnt lgkmcnt(3)
  v_mfma_f32_16x16x32_bf16 v[80:83], v[64:67], v[152:155], v[80:83]
  v_mfma_f32_16x16x32_bf16 v[84:87], v[64:67], v[156:159], v[84:87]
  ds_read_b128 v[56:59], v9 offset:512
  s_waitcnt lgkmcnt(3)
  v_mfma_f32_16x16x32_bf16 v[88:91], v[68:71], v[152:155], v[88:91]
  v_mfma_f32_16x16x32_bf16 v[92:95], v[68:71], v[156:159], v[92:95]
  ds_read_b128 v[60:63], v9 offset:20992
  s_waitcnt vmcnt(3)
  s_barrier
  s_add_u32 s30, s30, 40960
  s_waitcnt lgkmcnt(3)
  v_mfma_f32_16x16x32_bf16 v[80:83], v[72:75], v[160:163], v[80:83]
  v_mfma_f32_16x16x32_bf16 v[84:87], v[72:75], v[164:167], v[84:87]
  ds_read_b128 v[64:67], v10 offset:512
  s_cmp_ge_u32 s27, 62
  s_cbranch_scc1 L_qkv_o1a_nd16
  s_add_u32 m0, s32, 81920
  s_nop 0
  buffer_load_dwordx4 v2, s[12:15], s30 offen lds
L_qkv_o1a_nd16:
  s_waitcnt lgkmcnt(3)
  v_mfma_f32_16x16x32_bf16 v[88:91], v[76:79], v[160:163], v[88:91]
  v_mfma_f32_16x16x32_bf16 v[92:95], v[76:79], v[164:167], v[92:95]
  ds_read_b128 v[68:71], v10 offset:20992
  s_cmp_ge_u32 s27, 62
  s_cbranch_scc1 L_qkv_o1a_nd17
  s_add_u32 m0, s32, 82944
  s_nop 0
  buffer_load_dwordx4 v3, s[12:15], s30 offen lds
L_qkv_o1a_nd17:
  s_waitcnt lgkmcnt(3)
  v_mfma_f32_16x16x32_bf16 v[80:83], v[56:59], v[168:171], v[80:83]
  v_mfma_f32_16x16x32_bf16 v[84:87], v[56:59], v[172:175], v[84:87]
  ds_read_b128 v[72:75], v11 offset:512
  s_cmp_ge_u32 s27, 62
  s_cbranch_scc1 L_qkv_o1a_nd18
  s_add_u32 m0, s32, 83968
  s_nop 0
  buffer_load_dwordx4 v4, s[12:15], s30 offen lds
L_qkv_o1a_nd18:
  s_waitcnt lgkmcnt(3)
  v_mfma_f32_16x16x32_bf16 v[88:91], v[60:63], v[168:171], v[88:91]
  v_mfma_f32_16x16x32_bf16 v[92:95], v[60:63], v[172:175], v[92:95]
  ds_read_b128 v[76:79], v11 offset:20992
  s_cmp_ge_u32 s27, 62
  s_cbranch_scc1 L_qkv_o1a_nd19
  s_add_u32 m0, s32, 84992
  s_nop 0
  buffer_load_dwordx4 v5, s[12:15], s30 offen lds
L_qkv_o1a_nd19:
  s_waitcnt lgkmcnt(3)
  v_mfma_f32_16x16x32_bf16 v[80:83], v[64:67], v[176:179], v[80:83]
  v_mfma_f32_16x16x32_bf16 v[84:87], v[64:67], v[180:183], v[84:87]
  ds_read_b128 v[56:59], v8 offset:768
  s_cmp_ge_u32 s27, 62
  s_cbranch_scc1 L_qkv_o1a_nd20
  s_add_u32 m0, s32, 86016
  s_nop 0
  buffer_load_dwordx4 v6, s[12:15], s30 offen lds
L_qkv_o1a_nd20:
  s_waitcnt lgkmcnt(3)
  v_mfma_f32_16x16x32_bf16 v[88:91], v[68:71], v[176:179], v[88:91]
  v_mfma_f32_16x16x32_bf16 v[92:95], v[68:71], v[180:183], v[92:95]
  ds_read_b128 v[60:63], v8 offset:21248
  s_waitcnt lgkmcnt(3)
  v_mfma_f32_16x16x32_bf16 v[80:83], v[72:75], v[184:187], v[80:83]
  v_mfma_f32_16x16x32_bf16 v[84:87], v[72:75], v[188:191], v[84:87]
  ds_read_b128 v[64:67], v9 offset:768
  s_waitcnt lgkmcnt(3)
  v_mfma_f32_16x16x32_bf16 v[88:91], v[76:79], v[184:187], v[88:91]
  v_mfma_f32_16x16x32_bf16 v[92:95], v[76:79], v[188:191], v[92:95]
  ds_read_b128 v[68:71], v9 offset:21248
  s_waitcnt lgkmcnt(3)
  v_mfma_f32_16x16x32_bf16 v[80:83], v[56:59], v[192:195], v[80:83]
  v_mfma_f32_16x16x32_bf16 v[84:87], v[56:59], v[196:199], v[84:87]
  ds_read_b128 v[72:75], v10 offset:768
  s_waitcnt lgkmcnt(3)
  v_mfma_f32_16x16x32_bf16 v[88:91], v[60:63], v[192:195], v[88:91]
  v_mfma_f32_16x16x32_bf16 v[92:95], v[60:63], v[196:199], v[92:95]
  ds_read_b128 v[76:79], v10 offset:21248
  s_waitcnt lgkmcnt(3)
  v_mfma_f32_16x16x32_bf16 v[80:83], v[64:67], v[200:203], v[80:83]
  v_mfma_f32_16x16x32_bf16 v[84:87], v[64:67], v[204:207], v[84:87]
  ds_read_b128 v[56:59], v11 offset:768
  s_waitcnt lgkmcnt(3)
  v_mfma_f32_16x16x32_bf16 v[88:91], v[68:71], v[200:203], v[88:91]
  v_mfma_f32_16x16x32_bf16 v[92:95], v[68:71], v[204:207], v[92:95]
  ds_read_b128 v[60:63], v11 offset:21248
  s_waitcnt lgkmcnt(3)
  v_mfma_f32_16x16x32_bf16 v[80:83], v[72:75], v[208:211], v[80:83]
  v_mfma_f32_16x16x32_bf16 v[84:87], v[72:75], v[212:215], v[84:87]
  ds_read_b128 v[64:67], v8 offset:1024
  s_waitcnt lgkmcnt(3)
  v_mfma_f32_16x16x32_bf16 v[88:91], v[76:79], v[208:211], v[88:91]
  v_mfma_f32_16x16x32_bf16 v[92:95], v[76:79], v[212:215], v[92:95]
  ds_read_b128 v[68:71], v8 offset:21504
  s_waitcnt lgkmcnt(3)
  v_mfma_f32_16x16x32_bf16 v[80:83], v[56:59], v[216:219], v[80:83]
  v_mfma_f32_16x16x32_bf16 v[84:87], v[56:59], v[220:223], v[84:87]
  ds_read_b128 v[72:75], v9 offset:1024
  s_cmp_ge_u32 s27, 62
  s_cbranch_scc1 L_qkv_o1a_w0
  s_waitcnt vmcnt(5)
  s_branch L_qkv_o1a_w1
L_qkv_o1a_w0:
  s_waitcnt vmcnt(0)
L_qkv_o1a_w1:
  v_mov_b32 v27, 1073741824
  s_cmp_eq_u32 s27, s33
  s_cselect_b64 vcc, -1, 0
  v_mov_b32 v24, s27
  v_cndmask_b32 v27, v17, v27, vcc
  buffer_store_dword v24, v27, s[8:11], 0 offen sc1
  s_waitcnt lgkmcnt(3)
  v_mfma_f32_16x16x32_bf16 v[88:91], v[60:63], v[216:219], v[88:91]
  v_mfma_f32_16x16x32_bf16 v[92:95], v[60:63], v[220:223], v[92:95]
  ds_read_b128 v[76:79], v9 offset:21504
  s_waitcnt lgkmcnt(3)
  v_mfma_f32_16x16x32_bf16 v[80:83], v[64:67], v[224:227], v[80:83]
  v_mfma_f32_16x16x32_bf16 v[84:87], v[64:67], v[228:231], v[84:87]
  ds_read_b128 v[56:59], v10 offset:1024
  s_waitcnt lgkmcnt(3)
  v_mfma_f32_16x16x32_bf16 v[88:91], v[68:71], v[224:227], v[88:91]
  v_mfma_f32_16x16x32_bf16 v[92:95], v[68:71], v[228:231], v[92:95]
  ds_read_b128 v[60:63], v10 offset:21504
  s_waitcnt lgkmcnt(3)
  v_mfma_f32_16x16x32_bf16 v[80:83], v[72:75], v[232:235], v[80:83]
  v_mfma_f32_16x16x32_bf16 v[84:87], v[72:75], v[236:239], v[84:87]
  ds_read_b128 v[64:67], v11 offset:1024
  s_waitcnt lgkmcnt(3)
  v_mfma_f32_16x16x32_bf16 v[88:91], v[76:79], v[232:235], v[88:91]
  v_mfma_f32_16x16x32_bf16 v[92:95], v[76:79], v[236:239], v[92:95]
  ds_read_b128 v[68:71], v11 offset:21504
  s_waitcnt lgkmcnt(3)
  v_mfma_f32_16x16x32_bf16 v[80:83], v[56:59], v[240:243], v[80:83]
  v_mfma_f32_16x16x32_bf16 v[84:87], v[56:59], v[244:247], v[84:87]
  ds_read_b128 v[72:75], v8 offset:40960
  s_waitcnt lgkmcnt(3)
  v_mfma_f32_16x16x32_bf16 v[88:91], v[60:63], v[240:243], v[88:91]
  v_mfma_f32_16x16x32_bf16 v[92:95], v[60:63], v[244:247], v[92:95]
  ds_read_b128 v[76:79], v8 offset:61440
  s_waitcnt lgkmcnt(3)
  v_mfma_f32_16x16x32_bf16 v[80:83], v[64:67], v[248:251], v[80:83]
  v_mfma_f32_16x16x32_bf16 v[84:87], v[64:67], v[252:255], v[84:87]
  ds_read_b128 v[56:59], v9 offset:40960
  s_waitcnt lgkmcnt(3)
  v_mfma_f32_16x16x32_bf16 v[88:91], v[68:71], v[248:251], v[88:91]
  v_mfma_f32_16x16x32_bf16 v[92:95], v[68:71], v[252:255], v[92:95]
  ds_read_b128 v[60:63], v9 offset:61440
  s_sub_u32 s28, s27, s33
  s_or_b32 s28, s28, s98
  s_cmp_eq_u32 s28, 0
  s_cbranch_scc0 L_qkv_o1a_ne
L_qkv_o1a_vote:
  v_readfirstlane_b32 s60, v25
  s_nop 0
  s_cmp_eq_u32 s60, 1
  s_cbranch_scc1 L_qkv_o1a_vote_all
  s_cmp_eq_u32 s60, 2
  s_cbranch_scc1 L_restart
  s_add_u32 s63, s63, 1
  s_cmp_ge_u32 s63, 0x40000
  s_cbranch_scc1 L_restart
  s_sleep 4
  buffer_load_dword v25, v26, s[56:59], 0 offen sc1
  s_waitcnt vmcnt(0)
  s_branch L_qkv_o1a_vote
L_qkv_o1a_vote_all:
L_qkv_o1a_ne:
  s_lshl_b32 s31, s27, 18
  s_add_u32 s27, s27, 1
  s_nop 4
  v_cvt_pk_bf16_f32 v48, v80, v81
  v_cvt_pk_bf16_f32 v49, v82, v83
  v_cvt_pk_bf16_f32 v50, v88, v89
  v_cvt_pk_bf16_f32 v51, v90, v91
  v_cvt_pk_bf16_f32 v52, v84, v85
  v_cvt_pk_bf16_f32 v53, v86, v87
  v_cvt_pk_bf16_f32 v54, v92, v93
  v_cvt_pk_bf16_f32 v55, v94, v95
  buffer_store_dwordx4 v[48:51], v16, s[8:11], s31 offen sc1
  buffer_store_dwordx4 v[52:55], v16, s[8:11], s31 offen offset:1024 sc1
  s_add_u32 s28, s33, 1
  s_cmp_eq_u32 s27, s28
  s_cbranch_scc0 L_qkv_o1a_nf
  s_mov_b32 s63, 0
L_qkv_o1a_bw:
  buffer_load_dword v27, v17, s[8:11], 0 offen sc1
  s_waitcnt vmcnt(0)
  v_readfirstlane_b32 s29, v27
  s_nop 0
  s_cmp_ge_u32 s29, s33
  s_cbranch_scc1 L_qkv_o1a_bok
  s_sleep 4
  s_add_u32 s63, s63, 1
  s_cmp_lt_u32 s63, 0x40000
  s_cbranch_scc1 L_qkv_o1a_bw
L_qkv_o1a_bok:
  v_mov_b32 v24, s27
  buffer_store_dword v24, v17, s[8:11], 0 offen sc1
L_qkv_o1a_nf:
  s_cmp_ge_u32 s27, 64
  s_cbranch_scc1 L_qkv_exit
  s_waitcnt lgkmcnt(3)
  v_mfma_f32_16x16x32_bf16 v[80:83], v[72:75], v[96:99], 0
  v_mfma_f32_16x16x32_bf16 v[84:87], v[72:75], v[100:103], 0
  ds_read_b128 v[64:67], v10 offset:40960
  s_waitcnt lgkmcnt(3)
  v_mfma_f32_16x16x32_bf16 v[88:91], v[76:79], v[96:99], 0
  v_mfma_f32_16x16x32_bf16 v[92:95], v[76:79], v[100:103], 0
  ds_read_b128 v[68:71], v10 offset:61440
  s_waitcnt lgkmcnt(3)
  v_mfma_f32_16x16x32_bf16 v[80:83], v[56:59], v[104:107], v[80:83]
  v_mfma_f32_16x16x32_bf16 v[84:87], v[56:59], v[108:111], v[84:87]
  ds_read_b128 v[72:75], v11 offset:40960
  s_waitcnt lgkmcnt(3)
  v_mfma_f32_16x16x32_bf16 v[88:91], v[60:63], v[104:107], v[88:91]
  v_mfma_f32_16x16x32_bf16 v[92:95], v[60:63], v[108:111], v[92:95]
  ds_read_b128 v[76:79], v11 offset:61440
  s_waitcnt lgkmcnt(3)
  v_mfma_f32_16x16x32_bf16 v[80:83], v[64:67], v[112:115], v[80:83]
  v_mfma_f32_16x16x32_bf16 v[84:87], v[64:67], v[116:119], v[84:87]
  ds_read_b128 v[56:59], v8 offset:41216
  s_waitcnt lgkmcnt(3)
  v_mfma_f32_16x16x32_bf16 v[88:91], v[68:71], v[112:115], v[88:91]
  v_mfma_f32_16x16x32_bf16 v[92:95], v[68:71], v[116:119], v[92:95]
  ds_read_b128 v[60:63], v8 offset:61696
  s_waitcnt lgkmcnt(3)
  v_mfma_f32_16x16x32_bf16 v[80:83], v[72:75], v[120:123], v[80:83]
  v_mfma_f32_16x16x32_bf16 v[84:87], v[72:75], v[124:127], v[84:87]
  ds_read_b128 v[64:67], v9 offset:41216
  s_waitcnt lgkmcnt(3)
  v_mfma_f32_16x16x32_bf16 v[88:91], v[76:79], v[120:123], v[88:91]
  v_mfma_f32_16x16x32_bf16 v[92:95], v[76:79], v[124:127], v[92:95]
  ds_read_b128 v[68:71], v9 offset:61696
  s_waitcnt lgkmcnt(3)
  v_mfma_f32_16x16x32_bf16 v[80:83], v[56:59], v[128:131], v[80:83]
  v_mfma_f32_16x16x32_bf16 v[84:87], v[56:59], v[132:135], v[84:87]
  ds_read_b128 v[72:75], v10 offset:41216
  s_waitcnt lgkmcnt(3)
  v_mfma_f32_16x16x32_bf16 v[88:91], v[60:63], v[128:131], v[88:91]
  v_mfma_f32_16x16x32_bf16 v[92:95], v[60:63], v[132:135], v[92:95]
  ds_read_b128 v[76:79], v10 offset:61696
  s_waitcnt lgkmcnt(3)
  v_mfma_f32_16x16x32_bf16 v[80:83], v[64:67], v[136:139], v[80:83]
  v_mfma_f32_16x16x32_bf16 v[84:87], v[64:67], v[140:143], v[84:87]
  ds_read_b128 v[56:59], v11 offset:41216
  s_waitcnt lgkmcnt(3)
  v_mfma_f32_16x16x32_bf16 v[88:91], v[68:71], v[136:139], v[88:91]
  v_mfma_f32_16x16x32_bf16 v[92:95], v[68:71], v[140:143], v[92:95]
  ds_read_b128 v[60:63], v11 offset:61696
  s_waitcnt lgkmcnt(3)
  v_mfma_f32_16x16x32_bf16 v[80:83], v[72:75], v[144:147], v[80:83]
  v_mfma_f32_16x16x32_bf16 v[84:87], v[72:75], v[148:151], v[84:87]
  ds_read_b128 v[64:67], v8 offset:41472
  s_waitcnt lgkmcnt(3)
  v_mfma_f32_16x16x32_bf16 v[88:91], v[76:79], v[144:147], v[88:91]
  v_mfma_f32_16x16x32_bf16 v[92:95], v[76:79], v[148:151], v[92:95]
  ds_read_b128 v[68:71], v8 offset:61952
  s_waitcnt lgkmcnt(3)
  v_mfma_f32_16x16x32_bf16 v[80:83], v[56:59], v[152:155], v[80:83]
  v_mfma_f32_16x16x32_bf16 v[84:87], v[56:59], v[156:159], v[84:87]
  ds_read_b128 v[72:75], v9 offset:41472
  s_waitcnt lgkmcnt(3)
  v_mfma_f32_16x16x32_bf16 v[88:91], v[60:63], v[152:155], v[88:91]
  v_mfma_f32_16x16x32_bf16 v[92:95], v[60:63], v[156:159], v[92:95]
  ds_read_b128 v[76:79], v9 offset:61952
  s_waitcnt vmcnt(3)
  s_barrier
  s_add_u32 s30, s30, 40960
  s_waitcnt lgkmcnt(3)
  v_mfma_f32_16x16x32_bf16 v[80:83], v[64:67], v[160:163], v[80:83]
  v_mfma_f32_16x16x32_bf16 v[84:87], v[64:67], v[164:167], v[84:87]
  ds_read_b128 v[56:59], v10 offset:41472
  s_cmp_ge_u32 s27, 62
  s_cbranch_scc1 L_qkv_o1b_nd16
  s_add_u32 m0, s32, 0
  s_nop 0
  buffer_load_dwordx4 v2, s[12:15], s30 offen lds
L_qkv_o1b_nd16:
  s_waitcnt lgkmcnt(3)
  v_mfma_f32_16x16x32_bf16 v[88:91], v[68:71], v[160:163], v[88:91]
  v_mfma_f32_16x16x32_bf16 v[92:95], v[68:71], v[164:167], v[92:95]
  ds_read_b128 v[60:63], v10 offset:61952
  s_cmp_ge_u32 s27, 62
  s_cbranch_scc1 L_qkv_o1b_nd17
  s_add_u32 m0, s32, 1024
  s_nop 0
  buffer_load_dwordx4 v3, s[12:15], s30 offen lds
L_qkv_o1b_nd17:
  s_waitcnt lgkmcnt(3)
  v_mfma_f32_16x16x32_bf16 v[80:83], v[72:75], v[168:171], v[80:83]
  v_mfma_f32_16x16x32_bf16 v[84:87], v[72:75], v[172:175], v[84:87]
  ds_read_b128 v[64:67], v11 offset:41472
  s_cmp_ge_u32 s27, 62
  s_cbranch_scc1 L_qkv_o1b_nd18
  s_add_u32 m0, s32, 2048
  s_nop 0
  buffer_load_dwordx4 v4, s[12:15], s30 offen lds
L_qkv_o1b_nd18:
  s_waitcnt lgkmcnt(3)
  v_mfma_f32_16x16x32_bf16 v[88:91], v[76:79], v[168:171], v[88:91]
  v_mfma_f32_16x16x32_bf16 v[92:95], v[76:79], v[172:175], v[92:95]
  ds_read_b128 v[68:71], v11 offset:61952
  s_cmp_ge_u32 s27, 62
  s_cbranch_scc1 L_qkv_o1b_nd19
  s_add_u32 m0, s32, 3072
  s_nop 0
  buffer_load_dwordx4 v5, s[12:15], s30 offen lds
L_qkv_o1b_nd19:
  s_waitcnt lgkmcnt(3)
  v_mfma_f32_16x16x32_bf16 v[80:83], v[56:59], v[176:179], v[80:83]
  v_mfma_f32_16x16x32_bf16 v[84:87], v[56:59], v[180:183], v[84:87]
  ds_read_b128 v[72:75], v8 offset:41728
  s_cmp_ge_u32 s27, 62
  s_cbranch_scc1 L_qkv_o1b_nd20
  s_add_u32 m0, s32, 4096
  s_nop 0
  buffer_load_dwordx4 v6, s[12:15], s30 offen lds
L_qkv_o1b_nd20:
  s_waitcnt lgkmcnt(3)
  v_mfma_f32_16x16x32_bf16 v[88:91], v[60:63], v[176:179], v[88:91]
  v_mfma_f32_16x16x32_bf16 v[92:95], v[60:63], v[180:183], v[92:95]
  ds_read_b128 v[76:79], v8 offset:62208
  s_waitcnt lgkmcnt(3)
  v_mfma_f32_16x16x32_bf16 v[80:83], v[64:67], v[184:187], v[80:83]
  v_mfma_f32_16x16x32_bf16 v[84:87], v[64:67], v[188:191], v[84:87]
  ds_read_b128 v[56:59], v9 offset:41728
  s_waitcnt lgkmcnt(3)
  v_mfma_f32_16x16x32_bf16 v[88:91], v[68:71], v[184:187], v[88:91]
  v_mfma_f32_16x16x32_bf16 v[92:95], v[68:71], v[188:191], v[92:95]
  ds_read_b128 v[60:63], v9 offset:62208
  s_waitcnt lgkmcnt(3)
  v_mfma_f32_16x16x32_bf16 v[80:83], v[72:75], v[192:195], v[80:83]
  v_mfma_f32_16x16x32_bf16 v[84:87], v[72:75], v[196:199], v[84:87]
  ds_read_b128 v[64:67], v10 offset:41728
  s_waitcnt lgkmcnt(3)
  v_mfma_f32_16x16x32_bf16 v[88:91], v[76:79], v[192:195], v[88:91]
  v_mfma_f32_16x16x32_bf16 v[92:95], v[76:79], v[196:199], v[92:95]
  ds_read_b128 v[68:71], v10 offset:62208
  s_waitcnt lgkmcnt(3)
  v_mfma_f32_16x16x32_bf16 v[80:83], v[56:59], v[200:203], v[80:83]
  v_mfma_f32_16x16x32_bf16 v[84:87], v[56:59], v[204:207], v[84:87]
  ds_read_b128 v[72:75], v11 offset:41728
  s_waitcnt lgkmcnt(3)
  v_mfma_f32_16x16x32_bf16 v[88:91], v[60:63], v[200:203], v[88:91]
  v_mfma_f32_16x16x32_bf16 v[92:95], v[60:63], v[204:207], v[92:95]
  ds_read_b128 v[76:79], v11 offset:62208
  s_waitcnt lgkmcnt(3)
  v_mfma_f32_16x16x32_bf16 v[80:83], v[64:67], v[208:211], v[80:83]
  v_mfma_f32_16x16x32_bf16 v[84:87], v[64:67], v[212:215], v[84:87]
  ds_read_b128 v[56:59], v8 offset:41984
  s_waitcnt lgkmcnt(3)
  v_mfma_f32_16x16x32_bf16 v[88:91], v[68:71], v[208:211], v[88:91]
  v_mfma_f32_16x16x32_bf16 v[92:95], v[68:71], v[212:215], v[92:95]
  ds_read_b128 v[60:63], v8 offset:62464
  s_waitcnt lgkmcnt(3)
  v_mfma_f32_16x16x32_bf16 v[80:83], v[72:75], v[216:219], v[80:83]
  v_mfma_f32_16x16x32_bf16 v[84:87], v[72:75], v[220:223], v[84:87]
  ds_read_b128 v[64:67], v9 offset:41984
  s_cmp_ge_u32 s27, 62
  s_cbranch_scc1 L_qkv_o1b_w0
  s_waitcnt vmcnt(5)
  s_branch L_qkv_o1b_w1
L_qkv_o1b_w0:
  s_waitcnt vmcnt(0)
L_qkv_o1b_w1:
  v_mov_b32 v24, s27
  buffer_store_dword v24, v17, s[8:11], 0 offen sc1
  s_waitcnt lgkmcnt(3)
  v_mfma_f32_16x16x32_bf16 v[88:91], v[76:79], v[216:219], v[88:91]
  v_mfma_f32_16x16x32_bf16 v[92:95], v[76:79], v[220:223], v[92:95]
  ds_read_b128 v[68:71], v9 offset:62464
  s_waitcnt lgkmcnt(3)
  v_mfma_f32_16x16x32_bf16 v[80:83], v[56:59], v[224:227], v[80:83]
  v_mfma_f32_16x16x32_bf16 v[84:87], v[56:59], v[228:231], v[84:87]
  ds_read_b128 v[72:75], v10 offset:41984
  s_waitcnt lgkmcnt(3)
  v_mfma_f32_16x16x32_bf16 v[88:91], v[60:63], v[224:227], v[88:91]
  v_mfma_f32_16x16x32_bf16 v[92:95], v[60:63], v[228:231], v[92:95]
  ds_read_b128 v[76:79], v10 offset:62464
  s_waitcnt lgkmcnt(3)
  v_mfma_f32_16x16x32_bf16 v[80:83], v[64:67], v[232:235], v[80:83]
  v_mfma_f32_16x16x32_bf16 v[84:87], v[64:67], v[236:239], v[84:87]
  ds_read_b128 v[56:59], v11 offset:41984
  s_waitcnt lgkmcnt(3)
  v_mfma_f32_16x16x32_bf16 v[88:91], v[68:71], v[232:235], v[88:91]
  v_mfma_f32_16x16x32_bf16 v[92:95], v[68:71], v[236:239], v[92:95]
  ds_read_b128 v[60:63], v11 offset:62464
  s_waitcnt lgkmcnt(3)
  v_mfma_f32_16x16x32_bf16 v[80:83], v[72:75], v[240:243], v[80:83]
  v_mfma_f32_16x16x32_bf16 v[84:87], v[72:75], v[244:247], v[84:87]
  ds_read_b128 v[64:67], v12 offset:0
  s_waitcnt lgkmcnt(3)
  v_mfma_f32_16x16x32_bf16 v[88:91], v[76:79], v[240:243], v[88:91]
  v_mfma_f32_16x16x32_bf16 v[92:95], v[76:79], v[244:247], v[92:95]
  ds_read_b128 v[68:71], v12 offset:20480
  s_waitcnt lgkmcnt(3)
  v_mfma_f32_16x16x32_bf16 v[80:83], v[56:59], v[248:251], v[80:83]
  v_mfma_f32_16x16x32_bf16 v[84:87], v[56:59], v[252:255], v[84:87]
  ds_read_b128 v[72:75], v13 offset:0
  s_waitcnt lgkmcnt(3)
  v_mfma_f32_16x16x32_bf16 v[88:91], v[60:63], v[248:251], v[88:91]
  v_mfma_f32_16x16x32_bf16 v[92:95], v[60:63], v[252:255], v[92:95]
  ds_read_b128 v[76:79], v13 offset:20480
  s_lshl_b32 s31, s27, 18
  s_add_u32 s27, s27, 1
  s_nop 4
  v_cvt_pk_bf16_f32 v48, v80, v81
  v_cvt_pk_bf16_f32 v49, v82, v83
  v_cvt_pk_bf16_f32 v50, v88, v89
  v_cvt_pk_bf16_f32 v51, v90, v91
  v_cvt_pk_bf16_f32 v52, v84, v85
  v_cvt_pk_bf16_f32 v53, v86, v87
  v_cvt_pk_bf16_f32 v54, v92, v93
  v_cvt_pk_bf16_f32 v55, v94, v95
  buffer_store_dwordx4 v[48:51], v16, s[8:11], s31 offen sc1
  buffer_store_dwordx4 v[52:55], v16, s[8:11], s31 offen offset:1024 sc1
  s_cmp_ge_u32 s27, 64
  s_cbranch_scc1 L_qkv_exit
  s_waitcnt lgkmcnt(3)
  v_mfma_f32_16x16x32_bf16 v[80:83], v[64:67], v[96:99], 0
  v_mfma_f32_16x16x32_bf16 v[84:87], v[64:67], v[100:103], 0
  ds_read_b128 v[56:59], v14 offset:0
  s_waitcnt lgkmcnt(3)
  v_mfma_f32_16x16x32_bf16 v[88:91], v[68:71], v[96:99], 0
  v_mfma_f32_16x16x32_bf16 v[92:95], v[68:71], v[100:103], 0
  ds_read_b128 v[60:63], v14 offset:20480
  s_waitcnt lgkmcnt(3)
  v_mfma_f32_16x16x32_bf16 v[80:83], v[72:75], v[104:107], v[80:83]
  v_mfma_f32_16x16x32_bf16 v[84:87], v[72:75], v[108:111], v[84:87]
  ds_read_b128 v[64:67], v15 offset:0
  s_waitcnt lgkmcnt(3)
  v_mfma_f32_16x16x32_bf16 v[88:91], v[76:79], v[104:107], v[88:91]
  v_mfma_f32_16x16x32_bf16 v[92:95], v[76:79], v[108:111], v[92:95]
  ds_read_b128 v[68:71], v15 offset:20480
  s_waitcnt lgkmcnt(3)
  v_mfma_f32_16x16x32_bf16 v[80:83], v[56:59], v[112:115], v[80:83]
  v_mfma_f32_16x16x32_bf16 v[84:87], v[56:59], v[116:119], v[84:87]
  ds_read_b128 v[72:75], v12 offset:256
  s_waitcnt lgkmcnt(3)
  v_mfma_f32_16x16x32_bf16 v[88:91], v[60:63], v[112:115], v[88:91]
  v_mfma_f32_16x16x32_bf16 v[92:95], v[60:63], v[116:119], v[92:95]
  ds_read_b128 v[76:79], v12 offset:20736
  s_waitcnt lgkmcnt(3)
  v_mfma_f32_16x16x32_bf16 v[80:83], v[64:67], v[120:123], v[80:83]
  v_mfma_f32_16x16x32_bf16 v[84:87], v[64:67], v[124:127], v[84:87]
  ds_read_b128 v[56:59], v13 offset:256
  s_waitcnt lgkmcnt(3)
  v_mfma_f32_16x16x32_bf16 v[88:91], v[68:71], v[120:123], v[88:91]
  v_mfma_f32_16x16x32_bf16 v[92:95], v[68:71], v[124:127], v[92:95]
  ds_read_b128 v[60:63], v13 offset:20736
  s_waitcnt lgkmcnt(3)
  v_mfma_f32_16x16x32_bf16 v[80:83], v[72:75], v[128:131], v[80:83]
  v_mfma_f32_16x16x32_bf16 v[84:87], v[72:75], v[132:135], v[84:87]
  ds_read_b128 v[64:67], v14 offset:256
  s_waitcnt lgkmcnt(3)
  v_mfma_f32_16x16x32_bf16 v[88:91], v[76:79], v[128:131], v[88:91]
  v_mfma_f32_16x16x32_bf16 v[92:95], v[76:79], v[132:135], v[92:95]
  ds_read_b128 v[68:71], v14 offset:20736
  s_waitcnt lgkmcnt(3)
  v_mfma_f32_16x16x32_bf16 v[80:83], v[56:59], v[136:139], v[80:83]
  v_mfma_f32_16x16x32_bf16 v[84:87], v[56:59], v[140:143], v[84:87]
  ds_read_b128 v[72:75], v15 offset:256
  s_waitcnt lgkmcnt(3)
  v_mfma_f32_16x16x32_bf16 v[88:91], v[60:63], v[136:139], v[88:91]
  v_mfma_f32_16x16x32_bf16 v[92:95], v[60:63], v[140:143], v[92:95]
  ds_read_b128 v[76:79], v15 offset:20736
  s_waitcnt lgkmcnt(3)
  v_mfma_f32_16x16x32_bf16 v[80:83], v[64:67], v[144:147], v[80:83]
  v_mfma_f32_16x16x32_bf16 v[84:87], v[64:67], v[148:151], v[84:87]
  ds_read_b128 v[56:59], v12 offset:512
  s_waitcnt lgkmcnt(3)
  v_mfma_f32_16x16x32_bf16 v[88:91], v[68:71], v[144:147], v[88:91]
  v_mfma_f32_16x16x32_bf16 v[92:95], v[68:71], v[148:151], v[92:95]
  ds_read_b128 v[60:63], v12 offset:20992
  s_waitcnt lgkmcnt(3)
  v_mfma_f32_16x16x32_bf16 v[80:83], v[72:75], v[152:155], v[80:83]
  v_mfma_f32_16x16x32_bf16 v[84:87], v[72:75], v[156:159], v[84:87]
  ds_read_b128 v[64:67], v13 offset:512
  s_waitcnt lgkmcnt(3)
  v_mfma_f32_16x16x32_bf16 v[88:91], v[76:79], v[152:155], v[88:91]
  v_mfma_f32_16x16x32_bf16 v[92:95], v[76:79], v[156:159], v[92:95]
  ds_read_b128 v[68:71], v13 offset:20992
  s_waitcnt vmcnt(3)
  s_barrier
  s_add_u32 s30, s30, 40960
  s_waitcnt lgkmcnt(3)
  v_mfma_f32_16x16x32_bf16 v[80:83], v[56:59], v[160:163], v[80:83]
  v_mfma_f32_16x16x32_bf16 v[84:87], v[56:59], v[164:167], v[84:87]
  ds_read_b128 v[72:75], v14 offset:512
  s_cmp_ge_u32 s27, 62
  s_cbranch_scc1 L_qkv_o1c_nd16
  s_add_u32 m0, s32, 40960
  s_nop 0
  buffer_load_dwordx4 v2, s[12:15], s30 offen lds
L_qkv_o1c_nd16:
  s_waitcnt lgkmcnt(3)
  v_mfma_f32_16x16x32_bf16 v[88:91], v[60:63], v[160:163], v[88:91]
  v_mfma_f32_16x16x32_bf16 v[92:95], v[60:63], v[164:167], v[92:95]
  ds_read_b128 v[76:79], v14 offset:20992
  s_cmp_ge_u32 s27, 62
  s_cbranch_scc1 L_qkv_o1c_nd17
  s_add_u32 m0, s32, 41984
  s_nop 0
  buffer_load_dwordx4 v3, s[12:15], s30 offen lds
L_qkv_o1c_nd17:
  s_waitcnt lgkmcnt(3)
  v_mfma_f32_16x16x32_bf16 v[80:83], v[64:67], v[168:171], v[80:83]
  v_mfma_f32_16x16x32_bf16 v[84:87], v[64:67], v[172:175], v[84:87]
  ds_read_b128 v[56:59], v15 offset:512
  s_cmp_ge_u32 s27, 62
  s_cbranch_scc1 L_qkv_o1c_nd18
  s_add_u32 m0, s32, 43008
  s_nop 0
  buffer_load_dwordx4 v4, s[12:15], s30 offen lds
L_qkv_o1c_nd18:
  s_waitcnt lgkmcnt(3)
  v_mfma_f32_16x16x32_bf16 v[88:91], v[68:71], v[168:171], v[88:91]
  v_mfma_f32_16x16x32_bf16 v[92:95], v[68:71], v[172:175], v[92:95]
  ds_read_b128 v[60:63], v15 offset:20992
  s_cmp_ge_u32 s27, 62
  s_cbranch_scc1 L_qkv_o1c_nd19
  s_add_u32 m0, s32, 44032
  s_nop 0
  buffer_load_dwordx4 v5, s[12:15], s30 offen lds
L_qkv_o1c_nd19:
  s_waitcnt lgkmcnt(3)
  v_mfma_f32_16x16x32_bf16 v[80:83], v[72:75], v[176:179], v[80:83]
  v_mfma_f32_16x16x32_bf16 v[84:87], v[72:75], v[180:183], v[84:87]
  ds_read_b128 v[64:67], v12 offset:768
  s_cmp_ge_u32 s27, 62
  s_cbranch_scc1 L_qkv_o1c_nd20
  s_add_u32 m0, s32, 45056
  s_nop 0
  buffer_load_dwordx4 v6, s[12:15], s30 offen lds
L_qkv_o1c_nd20:
  s_waitcnt lgkmcnt(3)
  v_mfma_f32_16x16x32_bf16 v[88:91], v[76:79], v[176:179], v[88:91]
  v_mfma_f32_16x16x32_bf16 v[92:95], v[76:79], v[180:183], v[92:95]
  ds_read_b128 v[68:71], v12 offset:21248
  s_waitcnt lgkmcnt(3)
  v_mfma_f32_16x16x32_bf16 v[80:83], v[56:59], v[184:187], v[80:83]
  v_mfma_f32_16x16x32_bf16 v[84:87], v[56:59], v[188:191], v[84:87]
  ds_read_b128 v[72:75], v13 offset:768
  s_waitcnt lgkmcnt(3)
  v_mfma_f32_16x16x32_bf16 v[88:91], v[60:63], v[184:187], v[88:91]
  v_mfma_f32_16x16x32_bf16 v[92:95], v[60:63], v[188:191], v[92:95]
  ds_read_b128 v[76:79], v13 offset:21248
  s_waitcnt lgkmcnt(3)
  v_mfma_f32_16x16x32_bf16 v[80:83], v[64:67], v[192:195], v[80:83]
  v_mfma_f32_16x16x32_bf16 v[84:87], v[64:67], v[196:199], v[84:87]
  ds_read_b128 v[56:59], v14 offset:768
  s_waitcnt lgkmcnt(3)
  v_mfma_f32_16x16x32_bf16 v[88:91], v[68:71], v[192:195], v[88:91]
  v_mfma_f32_16x16x32_bf16 v[92:95], v[68:71], v[196:199], v[92:95]
  ds_read_b128 v[60:63], v14 offset:21248
  s_waitcnt lgkmcnt(3)
  v_mfma_f32_16x16x32_bf16 v[80:83], v[72:75], v[200:203], v[80:83]
  v_mfma_f32_16x16x32_bf16 v[84:87], v[72:75], v[204:207], v[84:87]
  ds_read_b128 v[64:67], v15 offset:768
  s_waitcnt lgkmcnt(3)
  v_mfma_f32_16x16x32_bf16 v[88:91], v[76:79], v[200:203], v[88:91]
  v_mfma_f32_16x16x32_bf16 v[92:95], v[76:79], v[204:207], v[92:95]
  ds_read_b128 v[68:71], v15 offset:21248
  s_waitcnt lgkmcnt(3)
  v_mfma_f32_16x16x32_bf16 v[80:83], v[56:59], v[208:211], v[80:83]
  v_mfma_f32_16x16x32_bf16 v[84:87], v[56:59], v[212:215], v[84:87]
  ds_read_b128 v[72:75], v12 offset:1024
  s_waitcnt lgkmcnt(3)
  v_mfma_f32_16x16x32_bf16 v[88:91], v[60:63], v[208:211], v[88:91]
  v_mfma_f32_16x16x32_bf16 v[92:95], v[60:63], v[212:215], v[92:95]
  ds_read_b128 v[76:79], v12 offset:21504
  s_waitcnt lgkmcnt(3)
  v_mfma_f32_16x16x32_bf16 v[80:83], v[64:67], v[216:219], v[80:83]
  v_mfma_f32_16x16x32_bf16 v[84:87], v[64:67], v[220:223], v[84:87]
  ds_read_b128 v[56:59], v13 offset:1024
  s_cmp_ge_u32 s27, 62
  s_cbranch_scc1 L_qkv_o1c_w0
  s_waitcnt vmcnt(5)
  s_branch L_qkv_o1c_w1
L_qkv_o1c_w0:
  s_waitcnt vmcnt(0)
L_qkv_o1c_w1:
  v_mov_b32 v24, s27
  buffer_store_dword v24, v17, s[8:11], 0 offen sc1
  s_waitcnt lgkmcnt(3)
  v_mfma_f32_16x16x32_bf16 v[88:91], v[68:71], v[216:219], v[88:91]
  v_mfma_f32_16x16x32_bf16 v[92:95], v[68:71], v[220:223], v[92:95]
  ds_read_b128 v[60:63], v13 offset:21504
  s_waitcnt lgkmcnt(3)
  v_mfma_f32_16x16x32_bf16 v[80:83], v[72:75], v[224:227], v[80:83]
  v_mfma_f32_16x16x32_bf16 v[84:87], v[72:75], v[228:231], v[84:87]
  ds_read_b128 v[64:67], v14 offset:1024
  s_waitcnt lgkmcnt(3)
  v_mfma_f32_16x16x32_bf16 v[88:91], v[76:79], v[224:227], v[88:91]
  v_mfma_f32_16x16x32_bf16 v[92:95], v[76:79], v[228:231], v[92:95]
  ds_read_b128 v[68:71], v14 offset:21504
  s_waitcnt lgkmcnt(3)
  v_mfma_f32_16x16x32_bf16 v[80:83], v[56:59], v[232:235], v[80:83]
  v_mfma_f32_16x16x32_bf16 v[84:87], v[56:59], v[236:239], v[84:87]
  ds_read_b128 v[72:75], v15 offset:1024
  s_waitcnt lgkmcnt(3)
  v_mfma_f32_16x16x32_bf16 v[88:91], v[60:63], v[232:235], v[88:91]
  v_mfma_f32_16x16x32_bf16 v[92:95], v[60:63], v[236:239], v[92:95]
  ds_read_b128 v[76:79], v15 offset:21504
  s_waitcnt lgkmcnt(3)
  v_mfma_f32_16x16x32_bf16 v[80:83], v[64:67], v[240:243], v[80:83]
  v_mfma_f32_16x16x32_bf16 v[84:87], v[64:67], v[244:247], v[84:87]
  ds_read_b128 v[56:59], v8 offset:0
  s_waitcnt lgkmcnt(3)
  v_mfma_f32_16x16x32_bf16 v[88:91], v[68:71], v[240:243], v[88:91]
  v_mfma_f32_16x16x32_bf16 v[92:95], v[68:71], v[244:247], v[92:95]
  ds_read_b128 v[60:63], v8 offset:20480
  s_waitcnt lgkmcnt(3)
  v_mfma_f32_16x16x32_bf16 v[80:83], v[72:75], v[248:251], v[80:83]
  v_mfma_f32_16x16x32_bf16 v[84:87], v[72:75], v[252:255], v[84:87]
  ds_read_b128 v[64:67], v9 offset:0
  s_waitcnt lgkmcnt(3)
  v_mfma_f32_16x16x32_bf16 v[88:91], v[76:79], v[248:251], v[88:91]
  v_mfma_f32_16x16x32_bf16 v[92:95], v[76:79], v[252:255], v[92:95]
  ds_read_b128 v[68:71], v9 offset:20480
  s_lshl_b32 s31, s27, 18
  s_add_u32 s27, s27, 1
  s_nop 4
  v_cvt_pk_bf16_f32 v48, v80, v81
  v_cvt_pk_bf16_f32 v49, v82, v83
  v_cvt_pk_bf16_f32 v50, v88, v89
  v_cvt_pk_bf16_f32 v51, v90, v91
  v_cvt_pk_bf16_f32 v52, v84, v85
  v_cvt_pk_bf16_f32 v53, v86, v87
  v_cvt_pk_bf16_f32 v54, v92, v93
  v_cvt_pk_bf16_f32 v55, v94, v95
  buffer_store_dwordx4 v[48:51], v16, s[8:11], s31 offen sc1
  buffer_store_dwordx4 v[52:55], v16, s[8:11], s31 offen offset:1024 sc1
  s_cmp_ge_u32 s27, 64
  s_cbranch_scc1 L_qkv_exit
  s_branch L_qkv_o1_loop
L_qkv_exit:
  s_waitcnt vmcnt(0) lgkmcnt(0)
  v_mov_b32 v24, 64
  buffer_store_dword v24, v17, s[8:11], 0 offen sc1
  s_cmp_lt_u32 s4, 40
  s_cbranch_scc0 L_qkv_done
  s_waitcnt vmcnt(0) lgkmcnt(0)
  s_barrier
  s_branch L_out2
L_qkv_done:
  s_endpgm
L_attx:
  s_cmp_eq_u32 s98, 0
  s_cbranch_scc0 L_attx_vote_skip
  s_cmp_eq_u32 s3, 0
  s_cbranch_scc0 L_attx_vote_w
  s_mov_b32 s56, s86
  s_and_b32 s57, s87, 0xffff
  s_mov_b32 s58, 256
  s_mov_b32 s59, 0x20000
  s_and_b32 s60, s7, 3
  s_cmp_eq_u32 s60, 3
  s_cbranch_scc0 L_attx_vote_lead_no
  v_and_b32 v3, 7, v1
  v_lshlrev_b32 v3, 2, v3
  s_mov_b32 s63, 0
L_attx_vote_lead:
  s_sleep 8
  buffer_load_dword v2, v3, s[56:59], 0 offen sc1
  s_waitcnt vmcnt(0)
  s_mov_b32 s60, 0
  s_mov_b32 s61, 0
  v_readlane_b32 s62, v2, 0
  s_nop 0
  s_add_u32 s60, s60, s62
  s_max_u32 s61, s61, s62
  v_readlane_b32 s62, v2, 1
  s_nop 0
  s_add_u32 s60, s60, s62
  s_max_u32 s61, s61, s62
  v_readlane_b32 s62, v2, 2
  s_nop 0
  s_add_u32 s60, s60, s62
  s_max_u32 s61, s61, s62
  v_readlane_b32 s62, v2, 3
  s_nop 0
  s_add_u32 s60, s60, s62
  s_max_u32 s61, s61, s62
  v_readlane_b32 s62, v2, 4
  s_nop 0
  s_add_u32 s60, s60, s62
  s_max_u32 s61, s61, s62
  v_readlane_b32 s62, v2, 5
  s_nop 0
  s_add_u32 s60, s60, s62
  s_max_u32 s61, s61, s62
  v_readlane_b32 s62, v2, 6
  s_nop 0
  s_add_u32 s60, s60, s62
  s_max_u32 s61, s61, s62
  v_readlane_b32 s62, v2, 7
  s_nop 0
  s_add_u32 s60, s60, s62
  s_max_u32 s61, s61, s62
  s_cmp_ge_u32 s60, 256
  s_cbranch_scc1 L_attx_vote_lead_all
  s_add_u32 s63, s63, 1
  s_cmp_lt_u32 s63, 0x40000
  s_cbranch_scc1 L_attx_vote_lead
L_attx_vote_lead_all:
  s_cmp_eq_u32 s61, 256
  s_cselect_b32 s60, 1, 2
  v_mov_b32 v2, s60
  v_mov_b32 v3, 128
  s_mov_b64 exec, 1
  buffer_store_dword v2, v3, s[56:59], 0 offen sc1
  s_mov_b64 exec, -1
L_attx_vote_lead_no:
  s_mov_b32 s63, 0
  v_mov_b32 v3, 128
  buffer_load_dword v2, v3, s[56:59], 0 offen sc1
  s_waitcnt vmcnt(0)
L_attx_vote:
  v_readfirstlane_b32 s60, v2
  s_nop 0
  s_cmp_eq_u32 s60, 1
  s_cbranch_scc1 L_attx_vote_all
  s_cmp_eq_u32 s60, 2
  s_cbranch_scc1 L_attx_vote_bad
  s_add_u32 s63, s63, 1
  s_cmp_ge_u32 s63, 0x40000
  s_cbranch_scc1 L_attx_vote_bad
  s_sleep 8
  buffer_load_dword v2, v3, s[56:59], 0 offen sc1
  s_waitcnt vmcnt(0)
  s_branch L_attx_vote
L_attx_vote_all:
  v_mov_b32 v2, 1
  s_branch L_attx_vote_pub
L_attx_vote_bad:
  v_mov_b32 v2, 2
L_attx_vote_pub:
  v_mov_b32 v3, 163824
  ds_write_b32 v3, v2
  s_waitcnt lgkmcnt(0)
L_attx_vote_w:
  s_barrier
  v_mov_b32 v3, 163824
  ds_read_b32 v2, v3
  s_waitcnt lgkmcnt(0)
  v_readfirstlane_b32 s60, v2
  s_nop 0
  s_cmp_eq_u32 s60, 2
  s_cbranch_scc1 L_restart
L_attx_vote_skip:
  s_cmp_eq_u32 s4, 0
  s_cbranch_scc0 L_attx_noprobe
  s_cmp_eq_u32 s3, 0
  s_cbranch_scc0 L_attx_noprobe
  s_mov_b32 s40, -1
  s_mov_b32 s41, -1
  v_mov_b32 v16, 0
  v_mov_b32 v14, 118226944
  v_mov_b32 v15, 118235136
  s_mov_b64 exec, 1
  s_memtime s[42:43]
  s_waitcnt lgkmcnt(0)
  buffer_store_dword v16, v14, s[8:11], 0 offen sc1
  s_waitcnt vmcnt(0)
  s_memtime s[44:45]
  s_waitcnt lgkmcnt(0)
  s_sub_u32 s44, s44, s42
  s_min_u32 s40, s40, s44
  s_memtime s[42:43]
  s_waitcnt lgkmcnt(0)
  buffer_store_dword v16, v15, s[8:11], 0 offen sc1
  s_waitcnt vmcnt(0)
  s_memtime s[44:45]
  s_waitcnt lgkmcnt(0)
  s_sub_u32 s44, s44, s42
  s_min_u32 s41, s41, s44
  s_memtime s[42:43]
  s_waitcnt lgkmcnt(0)
  buffer_store_dword v16, v14, s[8:11], 0 offen sc1
  s_waitcnt vmcnt(0)
  s_memtime s[44:45]
  s_waitcnt lgkmcnt(0)
  s_sub_u32 s44, s44, s42
  s_min_u32 s40, s40, s44
  s_memtime s[42:43]
  s_waitcnt lgkmcnt(0)
  buffer_store_dword v16, v15, s[8:11], 0 offen sc1
  s_waitcnt vmcnt(0)
  s_memtime s[44:45]
  s_waitcnt lgkmcnt(0)
  s_sub_u32 s44, s44, s42
  s_min_u32 s41, s41, s44
  s_memtime s[42:43]
  s_waitcnt lgkmcnt(0)
  buffer_store_dword v16, v14, s[8:11], 0 offen sc1
  s_waitcnt vmcnt(0)
  s_memtime s[44:45]
  s_waitcnt lgkmcnt(0)
  s_sub_u32 s44, s44, s42
  s_min_u32 s40, s40, s44
  s_memtime s[42:43]
  s_waitcnt lgkmcnt(0)
  buffer_store_dword v16, v15, s[8:11], 0 offen sc1
  s_waitcnt vmcnt(0)
  s_memtime s[44:45]
  s_waitcnt lgkmcnt(0)
  s_sub_u32 s44, s44, s42
  s_min_u32 s41, s41, s44
  s_memtime s[42:43]
  s_waitcnt lgkmcnt(0)
  buffer_store_dword v16, v14, s[8:11], 0 offen sc1
  s_waitcnt vmcnt(0)
  s_memtime s[44:45]
  s_waitcnt lgkmcnt(0)
  s_sub_u32 s44, s44, s42
  s_min_u32 s40, s40, s44
  s_memtime s[42:43]
  s_waitcnt lgkmcnt(0)
  buffer_store_dword v16, v15, s[8:11], 0 offen sc1
  s_waitcnt vmcnt(0)
  s_memtime s[44:45]
  s_waitcnt lgkmcnt(0)
  s_sub_u32 s44, s44, s42
  s_min_u32 s41, s41, s44
  s_cmp_lt_u32 s41, s40
  s_cselect_b32 s42, 1, 2
  v_mov_b32 v16, s42
  v_mov_b32 v14, 15360
  buffer_store_dword v16, v14, s[8:11], 0 offen sc1
  s_mov_b64 exec, -1
L_attx_noprobe:
  s_lshl_b32 s28, s4, 3
  s_add_u32 s28, s28, s3
  s_lshr_b32 s24, s28, 1
  s_and_b32 s26, s28, 1
  s_mov_b32 s46, 2
  s_mov_b32 s47, 40
  s_branch L_attx_common
L_attx2:
  s_mov_b32 s24, s4
  s_add_u32 s26, s3, 40
  s_mov_b32 s46, 8
  s_mov_b32 s47, 64
L_attx_common:
  s_mov_b32 s27, 0
  s_mov_b32 s32, 0
  s_mov_b32 s33, 0
  v_lshlrev_b32 v2, 4, v1
  v_and_b32 v10, 15, v1
  v_lshrrev_b32 v11, 4, v1
  v_and_b32 v12, 7, v1
  v_lshlrev_b32 v13, 7, v11
  v_lshl_add_u32 v3, v12, 4, v13
  v_and_b32 v13, 1, v11
  v_lshlrev_b32 v13, 8, v13
  v_lshl_add_u32 v4, v10, 4, v13
  v_lshlrev_b32 v13, 2, v11
  v_add_u32 v14, 0, v13
  v_cmp_le_u32 s[36:37], v14, v10
  v_add_u32 v14, 1, v13
  v_cmp_le_u32 s[38:39], v14, v10
  v_add_u32 v14, 2, v13
  v_cmp_le_u32 s[40:41], v14, v10
  v_add_u32 v14, 3, v13
  v_cmp_le_u32 s[42:43], v14, v10
  v_cmp_gt_u32 s[44:45], 2, v11
  v_and_b32 v13, 15, v1
  v_min_u32 v13, 11, v13
  v_lshrrev_b32 v14, 2, v13
  v_lshlrev_b32 v14, 11, v14
  v_and_b32 v13, 3, v13
  v_lshl_add_u32 v14, v13, 2, v14
  s_lshl_b32 s28, s24, 6
  s_add_u32 s29, s28, 0
  v_add_u32 v5, s29, v14
  s_lshr_b32 s29, s24, 3
  s_lshl_b32 s29, s29, 6
  s_add_u32 s29, s29, 14336
  v_mov_b32 v6, s29
  s_add_u32 s29, s28, 8192
  v_and_b32 v13, 7, v1
  v_lshl_add_u32 v7, v13, 2, s29
  s_lshl_b32 s29, s24, 2
  s_add_u32 s29, s29, 32768
  v_mov_b32 v8, 1073741824
  v_cmp_eq_u32 vcc, 0, v1
  v_mov_b32 v13, s29
  s_nop 0
  v_cndmask_b32 v8, v8, v13, vcc
L_attx_loop:
  s_add_u32 s30, s26, 1
  s_cmp_ge_u32 s32, s30
  s_cbranch_scc1 L_attx_wq_ok
L_attx_wq:
  buffer_load_dword v9, v5, s[8:11], 0 offen sc1
  s_waitcnt vmcnt(0)
  v_readlane_b32 s32, v9, 0
  v_readlane_b32 s31, v9, 1
  s_nop 0
  s_min_u32 s32, s32, s31
  v_readlane_b32 s31, v9, 2
  s_nop 0
  s_min_u32 s32, s32, s31
  v_readlane_b32 s31, v9, 3
  s_nop 0
  s_min_u32 s32, s32, s31
  v_readlane_b32 s31, v9, 4
  s_nop 0
  s_min_u32 s32, s32, s31
  v_readlane_b32 s31, v9, 5
  s_nop 0
  s_min_u32 s32, s32, s31
  v_readlane_b32 s31, v9, 6
  s_nop 0
  s_min_u32 s32, s32, s31
  v_readlane_b32 s31, v9, 7
  s_nop 0
  s_min_u32 s32, s32, s31
  v_readlane_b32 s31, v9, 8
  s_nop 0
  s_min_u32 s32, s32, s31
  v_readlane_b32 s31, v9, 9
  s_nop 0
  s_min_u32 s32, s32, s31
  v_readlane_b32 s31, v9, 10
  s_nop 0
  s_min_u32 s32, s32, s31
  v_readlane_b32 s31, v9, 11
  s_nop 0
  s_min_u32 s32, s32, s31
  s_nop 0
  s_cmp_ge_u32 s32, s30
  s_cbranch_scc1 L_attx_wq_ok
  s_sleep 8
  s_add_u32 s27, s27, 1
  s_cmp_lt_u32 s27, 262144
  s_cbranch_scc1 L_attx_wq
L_attx_wq_ok:
  s_lshl_b32 s28, s26, 5
  s_add_u32 s28, s28, s24
  s_lshl_b32 s34, s28, 13
  s_lshl_b32 s35, s28, 11
  s_add_u32 s28, s34, 37748736
  s_add_u32 s29, s28, 4096
  buffer_load_dwordx4 v[16:19], v2, s[8:11], s28 offen offset:0 sc1
  buffer_load_dwordx4 v[20:23], v2, s[8:11], s28 offen offset:1024 sc1
  buffer_load_dwordx4 v[24:27], v2, s[8:11], s28 offen offset:2048 sc1
  buffer_load_dwordx4 v[28:31], v2, s[8:11], s28 offen offset:3072 sc1
  buffer_load_dwordx4 v[32:35], v2, s[8:11], s29 offen offset:0 sc1
  buffer_load_dwordx4 v[36:39], v2, s[8:11], s29 offen offset:1024 sc1
  buffer_load_dwordx4 v[40:43], v2, s[8:11], s29 offen offset:2048 sc1
  buffer_load_dwordx4 v[44:47], v2, s[8:11], s29 offen offset:3072 sc1
  s_add_u32 s28, s34, 4194304
  s_add_u32 s29, s28, 4096
  buffer_load_dwordx4 v[48:51], v2, s[8:11], s28 offen offset:0 sc1
  buffer_load_dwordx4 v[52:55], v2, s[8:11], s28 offen offset:1024 sc1
  buffer_load_dwordx4 v[56:59], v2, s[8:11], s28 offen offset:2048 sc1
  buffer_load_dwordx4 v[60:63], v2, s[8:11], s28 offen offset:3072 sc1
  buffer_load_dwordx4 v[64:67], v2, s[8:11], s29 offen offset:0 sc1
  buffer_load_dwordx4 v[68:71], v2, s[8:11], s29 offen offset:1024 sc1
  buffer_load_dwordx4 v[72:75], v2, s[8:11], s29 offen offset:2048 sc1
  buffer_load_dwordx4 v[76:79], v2, s[8:11], s29 offen offset:3072 sc1
  s_add_u32 s28, s34, 20971520
  s_add_u32 s29, s28, 4096
  buffer_load_dwordx4 v[80:83], v2, s[8:11], s28 offen offset:0 sc1
  buffer_load_dwordx4 v[84:87], v2, s[8:11], s28 offen offset:1024 sc1
  buffer_load_dwordx4 v[88:91], v2, s[8:11], s28 offen offset:2048 sc1
  buffer_load_dwordx4 v[92:95], v2, s[8:11], s28 offen offset:3072 sc1
  buffer_load_dwordx4 v[96:99], v2, s[8:11], s29 offen offset:0 sc1
  buffer_load_dwordx4 v[100:103], v2, s[8:11], s29 offen offset:1024 sc1
  buffer_load_dwordx4 v[104:107], v2, s[8:11], s29 offen offset:2048 sc1
  buffer_load_dwordx4 v[108:111], v2, s[8:11], s29 offen offset:3072 sc1
  s_add_u32 s30, s26, 1
  s_cmp_ge_u32 s26, 62
  s_cbranch_scc1 L_attx_fin
  s_cmp_ge_u32 s33, s30
  s_cbranch_scc1 L_attx_wx_ok
L_attx_wx:
  buffer_load_dword v9, v6, s[8:11], 0 offen sc1
  s_waitcnt vmcnt(0)
  v_readlane_b32 s33, v9, 0
  s_nop 0
  s_cmp_ge_u32 s33, s30
  s_cbranch_scc1 L_attx_wx_ok
  s_sleep 2
  s_add_u32 s27, s27, 1
  s_cmp_lt_u32 s27, 262144
  s_cbranch_scc1 L_attx_wx
L_attx_wx_ok:
  s_branch L_attx_go
L_attx_fin:
  s_mov_b32 s30, 64
  s_mov_b32 s33, 0
  s_cmp_ge_u32 s33, s30
  s_cbranch_scc1 L_attx_we_ok
L_attx_we:
  buffer_load_dword v9, v7, s[8:11], 0 offen sc1
  s_waitcnt vmcnt(0)
  v_readlane_b32 s33, v9, 0
  v_readlane_b32 s31, v9, 1
  s_nop 0
  s_min_u32 s33, s33, s31
  v_readlane_b32 s31, v9, 2
  s_nop 0
  s_min_u32 s33, s33, s31
  v_readlane_b32 s31, v9, 3
  s_nop 0
  s_min_u32 s33, s33, s31
  v_readlane_b32 s31, v9, 4
  s_nop 0
  s_min_u32 s33, s33, s31
  v_readlane_b32 s31, v9, 5
  s_nop 0
  s_min_u32 s33, s33, s31
  v_readlane_b32 s31, v9, 6
  s_nop 0
  s_min_u32 s33, s33, s31
  v_readlane_b32 s31, v9, 7
  s_nop 0
  s_min_u32 s33, s33, s31
  s_nop 0
  s_cmp_ge_u32 s33, s30
  s_cbranch_scc1 L_attx_we_ok
  s_sleep 1
  s_add_u32 s27, s27, 1
  s_cmp_lt_u32 s27, 262144
  s_cbranch_scc1 L_attx_we
L_attx_we_ok:
L_attx_go:
  s_add_u32 s28, s35, 71303168
  buffer_load_dwordx4 v[112:115], v3, s[8:11], s28 offen offset:0 sc1
  buffer_load_dwordx4 v[116:119], v3, s[8:11], s28 offen offset:512 sc1
  buffer_load_dwordx4 v[120:123], v3, s[8:11], s28 offen offset:1024 sc1
  buffer_load_dwordx4 v[124:127], v3, s[8:11], s28 offen offset:1536 sc1
  s_add_u32 s28, s35, 75497472
  buffer_load_dwordx4 v[128:131], v4, s[8:11], s28 offen offset:0 sc1
  buffer_load_dwordx4 v[132:135], v4, s[8:11], s28 offen offset:512 sc1
  buffer_load_dwordx4 v[136:139], v4, s[8:11], s28 offen offset:1024 sc1
  buffer_load_dwordx4 v[140:143], v4, s[8:11], s28 offen offset:1536 sc1
  s_waitcnt vmcnt(4)
  v_mfma_f32_16x16x32_bf16 v[144:147], v[48:51], v[16:19], 0
  v_mfma_f32_16x16x32_bf16 v[148:151], v[112:115], v[16:19], 0
  v_mfma_f32_16x16x32_bf16 v[152:155], v[48:51], v[20:23], 0
  v_mfma_f32_16x16x32_bf16 v[156:159], v[52:55], v[20:23], 0
  v_mfma_f32_16x16x32_bf16 v[160:163], v[112:115], v[20:23], 0
  v_mfma_f32_16x16x32_bf16 v[144:147], v[56:59], v[24:27], v[144:147]
  v_mfma_f32_16x16x32_bf16 v[148:151], v[116:119], v[24:27], v[148:151]
  v_mfma_f32_16x16x32_bf16 v[152:155], v[56:59], v[28:31], v[152:155]
  v_mfma_f32_16x16x32_bf16 v[156:159], v[60:63], v[28:31], v[156:159]
  v_mfma_f32_16x16x32_bf16 v[160:163], v[116:119], v[28:31], v[160:163]
  v_mfma_f32_16x16x32_bf16 v[144:147], v[64:67], v[32:35], v[144:147]
  v_mfma_f32_16x16x32_bf16 v[148:151], v[120:123], v[32:35], v[148:151]
  v_mfma_f32_16x16x32_bf16 v[152:155], v[64:67], v[36:39], v[152:155]
  v_mfma_f32_16x16x32_bf16 v[156:159], v[68:71], v[36:39], v[156:159]
  v_mfma_f32_16x16x32_bf16 v[160:163], v[120:123], v[36:39], v[160:163]
  v_mfma_f32_16x16x32_bf16 v[144:147], v[72:75], v[40:43], v[144:147]
  v_mfma_f32_16x16x32_bf16 v[148:151], v[124:127], v[40:43], v[148:151]
  v_mfma_f32_16x16x32_bf16 v[152:155], v[72:75], v[44:47], v[152:155]
  v_mfma_f32_16x16x32_bf16 v[156:159], v[76:79], v[44:47], v[156:159]
  v_mfma_f32_16x16x32_bf16 v[160:163], v[124:127], v[44:47], v[160:163]
  s_nop 7
  v_mov_b32 v10, 0xff800000
  v_cndmask_b32 v144, v10, v144, s[36:37]
  v_cndmask_b32 v145, v10, v145, s[38:39]
  v_cndmask_b32 v146, v10, v146, s[40:41]
  v_cndmask_b32 v147, v10, v147, s[42:43]
  v_cndmask_b32 v148, v10, v148, s[44:45]
  v_cndmask_b32 v149, v10, v149, s[44:45]
  v_cndmask_b32 v150, v10, v150, s[44:45]
  v_cndmask_b32 v151, v10, v151, s[44:45]
  v_cndmask_b32 v156, v10, v156, s[36:37]
  v_cndmask_b32 v157, v10, v157, s[38:39]
  v_cndmask_b32 v158, v10, v158, s[40:41]
  v_cndmask_b32 v159, v10, v159, s[42:43]
  v_cndmask_b32 v160, v10, v160, s[44:45]
  v_cndmask_b32 v161, v10, v161, s[44:45]
  v_cndmask_b32 v162, v10, v162, s[44:45]
  v_cndmask_b32 v163, v10, v163, s[44:45]
  s_mov_b32 s29, 0x3e0293ee
  v_max3_f32 v11, v144, v145, v146
  v_max3_f32 v11, v11, v147, v148
  v_max3_f32 v11, v11, v149, v150
  v_max_f32 v11, v11, v151
  v_mov_b32 v12, v11
  s_nop 1
  v_permlane16_swap_b32 v11, v12
  v_max_f32 v11, v11, v12
  v_mov_b32 v12, v11
  s_nop 1
  v_permlane32_swap_b32 v11, v12
  v_max_f32 v11, v11, v12
  v_mul_f32 v11, s29, v11
  v_fma_f32 v144, v144, s29, -v11
  v_fma_f32 v145, v145, s29, -v11
  v_fma_f32 v146, v146, s29, -v11
  v_fma_f32 v147, v147, s29, -v11
  v_fma_f32 v148, v148, s29, -v11
  v_fma_f32 v149, v149, s29, -v11
  v_fma_f32 v150, v150, s29, -v11
  v_fma_f32 v151, v151, s29, -v11
  v_exp_f32 v144, v144
  v_exp_f32 v145, v145
  v_exp_f32 v146, v146
  v_exp_f32 v147, v147
  v_exp_f32 v148, v148
  v_exp_f32 v149, v149
  v_exp_f32 v150, v150
  v_exp_f32 v151, v151
  s_nop 0
  v_cvt_pk_bf16_f32 v168, v144, v145
  v_cvt_pk_bf16_f32 v169, v146, v147
  v_mov_b32 v170, 0
  v_mov_b32 v171, 0
  v_cvt_pk_bf16_f32 v176, v148, v149
  v_cvt_pk_bf16_f32 v177, v150, v151
  v_add_f32 v11, v144, v145
  v_add_f32 v11, v11, v146
  v_add_f32 v11, v11, v147
  v_add_f32 v11, v11, v148
  v_add_f32 v11, v11, v149
  v_add_f32 v11, v11, v150
  v_add_f32 v11, v11, v151
  v_mov_b32 v12, v11
  s_nop 1
  v_permlane16_swap_b32 v11, v12
  v_add_f32 v11, v11, v12
  v_mov_b32 v12, v11
  s_nop 1
  v_permlane32_swap_b32 v11, v12
  v_add_f32 v11, v11, v12
  v_rcp_f32 v11, v11
  v_max3_f32 v13, v152, v153, v154
  v_max3_f32 v13, v13, v155, v156
  v_max3_f32 v13, v13, v157, v158
  v_max3_f32 v13, v13, v159, v160
  v_max3_f32 v13, v13, v161, v162
  v_max_f32 v13, v13, v163
  v_mov_b32 v14, v13
  s_nop 1
  v_permlane16_swap_b32 v13, v14
  v_max_f32 v13, v13, v14
  v_mov_b32 v14, v13
  s_nop 1
  v_permlane32_swap_b32 v13, v14
  v_max_f32 v13, v13, v14
  v_mul_f32 v13, s29, v13
  v_fma_f32 v152, v152, s29, -v13
  v_fma_f32 v153, v153, s29, -v13
  v_fma_f32 v154, v154, s29, -v13
  v_fma_f32 v155, v155, s29, -v13
  v_fma_f32 v156, v156, s29, -v13
  v_fma_f32 v157, v157, s29, -v13
  v_fma_f32 v158, v158, s29, -v13
  v_fma_f32 v159, v159, s29, -v13
  v_fma_f32 v160, v160, s29, -v13
  v_fma_f32 v161, v161, s29, -v13
  v_fma_f32 v162, v162, s29, -v13
  v_fma_f32 v163, v163, s29, -v13
  v_exp_f32 v152, v152
  v_exp_f32 v153, v153
  v_exp_f32 v154, v154
  v_exp_f32 v155, v155
  v_exp_f32 v156, v156
  v_exp_f32 v157, v157
  v_exp_f32 v158, v158
  v_exp_f32 v159, v159
  v_exp_f32 v160, v160
  v_exp_f32 v161, v161
  v_exp_f32 v162, v162
  v_exp_f32 v163, v163
  s_nop 0
  v_cvt_pk_bf16_f32 v172, v152, v153
  v_cvt_pk_bf16_f32 v173, v154, v155
  v_cvt_pk_bf16_f32 v174, v156, v157
  v_cvt_pk_bf16_f32 v175, v158, v159
  v_cvt_pk_bf16_f32 v178, v160, v161
  v_cvt_pk_bf16_f32 v179, v162, v163
  v_add_f32 v13, v152, v153
  v_add_f32 v13, v13, v154
  v_add_f32 v13, v13, v155
  v_add_f32 v13, v13, v156
  v_add_f32 v13, v13, v157
  v_add_f32 v13, v13, v158
  v_add_f32 v13, v13, v159
  v_add_f32 v13, v13, v160
  v_add_f32 v13, v13, v161
  v_add_f32 v13, v13, v162
  v_add_f32 v13, v13, v163
  v_mov_b32 v14, v13
  s_nop 1
  v_permlane16_swap_b32 v13, v14
  v_add_f32 v13, v13, v14
  v_mov_b32 v14, v13
  s_nop 1
  v_permlane32_swap_b32 v13, v14
  v_add_f32 v13, v13, v14
  v_rcp_f32 v13, v13
  s_waitcnt vmcnt(0)
  s_add_u32 s28, s34, 54525952
  s_add_u32 s29, s28, 4096
  v_mfma_f32_16x16x32_bf16 v[180:183], v[80:83], v[168:171], 0
  v_mfma_f32_16x16x32_bf16 v[184:187], v[84:87], v[168:171], 0
  v_mfma_f32_16x16x32_bf16 v[188:191], v[80:83], v[172:175], 0
  v_mfma_f32_16x16x32_bf16 v[192:195], v[84:87], v[172:175], 0
  v_mfma_f32_16x16x16_bf16 v[180:183], v[128:129], v[176:177], v[180:183]
  v_mfma_f32_16x16x16_bf16 v[184:187], v[130:131], v[176:177], v[184:187]
  v_mfma_f32_16x16x16_bf16 v[188:191], v[128:129], v[178:179], v[188:191]
  v_mfma_f32_16x16x16_bf16 v[192:195], v[130:131], v[178:179], v[192:195]
  s_nop 4
  v_mul_f32 v180, v180, v11
  v_mul_f32 v181, v181, v11
  v_mul_f32 v182, v182, v11
  v_mul_f32 v183, v183, v11
  v_mul_f32 v184, v184, v11
  v_mul_f32 v185, v185, v11
  v_mul_f32 v186, v186, v11
  v_mul_f32 v187, v187, v11
  v_cvt_pk_bf16_f32 v196, v180, v181
  v_cvt_pk_bf16_f32 v197, v182, v183
  v_cvt_pk_bf16_f32 v198, v184, v185
  v_cvt_pk_bf16_f32 v199, v186, v187
  buffer_store_dwordx4 v[196:199], v2, s[8:11], s28 offen offset:0 sc1
  v_mul_f32 v188, v188, v13
  v_mul_f32 v189, v189, v13
  v_mul_f32 v190, v190, v13
  v_mul_f32 v191, v191, v13
  v_mul_f32 v192, v192, v13
  v_mul_f32 v193, v193, v13
  v_mul_f32 v194, v194, v13
  v_mul_f32 v195, v195, v13
  v_cvt_pk_bf16_f32 v200, v188, v189
  v_cvt_pk_bf16_f32 v201, v190, v191
  v_cvt_pk_bf16_f32 v202, v192, v193
  v_cvt_pk_bf16_f32 v203, v194, v195
  buffer_store_dwordx4 v[200:203], v2, s[8:11], s28 offen offset:1024 sc1
  s_nop 1
  v_mfma_f32_16x16x32_bf16 v[180:183], v[88:91], v[168:171], 0
  v_mfma_f32_16x16x32_bf16 v[184:187], v[92:95], v[168:171], 0
  v_mfma_f32_16x16x32_bf16 v[188:191], v[88:91], v[172:175], 0
  v_mfma_f32_16x16x32_bf16 v[192:195], v[92:95], v[172:175], 0
  v_mfma_f32_16x16x16_bf16 v[180:183], v[132:133], v[176:177], v[180:183]
  v_mfma_f32_16x16x16_bf16 v[184:187], v[134:135], v[176:177], v[184:187]
  v_mfma_f32_16x16x16_bf16 v[188:191], v[132:133], v[178:179], v[188:191]
  v_mfma_f32_16x16x16_bf16 v[192:195], v[134:135], v[178:179], v[192:195]
  s_nop 4
  v_mul_f32 v180, v180, v11
  v_mul_f32 v181, v181, v11
  v_mul_f32 v182, v182, v11
  v_mul_f32 v183, v183, v11
  v_mul_f32 v184, v184, v11
  v_mul_f32 v185, v185, v11
  v_mul_f32 v186, v186, v11
  v_mul_f32 v187, v187, v11
  v_cvt_pk_bf16_f32 v204, v180, v181
  v_cvt_pk_bf16_f32 v205, v182, v183
  v_cvt_pk_bf16_f32 v206, v184, v185
  v_cvt_pk_bf16_f32 v207, v186, v187
  buffer_store_dwordx4 v[204:207], v2, s[8:11], s28 offen offset:2048 sc1
  v_mul_f32 v188, v188, v13
  v_mul_f32 v189, v189, v13
  v_mul_f32 v190, v190, v13
  v_mul_f32 v191, v191, v13
  v_mul_f32 v192, v192, v13
  v_mul_f32 v193, v193, v13
  v_mul_f32 v194, v194, v13
  v_mul_f32 v195, v195, v13
  v_cvt_pk_bf16_f32 v208, v188, v189
  v_cvt_pk_bf16_f32 v209, v190, v191
  v_cvt_pk_bf16_f32 v210, v192, v193
  v_cvt_pk_bf16_f32 v211, v194, v195
  buffer_store_dwordx4 v[208:211], v2, s[8:11], s28 offen offset:3072 sc1
  s_nop 1
  v_mfma_f32_16x16x32_bf16 v[180:183], v[96:99], v[168:171], 0
  v_mfma_f32_16x16x32_bf16 v[184:187], v[100:103], v[168:171], 0
  v_mfma_f32_16x16x32_bf16 v[188:191], v[96:99], v[172:175], 0
  v_mfma_f32_16x16x32_bf16 v[192:195], v[100:103], v[172:175], 0
  v_mfma_f32_16x16x16_bf16 v[180:183], v[136:137], v[176:177], v[180:183]
  v_mfma_f32_16x16x16_bf16 v[184:187], v[138:139], v[176:177], v[184:187]
  v_mfma_f32_16x16x16_bf16 v[188:191], v[136:137], v[178:179], v[188:191]
  v_mfma_f32_16x16x16_bf16 v[192:195], v[138:139], v[178:179], v[192:195]
  s_nop 4
  v_mul_f32 v180, v180, v11
  v_mul_f32 v181, v181, v11
  v_mul_f32 v182, v182, v11
  v_mul_f32 v183, v183, v11
  v_mul_f32 v184, v184, v11
  v_mul_f32 v185, v185, v11
  v_mul_f32 v186, v186, v11
  v_mul_f32 v187, v187, v11
  v_cvt_pk_bf16_f32 v196, v180, v181
  v_cvt_pk_bf16_f32 v197, v182, v183
  v_cvt_pk_bf16_f32 v198, v184, v185
  v_cvt_pk_bf16_f32 v199, v186, v187
  buffer_store_dwordx4 v[196:199], v2, s[8:11], s29 offen offset:0 sc1
  v_mul_f32 v188, v188, v13
  v_mul_f32 v189, v189, v13
  v_mul_f32 v190, v190, v13
  v_mul_f32 v191, v191, v13
  v_mul_f32 v192, v192, v13
  v_mul_f32 v193, v193, v13
  v_mul_f32 v194, v194, v13
  v_mul_f32 v195, v195, v13
  v_cvt_pk_bf16_f32 v200, v188, v189
  v_cvt_pk_bf16_f32 v201, v190, v191
  v_cvt_pk_bf16_f32 v202, v192, v193
  v_cvt_pk_bf16_f32 v203, v194, v195
  buffer_store_dwordx4 v[200:203], v2, s[8:11], s29 offen offset:1024 sc1
  s_nop 1
  v_mfma_f32_16x16x32_bf16 v[180:183], v[104:107], v[168:171], 0
  v_mfma_f32_16x16x32_bf16 v[184:187], v[108:111], v[168:171], 0
  v_mfma_f32_16x16x32_bf16 v[188:191], v[104:107], v[172:175], 0
  v_mfma_f32_16x16x32_bf16 v[192:195], v[108:111], v[172:175], 0
  v_mfma_f32_16x16x16_bf16 v[180:183], v[140:141], v[176:177], v[180:183]
  v_mfma_f32_16x16x16_bf16 v[184:187], v[142:143], v[176:177], v[184:187]
  v_mfma_f32_16x16x16_bf16 v[188:191], v[140:141], v[178:179], v[188:191]
  v_mfma_f32_16x16x16_bf16 v[192:195], v[142:143], v[178:179], v[192:195]
  s_nop 4
  v_mul_f32 v180, v180, v11
  v_mul_f32 v181, v181, v11
  v_mul_f32 v182, v182, v11
  v_mul_f32 v183, v183, v11
  v_mul_f32 v184, v184, v11
  v_mul_f32 v185, v185, v11
  v_mul_f32 v186, v186, v11
  v_mul_f32 v187, v187, v11
  v_cvt_pk_bf16_f32 v204, v180, v181
  v_cvt_pk_bf16_f32 v205, v182, v183
  v_cvt_pk_bf16_f32 v206, v184, v185
  v_cvt_pk_bf16_f32 v207, v186, v187
  buffer_store_dwordx4 v[204:207], v2, s[8:11], s29 offen offset:2048 sc1
  v_mul_f32 v188, v188, v13
  v_mul_f32 v189, v189, v13
  v_mul_f32 v190, v190, v13
  v_mul_f32 v191, v191, v13
  v_mul_f32 v192, v192, v13
  v_mul_f32 v193, v193, v13
  v_mul_f32 v194, v194, v13
  v_mul_f32 v195, v195, v13
  v_cvt_pk_bf16_f32 v208, v188, v189
  v_cvt_pk_bf16_f32 v209, v190, v191
  v_cvt_pk_bf16_f32 v210, v192, v193
  v_cvt_pk_bf16_f32 v211, v194, v195
  buffer_store_dwordx4 v[208:211], v2, s[8:11], s29 offen offset:3072 sc1
  s_nop 1
  s_waitcnt vmcnt(0)
  v_mov_b32 v9, 1
  s_lshl_b32 s29, s26, 7
  buffer_store_dword v9, v8, s[8:11], s29 offen sc1
  s_add_u32 s26, s26, s46
  s_cmp_lt_u32 s26, s47
  s_cbranch_scc1 L_attx_loop
  s_endpgm
L_out:
  s_mov_b32 s33, s4
  s_branch L_boot_entry
L_out_after_boot:
  s_cmp_lt_u32 s4, 20
  s_cselect_b32 s25, 0, 1
  s_cselect_b32 s28, 0, 20
  s_sub_u32 s24, s4, s28
  s_mov_b32 s26, s25
  s_branch L_out_common
L_out2:
  s_cmp_lt_u32 s4, 20
  s_cselect_b32 s25, 2, 3
  s_cselect_b32 s28, 0, 20
  s_sub_u32 s24, s4, s28
  s_add_u32 s26, s25, 52
L_out_common:
  s_mov_b32 s27, 0
  s_mov_b32 s32, 0
  s_mov_b32 s16, s74
  s_and_b32 s17, s75, 0xffff
  s_mov_b32 s18, 5242880
  s_mov_b32 s19, 0x20000
  s_mov_b32 s20, s84
  s_and_b32 s21, s85, 0xffff
  s_mov_b32 s22, 5242880
  s_mov_b32 s23, 0x20000
  v_lshlrev_b32 v2, 4, v1
  v_lshrrev_b32 v8, 2, v1
  v_mul_u32_u24 v8, 1280, v8
  v_and_b32 v9, 3, v1
  v_lshl_or_b32 v8, v9, 4, v8
  s_mul_i32 s28, s3, 655360
  s_lshl_b32 s29, s24, 6
  s_add_u32 s28, s28, s29
  buffer_load_dwordx4 v[128:131], v8, s[16:19], s28 offen
  s_add_u32 s28, s28, 20480
  buffer_load_dwordx4 v[132:135], v8, s[16:19], s28 offen
  s_add_u32 s28, s28, 20480
  buffer_load_dwordx4 v[136:139], v8, s[16:19], s28 offen
  s_add_u32 s28, s28, 20480
  buffer_load_dwordx4 v[140:143], v8, s[16:19], s28 offen
  s_add_u32 s28, s28, 20480
  buffer_load_dwordx4 v[144:147], v8, s[16:19], s28 offen
  s_add_u32 s28, s28, 20480
  buffer_load_dwordx4 v[148:151], v8, s[16:19], s28 offen
  s_add_u32 s28, s28, 20480
  buffer_load_dwordx4 v[152:155], v8, s[16:19], s28 offen
  s_add_u32 s28, s28, 20480
  buffer_load_dwordx4 v[156:159], v8, s[16:19], s28 offen
  s_add_u32 s28, s28, 20480
  buffer_load_dwordx4 v[160:163], v8, s[16:19], s28 offen
  s_add_u32 s28, s28, 20480
  buffer_load_dwordx4 v[164:167], v8, s[16:19], s28 offen
  s_add_u32 s28, s28, 20480
  buffer_load_dwordx4 v[168:171], v8, s[16:19], s28 offen
  s_add_u32 s28, s28, 20480
  buffer_load_dwordx4 v[172:175], v8, s[16:19], s28 offen
  s_add_u32 s28, s28, 20480
  buffer_load_dwordx4 v[176:179], v8, s[16:19], s28 offen
  s_add_u32 s28, s28, 20480
  buffer_load_dwordx4 v[180:183], v8, s[16:19], s28 offen
  s_add_u32 s28, s28, 20480
  buffer_load_dwordx4 v[184:187], v8, s[16:19], s28 offen
  s_add_u32 s28, s28, 20480
  buffer_load_dwordx4 v[188:191], v8, s[16:19], s28 offen
  s_add_u32 s28, s28, 20480
  buffer_load_dwordx4 v[192:195], v8, s[16:19], s28 offen
  s_add_u32 s28, s28, 20480
  buffer_load_dwordx4 v[196:199], v8, s[16:19], s28 offen
  s_add_u32 s28, s28, 20480
  buffer_load_dwordx4 v[200:203], v8, s[16:19], s28 offen
  s_add_u32 s28, s28, 20480
  buffer_load_dwordx4 v[204:207], v8, s[16:19], s28 offen
  s_add_u32 s28, s28, 20480
  buffer_load_dwordx4 v[208:211], v8, s[16:19], s28 offen
  s_add_u32 s28, s28, 20480
  buffer_load_dwordx4 v[212:215], v8, s[16:19], s28 offen
  s_add_u32 s28, s28, 20480
  buffer_load_dwordx4 v[216:219], v8, s[16:19], s28 offen
  s_add_u32 s28, s28, 20480
  buffer_load_dwordx4 v[220:223], v8, s[16:19], s28 offen
  s_add_u32 s28, s28, 20480
  buffer_load_dwordx4 v[224:227], v8, s[16:19], s28 offen
  s_add_u32 s28, s28, 20480
  buffer_load_dwordx4 v[228:231], v8, s[16:19], s28 offen
  s_add_u32 s28, s28, 20480
  buffer_load_dwordx4 v[232:235], v8, s[16:19], s28 offen
  s_add_u32 s28, s28, 20480
  buffer_load_dwordx4 v[236:239], v8, s[16:19], s28 offen
  s_add_u32 s28, s28, 20480
  buffer_load_dwordx4 v[240:243], v8, s[16:19], s28 offen
  s_add_u32 s28, s28, 20480
  buffer_load_dwordx4 v[244:247], v8, s[16:19], s28 offen
  s_add_u32 s28, s28, 20480
  buffer_load_dwordx4 v[248:251], v8, s[16:19], s28 offen
  s_add_u32 s28, s28, 20480
  buffer_load_dwordx4 v[252:255], v8, s[16:19], s28 offen
  s_lshl_b32 s28, s3, 11
  s_add_u32 s28, s28, 65536
  v_add_u32 v10, s28, v2
  v_lshrrev_b32 v11, 4, v1
  v_bfe_u32 v12, v1, 2, 2
  v_lshl_add_u32 v11, v11, 2, v12
  v_lshlrev_b32 v11, 6, v11
  v_and_b32 v12, 3, v1
  v_lshl_add_u32 v11, v12, 3, v11
  v_add_u32 v11, s28, v11
  s_waitcnt vmcnt(30)
  ds_write_b128 v10, v[128:131]
  ds_write_b128 v10, v[132:135] offset:1024
  ds_read_b64_tr_b16 v[128:129], v11 offset:0
  ds_read_b64_tr_b16 v[130:131], v11 offset:1024
  ds_read_b64_tr_b16 v[132:133], v11 offset:32
  ds_read_b64_tr_b16 v[134:135], v11 offset:1056
  s_waitcnt vmcnt(28)
  ds_write_b128 v10, v[136:139]
  ds_write_b128 v10, v[140:143] offset:1024
  ds_read_b64_tr_b16 v[136:137], v11 offset:0
  ds_read_b64_tr_b16 v[138:139], v11 offset:1024
  ds_read_b64_tr_b16 v[140:141], v11 offset:32
  ds_read_b64_tr_b16 v[142:143], v11 offset:1056
  s_waitcnt vmcnt(26)
  ds_write_b128 v10, v[144:147]
  ds_write_b128 v10, v[148:151] offset:1024
  ds_read_b64_tr_b16 v[144:145], v11 offset:0
  ds_read_b64_tr_b16 v[146:147], v11 offset:1024
  ds_read_b64_tr_b16 v[148:149], v11 offset:32
  ds_read_b64_tr_b16 v[150:151], v11 offset:1056
  s_waitcnt vmcnt(24)
  ds_write_b128 v10, v[152:155]
  ds_write_b128 v10, v[156:159] offset:1024
  ds_read_b64_tr_b16 v[152:153], v11 offset:0
  ds_read_b64_tr_b16 v[154:155], v11 offset:1024
  ds_read_b64_tr_b16 v[156:157], v11 offset:32
  ds_read_b64_tr_b16 v[158:159], v11 offset:1056
  s_waitcnt vmcnt(22)
  ds_write_b128 v10, v[160:163]
  ds_write_b128 v10, v[164:167] offset:1024
  ds_read_b64_tr_b16 v[160:161], v11 offset:0
  ds_read_b64_tr_b16 v[162:163], v11 offset:1024
  ds_read_b64_tr_b16 v[164:165], v11 offset:32
  ds_read_b64_tr_b16 v[166:167], v11 offset:1056
  s_waitcnt vmcnt(20)
  ds_write_b128 v10, v[168:171]
  ds_write_b128 v10, v[172:175] offset:1024
  ds_read_b64_tr_b16 v[168:169], v11 offset:0
  ds_read_b64_tr_b16 v[170:171], v11 offset:1024
  ds_read_b64_tr_b16 v[172:173], v11 offset:32
  ds_read_b64_tr_b16 v[174:175], v11 offset:1056
  s_waitcnt vmcnt(18)
  ds_write_b128 v10, v[176:179]
  ds_write_b128 v10, v[180:183] offset:1024
  ds_read_b64_tr_b16 v[176:177], v11 offset:0
  ds_read_b64_tr_b16 v[178:179], v11 offset:1024
  ds_read_b64_tr_b16 v[180:181], v11 offset:32
  ds_read_b64_tr_b16 v[182:183], v11 offset:1056
  s_waitcnt vmcnt(16)
  ds_write_b128 v10, v[184:187]
  ds_write_b128 v10, v[188:191] offset:1024
  ds_read_b64_tr_b16 v[184:185], v11 offset:0
  ds_read_b64_tr_b16 v[186:187], v11 offset:1024
  ds_read_b64_tr_b16 v[188:189], v11 offset:32
  ds_read_b64_tr_b16 v[190:191], v11 offset:1056
  s_waitcnt vmcnt(14)
  ds_write_b128 v10, v[192:195]
  ds_write_b128 v10, v[196:199] offset:1024
  ds_read_b64_tr_b16 v[192:193], v11 offset:0
  ds_read_b64_tr_b16 v[194:195], v11 offset:1024
  ds_read_b64_tr_b16 v[196:197], v11 offset:32
  ds_read_b64_tr_b16 v[198:199], v11 offset:1056
  s_waitcnt vmcnt(12)
  ds_write_b128 v10, v[200:203]
  ds_write_b128 v10, v[204:207] offset:1024
  ds_read_b64_tr_b16 v[200:201], v11 offset:0
  ds_read_b64_tr_b16 v[202:203], v11 offset:1024
  ds_read_b64_tr_b16 v[204:205], v11 offset:32
  ds_read_b64_tr_b16 v[206:207], v11 offset:1056
  s_waitcnt vmcnt(10)
  ds_write_b128 v10, v[208:211]
  ds_write_b128 v10, v[212:215] offset:1024
  ds_read_b64_tr_b16 v[208:209], v11 offset:0
  ds_read_b64_tr_b16 v[210:211], v11 offset:1024
  ds_read_b64_tr_b16 v[212:213], v11 offset:32
  ds_read_b64_tr_b16 v[214:215], v11 offset:1056
  s_waitcnt vmcnt(8)
  ds_write_b128 v10, v[216:219]
  ds_write_b128 v10, v[220:223] offset:1024
  ds_read_b64_tr_b16 v[216:217], v11 offset:0
  ds_read_b64_tr_b16 v[218:219], v11 offset:1024
  ds_read_b64_tr_b16 v[220:221], v11 offset:32
  ds_read_b64_tr_b16 v[222:223], v11 offset:1056
  s_waitcnt vmcnt(6)
  ds_write_b128 v10, v[224:227]
  ds_write_b128 v10, v[228:231] offset:1024
  ds_read_b64_tr_b16 v[224:225], v11 offset:0
  ds_read_b64_tr_b16 v[226:227], v11 offset:1024
  ds_read_b64_tr_b16 v[228:229], v11 offset:32
  ds_read_b64_tr_b16 v[230:231], v11 offset:1056
  s_waitcnt vmcnt(4)
  ds_write_b128 v10, v[232:235]
  ds_write_b128 v10, v[236:239] offset:1024
  ds_read_b64_tr_b16 v[232:233], v11 offset:0
  ds_read_b64_tr_b16 v[234:235], v11 offset:1024
  ds_read_b64_tr_b16 v[236:237], v11 offset:32
  ds_read_b64_tr_b16 v[238:239], v11 offset:1056
  s_waitcnt vmcnt(2)
  ds_write_b128 v10, v[240:243]
  ds_write_b128 v10, v[244:247] offset:1024
  ds_read_b64_tr_b16 v[240:241], v11 offset:0
  ds_read_b64_tr_b16 v[242:243], v11 offset:1024
  ds_read_b64_tr_b16 v[244:245], v11 offset:32
  ds_read_b64_tr_b16 v[246:247], v11 offset:1056
  s_waitcnt vmcnt(0)
  ds_write_b128 v10, v[248:251]
  ds_write_b128 v10, v[252:255] offset:1024
  ds_read_b64_tr_b16 v[248:249], v11 offset:0
  ds_read_b64_tr_b16 v[250:251], v11 offset:1024
  ds_read_b64_tr_b16 v[252:253], v11 offset:32
  ds_read_b64_tr_b16 v[254:255], v11 offset:1056
  s_lshl_b32 s28, s3, 4
  s_add_u32 s28, s28, 32768
  v_and_b32 v8, 3, v1
  v_lshl_add_u32 v3, v8, 2, s28
  s_lshl_b32 s28, s3, 12
  v_add_u32 v4, s28, v2
  s_and_b32 s28, s3, 3
  s_lshr_b32 s29, s28, 1
  s_mul_i32 s29, s29, 40960
  s_and_b32 s28, s28, 1
  s_lshl_b32 s28, s28, 5
  s_add_u32 s29, s29, s28
  s_lshl_b32 s28, s24, 6
  s_add_u32 s29, s29, s28
  v_and_b32 v8, 15, v1
  v_mul_u32_u24 v8, 2560, v8
  v_lshrrev_b32 v9, 4, v1
  v_lshl_add_u32 v8, v9, 3, v8
  v_add_u32 v5, s29, v8
  s_mov_b32 s34, 0
  s_waitcnt lgkmcnt(0)
L_out_loop:
  s_mov_b32 s30, 1
  s_lshl_b32 s31, s26, 7
L_out_wait:
  buffer_load_dword v9, v3, s[8:11], s31 offen sc1
  s_waitcnt vmcnt(0)
  v_readlane_b32 s36, v9, 0
  v_readlane_b32 s37, v9, 1
  v_readlane_b32 s38, v9, 2
  v_readlane_b32 s39, v9, 3
  s_min_u32 s36, s36, s37
  s_min_u32 s38, s38, s39
  s_min_u32 s32, s36, s38
  s_cmp_ge_u32 s32, s30
  s_cbranch_scc1 L_out_ok
  s_sleep 2
  s_add_u32 s27, s27, 1
  s_cmp_lt_u32 s27, 262144
  s_cbranch_scc1 L_out_wait
L_out_ok:
  s_lshl_b32 s28, s26, 5
  s_lshl_b32 s29, s3, 2
  s_add_u32 s28, s28, s29
  s_lshl_b32 s28, s28, 13
  s_add_u32 s33, s28, 54525952
  buffer_load_dwordx4 v[64:67], v2, s[8:11], s33 offen offset:0 sc1
  buffer_load_dwordx4 v[68:71], v2, s[8:11], s33 offen offset:1024 sc1
  buffer_load_dwordx4 v[72:75], v2, s[8:11], s33 offen offset:2048 sc1
  buffer_load_dwordx4 v[76:79], v2, s[8:11], s33 offen offset:3072 sc1
  s_add_u32 s33, s33, 4096
  buffer_load_dwordx4 v[80:83], v2, s[8:11], s33 offen offset:0 sc1
  buffer_load_dwordx4 v[84:87], v2, s[8:11], s33 offen offset:1024 sc1
  buffer_load_dwordx4 v[88:91], v2, s[8:11], s33 offen offset:2048 sc1
  buffer_load_dwordx4 v[92:95], v2, s[8:11], s33 offen offset:3072 sc1
  s_add_u32 s33, s33, 4096
  buffer_load_dwordx4 v[96:99], v2, s[8:11], s33 offen offset:0 sc1
  buffer_load_dwordx4 v[100:103], v2, s[8:11], s33 offen offset:1024 sc1
  buffer_load_dwordx4 v[104:107], v2, s[8:11], s33 offen offset:2048 sc1
  buffer_load_dwordx4 v[108:111], v2, s[8:11], s33 offen offset:3072 sc1
  s_add_u32 s33, s33, 4096
  buffer_load_dwordx4 v[112:115], v2, s[8:11], s33 offen offset:0 sc1
  buffer_load_dwordx4 v[116:119], v2, s[8:11], s33 offen offset:1024 sc1
  buffer_load_dwordx4 v[120:123], v2, s[8:11], s33 offen offset:2048 sc1
  buffer_load_dwordx4 v[124:127], v2, s[8:11], s33 offen offset:3072 sc1
  s_waitcnt vmcnt(15)
  v_mfma_f32_16x16x32_bf16 v[48:51], v[128:131], v[64:67], 0
  v_mfma_f32_16x16x32_bf16 v[52:55], v[132:135], v[64:67], 0
  s_add_u32 s33, s33, 4096
  buffer_load_dwordx4 v[64:67], v2, s[8:11], s33 offen offset:0 sc1
  s_waitcnt vmcnt(15)
  v_mfma_f32_16x16x32_bf16 v[56:59], v[128:131], v[68:71], 0
  v_mfma_f32_16x16x32_bf16 v[60:63], v[132:135], v[68:71], 0
  buffer_load_dwordx4 v[68:71], v2, s[8:11], s33 offen offset:1024 sc1
  s_waitcnt vmcnt(15)
  v_mfma_f32_16x16x32_bf16 v[48:51], v[136:139], v[72:75], v[48:51]
  v_mfma_f32_16x16x32_bf16 v[52:55], v[140:143], v[72:75], v[52:55]
  buffer_load_dwordx4 v[72:75], v2, s[8:11], s33 offen offset:2048 sc1
  s_waitcnt vmcnt(15)
  v_mfma_f32_16x16x32_bf16 v[56:59], v[136:139], v[76:79], v[56:59]
  v_mfma_f32_16x16x32_bf16 v[60:63], v[140:143], v[76:79], v[60:63]
  buffer_load_dwordx4 v[76:79], v2, s[8:11], s33 offen offset:3072 sc1
  s_waitcnt vmcnt(15)
  v_mfma_f32_16x16x32_bf16 v[48:51], v[144:147], v[80:83], v[48:51]
  v_mfma_f32_16x16x32_bf16 v[52:55], v[148:151], v[80:83], v[52:55]
  s_add_u32 s33, s33, 4096
  buffer_load_dwordx4 v[80:83], v2, s[8:11], s33 offen offset:0 sc1
  s_waitcnt vmcnt(15)
  v_mfma_f32_16x16x32_bf16 v[56:59], v[144:147], v[84:87], v[56:59]
  v_mfma_f32_16x16x32_bf16 v[60:63], v[148:151], v[84:87], v[60:63]
  buffer_load_dwordx4 v[84:87], v2, s[8:11], s33 offen offset:1024 sc1
  s_waitcnt vmcnt(15)
  v_mfma_f32_16x16x32_bf16 v[48:51], v[152:155], v[88:91], v[48:51]
  v_mfma_f32_16x16x32_bf16 v[52:55], v[156:159], v[88:91], v[52:55]
  buffer_load_dwordx4 v[88:91], v2, s[8:11], s33 offen offset:2048 sc1
  s_waitcnt vmcnt(15)
  v_mfma_f32_16x16x32_bf16 v[56:59], v[152:155], v[92:95], v[56:59]
  v_mfma_f32_16x16x32_bf16 v[60:63], v[156:159], v[92:95], v[60:63]
  buffer_load_dwordx4 v[92:95], v2, s[8:11], s33 offen offset:3072 sc1
  s_waitcnt vmcnt(15)
  v_mfma_f32_16x16x32_bf16 v[48:51], v[160:163], v[96:99], v[48:51]
  v_mfma_f32_16x16x32_bf16 v[52:55], v[164:167], v[96:99], v[52:55]
  s_add_u32 s33, s33, 4096
  buffer_load_dwordx4 v[96:99], v2, s[8:11], s33 offen offset:0 sc1
  s_waitcnt vmcnt(15)
  v_mfma_f32_16x16x32_bf16 v[56:59], v[160:163], v[100:103], v[56:59]
  v_mfma_f32_16x16x32_bf16 v[60:63], v[164:167], v[100:103], v[60:63]
  buffer_load_dwordx4 v[100:103], v2, s[8:11], s33 offen offset:1024 sc1
  s_waitcnt vmcnt(15)
  v_mfma_f32_16x16x32_bf16 v[48:51], v[168:171], v[104:107], v[48:51]
  v_mfma_f32_16x16x32_bf16 v[52:55], v[172:175], v[104:107], v[52:55]
  buffer_load_dwordx4 v[104:107], v2, s[8:11], s33 offen offset:2048 sc1
  s_waitcnt vmcnt(15)
  v_mfma_f32_16x16x32_bf16 v[56:59], v[168:171], v[108:111], v[56:59]
  v_mfma_f32_16x16x32_bf16 v[60:63], v[172:175], v[108:111], v[60:63]
  buffer_load_dwordx4 v[108:111], v2, s[8:11], s33 offen offset:3072 sc1
  s_waitcnt vmcnt(15)
  v_mfma_f32_16x16x32_bf16 v[48:51], v[176:179], v[112:115], v[48:51]
  v_mfma_f32_16x16x32_bf16 v[52:55], v[180:183], v[112:115], v[52:55]
  s_add_u32 s33, s33, 4096
  buffer_load_dwordx4 v[112:115], v2, s[8:11], s33 offen offset:0 sc1
  s_waitcnt vmcnt(15)
  v_mfma_f32_16x16x32_bf16 v[56:59], v[176:179], v[116:119], v[56:59]
  v_mfma_f32_16x16x32_bf16 v[60:63], v[180:183], v[116:119], v[60:63]
  buffer_load_dwordx4 v[116:119], v2, s[8:11], s33 offen offset:1024 sc1
  s_waitcnt vmcnt(15)
  v_mfma_f32_16x16x32_bf16 v[48:51], v[184:187], v[120:123], v[48:51]
  v_mfma_f32_16x16x32_bf16 v[52:55], v[188:191], v[120:123], v[52:55]
  buffer_load_dwordx4 v[120:123], v2, s[8:11], s33 offen offset:2048 sc1
  s_waitcnt vmcnt(15)
  v_mfma_f32_16x16x32_bf16 v[56:59], v[184:187], v[124:127], v[56:59]
  v_mfma_f32_16x16x32_bf16 v[60:63], v[188:191], v[124:127], v[60:63]
  buffer_load_dwordx4 v[124:127], v2, s[8:11], s33 offen offset:3072 sc1
  s_waitcnt vmcnt(15)
  v_mfma_f32_16x16x32_bf16 v[48:51], v[192:195], v[64:67], v[48:51]
  v_mfma_f32_16x16x32_bf16 v[52:55], v[196:199], v[64:67], v[52:55]
  s_waitcnt vmcnt(14)
  v_mfma_f32_16x16x32_bf16 v[56:59], v[192:195], v[68:71], v[56:59]
  v_mfma_f32_16x16x32_bf16 v[60:63], v[196:199], v[68:71], v[60:63]
  s_waitcnt vmcnt(13)
  v_mfma_f32_16x16x32_bf16 v[48:51], v[200:203], v[72:75], v[48:51]
  v_mfma_f32_16x16x32_bf16 v[52:55], v[204:207], v[72:75], v[52:55]
  s_waitcnt vmcnt(12)
  v_mfma_f32_16x16x32_bf16 v[56:59], v[200:203], v[76:79], v[56:59]
  v_mfma_f32_16x16x32_bf16 v[60:63], v[204:207], v[76:79], v[60:63]
  s_waitcnt vmcnt(11)
  v_mfma_f32_16x16x32_bf16 v[48:51], v[208:211], v[80:83], v[48:51]
  v_mfma_f32_16x16x32_bf16 v[52:55], v[212:215], v[80:83], v[52:55]
  s_waitcnt vmcnt(10)
  v_mfma_f32_16x16x32_bf16 v[56:59], v[208:211], v[84:87], v[56:59]
  v_mfma_f32_16x16x32_bf16 v[60:63], v[212:215], v[84:87], v[60:63]
  s_waitcnt vmcnt(9)
  v_mfma_f32_16x16x32_bf16 v[48:51], v[216:219], v[88:91], v[48:51]
  v_mfma_f32_16x16x32_bf16 v[52:55], v[220:223], v[88:91], v[52:55]
  s_waitcnt vmcnt(8)
  v_mfma_f32_16x16x32_bf16 v[56:59], v[216:219], v[92:95], v[56:59]
  v_mfma_f32_16x16x32_bf16 v[60:63], v[220:223], v[92:95], v[60:63]
  s_waitcnt vmcnt(7)
  v_mfma_f32_16x16x32_bf16 v[48:51], v[224:227], v[96:99], v[48:51]
  v_mfma_f32_16x16x32_bf16 v[52:55], v[228:231], v[96:99], v[52:55]
  s_waitcnt vmcnt(6)
  v_mfma_f32_16x16x32_bf16 v[56:59], v[224:227], v[100:103], v[56:59]
  v_mfma_f32_16x16x32_bf16 v[60:63], v[228:231], v[100:103], v[60:63]
  s_waitcnt vmcnt(5)
  v_mfma_f32_16x16x32_bf16 v[48:51], v[232:235], v[104:107], v[48:51]
  v_mfma_f32_16x16x32_bf16 v[52:55], v[236:239], v[104:107], v[52:55]
  s_waitcnt vmcnt(4)
  v_mfma_f32_16x16x32_bf16 v[56:59], v[232:235], v[108:111], v[56:59]
  v_mfma_f32_16x16x32_bf16 v[60:63], v[236:239], v[108:111], v[60:63]
  s_waitcnt vmcnt(3)
  v_mfma_f32_16x16x32_bf16 v[48:51], v[240:243], v[112:115], v[48:51]
  v_mfma_f32_16x16x32_bf16 v[52:55], v[244:247], v[112:115], v[52:55]
  s_waitcnt vmcnt(2)
  v_mfma_f32_16x16x32_bf16 v[56:59], v[240:243], v[116:119], v[56:59]
  v_mfma_f32_16x16x32_bf16 v[60:63], v[244:247], v[116:119], v[60:63]
  s_waitcnt vmcnt(1)
  v_mfma_f32_16x16x32_bf16 v[48:51], v[248:251], v[120:123], v[48:51]
  v_mfma_f32_16x16x32_bf16 v[52:55], v[252:255], v[120:123], v[52:55]
  s_waitcnt vmcnt(0)
  v_mfma_f32_16x16x32_bf16 v[56:59], v[248:251], v[124:127], v[56:59]
  v_mfma_f32_16x16x32_bf16 v[60:63], v[252:255], v[124:127], v[60:63]
  s_nop 5
  v_add_u32 v9, s34, v4
  ds_write_b128 v9, v[48:51] offset:0
  ds_write_b128 v9, v[52:55] offset:1024
  ds_write_b128 v9, v[56:59] offset:2048
  ds_write_b128 v9, v[60:63] offset:3072
  s_waitcnt lgkmcnt(0)
  s_barrier
  s_cmp_ge_u32 s3, 4
  s_cbranch_scc1 L_out_next
  s_lshl_b32 s28, s3, 10
  s_add_u32 s28, s28, s34
  v_add_u32 v9, s28, v2
  ds_read_b128 v[16:19], v9 offset:0
  ds_read_b128 v[20:23], v9 offset:4096
  ds_read_b128 v[24:27], v9 offset:8192
  ds_read_b128 v[28:31], v9 offset:12288
  ds_read_b128 v[32:35], v9 offset:16384
  ds_read_b128 v[36:39], v9 offset:20480
  ds_read_b128 v[40:43], v9 offset:24576
  ds_read_b128 v[44:47], v9 offset:28672
  s_waitcnt lgkmcnt(6)
  v_add_f32 v16, v16, v20
  v_add_f32 v17, v17, v21
  v_add_f32 v18, v18, v22
  v_add_f32 v19, v19, v23
  s_waitcnt lgkmcnt(4)
  v_add_f32 v24, v24, v28
  v_add_f32 v25, v25, v29
  v_add_f32 v26, v26, v30
  v_add_f32 v27, v27, v31
  s_waitcnt lgkmcnt(2)
  v_add_f32 v32, v32, v36
  v_add_f32 v33, v33, v37
  v_add_f32 v34, v34, v38
  v_add_f32 v35, v35, v39
  s_waitcnt lgkmcnt(0)
  v_add_f32 v40, v40, v44
  v_add_f32 v41, v41, v45
  v_add_f32 v42, v42, v46
  v_add_f32 v43, v43, v47
  v_add_f32 v16, v16, v24
  v_add_f32 v17, v17, v25
  v_add_f32 v18, v18, v26
  v_add_f32 v19, v19, v27
  v_add_f32 v32, v32, v40
  v_add_f32 v33, v33, v41
  v_add_f32 v34, v34, v42
  v_add_f32 v35, v35, v43
  v_add_f32 v16, v16, v32
  v_add_f32 v17, v17, v33
  v_add_f32 v18, v18, v34
  v_add_f32 v19, v19, v35
  v_cvt_pk_bf16_f32 v12, v16, v17
  v_cvt_pk_bf16_f32 v13, v18, v19
  s_mul_i32 s28, s26, 81920
  buffer_store_dwordx2 v[12:13], v5, s[20:23], s28 offen
L_out_next:
  s_xor_b32 s34, s34, 32768
  s_cmp_ge_u32 s26, 52
  s_cbranch_scc1 L_out_s4
  s_add_u32 s26, s26, 2
  s_cmp_lt_u32 s26, 52
  s_cbranch_scc1 L_out_loop
  s_add_u32 s26, s25, 52
  s_branch L_out_loop
L_out_s4:
  s_add_u32 s26, s26, 4
  s_cmp_lt_u32 s26, 64
  s_cbranch_scc1 L_out_loop
  s_endpgm
L_b:
  s_cmp_lt_u32 s4, 24
  s_cbranch_scc0 L_b_noboot
  s_add_u32 s33, s4, 40
  s_branch L_boot_entry
L_b_noboot:
  s_cmp_eq_u32 s98, 0
  s_cbranch_scc0 L_b_vote_skip
  s_cmp_eq_u32 s3, 0
  s_cbranch_scc0 L_b_vote_w
  s_mov_b32 s56, s86
  s_and_b32 s57, s87, 0xffff
  s_mov_b32 s58, 256
  s_mov_b32 s59, 0x20000
  s_and_b32 s60, s7, 3
  s_cmp_eq_u32 s60, 3
  s_cbranch_scc0 L_b_vote_lead_no
  v_and_b32 v3, 7, v1
  v_lshlrev_b32 v3, 2, v3
  s_mov_b32 s63, 0
L_b_vote_lead:
  s_sleep 8
  buffer_load_dword v2, v3, s[56:59], 0 offen sc1
  s_waitcnt vmcnt(0)
  s_mov_b32 s60, 0
  s_mov_b32 s61, 0
  v_readlane_b32 s62, v2, 0
  s_nop 0
  s_add_u32 s60, s60, s62
  s_max_u32 s61, s61, s62
  v_readlane_b32 s62, v2, 1
  s_nop 0
  s_add_u32 s60, s60, s62
  s_max_u32 s61, s61, s62
  v_readlane_b32 s62, v2, 2
  s_nop 0
  s_add_u32 s60, s60, s62
  s_max_u32 s61, s61, s62
  v_readlane_b32 s62, v2, 3
  s_nop 0
  s_add_u32 s60, s60, s62
  s_max_u32 s61, s61, s62
  v_readlane_b32 s62, v2, 4
  s_nop 0
  s_add_u32 s60, s60, s62
  s_max_u32 s61, s61, s62
  v_readlane_b32 s62, v2, 5
  s_nop 0
  s_add_u32 s60, s60, s62
  s_max_u32 s61, s61, s62
  v_readlane_b32 s62, v2, 6
  s_nop 0
  s_add_u32 s60, s60, s62
  s_max_u32 s61, s61, s62
  v_readlane_b32 s62, v2, 7
  s_nop 0
  s_add_u32 s60, s60, s62
  s_max_u32 s61, s61, s62
  s_cmp_ge_u32 s60, 256
  s_cbranch_scc1 L_b_vote_lead_all
  s_add_u32 s63, s63, 1
  s_cmp_lt_u32 s63, 0x40000
  s_cbranch_scc1 L_b_vote_lead
L_b_vote_lead_all:
  s_cmp_eq_u32 s61, 256
  s_cselect_b32 s60, 1, 2
  v_mov_b32 v2, s60
  v_mov_b32 v3, 128
  s_mov_b64 exec, 1
  buffer_store_dword v2, v3, s[56:59], 0 offen sc1
  s_mov_b64 exec, -1
L_b_vote_lead_no:
  s_mov_b32 s63, 0
  v_mov_b32 v3, 128
  buffer_load_dword v2, v3, s[56:59], 0 offen sc1
  s_waitcnt vmcnt(0)
L_b_vote:
  v_readfirstlane_b32 s60, v2
  s_nop 0
  s_cmp_eq_u32 s60, 1
  s_cbranch_scc1 L_b_vote_all
  s_cmp_eq_u32 s60, 2
  s_cbranch_scc1 L_b_vote_bad
  s_add_u32 s63, s63, 1
  s_cmp_ge_u32 s63, 0x40000
  s_cbranch_scc1 L_b_vote_bad
  s_sleep 8
  buffer_load_dword v2, v3, s[56:59], 0 offen sc1
  s_waitcnt vmcnt(0)
  s_branch L_b_vote
L_b_vote_all:
  v_mov_b32 v2, 1
  s_branch L_b_vote_pub
L_b_vote_bad:
  v_mov_b32 v2, 2
L_b_vote_pub:
  v_mov_b32 v3, 163824
  ds_write_b32 v3, v2
  s_waitcnt lgkmcnt(0)
L_b_vote_w:
  s_barrier
  v_mov_b32 v3, 163824
  ds_read_b32 v2, v3
  s_waitcnt lgkmcnt(0)
  v_readfirstlane_b32 s60, v2
  s_nop 0
  s_cmp_eq_u32 s60, 2
  s_cbranch_scc1 L_restart
L_b_vote_skip:
L_b_after_boot:
  s_mov_b32 s24, 0
  s_lshl_b32 s29, s4, 3
  s_add_u32 s29, s29, s3
  v_lshlrev_b32 v2, 4, v1
  s_mov_b32 s12, s78
  s_and_b32 s13, s79, 0xffff
  s_mov_b32 s14, 2621440
  s_mov_b32 s15, 0x20000
  s_mov_b32 s16, s80
  s_and_b32 s17, s81, 0xffff
  s_mov_b32 s18, 2457600
  s_mov_b32 s19, 0x20000
  s_mov_b32 s20, s82
  s_and_b32 s21, s83, 0xffff
  s_mov_b32 s22, 819200
  s_mov_b32 s23, 0x20000
  s_mul_i32 s28, s4, 81920
  s_mul_i32 s26, s3, 640
  s_add_u32 s26, s26, 0
  v_add_u32 v9, s26, v1
  v_mul_u32_u24 v10, 52429, v9
  v_lshrrev_b32 v10, 22, v10
  v_mul_u32_u24 v11, 80, v10
  v_sub_u32 v11, v9, v11
  v_xor_b32 v12, v11, v10
  v_and_b32 v12, 15, v12
  v_and_b32 v11, 0x70, v11
  v_or_b32 v11, v11, v12
  v_mul_u32_u24 v10, 1280, v10
  v_lshl_add_u32 v13, v11, 4, v10
  s_lshl_b32 s26, s26, 4
  s_mov_b32 m0, s26
  s_nop 0
  buffer_load_dwordx4 v13, s[12:15], s28 offen lds
  s_mul_i32 s26, s3, 640
  s_add_u32 s26, s26, 64
  v_add_u32 v9, s26, v1
  v_mul_u32_u24 v10, 52429, v9
  v_lshrrev_b32 v10, 22, v10
  v_mul_u32_u24 v11, 80, v10
  v_sub_u32 v11, v9, v11
  v_xor_b32 v12, v11, v10
  v_and_b32 v12, 15, v12
  v_and_b32 v11, 0x70, v11
  v_or_b32 v11, v11, v12
  v_mul_u32_u24 v10, 1280, v10
  v_lshl_add_u32 v13, v11, 4, v10
  s_lshl_b32 s26, s26, 4
  s_mov_b32 m0, s26
  s_nop 0
  buffer_load_dwordx4 v13, s[12:15], s28 offen lds
  s_mul_i32 s26, s3, 640
  s_add_u32 s26, s26, 128
  v_add_u32 v9, s26, v1
  v_mul_u32_u24 v10, 52429, v9
  v_lshrrev_b32 v10, 22, v10
  v_mul_u32_u24 v11, 80, v10
  v_sub_u32 v11, v9, v11
  v_xor_b32 v12, v11, v10
  v_and_b32 v12, 15, v12
  v_and_b32 v11, 0x70, v11
  v_or_b32 v11, v11, v12
  v_mul_u32_u24 v10, 1280, v10
  v_lshl_add_u32 v13, v11, 4, v10
  s_lshl_b32 s26, s26, 4
  s_mov_b32 m0, s26
  s_nop 0
  buffer_load_dwordx4 v13, s[12:15], s28 offen lds
  s_mul_i32 s26, s3, 640
  s_add_u32 s26, s26, 192
  v_add_u32 v9, s26, v1
  v_mul_u32_u24 v10, 52429, v9
  v_lshrrev_b32 v10, 22, v10
  v_mul_u32_u24 v11, 80, v10
  v_sub_u32 v11, v9, v11
  v_xor_b32 v12, v11, v10
  v_and_b32 v12, 15, v12
  v_and_b32 v11, 0x70, v11
  v_or_b32 v11, v11, v12
  v_mul_u32_u24 v10, 1280, v10
  v_lshl_add_u32 v13, v11, 4, v10
  s_lshl_b32 s26, s26, 4
  s_mov_b32 m0, s26
  s_nop 0
  buffer_load_dwordx4 v13, s[12:15], s28 offen lds
  s_mul_i32 s26, s3, 640
  s_add_u32 s26, s26, 256
  v_add_u32 v9, s26, v1
  v_mul_u32_u24 v10, 52429, v9
  v_lshrrev_b32 v10, 22, v10
  v_mul_u32_u24 v11, 80, v10
  v_sub_u32 v11, v9, v11
  v_xor_b32 v12, v11, v10
  v_and_b32 v12, 15, v12
  v_and_b32 v11, 0x70, v11
  v_or_b32 v11, v11, v12
  v_mul_u32_u24 v10, 1280, v10
  v_lshl_add_u32 v13, v11, 4, v10
  s_lshl_b32 s26, s26, 4
  s_mov_b32 m0, s26
  s_nop 0
  buffer_load_dwordx4 v13, s[12:15], s28 offen lds
  s_mul_i32 s26, s3, 640
  s_add_u32 s26, s26, 320
  v_add_u32 v9, s26, v1
  v_mul_u32_u24 v10, 52429, v9
  v_lshrrev_b32 v10, 22, v10
  v_mul_u32_u24 v11, 80, v10
  v_sub_u32 v11, v9, v11
  v_xor_b32 v12, v11, v10
  v_and_b32 v12, 15, v12
  v_and_b32 v11, 0x70, v11
  v_or_b32 v11, v11, v12
  v_mul_u32_u24 v10, 1280, v10
  v_lshl_add_u32 v13, v11, 4, v10
  s_lshl_b32 s26, s26, 4
  s_mov_b32 m0, s26
  s_nop 0
  buffer_load_dwordx4 v13, s[12:15], s28 offen lds
  s_mul_i32 s26, s3, 640
  s_add_u32 s26, s26, 384
  v_add_u32 v9, s26, v1
  v_mul_u32_u24 v10, 52429, v9
  v_lshrrev_b32 v10, 22, v10
  v_mul_u32_u24 v11, 80, v10
  v_sub_u32 v11, v9, v11
  v_xor_b32 v12, v11, v10
  v_and_b32 v12, 15, v12
  v_and_b32 v11, 0x70, v11
  v_or_b32 v11, v11, v12
  v_mul_u32_u24 v10, 1280, v10
  v_lshl_add_u32 v13, v11, 4, v10
  s_lshl_b32 s26, s26, 4
  s_mov_b32 m0, s26
  s_nop 0
  buffer_load_dwordx4 v13, s[12:15], s28 offen lds
  s_mul_i32 s26, s3, 640
  s_add_u32 s26, s26, 448
  v_add_u32 v9, s26, v1
  v_mul_u32_u24 v10, 52429, v9
  v_lshrrev_b32 v10, 22, v10
  v_mul_u32_u24 v11, 80, v10
  v_sub_u32 v11, v9, v11
  v_xor_b32 v12, v11, v10
  v_and_b32 v12, 15, v12
  v_and_b32 v11, 0x70, v11
  v_or_b32 v11, v11, v12
  v_mul_u32_u24 v10, 1280, v10
  v_lshl_add_u32 v13, v11, 4, v10
  s_lshl_b32 s26, s26, 4
  s_mov_b32 m0, s26
  s_nop 0
  buffer_load_dwordx4 v13, s[12:15], s28 offen lds
  s_mul_i32 s26, s3, 640
  s_add_u32 s26, s26, 512
  v_add_u32 v9, s26, v1
  v_mul_u32_u24 v10, 52429, v9
  v_lshrrev_b32 v10, 22, v10
  v_mul_u32_u24 v11, 80, v10
  v_sub_u32 v11, v9, v11
  v_xor_b32 v12, v11, v10
  v_and_b32 v12, 15, v12
  v_and_b32 v11, 0x70, v11
  v_or_b32 v11, v11, v12
  v_mul_u32_u24 v10, 1280, v10
  v_lshl_add_u32 v13, v11, 4, v10
  s_lshl_b32 s26, s26, 4
  s_mov_b32 m0, s26
  s_nop 0
  buffer_load_dwordx4 v13, s[12:15], s28 offen lds
  s_mul_i32 s26, s3, 640
  s_add_u32 s26, s26, 576
  v_add_u32 v9, s26, v1
  v_mul_u32_u24 v10, 52429, v9
  v_lshrrev_b32 v10, 22, v10
  v_mul_u32_u24 v11, 80, v10
  v_sub_u32 v11, v9, v11
  v_xor_b32 v12, v11, v10
  v_and_b32 v12, 15, v12
  v_and_b32 v11, 0x70, v11
  v_or_b32 v11, v11, v12
  v_mul_u32_u24 v10, 1280, v10
  v_lshl_add_u32 v13, v11, 4, v10
  s_lshl_b32 s26, s26, 4
  s_mov_b32 m0, s26
  s_nop 0
  buffer_load_dwordx4 v13, s[12:15], s28 offen lds
  v_and_b32 v9, 15, v1
  v_lshrrev_b32 v10, 4, v1
  v_xor_b32 v10, v10, v9
  v_mul_u32_u24 v9, 1280, v9
  v_xor_b32 v11, 0, v10
  v_lshl_add_u32 v3, v11, 4, v9
  v_xor_b32 v11, 4, v10
  v_lshl_add_u32 v4, v11, 4, v9
  v_xor_b32 v11, 8, v10
  v_lshl_add_u32 v5, v11, 4, v9
  v_xor_b32 v11, 12, v10
  v_lshl_add_u32 v6, v11, 4, v9
  v_add_u32 v7, 81920, v2
  v_add_u32 v8, 122880, v2
  s_lshl_b32 s25, s3, 10
  s_add_u32 s25, s25, 81920
  v_add_u32 v10, s25, v2
  v_lshrrev_b32 v11, 4, v1
  v_bfe_u32 v12, v1, 2, 2
  v_and_b32 v13, 3, v1
  v_lshl_add_u32 v14, v11, 3, v12
  v_lshlrev_b32 v14, 5, v14
  v_lshl_add_u32 v14, v13, 3, v14
  v_add_u32 v14, s25, v14
  v_lshl_add_u32 v15, v11, 2, v12
  v_lshlrev_b32 v15, 5, v15
  v_lshl_add_u32 v15, v13, 3, v15
  v_add_u32 v15, s25, v15
  v_lshrrev_b32 v11, 1, v1
  v_and_b32 v12, 1, v1
  v_mul_u32_u24 v13, 3840, v11
  v_lshl_or_b32 v13, v12, 4, v13
  v_mul_u32_u24 v11, 1280, v11
  v_lshl_or_b32 v11, v12, 4, v11
  s_add_u32 s33, s29, 0
  s_min_u32 s33, s33, 2399
  s_mul_i32 s25, s33, 3277
  s_lshr_b32 s25, s25, 16
  s_mul_i32 s26, s25, 20
  s_sub_u32 s26, s33, s26
  s_mul_i32 s26, s26, 122880
  s_lshl_b32 s25, s25, 5
  s_add_u32 s25, s25, s26
  buffer_load_dwordx4 v[48:51], v13, s[16:19], s25 offen
  s_add_u32 s33, s29, 256
  s_min_u32 s33, s33, 2399
  s_mul_i32 s25, s33, 3277
  s_lshr_b32 s25, s25, 16
  s_mul_i32 s26, s25, 20
  s_sub_u32 s26, s33, s26
  s_mul_i32 s26, s26, 122880
  s_lshl_b32 s25, s25, 5
  s_add_u32 s25, s25, s26
  buffer_load_dwordx4 v[52:55], v13, s[16:19], s25 offen
  s_add_u32 s33, s29, 512
  s_min_u32 s33, s33, 2399
  s_mul_i32 s25, s33, 3277
  s_lshr_b32 s25, s25, 16
  s_mul_i32 s26, s25, 20
  s_sub_u32 s26, s33, s26
  s_mul_i32 s26, s26, 122880
  s_lshl_b32 s25, s25, 5
  s_add_u32 s25, s25, s26
  buffer_load_dwordx4 v[56:59], v13, s[16:19], s25 offen
  s_add_u32 s33, s29, 768
  s_min_u32 s33, s33, 2399
  s_mul_i32 s25, s33, 3277
  s_lshr_b32 s25, s25, 16
  s_mul_i32 s26, s25, 20
  s_sub_u32 s26, s33, s26
  s_mul_i32 s26, s26, 122880
  s_lshl_b32 s25, s25, 5
  s_add_u32 s25, s25, s26
  buffer_load_dwordx4 v[60:63], v13, s[16:19], s25 offen
  s_add_u32 s33, s29, 1024
  s_min_u32 s33, s33, 2399
  s_mul_i32 s25, s33, 3277
  s_lshr_b32 s25, s25, 16
  s_mul_i32 s26, s25, 20
  s_sub_u32 s26, s33, s26
  s_mul_i32 s26, s26, 122880
  s_lshl_b32 s25, s25, 5
  s_add_u32 s25, s25, s26
  buffer_load_dwordx4 v[64:67], v13, s[16:19], s25 offen
  s_add_u32 s33, s29, 1280
  s_min_u32 s33, s33, 2399
  s_mul_i32 s25, s33, 3277
  s_lshr_b32 s25, s25, 16
  s_mul_i32 s26, s25, 20
  s_sub_u32 s26, s33, s26
  s_mul_i32 s26, s26, 122880
  s_lshl_b32 s25, s25, 5
  s_add_u32 s25, s25, s26
  buffer_load_dwordx4 v[68:71], v13, s[16:19], s25 offen
  s_add_u32 s33, s29, 1536
  s_min_u32 s33, s33, 2399
  s_mul_i32 s25, s33, 3277
  s_lshr_b32 s25, s25, 16
  s_mul_i32 s26, s25, 20
  s_sub_u32 s26, s33, s26
  s_mul_i32 s26, s26, 122880
  s_lshl_b32 s25, s25, 5
  s_add_u32 s25, s25, s26
  buffer_load_dwordx4 v[72:75], v13, s[16:19], s25 offen
  s_add_u32 s33, s29, 1792
  s_min_u32 s33, s33, 2399
  s_mul_i32 s25, s33, 3277
  s_lshr_b32 s25, s25, 16
  s_mul_i32 s26, s25, 20
  s_sub_u32 s26, s33, s26
  s_mul_i32 s26, s26, 122880
  s_lshl_b32 s25, s25, 5
  s_add_u32 s25, s25, s26
  buffer_load_dwordx4 v[76:79], v13, s[16:19], s25 offen
  s_add_u32 s33, s29, 2048
  s_min_u32 s33, s33, 2399
  s_mul_i32 s25, s33, 3277
  s_lshr_b32 s25, s25, 16
  s_mul_i32 s26, s25, 20
  s_sub_u32 s26, s33, s26
  s_mul_i32 s26, s26, 122880
  s_lshl_b32 s25, s25, 5
  s_add_u32 s25, s25, s26
  buffer_load_dwordx4 v[80:83], v13, s[16:19], s25 offen
  s_add_u32 s33, s29, 2304
  s_min_u32 s33, s33, 2399
  s_mul_i32 s25, s33, 3277
  s_lshr_b32 s25, s25, 16
  s_mul_i32 s26, s25, 20
  s_sub_u32 s26, s33, s26
  s_mul_i32 s26, s26, 122880
  s_lshl_b32 s25, s25, 5
  s_add_u32 s25, s25, s26
  buffer_load_dwordx4 v[84:87], v13, s[16:19], s25 offen
  s_waitcnt vmcnt(9)
  ds_write_b128 v10, v[48:51]
  ds_read_b64_tr_b16 v[48:49], v14
  ds_read_b64_tr_b16 v[50:51], v14 offset:128
  s_add_u32 s33, s29, 0
  s_min_u32 s33, s33, 2399
  s_lshl_b32 s33, s33, 10
  s_add_u32 s33, s33, 83886080
  s_waitcnt lgkmcnt(0)
  buffer_store_dwordx4 v[48:51], v2, s[8:11], s33 offen sc1
  s_waitcnt vmcnt(9)
  ds_write_b128 v10, v[52:55]
  ds_read_b64_tr_b16 v[52:53], v14
  ds_read_b64_tr_b16 v[54:55], v14 offset:128
  s_add_u32 s33, s29, 256
  s_min_u32 s33, s33, 2399
  s_lshl_b32 s33, s33, 10
  s_add_u32 s33, s33, 83886080
  s_waitcnt lgkmcnt(0)
  buffer_store_dwordx4 v[52:55], v2, s[8:11], s33 offen sc1
  s_waitcnt vmcnt(9)
  ds_write_b128 v10, v[56:59]
  ds_read_b64_tr_b16 v[56:57], v14
  ds_read_b64_tr_b16 v[58:59], v14 offset:128
  s_add_u32 s33, s29, 512
  s_min_u32 s33, s33, 2399
  s_lshl_b32 s33, s33, 10
  s_add_u32 s33, s33, 83886080
  s_waitcnt lgkmcnt(0)
  buffer_store_dwordx4 v[56:59], v2, s[8:11], s33 offen sc1
  s_waitcnt vmcnt(9)
  ds_write_b128 v10, v[60:63]
  ds_read_b64_tr_b16 v[60:61], v14
  ds_read_b64_tr_b16 v[62:63], v14 offset:128
  s_add_u32 s33, s29, 768
  s_min_u32 s33, s33, 2399
  s_lshl_b32 s33, s33, 10
  s_add_u32 s33, s33, 83886080
  s_waitcnt lgkmcnt(0)
  buffer_store_dwordx4 v[60:63], v2, s[8:11], s33 offen sc1
  s_waitcnt vmcnt(9)
  ds_write_b128 v10, v[64:67]
  ds_read_b64_tr_b16 v[64:65], v14
  ds_read_b64_tr_b16 v[66:67], v14 offset:128
  s_add_u32 s33, s29, 1024
  s_min_u32 s33, s33, 2399
  s_lshl_b32 s33, s33, 10
  s_add_u32 s33, s33, 83886080
  s_waitcnt lgkmcnt(0)
  buffer_store_dwordx4 v[64:67], v2, s[8:11], s33 offen sc1
  s_waitcnt vmcnt(9)
  ds_write_b128 v10, v[68:71]
  ds_read_b64_tr_b16 v[68:69], v14
  ds_read_b64_tr_b16 v[70:71], v14 offset:128
  s_add_u32 s33, s29, 1280
  s_min_u32 s33, s33, 2399
  s_lshl_b32 s33, s33, 10
  s_add_u32 s33, s33, 83886080
  s_waitcnt lgkmcnt(0)
  buffer_store_dwordx4 v[68:71], v2, s[8:11], s33 offen sc1
  s_waitcnt vmcnt(9)
  ds_write_b128 v10, v[72:75]
  ds_read_b64_tr_b16 v[72:73], v14
  ds_read_b64_tr_b16 v[74:75], v14 offset:128
  s_add_u32 s33, s29, 1536
  s_min_u32 s33, s33, 2399
  s_lshl_b32 s33, s33, 10
  s_add_u32 s33, s33, 83886080
  s_waitcnt lgkmcnt(0)
  buffer_store_dwordx4 v[72:75], v2, s[8:11], s33 offen sc1
  s_waitcnt vmcnt(9)
  ds_write_b128 v10, v[76:79]
  ds_read_b64_tr_b16 v[76:77], v14
  ds_read_b64_tr_b16 v[78:79], v14 offset:128
  s_add_u32 s33, s29, 1792
  s_min_u32 s33, s33, 2399
  s_lshl_b32 s33, s33, 10
  s_add_u32 s33, s33, 83886080
  s_waitcnt lgkmcnt(0)
  buffer_store_dwordx4 v[76:79], v2, s[8:11], s33 offen sc1
  s_waitcnt vmcnt(9)
  ds_write_b128 v10, v[80:83]
  ds_read_b64_tr_b16 v[80:81], v14
  ds_read_b64_tr_b16 v[82:83], v14 offset:128
  s_add_u32 s33, s29, 2048
  s_min_u32 s33, s33, 2399
  s_lshl_b32 s33, s33, 10
  s_add_u32 s33, s33, 83886080
  s_waitcnt lgkmcnt(0)
  buffer_store_dwordx4 v[80:83], v2, s[8:11], s33 offen sc1
  s_waitcnt vmcnt(9)
  ds_write_b128 v10, v[84:87]
  ds_read_b64_tr_b16 v[84:85], v14
  ds_read_b64_tr_b16 v[86:87], v14 offset:128
  s_add_u32 s33, s29, 2304
  s_min_u32 s33, s33, 2399
  s_lshl_b32 s33, s33, 10
  s_add_u32 s33, s33, 83886080
  s_waitcnt lgkmcnt(0)
  buffer_store_dwordx4 v[84:87], v2, s[8:11], s33 offen sc1
  s_add_u32 s33, s29, 0
  s_min_u32 s33, s33, 799
  s_mul_i32 s25, s33, 3277
  s_lshr_b32 s25, s25, 16
  s_mul_i32 s26, s25, 20
  s_sub_u32 s26, s33, s26
  s_mul_i32 s26, s26, 40960
  s_lshl_b32 s25, s25, 5
  s_add_u32 s25, s25, s26
  buffer_load_dwordx4 v[48:51], v11, s[20:23], s25 offen
  s_add_u32 s33, s29, 256
  s_min_u32 s33, s33, 799
  s_mul_i32 s25, s33, 3277
  s_lshr_b32 s25, s25, 16
  s_mul_i32 s26, s25, 20
  s_sub_u32 s26, s33, s26
  s_mul_i32 s26, s26, 40960
  s_lshl_b32 s25, s25, 5
  s_add_u32 s25, s25, s26
  buffer_load_dwordx4 v[52:55], v11, s[20:23], s25 offen
  s_add_u32 s33, s29, 512
  s_min_u32 s33, s33, 799
  s_mul_i32 s25, s33, 3277
  s_lshr_b32 s25, s25, 16
  s_mul_i32 s26, s25, 20
  s_sub_u32 s26, s33, s26
  s_mul_i32 s26, s26, 40960
  s_lshl_b32 s25, s25, 5
  s_add_u32 s25, s25, s26
  buffer_load_dwordx4 v[56:59], v11, s[20:23], s25 offen
  s_add_u32 s33, s29, 768
  s_min_u32 s33, s33, 799
  s_mul_i32 s25, s33, 3277
  s_lshr_b32 s25, s25, 16
  s_mul_i32 s26, s25, 20
  s_sub_u32 s26, s33, s26
  s_mul_i32 s26, s26, 40960
  s_lshl_b32 s25, s25, 5
  s_add_u32 s25, s25, s26
  buffer_load_dwordx4 v[60:63], v11, s[20:23], s25 offen
  s_waitcnt vmcnt(3)
  ds_write_b128 v10, v[48:51]
  ds_read_b64_tr_b16 v[48:49], v15
  ds_read_b64_tr_b16 v[50:51], v15 offset:512
  s_add_u32 s33, s29, 0
  s_min_u32 s33, s33, 799
  s_lshl_b32 s33, s33, 10
  s_add_u32 s33, s33, 86343680
  s_waitcnt lgkmcnt(0)
  buffer_store_dwordx4 v[48:51], v2, s[8:11], s33 offen sc1
  s_waitcnt vmcnt(3)
  ds_write_b128 v10, v[52:55]
  ds_read_b64_tr_b16 v[52:53], v15
  ds_read_b64_tr_b16 v[54:55], v15 offset:512
  s_add_u32 s33, s29, 256
  s_min_u32 s33, s33, 799
  s_lshl_b32 s33, s33, 10
  s_add_u32 s33, s33, 86343680
  s_waitcnt lgkmcnt(0)
  buffer_store_dwordx4 v[52:55], v2, s[8:11], s33 offen sc1
  s_waitcnt vmcnt(3)
  ds_write_b128 v10, v[56:59]
  ds_read_b64_tr_b16 v[56:57], v15
  ds_read_b64_tr_b16 v[58:59], v15 offset:512
  s_add_u32 s33, s29, 512
  s_min_u32 s33, s33, 799
  s_lshl_b32 s33, s33, 10
  s_add_u32 s33, s33, 86343680
  s_waitcnt lgkmcnt(0)
  buffer_store_dwordx4 v[56:59], v2, s[8:11], s33 offen sc1
  s_waitcnt vmcnt(3)
  ds_write_b128 v10, v[60:63]
  ds_read_b64_tr_b16 v[60:61], v15
  ds_read_b64_tr_b16 v[62:63], v15 offset:512
  s_add_u32 s33, s29, 768
  s_min_u32 s33, s33, 799
  s_lshl_b32 s33, s33, 10
  s_add_u32 s33, s33, 86343680
  s_waitcnt lgkmcnt(0)
  buffer_store_dwordx4 v[60:63], v2, s[8:11], s33 offen sc1
  s_waitcnt vmcnt(0) lgkmcnt(0)
  s_barrier
  s_cmp_eq_u32 s3, 0
  s_cbranch_scc0 L_b_sync0_w
  v_mov_b32 v9, 1
  v_mov_b32 v10, 16384
  s_mov_b64 exec, 1
  buffer_atomic_add v9, v10, s[8:11], 0 offen
  s_mov_b64 exec, -1
L_b_sync0:
  buffer_load_dword v9, v10, s[8:11], 0 offen sc1
  s_waitcnt vmcnt(0)
  v_readfirstlane_b32 s25, v9
  s_nop 0
  s_cmp_ge_u32 s25, 32
  s_cbranch_scc1 L_b_sync0_w
  s_sleep 8
  s_add_u32 s24, s24, 1
  s_cmp_lt_u32 s24, 262144
  s_cbranch_scc1 L_b_sync0
L_b_sync0_w:
  s_barrier
  s_mov_b32 s34, 0x3fb8aa3b
  s_mov_b32 s35, 0x358637bd
  v_mov_b32 v240, 0x3f803f80
  v_mov_b32 v241, 0x3f803f80
  v_mov_b32 v242, 0x3f803f80
  v_mov_b32 v243, 0x3f803f80
  v_mov_b32 v168, 0
  v_mov_b32 v169, 0
  v_mov_b32 v170, 0
  v_mov_b32 v171, 0
  v_mov_b32 v172, 0
  v_mov_b32 v173, 0
  v_mov_b32 v174, 0
  v_mov_b32 v175, 0
  v_mov_b32 v176, 0
  v_mov_b32 v177, 0
  v_mov_b32 v178, 0
  v_mov_b32 v179, 0
  v_mov_b32 v180, 0
  v_mov_b32 v181, 0
  v_mov_b32 v182, 0
  v_mov_b32 v183, 0
  v_mov_b32 v184, 0
  v_mov_b32 v185, 0
  v_mov_b32 v186, 0
  v_mov_b32 v187, 0
  v_mov_b32 v188, 0
  v_mov_b32 v189, 0
  v_mov_b32 v190, 0
  v_mov_b32 v191, 0
  v_mov_b32 v192, 0
  v_mov_b32 v193, 0
  v_mov_b32 v194, 0
  v_mov_b32 v195, 0
  v_mov_b32 v196, 0
  v_mov_b32 v197, 0
  v_mov_b32 v198, 0
  v_mov_b32 v199, 0
  v_mov_b32 v200, 0
  v_mov_b32 v201, 0
  v_mov_b32 v202, 0
  v_mov_b32 v203, 0
  v_mov_b32 v204, 0
  v_mov_b32 v205, 0
  v_mov_b32 v206, 0
  v_mov_b32 v207, 0
  v_mov_b32 v208, 0
  v_mov_b32 v209, 0
  v_mov_b32 v210, 0
  v_mov_b32 v211, 0
  v_mov_b32 v212, 0
  v_mov_b32 v213, 0
  v_mov_b32 v214, 0
  v_mov_b32 v215, 0
  v_mov_b32 v216, 0
  v_mov_b32 v217, 0
  v_mov_b32 v218, 0
  v_mov_b32 v219, 0
  v_mov_b32 v220, 0
  v_mov_b32 v221, 0
  v_mov_b32 v222, 0
  v_mov_b32 v223, 0
  v_mov_b32 v224, 0
  v_mov_b32 v225, 0
  v_mov_b32 v226, 0
  v_mov_b32 v227, 0
  v_mov_b32 v228, 0
  v_mov_b32 v229, 0
  v_mov_b32 v230, 0
  v_mov_b32 v231, 0
  v_mov_b32 v232, 0
  v_mov_b32 v233, 0
  v_mov_b32 v234, 0
  v_mov_b32 v235, 0
  v_mov_b32 v236, 0
  v_mov_b32 v237, 0
  v_mov_b32 v238, 0
  v_mov_b32 v239, 0
  s_mul_i32 s38, s3, 102400
  s_add_u32 s38, s38, 85524480
  s_mul_i32 s39, s3, 102400
  s_add_u32 s39, s39, 85544960
  buffer_load_dwordx4 v[48:51], v2, s[8:11], s38 offen offset:0 sc1
  buffer_load_dwordx4 v[52:55], v2, s[8:11], s39 offen offset:0 sc1
  buffer_load_dwordx4 v[56:59], v2, s[8:11], s38 offen offset:1024 sc1
  buffer_load_dwordx4 v[60:63], v2, s[8:11], s39 offen offset:1024 sc1
  buffer_load_dwordx4 v[64:67], v2, s[8:11], s38 offen offset:2048 sc1
  buffer_load_dwordx4 v[68:71], v2, s[8:11], s39 offen offset:2048 sc1
  ds_read_b128 v[80:83], v3 offset:0
  ds_read_b128 v[84:87], v3 offset:20480
  ds_read_b128 v[88:91], v3 offset:40960
  ds_read_b128 v[92:95], v3 offset:61440
  buffer_load_dwordx4 v[72:75], v2, s[8:11], s38 offen offset:3072 sc1
  buffer_load_dwordx4 v[76:79], v2, s[8:11], s39 offen offset:3072 sc1
  s_add_u32 s38, s38, 4096
  s_add_u32 s39, s39, 4096
  ds_read_b128 v[96:99], v4 offset:0
  ds_read_b128 v[100:103], v4 offset:20480
  ds_read_b128 v[104:107], v4 offset:40960
  ds_read_b128 v[108:111], v4 offset:61440
  s_waitcnt vmcnt(6) lgkmcnt(4)
  v_mfma_f32_16x16x32_bf16 v[16:19], v[80:83], v[48:51], 0
  v_mfma_f32_16x16x32_bf16 v[20:23], v[84:87], v[48:51], 0
  v_mfma_f32_16x16x32_bf16 v[24:27], v[88:91], v[48:51], 0
  v_mfma_f32_16x16x32_bf16 v[28:31], v[92:95], v[48:51], 0
  v_mfma_f32_16x16x32_bf16 v[32:35], v[80:83], v[52:55], 0
  v_mfma_f32_16x16x32_bf16 v[36:39], v[84:87], v[52:55], 0
  v_mfma_f32_16x16x32_bf16 v[40:43], v[88:91], v[52:55], 0
  v_mfma_f32_16x16x32_bf16 v[44:47], v[92:95], v[52:55], 0
  buffer_load_dwordx4 v[48:51], v2, s[8:11], s38 offen offset:0 sc1
  buffer_load_dwordx4 v[52:55], v2, s[8:11], s39 offen offset:0 sc1
  ds_read_b128 v[80:83], v5 offset:0
  ds_read_b128 v[84:87], v5 offset:20480
  ds_read_b128 v[88:91], v5 offset:40960
  ds_read_b128 v[92:95], v5 offset:61440
  s_waitcnt vmcnt(6) lgkmcnt(4)
  v_mfma_f32_16x16x32_bf16 v[16:19], v[96:99], v[56:59], v[16:19]
  v_mfma_f32_16x16x32_bf16 v[20:23], v[100:103], v[56:59], v[20:23]
  v_mfma_f32_16x16x32_bf16 v[24:27], v[104:107], v[56:59], v[24:27]
  v_mfma_f32_16x16x32_bf16 v[28:31], v[108:111], v[56:59], v[28:31]
  v_mfma_f32_16x16x32_bf16 v[32:35], v[96:99], v[60:63], v[32:35]
  v_mfma_f32_16x16x32_bf16 v[36:39], v[100:103], v[60:63], v[36:39]
  v_mfma_f32_16x16x32_bf16 v[40:43], v[104:107], v[60:63], v[40:43]
  v_mfma_f32_16x16x32_bf16 v[44:47], v[108:111], v[60:63], v[44:47]
  buffer_load_dwordx4 v[56:59], v2, s[8:11], s38 offen offset:1024 sc1
  buffer_load_dwordx4 v[60:63], v2, s[8:11], s39 offen offset:1024 sc1
  ds_read_b128 v[96:99], v6 offset:0
  ds_read_b128 v[100:103], v6 offset:20480
  ds_read_b128 v[104:107], v6 offset:40960
  ds_read_b128 v[108:111], v6 offset:61440
  s_waitcnt vmcnt(6) lgkmcnt(4)
  v_mfma_f32_16x16x32_bf16 v[16:19], v[80:83], v[64:67], v[16:19]
  v_mfma_f32_16x16x32_bf16 v[20:23], v[84:87], v[64:67], v[20:23]
  v_mfma_f32_16x16x32_bf16 v[24:27], v[88:91], v[64:67], v[24:27]
  v_mfma_f32_16x16x32_bf16 v[28:31], v[92:95], v[64:67], v[28:31]
  v_mfma_f32_16x16x32_bf16 v[32:35], v[80:83], v[68:71], v[32:35]
  v_mfma_f32_16x16x32_bf16 v[36:39], v[84:87], v[68:71], v[36:39]
  v_mfma_f32_16x16x32_bf16 v[40:43], v[88:91], v[68:71], v[40:43]
  v_mfma_f32_16x16x32_bf16 v[44:47], v[92:95], v[68:71], v[44:47]
  buffer_load_dwordx4 v[64:67], v2, s[8:11], s38 offen offset:2048 sc1
  buffer_load_dwordx4 v[68:71], v2, s[8:11], s39 offen offset:2048 sc1
  ds_read_b128 v[80:83], v3 offset:256
  ds_read_b128 v[84:87], v3 offset:20736
  ds_read_b128 v[88:91], v3 offset:41216
  ds_read_b128 v[92:95], v3 offset:61696
  s_waitcnt vmcnt(6) lgkmcnt(4)
  v_mfma_f32_16x16x32_bf16 v[16:19], v[96:99], v[72:75], v[16:19]
  v_mfma_f32_16x16x32_bf16 v[20:23], v[100:103], v[72:75], v[20:23]
  v_mfma_f32_16x16x32_bf16 v[24:27], v[104:107], v[72:75], v[24:27]
  v_mfma_f32_16x16x32_bf16 v[28:31], v[108:111], v[72:75], v[28:31]
  v_mfma_f32_16x16x32_bf16 v[32:35], v[96:99], v[76:79], v[32:35]
  v_mfma_f32_16x16x32_bf16 v[36:39], v[100:103], v[76:79], v[36:39]
  v_mfma_f32_16x16x32_bf16 v[40:43], v[104:107], v[76:79], v[40:43]
  v_mfma_f32_16x16x32_bf16 v[44:47], v[108:111], v[76:79], v[44:47]
  buffer_load_dwordx4 v[72:75], v2, s[8:11], s38 offen offset:3072 sc1
  buffer_load_dwordx4 v[76:79], v2, s[8:11], s39 offen offset:3072 sc1
  s_add_u32 s38, s38, 4096
  s_add_u32 s39, s39, 4096
  ds_read_b128 v[96:99], v4 offset:256
  ds_read_b128 v[100:103], v4 offset:20736
  ds_read_b128 v[104:107], v4 offset:41216
  ds_read_b128 v[108:111], v4 offset:61696
  s_waitcnt vmcnt(6) lgkmcnt(4)
  v_mfma_f32_16x16x32_bf16 v[16:19], v[80:83], v[48:51], v[16:19]
  v_mfma_f32_16x16x32_bf16 v[20:23], v[84:87], v[48:51], v[20:23]
  v_mfma_f32_16x16x32_bf16 v[24:27], v[88:91], v[48:51], v[24:27]
  v_mfma_f32_16x16x32_bf16 v[28:31], v[92:95], v[48:51], v[28:31]
  v_mfma_f32_16x16x32_bf16 v[32:35], v[80:83], v[52:55], v[32:35]
  v_mfma_f32_16x16x32_bf16 v[36:39], v[84:87], v[52:55], v[36:39]
  v_mfma_f32_16x16x32_bf16 v[40:43], v[88:91], v[52:55], v[40:43]
  v_mfma_f32_16x16x32_bf16 v[44:47], v[92:95], v[52:55], v[44:47]
  buffer_load_dwordx4 v[48:51], v2, s[8:11], s38 offen offset:0 sc1
  buffer_load_dwordx4 v[52:55], v2, s[8:11], s39 offen offset:0 sc1
  ds_read_b128 v[80:83], v5 offset:256
  ds_read_b128 v[84:87], v5 offset:20736
  ds_read_b128 v[88:91], v5 offset:41216
  ds_read_b128 v[92:95], v5 offset:61696
  s_waitcnt vmcnt(6) lgkmcnt(4)
  v_mfma_f32_16x16x32_bf16 v[16:19], v[96:99], v[56:59], v[16:19]
  v_mfma_f32_16x16x32_bf16 v[20:23], v[100:103], v[56:59], v[20:23]
  v_mfma_f32_16x16x32_bf16 v[24:27], v[104:107], v[56:59], v[24:27]
  v_mfma_f32_16x16x32_bf16 v[28:31], v[108:111], v[56:59], v[28:31]
  v_mfma_f32_16x16x32_bf16 v[32:35], v[96:99], v[60:63], v[32:35]
  v_mfma_f32_16x16x32_bf16 v[36:39], v[100:103], v[60:63], v[36:39]
  v_mfma_f32_16x16x32_bf16 v[40:43], v[104:107], v[60:63], v[40:43]
  v_mfma_f32_16x16x32_bf16 v[44:47], v[108:111], v[60:63], v[44:47]
  buffer_load_dwordx4 v[56:59], v2, s[8:11], s38 offen offset:1024 sc1
  buffer_load_dwordx4 v[60:63], v2, s[8:11], s39 offen offset:1024 sc1
  ds_read_b128 v[96:99], v6 offset:256
  ds_read_b128 v[100:103], v6 offset:20736
  ds_read_b128 v[104:107], v6 offset:41216
  ds_read_b128 v[108:111], v6 offset:61696
  s_waitcnt vmcnt(6) lgkmcnt(4)
  v_mfma_f32_16x16x32_bf16 v[16:19], v[80:83], v[64:67], v[16:19]
  v_mfma_f32_16x16x32_bf16 v[20:23], v[84:87], v[64:67], v[20:23]
  v_mfma_f32_16x16x32_bf16 v[24:27], v[88:91], v[64:67], v[24:27]
  v_mfma_f32_16x16x32_bf16 v[28:31], v[92:95], v[64:67], v[28:31]
  v_mfma_f32_16x16x32_bf16 v[32:35], v[80:83], v[68:71], v[32:35]
  v_mfma_f32_16x16x32_bf16 v[36:39], v[84:87], v[68:71], v[36:39]
  v_mfma_f32_16x16x32_bf16 v[40:43], v[88:91], v[68:71], v[40:43]
  v_mfma_f32_16x16x32_bf16 v[44:47], v[92:95], v[68:71], v[44:47]
  buffer_load_dwordx4 v[64:67], v2, s[8:11], s38 offen offset:2048 sc1
  buffer_load_dwordx4 v[68:71], v2, s[8:11], s39 offen offset:2048 sc1
  ds_read_b128 v[80:83], v3 offset:512
  ds_read_b128 v[84:87], v3 offset:20992
  ds_read_b128 v[88:91], v3 offset:41472
  ds_read_b128 v[92:95], v3 offset:61952
  s_waitcnt vmcnt(6) lgkmcnt(4)
  v_mfma_f32_16x16x32_bf16 v[16:19], v[96:99], v[72:75], v[16:19]
  v_mfma_f32_16x16x32_bf16 v[20:23], v[100:103], v[72:75], v[20:23]
  v_mfma_f32_16x16x32_bf16 v[24:27], v[104:107], v[72:75], v[24:27]
  v_mfma_f32_16x16x32_bf16 v[28:31], v[108:111], v[72:75], v[28:31]
  v_mfma_f32_16x16x32_bf16 v[32:35], v[96:99], v[76:79], v[32:35]
  v_mfma_f32_16x16x32_bf16 v[36:39], v[100:103], v[76:79], v[36:39]
  v_mfma_f32_16x16x32_bf16 v[40:43], v[104:107], v[76:79], v[40:43]
  v_mfma_f32_16x16x32_bf16 v[44:47], v[108:111], v[76:79], v[44:47]
  buffer_load_dwordx4 v[72:75], v2, s[8:11], s38 offen offset:3072 sc1
  buffer_load_dwordx4 v[76:79], v2, s[8:11], s39 offen offset:3072 sc1
  s_add_u32 s38, s38, 4096
  s_add_u32 s39, s39, 4096
  ds_read_b128 v[96:99], v4 offset:512
  ds_read_b128 v[100:103], v4 offset:20992
  ds_read_b128 v[104:107], v4 offset:41472
  ds_read_b128 v[108:111], v4 offset:61952
  s_waitcnt vmcnt(6) lgkmcnt(4)
  v_mfma_f32_16x16x32_bf16 v[16:19], v[80:83], v[48:51], v[16:19]
  v_mfma_f32_16x16x32_bf16 v[20:23], v[84:87], v[48:51], v[20:23]
  v_mfma_f32_16x16x32_bf16 v[24:27], v[88:91], v[48:51], v[24:27]
  v_mfma_f32_16x16x32_bf16 v[28:31], v[92:95], v[48:51], v[28:31]
  v_mfma_f32_16x16x32_bf16 v[32:35], v[80:83], v[52:55], v[32:35]
  v_mfma_f32_16x16x32_bf16 v[36:39], v[84:87], v[52:55], v[36:39]
  v_mfma_f32_16x16x32_bf16 v[40:43], v[88:91], v[52:55], v[40:43]
  v_mfma_f32_16x16x32_bf16 v[44:47], v[92:95], v[52:55], v[44:47]
  buffer_load_dwordx4 v[48:51], v2, s[8:11], s38 offen offset:0 sc1
  buffer_load_dwordx4 v[52:55], v2, s[8:11], s39 offen offset:0 sc1
  ds_read_b128 v[80:83], v5 offset:512
  ds_read_b128 v[84:87], v5 offset:20992
  ds_read_b128 v[88:91], v5 offset:41472
  ds_read_b128 v[92:95], v5 offset:61952
  s_waitcnt vmcnt(6) lgkmcnt(4)
  v_mfma_f32_16x16x32_bf16 v[16:19], v[96:99], v[56:59], v[16:19]
  v_mfma_f32_16x16x32_bf16 v[20:23], v[100:103], v[56:59], v[20:23]
  v_mfma_f32_16x16x32_bf16 v[24:27], v[104:107], v[56:59], v[24:27]
  v_mfma_f32_16x16x32_bf16 v[28:31], v[108:111], v[56:59], v[28:31]
  v_mfma_f32_16x16x32_bf16 v[32:35], v[96:99], v[60:63], v[32:35]
  v_mfma_f32_16x16x32_bf16 v[36:39], v[100:103], v[60:63], v[36:39]
  v_mfma_f32_16x16x32_bf16 v[40:43], v[104:107], v[60:63], v[40:43]
  v_mfma_f32_16x16x32_bf16 v[44:47], v[108:111], v[60:63], v[44:47]
  buffer_load_dwordx4 v[56:59], v2, s[8:11], s38 offen offset:1024 sc1
  buffer_load_dwordx4 v[60:63], v2, s[8:11], s39 offen offset:1024 sc1
  ds_read_b128 v[96:99], v6 offset:512
  ds_read_b128 v[100:103], v6 offset:20992
  ds_read_b128 v[104:107], v6 offset:41472
  ds_read_b128 v[108:111], v6 offset:61952
  s_waitcnt vmcnt(6) lgkmcnt(4)
  v_mfma_f32_16x16x32_bf16 v[16:19], v[80:83], v[64:67], v[16:19]
  v_mfma_f32_16x16x32_bf16 v[20:23], v[84:87], v[64:67], v[20:23]
  v_mfma_f32_16x16x32_bf16 v[24:27], v[88:91], v[64:67], v[24:27]
  v_mfma_f32_16x16x32_bf16 v[28:31], v[92:95], v[64:67], v[28:31]
  v_mfma_f32_16x16x32_bf16 v[32:35], v[80:83], v[68:71], v[32:35]
  v_mfma_f32_16x16x32_bf16 v[36:39], v[84:87], v[68:71], v[36:39]
  v_mfma_f32_16x16x32_bf16 v[40:43], v[88:91], v[68:71], v[40:43]
  v_mfma_f32_16x16x32_bf16 v[44:47], v[92:95], v[68:71], v[44:47]
  buffer_load_dwordx4 v[64:67], v2, s[8:11], s38 offen offset:2048 sc1
  buffer_load_dwordx4 v[68:71], v2, s[8:11], s39 offen offset:2048 sc1
  ds_read_b128 v[80:83], v3 offset:768
  ds_read_b128 v[84:87], v3 offset:21248
  ds_read_b128 v[88:91], v3 offset:41728
  ds_read_b128 v[92:95], v3 offset:62208
  s_waitcnt vmcnt(6) lgkmcnt(4)
  v_mfma_f32_16x16x32_bf16 v[16:19], v[96:99], v[72:75], v[16:19]
  v_mfma_f32_16x16x32_bf16 v[20:23], v[100:103], v[72:75], v[20:23]
  v_mfma_f32_16x16x32_bf16 v[24:27], v[104:107], v[72:75], v[24:27]
  v_mfma_f32_16x16x32_bf16 v[28:31], v[108:111], v[72:75], v[28:31]
  v_mfma_f32_16x16x32_bf16 v[32:35], v[96:99], v[76:79], v[32:35]
  v_mfma_f32_16x16x32_bf16 v[36:39], v[100:103], v[76:79], v[36:39]
  v_mfma_f32_16x16x32_bf16 v[40:43], v[104:107], v[76:79], v[40:43]
  v_mfma_f32_16x16x32_bf16 v[44:47], v[108:111], v[76:79], v[44:47]
  buffer_load_dwordx4 v[72:75], v2, s[8:11], s38 offen offset:3072 sc1
  buffer_load_dwordx4 v[76:79], v2, s[8:11], s39 offen offset:3072 sc1
  s_add_u32 s38, s38, 4096
  s_add_u32 s39, s39, 4096
  ds_read_b128 v[96:99], v4 offset:768
  ds_read_b128 v[100:103], v4 offset:21248
  ds_read_b128 v[104:107], v4 offset:41728
  ds_read_b128 v[108:111], v4 offset:62208
  s_waitcnt vmcnt(6) lgkmcnt(4)
  v_mfma_f32_16x16x32_bf16 v[16:19], v[80:83], v[48:51], v[16:19]
  v_mfma_f32_16x16x32_bf16 v[20:23], v[84:87], v[48:51], v[20:23]
  v_mfma_f32_16x16x32_bf16 v[24:27], v[88:91], v[48:51], v[24:27]
  v_mfma_f32_16x16x32_bf16 v[28:31], v[92:95], v[48:51], v[28:31]
  v_mfma_f32_16x16x32_bf16 v[32:35], v[80:83], v[52:55], v[32:35]
  v_mfma_f32_16x16x32_bf16 v[36:39], v[84:87], v[52:55], v[36:39]
  v_mfma_f32_16x16x32_bf16 v[40:43], v[88:91], v[52:55], v[40:43]
  v_mfma_f32_16x16x32_bf16 v[44:47], v[92:95], v[52:55], v[44:47]
  buffer_load_dwordx4 v[48:51], v2, s[8:11], s38 offen offset:0 sc1
  buffer_load_dwordx4 v[52:55], v2, s[8:11], s39 offen offset:0 sc1
  ds_read_b128 v[80:83], v5 offset:768
  ds_read_b128 v[84:87], v5 offset:21248
  ds_read_b128 v[88:91], v5 offset:41728
  ds_read_b128 v[92:95], v5 offset:62208
  s_waitcnt vmcnt(6) lgkmcnt(4)
  v_mfma_f32_16x16x32_bf16 v[16:19], v[96:99], v[56:59], v[16:19]
  v_mfma_f32_16x16x32_bf16 v[20:23], v[100:103], v[56:59], v[20:23]
  v_mfma_f32_16x16x32_bf16 v[24:27], v[104:107], v[56:59], v[24:27]
  v_mfma_f32_16x16x32_bf16 v[28:31], v[108:111], v[56:59], v[28:31]
  v_mfma_f32_16x16x32_bf16 v[32:35], v[96:99], v[60:63], v[32:35]
  v_mfma_f32_16x16x32_bf16 v[36:39], v[100:103], v[60:63], v[36:39]
  v_mfma_f32_16x16x32_bf16 v[40:43], v[104:107], v[60:63], v[40:43]
  v_mfma_f32_16x16x32_bf16 v[44:47], v[108:111], v[60:63], v[44:47]
  buffer_load_dwordx4 v[56:59], v2, s[8:11], s38 offen offset:1024 sc1
  buffer_load_dwordx4 v[60:63], v2, s[8:11], s39 offen offset:1024 sc1
  ds_read_b128 v[96:99], v6 offset:768
  ds_read_b128 v[100:103], v6 offset:21248
  ds_read_b128 v[104:107], v6 offset:41728
  ds_read_b128 v[108:111], v6 offset:62208
  s_waitcnt vmcnt(6) lgkmcnt(4)
  v_mfma_f32_16x16x32_bf16 v[16:19], v[80:83], v[64:67], v[16:19]
  v_mfma_f32_16x16x32_bf16 v[20:23], v[84:87], v[64:67], v[20:23]
  v_mfma_f32_16x16x32_bf16 v[24:27], v[88:91], v[64:67], v[24:27]
  v_mfma_f32_16x16x32_bf16 v[28:31], v[92:95], v[64:67], v[28:31]
  v_mfma_f32_16x16x32_bf16 v[32:35], v[80:83], v[68:71], v[32:35]
  v_mfma_f32_16x16x32_bf16 v[36:39], v[84:87], v[68:71], v[36:39]
  v_mfma_f32_16x16x32_bf16 v[40:43], v[88:91], v[68:71], v[40:43]
  v_mfma_f32_16x16x32_bf16 v[44:47], v[92:95], v[68:71], v[44:47]
  buffer_load_dwordx4 v[64:67], v2, s[8:11], s38 offen offset:2048 sc1
  buffer_load_dwordx4 v[68:71], v2, s[8:11], s39 offen offset:2048 sc1
  ds_read_b128 v[80:83], v3 offset:1024
  ds_read_b128 v[84:87], v3 offset:21504
  ds_read_b128 v[88:91], v3 offset:41984
  ds_read_b128 v[92:95], v3 offset:62464
  s_waitcnt vmcnt(6) lgkmcnt(4)
  v_mfma_f32_16x16x32_bf16 v[16:19], v[96:99], v[72:75], v[16:19]
  v_mfma_f32_16x16x32_bf16 v[20:23], v[100:103], v[72:75], v[20:23]
  v_mfma_f32_16x16x32_bf16 v[24:27], v[104:107], v[72:75], v[24:27]
  v_mfma_f32_16x16x32_bf16 v[28:31], v[108:111], v[72:75], v[28:31]
  v_mfma_f32_16x16x32_bf16 v[32:35], v[96:99], v[76:79], v[32:35]
  v_mfma_f32_16x16x32_bf16 v[36:39], v[100:103], v[76:79], v[36:39]
  v_mfma_f32_16x16x32_bf16 v[40:43], v[104:107], v[76:79], v[40:43]
  v_mfma_f32_16x16x32_bf16 v[44:47], v[108:111], v[76:79], v[44:47]
  buffer_load_dwordx4 v[72:75], v2, s[8:11], s38 offen offset:3072 sc1
  buffer_load_dwordx4 v[76:79], v2, s[8:11], s39 offen offset:3072 sc1
  s_add_u32 s38, s38, 4096
  s_add_u32 s39, s39, 4096
  ds_read_b128 v[96:99], v4 offset:1024
  ds_read_b128 v[100:103], v4 offset:21504
  ds_read_b128 v[104:107], v4 offset:41984
  ds_read_b128 v[108:111], v4 offset:62464
  s_waitcnt vmcnt(6) lgkmcnt(4)
  v_mfma_f32_16x16x32_bf16 v[16:19], v[80:83], v[48:51], v[16:19]
  v_mfma_f32_16x16x32_bf16 v[20:23], v[84:87], v[48:51], v[20:23]
  v_mfma_f32_16x16x32_bf16 v[24:27], v[88:91], v[48:51], v[24:27]
  v_mfma_f32_16x16x32_bf16 v[28:31], v[92:95], v[48:51], v[28:31]
  v_mfma_f32_16x16x32_bf16 v[32:35], v[80:83], v[52:55], v[32:35]
  v_mfma_f32_16x16x32_bf16 v[36:39], v[84:87], v[52:55], v[36:39]
  v_mfma_f32_16x16x32_bf16 v[40:43], v[88:91], v[52:55], v[40:43]
  v_mfma_f32_16x16x32_bf16 v[44:47], v[92:95], v[52:55], v[44:47]
  ds_read_b128 v[80:83], v5 offset:1024
  ds_read_b128 v[84:87], v5 offset:21504
  ds_read_b128 v[88:91], v5 offset:41984
  ds_read_b128 v[92:95], v5 offset:62464
  s_waitcnt vmcnt(4) lgkmcnt(4)
  v_mfma_f32_16x16x32_bf16 v[16:19], v[96:99], v[56:59], v[16:19]
  v_mfma_f32_16x16x32_bf16 v[20:23], v[100:103], v[56:59], v[20:23]
  v_mfma_f32_16x16x32_bf16 v[24:27], v[104:107], v[56:59], v[24:27]
  v_mfma_f32_16x16x32_bf16 v[28:31], v[108:111], v[56:59], v[28:31]
  v_mfma_f32_16x16x32_bf16 v[32:35], v[96:99], v[60:63], v[32:35]
  v_mfma_f32_16x16x32_bf16 v[36:39], v[100:103], v[60:63], v[36:39]
  v_mfma_f32_16x16x32_bf16 v[40:43], v[104:107], v[60:63], v[40:43]
  v_mfma_f32_16x16x32_bf16 v[44:47], v[108:111], v[60:63], v[44:47]
  ds_read_b128 v[96:99], v6 offset:1024
  ds_read_b128 v[100:103], v6 offset:21504
  ds_read_b128 v[104:107], v6 offset:41984
  ds_read_b128 v[108:111], v6 offset:62464
  s_waitcnt vmcnt(2) lgkmcnt(4)
  v_mfma_f32_16x16x32_bf16 v[16:19], v[80:83], v[64:67], v[16:19]
  v_mfma_f32_16x16x32_bf16 v[20:23], v[84:87], v[64:67], v[20:23]
  v_mfma_f32_16x16x32_bf16 v[24:27], v[88:91], v[64:67], v[24:27]
  v_mfma_f32_16x16x32_bf16 v[28:31], v[92:95], v[64:67], v[28:31]
  v_mfma_f32_16x16x32_bf16 v[32:35], v[80:83], v[68:71], v[32:35]
  v_mfma_f32_16x16x32_bf16 v[36:39], v[84:87], v[68:71], v[36:39]
  v_mfma_f32_16x16x32_bf16 v[40:43], v[88:91], v[68:71], v[40:43]
  v_mfma_f32_16x16x32_bf16 v[44:47], v[92:95], v[68:71], v[44:47]
  s_waitcnt vmcnt(0) lgkmcnt(0)
  v_mfma_f32_16x16x32_bf16 v[16:19], v[96:99], v[72:75], v[16:19]
  v_mfma_f32_16x16x32_bf16 v[20:23], v[100:103], v[72:75], v[20:23]
  v_mfma_f32_16x16x32_bf16 v[24:27], v[104:107], v[72:75], v[24:27]
  v_mfma_f32_16x16x32_bf16 v[28:31], v[108:111], v[72:75], v[28:31]
  v_mfma_f32_16x16x32_bf16 v[32:35], v[96:99], v[76:79], v[32:35]
  v_mfma_f32_16x16x32_bf16 v[36:39], v[100:103], v[76:79], v[36:39]
  v_mfma_f32_16x16x32_bf16 v[40:43], v[104:107], v[76:79], v[40:43]
  v_mfma_f32_16x16x32_bf16 v[44:47], v[108:111], v[76:79], v[44:47]
  s_nop 7
  v_cvt_pk_bf16_f32 v112, v16, v17
  v_cvt_pk_bf16_f32 v113, v18, v19
  v_cvt_pk_bf16_f32 v114, v20, v21
  v_cvt_pk_bf16_f32 v115, v22, v23
  v_cvt_pk_bf16_f32 v116, v24, v25
  v_cvt_pk_bf16_f32 v117, v26, v27
  v_cvt_pk_bf16_f32 v118, v28, v29
  v_cvt_pk_bf16_f32 v119, v30, v31
  v_cvt_pk_bf16_f32 v120, v32, v33
  v_cvt_pk_bf16_f32 v121, v34, v35
  v_cvt_pk_bf16_f32 v122, v36, v37
  v_cvt_pk_bf16_f32 v123, v38, v39
  v_cvt_pk_bf16_f32 v124, v40, v41
  v_cvt_pk_bf16_f32 v125, v42, v43
  v_cvt_pk_bf16_f32 v126, v44, v45
  v_cvt_pk_bf16_f32 v127, v46, v47
  s_nop 1
  s_mul_i32 s38, s3, 102400
  s_add_u32 s38, s38, 85565440
  s_mul_i32 s39, s3, 102400
  s_add_u32 s39, s39, 85585920
  buffer_load_dwordx4 v[48:51], v2, s[8:11], s38 offen offset:0 sc1
  buffer_load_dwordx4 v[52:55], v2, s[8:11], s39 offen offset:0 sc1
  buffer_load_dwordx4 v[56:59], v2, s[8:11], s38 offen offset:1024 sc1
  buffer_load_dwordx4 v[60:63], v2, s[8:11], s39 offen offset:1024 sc1
  buffer_load_dwordx4 v[64:67], v2, s[8:11], s38 offen offset:2048 sc1
  buffer_load_dwordx4 v[68:71], v2, s[8:11], s39 offen offset:2048 sc1
  ds_read_b128 v[80:83], v3 offset:0
  ds_read_b128 v[84:87], v3 offset:20480
  ds_read_b128 v[88:91], v3 offset:40960
  ds_read_b128 v[92:95], v3 offset:61440
  buffer_load_dwordx4 v[72:75], v2, s[8:11], s38 offen offset:3072 sc1
  buffer_load_dwordx4 v[76:79], v2, s[8:11], s39 offen offset:3072 sc1
  s_add_u32 s38, s38, 4096
  s_add_u32 s39, s39, 4096
  ds_read_b128 v[96:99], v4 offset:0
  ds_read_b128 v[100:103], v4 offset:20480
  ds_read_b128 v[104:107], v4 offset:40960
  ds_read_b128 v[108:111], v4 offset:61440
  s_waitcnt vmcnt(6) lgkmcnt(4)
  v_mfma_f32_16x16x32_bf16 v[16:19], v[80:83], v[48:51], 0
  v_mfma_f32_16x16x32_bf16 v[20:23], v[84:87], v[48:51], 0
  v_mfma_f32_16x16x32_bf16 v[24:27], v[88:91], v[48:51], 0
  v_mfma_f32_16x16x32_bf16 v[28:31], v[92:95], v[48:51], 0
  v_mfma_f32_16x16x32_bf16 v[32:35], v[80:83], v[52:55], 0
  v_mfma_f32_16x16x32_bf16 v[36:39], v[84:87], v[52:55], 0
  v_mfma_f32_16x16x32_bf16 v[40:43], v[88:91], v[52:55], 0
  v_mfma_f32_16x16x32_bf16 v[44:47], v[92:95], v[52:55], 0
  buffer_load_dwordx4 v[48:51], v2, s[8:11], s38 offen offset:0 sc1
  buffer_load_dwordx4 v[52:55], v2, s[8:11], s39 offen offset:0 sc1
  ds_read_b128 v[80:83], v5 offset:0
  ds_read_b128 v[84:87], v5 offset:20480
  ds_read_b128 v[88:91], v5 offset:40960
  ds_read_b128 v[92:95], v5 offset:61440
  s_waitcnt vmcnt(6) lgkmcnt(4)
  v_mfma_f32_16x16x32_bf16 v[16:19], v[96:99], v[56:59], v[16:19]
  v_mfma_f32_16x16x32_bf16 v[20:23], v[100:103], v[56:59], v[20:23]
  v_mfma_f32_16x16x32_bf16 v[24:27], v[104:107], v[56:59], v[24:27]
  v_mfma_f32_16x16x32_bf16 v[28:31], v[108:111], v[56:59], v[28:31]
  v_mfma_f32_16x16x32_bf16 v[32:35], v[96:99], v[60:63], v[32:35]
  v_mfma_f32_16x16x32_bf16 v[36:39], v[100:103], v[60:63], v[36:39]
  v_mfma_f32_16x16x32_bf16 v[40:43], v[104:107], v[60:63], v[40:43]
  v_mfma_f32_16x16x32_bf16 v[44:47], v[108:111], v[60:63], v[44:47]
  buffer_load_dwordx4 v[56:59], v2, s[8:11], s38 offen offset:1024 sc1
  buffer_load_dwordx4 v[60:63], v2, s[8:11], s39 offen offset:1024 sc1
  ds_read_b128 v[96:99], v6 offset:0
  ds_read_b128 v[100:103], v6 offset:20480
  ds_read_b128 v[104:107], v6 offset:40960
  ds_read_b128 v[108:111], v6 offset:61440
  s_waitcnt vmcnt(6) lgkmcnt(4)
  v_mfma_f32_16x16x32_bf16 v[16:19], v[80:83], v[64:67], v[16:19]
  v_mfma_f32_16x16x32_bf16 v[20:23], v[84:87], v[64:67], v[20:23]
  v_mfma_f32_16x16x32_bf16 v[24:27], v[88:91], v[64:67], v[24:27]
  v_mfma_f32_16x16x32_bf16 v[28:31], v[92:95], v[64:67], v[28:31]
  v_mfma_f32_16x16x32_bf16 v[32:35], v[80:83], v[68:71], v[32:35]
  v_mfma_f32_16x16x32_bf16 v[36:39], v[84:87], v[68:71], v[36:39]
  v_mfma_f32_16x16x32_bf16 v[40:43], v[88:91], v[68:71], v[40:43]
  v_mfma_f32_16x16x32_bf16 v[44:47], v[92:95], v[68:71], v[44:47]
  buffer_load_dwordx4 v[64:67], v2, s[8:11], s38 offen offset:2048 sc1
  buffer_load_dwordx4 v[68:71], v2, s[8:11], s39 offen offset:2048 sc1
  ds_read_b128 v[80:83], v3 offset:256
  ds_read_b128 v[84:87], v3 offset:20736
  ds_read_b128 v[88:91], v3 offset:41216
  ds_read_b128 v[92:95], v3 offset:61696
  s_waitcnt vmcnt(6) lgkmcnt(4)
  v_mfma_f32_16x16x32_bf16 v[16:19], v[96:99], v[72:75], v[16:19]
  v_mfma_f32_16x16x32_bf16 v[20:23], v[100:103], v[72:75], v[20:23]
  v_mfma_f32_16x16x32_bf16 v[24:27], v[104:107], v[72:75], v[24:27]
  v_mfma_f32_16x16x32_bf16 v[28:31], v[108:111], v[72:75], v[28:31]
  v_mfma_f32_16x16x32_bf16 v[32:35], v[96:99], v[76:79], v[32:35]
  v_mfma_f32_16x16x32_bf16 v[36:39], v[100:103], v[76:79], v[36:39]
  v_mfma_f32_16x16x32_bf16 v[40:43], v[104:107], v[76:79], v[40:43]
  v_mfma_f32_16x16x32_bf16 v[44:47], v[108:111], v[76:79], v[44:47]
  buffer_load_dwordx4 v[72:75], v2, s[8:11], s38 offen offset:3072 sc1
  buffer_load_dwordx4 v[76:79], v2, s[8:11], s39 offen offset:3072 sc1
  s_add_u32 s38, s38, 4096
  s_add_u32 s39, s39, 4096
  ds_read_b128 v[96:99], v4 offset:256
  ds_read_b128 v[100:103], v4 offset:20736
  ds_read_b128 v[104:107], v4 offset:41216
  ds_read_b128 v[108:111], v4 offset:61696
  s_waitcnt vmcnt(6) lgkmcnt(4)
  v_mfma_f32_16x16x32_bf16 v[16:19], v[80:83], v[48:51], v[16:19]
  v_mfma_f32_16x16x32_bf16 v[20:23], v[84:87], v[48:51], v[20:23]
  v_mfma_f32_16x16x32_bf16 v[24:27], v[88:91], v[48:51], v[24:27]
  v_mfma_f32_16x16x32_bf16 v[28:31], v[92:95], v[48:51], v[28:31]
  v_mfma_f32_16x16x32_bf16 v[32:35], v[80:83], v[52:55], v[32:35]
  v_mfma_f32_16x16x32_bf16 v[36:39], v[84:87], v[52:55], v[36:39]
  v_mfma_f32_16x16x32_bf16 v[40:43], v[88:91], v[52:55], v[40:43]
  v_mfma_f32_16x16x32_bf16 v[44:47], v[92:95], v[52:55], v[44:47]
  buffer_load_dwordx4 v[48:51], v2, s[8:11], s38 offen offset:0 sc1
  buffer_load_dwordx4 v[52:55], v2, s[8:11], s39 offen offset:0 sc1
  ds_read_b128 v[80:83], v5 offset:256
  ds_read_b128 v[84:87], v5 offset:20736
  ds_read_b128 v[88:91], v5 offset:41216
  ds_read_b128 v[92:95], v5 offset:61696
  s_waitcnt vmcnt(6) lgkmcnt(4)
  v_mfma_f32_16x16x32_bf16 v[16:19], v[96:99], v[56:59], v[16:19]
  v_mfma_f32_16x16x32_bf16 v[20:23], v[100:103], v[56:59], v[20:23]
  v_mfma_f32_16x16x32_bf16 v[24:27], v[104:107], v[56:59], v[24:27]
  v_mfma_f32_16x16x32_bf16 v[28:31], v[108:111], v[56:59], v[28:31]
  v_mfma_f32_16x16x32_bf16 v[32:35], v[96:99], v[60:63], v[32:35]
  v_mfma_f32_16x16x32_bf16 v[36:39], v[100:103], v[60:63], v[36:39]
  v_mfma_f32_16x16x32_bf16 v[40:43], v[104:107], v[60:63], v[40:43]
  v_mfma_f32_16x16x32_bf16 v[44:47], v[108:111], v[60:63], v[44:47]
  buffer_load_dwordx4 v[56:59], v2, s[8:11], s38 offen offset:1024 sc1
  buffer_load_dwordx4 v[60:63], v2, s[8:11], s39 offen offset:1024 sc1
  ds_read_b128 v[96:99], v6 offset:256
  ds_read_b128 v[100:103], v6 offset:20736
  ds_read_b128 v[104:107], v6 offset:41216
  ds_read_b128 v[108:111], v6 offset:61696
  s_waitcnt vmcnt(6) lgkmcnt(4)
  v_mfma_f32_16x16x32_bf16 v[16:19], v[80:83], v[64:67], v[16:19]
  v_mfma_f32_16x16x32_bf16 v[20:23], v[84:87], v[64:67], v[20:23]
  v_mfma_f32_16x16x32_bf16 v[24:27], v[88:91], v[64:67], v[24:27]
  v_mfma_f32_16x16x32_bf16 v[28:31], v[92:95], v[64:67], v[28:31]
  v_mfma_f32_16x16x32_bf16 v[32:35], v[80:83], v[68:71], v[32:35]
  v_mfma_f32_16x16x32_bf16 v[36:39], v[84:87], v[68:71], v[36:39]
  v_mfma_f32_16x16x32_bf16 v[40:43], v[88:91], v[68:71], v[40:43]
  v_mfma_f32_16x16x32_bf16 v[44:47], v[92:95], v[68:71], v[44:47]
  buffer_load_dwordx4 v[64:67], v2, s[8:11], s38 offen offset:2048 sc1
  buffer_load_dwordx4 v[68:71], v2, s[8:11], s39 offen offset:2048 sc1
  ds_read_b128 v[80:83], v3 offset:512
  ds_read_b128 v[84:87], v3 offset:20992
  ds_read_b128 v[88:91], v3 offset:41472
  ds_read_b128 v[92:95], v3 offset:61952
  s_waitcnt vmcnt(6) lgkmcnt(4)
  v_mfma_f32_16x16x32_bf16 v[16:19], v[96:99], v[72:75], v[16:19]
  v_mfma_f32_16x16x32_bf16 v[20:23], v[100:103], v[72:75], v[20:23]
  v_mfma_f32_16x16x32_bf16 v[24:27], v[104:107], v[72:75], v[24:27]
  v_mfma_f32_16x16x32_bf16 v[28:31], v[108:111], v[72:75], v[28:31]
  v_mfma_f32_16x16x32_bf16 v[32:35], v[96:99], v[76:79], v[32:35]
  v_mfma_f32_16x16x32_bf16 v[36:39], v[100:103], v[76:79], v[36:39]
  v_mfma_f32_16x16x32_bf16 v[40:43], v[104:107], v[76:79], v[40:43]
  v_mfma_f32_16x16x32_bf16 v[44:47], v[108:111], v[76:79], v[44:47]
  buffer_load_dwordx4 v[72:75], v2, s[8:11], s38 offen offset:3072 sc1
  buffer_load_dwordx4 v[76:79], v2, s[8:11], s39 offen offset:3072 sc1
  s_add_u32 s38, s38, 4096
  s_add_u32 s39, s39, 4096
  ds_read_b128 v[96:99], v4 offset:512
  ds_read_b128 v[100:103], v4 offset:20992
  ds_read_b128 v[104:107], v4 offset:41472
  ds_read_b128 v[108:111], v4 offset:61952
  s_waitcnt vmcnt(6) lgkmcnt(4)
  v_mfma_f32_16x16x32_bf16 v[16:19], v[80:83], v[48:51], v[16:19]
  v_mfma_f32_16x16x32_bf16 v[20:23], v[84:87], v[48:51], v[20:23]
  v_mfma_f32_16x16x32_bf16 v[24:27], v[88:91], v[48:51], v[24:27]
  v_mfma_f32_16x16x32_bf16 v[28:31], v[92:95], v[48:51], v[28:31]
  v_mfma_f32_16x16x32_bf16 v[32:35], v[80:83], v[52:55], v[32:35]
  v_mfma_f32_16x16x32_bf16 v[36:39], v[84:87], v[52:55], v[36:39]
  v_mfma_f32_16x16x32_bf16 v[40:43], v[88:91], v[52:55], v[40:43]
  v_mfma_f32_16x16x32_bf16 v[44:47], v[92:95], v[52:55], v[44:47]
  buffer_load_dwordx4 v[48:51], v2, s[8:11], s38 offen offset:0 sc1
  buffer_load_dwordx4 v[52:55], v2, s[8:11], s39 offen offset:0 sc1
  ds_read_b128 v[80:83], v5 offset:512
  ds_read_b128 v[84:87], v5 offset:20992
  ds_read_b128 v[88:91], v5 offset:41472
  ds_read_b128 v[92:95], v5 offset:61952
  s_waitcnt vmcnt(6) lgkmcnt(4)
  v_mfma_f32_16x16x32_bf16 v[16:19], v[96:99], v[56:59], v[16:19]
  v_mfma_f32_16x16x32_bf16 v[20:23], v[100:103], v[56:59], v[20:23]
  v_mfma_f32_16x16x32_bf16 v[24:27], v[104:107], v[56:59], v[24:27]
  v_mfma_f32_16x16x32_bf16 v[28:31], v[108:111], v[56:59], v[28:31]
  v_mfma_f32_16x16x32_bf16 v[32:35], v[96:99], v[60:63], v[32:35]
  v_mfma_f32_16x16x32_bf16 v[36:39], v[100:103], v[60:63], v[36:39]
  v_mfma_f32_16x16x32_bf16 v[40:43], v[104:107], v[60:63], v[40:43]
  v_mfma_f32_16x16x32_bf16 v[44:47], v[108:111], v[60:63], v[44:47]
  buffer_load_dwordx4 v[56:59], v2, s[8:11], s38 offen offset:1024 sc1
  buffer_load_dwordx4 v[60:63], v2, s[8:11], s39 offen offset:1024 sc1
  ds_read_b128 v[96:99], v6 offset:512
  ds_read_b128 v[100:103], v6 offset:20992
  ds_read_b128 v[104:107], v6 offset:41472
  ds_read_b128 v[108:111], v6 offset:61952
  s_waitcnt vmcnt(6) lgkmcnt(4)
  v_mfma_f32_16x16x32_bf16 v[16:19], v[80:83], v[64:67], v[16:19]
  v_mfma_f32_16x16x32_bf16 v[20:23], v[84:87], v[64:67], v[20:23]
  v_mfma_f32_16x16x32_bf16 v[24:27], v[88:91], v[64:67], v[24:27]
  v_mfma_f32_16x16x32_bf16 v[28:31], v[92:95], v[64:67], v[28:31]
  v_mfma_f32_16x16x32_bf16 v[32:35], v[80:83], v[68:71], v[32:35]
  v_mfma_f32_16x16x32_bf16 v[36:39], v[84:87], v[68:71], v[36:39]
  v_mfma_f32_16x16x32_bf16 v[40:43], v[88:91], v[68:71], v[40:43]
  v_mfma_f32_16x16x32_bf16 v[44:47], v[92:95], v[68:71], v[44:47]
  buffer_load_dwordx4 v[64:67], v2, s[8:11], s38 offen offset:2048 sc1
  buffer_load_dwordx4 v[68:71], v2, s[8:11], s39 offen offset:2048 sc1
  ds_read_b128 v[80:83], v3 offset:768
  ds_read_b128 v[84:87], v3 offset:21248
  ds_read_b128 v[88:91], v3 offset:41728
  ds_read_b128 v[92:95], v3 offset:62208
  s_waitcnt vmcnt(6) lgkmcnt(4)
  v_mfma_f32_16x16x32_bf16 v[16:19], v[96:99], v[72:75], v[16:19]
  v_mfma_f32_16x16x32_bf16 v[20:23], v[100:103], v[72:75], v[20:23]
  v_mfma_f32_16x16x32_bf16 v[24:27], v[104:107], v[72:75], v[24:27]
  v_mfma_f32_16x16x32_bf16 v[28:31], v[108:111], v[72:75], v[28:31]
  v_mfma_f32_16x16x32_bf16 v[32:35], v[96:99], v[76:79], v[32:35]
  v_mfma_f32_16x16x32_bf16 v[36:39], v[100:103], v[76:79], v[36:39]
  v_mfma_f32_16x16x32_bf16 v[40:43], v[104:107], v[76:79], v[40:43]
  v_mfma_f32_16x16x32_bf16 v[44:47], v[108:111], v[76:79], v[44:47]
  buffer_load_dwordx4 v[72:75], v2, s[8:11], s38 offen offset:3072 sc1
  buffer_load_dwordx4 v[76:79], v2, s[8:11], s39 offen offset:3072 sc1
  s_add_u32 s38, s38, 4096
  s_add_u32 s39, s39, 4096
  ds_read_b128 v[96:99], v4 offset:768
  ds_read_b128 v[100:103], v4 offset:21248
  ds_read_b128 v[104:107], v4 offset:41728
  ds_read_b128 v[108:111], v4 offset:62208
  s_waitcnt vmcnt(6) lgkmcnt(4)
  v_mfma_f32_16x16x32_bf16 v[16:19], v[80:83], v[48:51], v[16:19]
  v_mfma_f32_16x16x32_bf16 v[20:23], v[84:87], v[48:51], v[20:23]
  v_mfma_f32_16x16x32_bf16 v[24:27], v[88:91], v[48:51], v[24:27]
  v_mfma_f32_16x16x32_bf16 v[28:31], v[92:95], v[48:51], v[28:31]
  v_mfma_f32_16x16x32_bf16 v[32:35], v[80:83], v[52:55], v[32:35]
  v_mfma_f32_16x16x32_bf16 v[36:39], v[84:87], v[52:55], v[36:39]
  v_mfma_f32_16x16x32_bf16 v[40:43], v[88:91], v[52:55], v[40:43]
  v_mfma_f32_16x16x32_bf16 v[44:47], v[92:95], v[52:55], v[44:47]
  buffer_load_dwordx4 v[48:51], v2, s[8:11], s38 offen offset:0 sc1
  buffer_load_dwordx4 v[52:55], v2, s[8:11], s39 offen offset:0 sc1
  ds_read_b128 v[80:83], v5 offset:768
  ds_read_b128 v[84:87], v5 offset:21248
  ds_read_b128 v[88:91], v5 offset:41728
  ds_read_b128 v[92:95], v5 offset:62208
  s_waitcnt vmcnt(6) lgkmcnt(4)
  v_mfma_f32_16x16x32_bf16 v[16:19], v[96:99], v[56:59], v[16:19]
  v_mfma_f32_16x16x32_bf16 v[20:23], v[100:103], v[56:59], v[20:23]
  v_mfma_f32_16x16x32_bf16 v[24:27], v[104:107], v[56:59], v[24:27]
  v_mfma_f32_16x16x32_bf16 v[28:31], v[108:111], v[56:59], v[28:31]
  v_mfma_f32_16x16x32_bf16 v[32:35], v[96:99], v[60:63], v[32:35]
  v_mfma_f32_16x16x32_bf16 v[36:39], v[100:103], v[60:63], v[36:39]
  v_mfma_f32_16x16x32_bf16 v[40:43], v[104:107], v[60:63], v[40:43]
  v_mfma_f32_16x16x32_bf16 v[44:47], v[108:111], v[60:63], v[44:47]
  buffer_load_dwordx4 v[56:59], v2, s[8:11], s38 offen offset:1024 sc1
  buffer_load_dwordx4 v[60:63], v2, s[8:11], s39 offen offset:1024 sc1
  ds_read_b128 v[96:99], v6 offset:768
  ds_read_b128 v[100:103], v6 offset:21248
  ds_read_b128 v[104:107], v6 offset:41728
  ds_read_b128 v[108:111], v6 offset:62208
  s_waitcnt vmcnt(6) lgkmcnt(4)
  v_mfma_f32_16x16x32_bf16 v[16:19], v[80:83], v[64:67], v[16:19]
  v_mfma_f32_16x16x32_bf16 v[20:23], v[84:87], v[64:67], v[20:23]
  v_mfma_f32_16x16x32_bf16 v[24:27], v[88:91], v[64:67], v[24:27]
  v_mfma_f32_16x16x32_bf16 v[28:31], v[92:95], v[64:67], v[28:31]
  v_mfma_f32_16x16x32_bf16 v[32:35], v[80:83], v[68:71], v[32:35]
  v_mfma_f32_16x16x32_bf16 v[36:39], v[84:87], v[68:71], v[36:39]
  v_mfma_f32_16x16x32_bf16 v[40:43], v[88:91], v[68:71], v[40:43]
  v_mfma_f32_16x16x32_bf16 v[44:47], v[92:95], v[68:71], v[44:47]
  buffer_load_dwordx4 v[64:67], v2, s[8:11], s38 offen offset:2048 sc1
  buffer_load_dwordx4 v[68:71], v2, s[8:11], s39 offen offset:2048 sc1
  ds_read_b128 v[80:83], v3 offset:1024
  ds_read_b128 v[84:87], v3 offset:21504
  ds_read_b128 v[88:91], v3 offset:41984
  ds_read_b128 v[92:95], v3 offset:62464
  s_waitcnt vmcnt(6) lgkmcnt(4)
  v_mfma_f32_16x16x32_bf16 v[16:19], v[96:99], v[72:75], v[16:19]
  v_mfma_f32_16x16x32_bf16 v[20:23], v[100:103], v[72:75], v[20:23]
  v_mfma_f32_16x16x32_bf16 v[24:27], v[104:107], v[72:75], v[24:27]
  v_mfma_f32_16x16x32_bf16 v[28:31], v[108:111], v[72:75], v[28:31]
  v_mfma_f32_16x16x32_bf16 v[32:35], v[96:99], v[76:79], v[32:35]
  v_mfma_f32_16x16x32_bf16 v[36:39], v[100:103], v[76:79], v[36:39]
  v_mfma_f32_16x16x32_bf16 v[40:43], v[104:107], v[76:79], v[40:43]
  v_mfma_f32_16x16x32_bf16 v[44:47], v[108:111], v[76:79], v[44:47]
  buffer_load_dwordx4 v[72:75], v2, s[8:11], s38 offen offset:3072 sc1
  buffer_load_dwordx4 v[76:79], v2, s[8:11], s39 offen offset:3072 sc1
  s_add_u32 s38, s38, 4096
  s_add_u32 s39, s39, 4096
  ds_read_b128 v[96:99], v4 offset:1024
  ds_read_b128 v[100:103], v4 offset:21504
  ds_read_b128 v[104:107], v4 offset:41984
  ds_read_b128 v[108:111], v4 offset:62464
  s_waitcnt vmcnt(6) lgkmcnt(4)
  v_mfma_f32_16x16x32_bf16 v[16:19], v[80:83], v[48:51], v[16:19]
  v_mfma_f32_16x16x32_bf16 v[20:23], v[84:87], v[48:51], v[20:23]
  v_mfma_f32_16x16x32_bf16 v[24:27], v[88:91], v[48:51], v[24:27]
  v_mfma_f32_16x16x32_bf16 v[28:31], v[92:95], v[48:51], v[28:31]
  v_mfma_f32_16x16x32_bf16 v[32:35], v[80:83], v[52:55], v[32:35]
  v_mfma_f32_16x16x32_bf16 v[36:39], v[84:87], v[52:55], v[36:39]
  v_mfma_f32_16x16x32_bf16 v[40:43], v[88:91], v[52:55], v[40:43]
  v_mfma_f32_16x16x32_bf16 v[44:47], v[92:95], v[52:55], v[44:47]
  ds_read_b128 v[80:83], v5 offset:1024
  ds_read_b128 v[84:87], v5 offset:21504
  ds_read_b128 v[88:91], v5 offset:41984
  ds_read_b128 v[92:95], v5 offset:62464
  s_waitcnt vmcnt(4) lgkmcnt(4)
  v_mfma_f32_16x16x32_bf16 v[16:19], v[96:99], v[56:59], v[16:19]
  v_mfma_f32_16x16x32_bf16 v[20:23], v[100:103], v[56:59], v[20:23]
  v_mfma_f32_16x16x32_bf16 v[24:27], v[104:107], v[56:59], v[24:27]
  v_mfma_f32_16x16x32_bf16 v[28:31], v[108:111], v[56:59], v[28:31]
  v_mfma_f32_16x16x32_bf16 v[32:35], v[96:99], v[60:63], v[32:35]
  v_mfma_f32_16x16x32_bf16 v[36:39], v[100:103], v[60:63], v[36:39]
  v_mfma_f32_16x16x32_bf16 v[40:43], v[104:107], v[60:63], v[40:43]
  v_mfma_f32_16x16x32_bf16 v[44:47], v[108:111], v[60:63], v[44:47]
  ds_read_b128 v[96:99], v6 offset:1024
  ds_read_b128 v[100:103], v6 offset:21504
  ds_read_b128 v[104:107], v6 offset:41984
  ds_read_b128 v[108:111], v6 offset:62464
  s_waitcnt vmcnt(2) lgkmcnt(4)
  v_mfma_f32_16x16x32_bf16 v[16:19], v[80:83], v[64:67], v[16:19]
  v_mfma_f32_16x16x32_bf16 v[20:23], v[84:87], v[64:67], v[20:23]
  v_mfma_f32_16x16x32_bf16 v[24:27], v[88:91], v[64:67], v[24:27]
  v_mfma_f32_16x16x32_bf16 v[28:31], v[92:95], v[64:67], v[28:31]
  v_mfma_f32_16x16x32_bf16 v[32:35], v[80:83], v[68:71], v[32:35]
  v_mfma_f32_16x16x32_bf16 v[36:39], v[84:87], v[68:71], v[36:39]
  v_mfma_f32_16x16x32_bf16 v[40:43], v[88:91], v[68:71], v[40:43]
  v_mfma_f32_16x16x32_bf16 v[44:47], v[92:95], v[68:71], v[44:47]
  s_waitcnt vmcnt(0) lgkmcnt(0)
  v_mfma_f32_16x16x32_bf16 v[16:19], v[96:99], v[72:75], v[16:19]
  v_mfma_f32_16x16x32_bf16 v[20:23], v[100:103], v[72:75], v[20:23]
  v_mfma_f32_16x16x32_bf16 v[24:27], v[104:107], v[72:75], v[24:27]
  v_mfma_f32_16x16x32_bf16 v[28:31], v[108:111], v[72:75], v[28:31]
  v_mfma_f32_16x16x32_bf16 v[32:35], v[96:99], v[76:79], v[32:35]
  v_mfma_f32_16x16x32_bf16 v[36:39], v[100:103], v[76:79], v[36:39]
  v_mfma_f32_16x16x32_bf16 v[40:43], v[104:107], v[76:79], v[40:43]
  v_mfma_f32_16x16x32_bf16 v[44:47], v[108:111], v[76:79], v[44:47]
  s_nop 7
  v_cvt_pk_bf16_f32 v128, v16, v17
  v_cvt_pk_bf16_f32 v129, v18, v19
  v_cvt_pk_bf16_f32 v130, v20, v21
  v_cvt_pk_bf16_f32 v131, v22, v23
  v_cvt_pk_bf16_f32 v132, v24, v25
  v_cvt_pk_bf16_f32 v133, v26, v27
  v_cvt_pk_bf16_f32 v134, v28, v29
  v_cvt_pk_bf16_f32 v135, v30, v31
  v_cvt_pk_bf16_f32 v136, v32, v33
  v_cvt_pk_bf16_f32 v137, v34, v35
  v_cvt_pk_bf16_f32 v138, v36, v37
  v_cvt_pk_bf16_f32 v139, v38, v39
  v_cvt_pk_bf16_f32 v140, v40, v41
  v_cvt_pk_bf16_f32 v141, v42, v43
  v_cvt_pk_bf16_f32 v142, v44, v45
  v_cvt_pk_bf16_f32 v143, v46, v47
  s_nop 1
  s_mul_i32 s38, s3, 102400
  s_add_u32 s38, s38, 85606400
  s_mul_i32 s39, s3, 102400
  s_add_u32 s39, s39, 84705280
  buffer_load_dwordx4 v[48:51], v2, s[8:11], s38 offen offset:0 sc1
  buffer_load_dwordx4 v[52:55], v2, s[8:11], s39 offen offset:0 sc1
  buffer_load_dwordx4 v[56:59], v2, s[8:11], s38 offen offset:1024 sc1
  buffer_load_dwordx4 v[60:63], v2, s[8:11], s39 offen offset:1024 sc1
  buffer_load_dwordx4 v[64:67], v2, s[8:11], s38 offen offset:2048 sc1
  buffer_load_dwordx4 v[68:71], v2, s[8:11], s39 offen offset:2048 sc1
  ds_read_b128 v[80:83], v3 offset:0
  ds_read_b128 v[84:87], v3 offset:20480
  ds_read_b128 v[88:91], v3 offset:40960
  ds_read_b128 v[92:95], v3 offset:61440
  buffer_load_dwordx4 v[72:75], v2, s[8:11], s38 offen offset:3072 sc1
  buffer_load_dwordx4 v[76:79], v2, s[8:11], s39 offen offset:3072 sc1
  s_add_u32 s38, s38, 4096
  s_add_u32 s39, s39, 4096
  ds_read_b128 v[96:99], v4 offset:0
  ds_read_b128 v[100:103], v4 offset:20480
  ds_read_b128 v[104:107], v4 offset:40960
  ds_read_b128 v[108:111], v4 offset:61440
  s_waitcnt vmcnt(6) lgkmcnt(4)
  v_mfma_f32_16x16x32_bf16 v[16:19], v[80:83], v[48:51], 0
  v_mfma_f32_16x16x32_bf16 v[20:23], v[84:87], v[48:51], 0
  v_mfma_f32_16x16x32_bf16 v[24:27], v[88:91], v[48:51], 0
  v_mfma_f32_16x16x32_bf16 v[28:31], v[92:95], v[48:51], 0
  v_mfma_f32_16x16x32_bf16 v[32:35], v[80:83], v[52:55], 0
  v_mfma_f32_16x16x32_bf16 v[36:39], v[84:87], v[52:55], 0
  v_mfma_f32_16x16x32_bf16 v[40:43], v[88:91], v[52:55], 0
  v_mfma_f32_16x16x32_bf16 v[44:47], v[92:95], v[52:55], 0
  buffer_load_dwordx4 v[48:51], v2, s[8:11], s38 offen offset:0 sc1
  buffer_load_dwordx4 v[52:55], v2, s[8:11], s39 offen offset:0 sc1
  ds_read_b128 v[80:83], v5 offset:0
  ds_read_b128 v[84:87], v5 offset:20480
  ds_read_b128 v[88:91], v5 offset:40960
  ds_read_b128 v[92:95], v5 offset:61440
  s_waitcnt vmcnt(6) lgkmcnt(4)
  v_mfma_f32_16x16x32_bf16 v[16:19], v[96:99], v[56:59], v[16:19]
  v_mfma_f32_16x16x32_bf16 v[20:23], v[100:103], v[56:59], v[20:23]
  v_mfma_f32_16x16x32_bf16 v[24:27], v[104:107], v[56:59], v[24:27]
  v_mfma_f32_16x16x32_bf16 v[28:31], v[108:111], v[56:59], v[28:31]
  v_mfma_f32_16x16x32_bf16 v[32:35], v[96:99], v[60:63], v[32:35]
  v_mfma_f32_16x16x32_bf16 v[36:39], v[100:103], v[60:63], v[36:39]
  v_mfma_f32_16x16x32_bf16 v[40:43], v[104:107], v[60:63], v[40:43]
  v_mfma_f32_16x16x32_bf16 v[44:47], v[108:111], v[60:63], v[44:47]
  buffer_load_dwordx4 v[56:59], v2, s[8:11], s38 offen offset:1024 sc1
  buffer_load_dwordx4 v[60:63], v2, s[8:11], s39 offen offset:1024 sc1
  ds_read_b128 v[96:99], v6 offset:0
  ds_read_b128 v[100:103], v6 offset:20480
  ds_read_b128 v[104:107], v6 offset:40960
  ds_read_b128 v[108:111], v6 offset:61440
  s_waitcnt vmcnt(6) lgkmcnt(4)
  v_mfma_f32_16x16x32_bf16 v[16:19], v[80:83], v[64:67], v[16:19]
  v_mfma_f32_16x16x32_bf16 v[20:23], v[84:87], v[64:67], v[20:23]
  v_mfma_f32_16x16x32_bf16 v[24:27], v[88:91], v[64:67], v[24:27]
  v_mfma_f32_16x16x32_bf16 v[28:31], v[92:95], v[64:67], v[28:31]
  v_mfma_f32_16x16x32_bf16 v[32:35], v[80:83], v[68:71], v[32:35]
  v_mfma_f32_16x16x32_bf16 v[36:39], v[84:87], v[68:71], v[36:39]
  v_mfma_f32_16x16x32_bf16 v[40:43], v[88:91], v[68:71], v[40:43]
  v_mfma_f32_16x16x32_bf16 v[44:47], v[92:95], v[68:71], v[44:47]
  buffer_load_dwordx4 v[64:67], v2, s[8:11], s38 offen offset:2048 sc1
  buffer_load_dwordx4 v[68:71], v2, s[8:11], s39 offen offset:2048 sc1
  ds_read_b128 v[80:83], v3 offset:256
  ds_read_b128 v[84:87], v3 offset:20736
  ds_read_b128 v[88:91], v3 offset:41216
  ds_read_b128 v[92:95], v3 offset:61696
  s_waitcnt vmcnt(6) lgkmcnt(4)
  v_mfma_f32_16x16x32_bf16 v[16:19], v[96:99], v[72:75], v[16:19]
  v_mfma_f32_16x16x32_bf16 v[20:23], v[100:103], v[72:75], v[20:23]
  v_mfma_f32_16x16x32_bf16 v[24:27], v[104:107], v[72:75], v[24:27]
  v_mfma_f32_16x16x32_bf16 v[28:31], v[108:111], v[72:75], v[28:31]
  v_mfma_f32_16x16x32_bf16 v[32:35], v[96:99], v[76:79], v[32:35]
  v_mfma_f32_16x16x32_bf16 v[36:39], v[100:103], v[76:79], v[36:39]
  v_mfma_f32_16x16x32_bf16 v[40:43], v[104:107], v[76:79], v[40:43]
  v_mfma_f32_16x16x32_bf16 v[44:47], v[108:111], v[76:79], v[44:47]
  buffer_load_dwordx4 v[72:75], v2, s[8:11], s38 offen offset:3072 sc1
  buffer_load_dwordx4 v[76:79], v2, s[8:11], s39 offen offset:3072 sc1
  s_add_u32 s38, s38, 4096
  s_add_u32 s39, s39, 4096
  ds_read_b128 v[96:99], v4 offset:256
  ds_read_b128 v[100:103], v4 offset:20736
  ds_read_b128 v[104:107], v4 offset:41216
  ds_read_b128 v[108:111], v4 offset:61696
  s_waitcnt vmcnt(6) lgkmcnt(4)
  v_mfma_f32_16x16x32_bf16 v[16:19], v[80:83], v[48:51], v[16:19]
  v_mfma_f32_16x16x32_bf16 v[20:23], v[84:87], v[48:51], v[20:23]
  v_mfma_f32_16x16x32_bf16 v[24:27], v[88:91], v[48:51], v[24:27]
  v_mfma_f32_16x16x32_bf16 v[28:31], v[92:95], v[48:51], v[28:31]
  v_mfma_f32_16x16x32_bf16 v[32:35], v[80:83], v[52:55], v[32:35]
  v_mfma_f32_16x16x32_bf16 v[36:39], v[84:87], v[52:55], v[36:39]
  v_mfma_f32_16x16x32_bf16 v[40:43], v[88:91], v[52:55], v[40:43]
  v_mfma_f32_16x16x32_bf16 v[44:47], v[92:95], v[52:55], v[44:47]
  buffer_load_dwordx4 v[48:51], v2, s[8:11], s38 offen offset:0 sc1
  buffer_load_dwordx4 v[52:55], v2, s[8:11], s39 offen offset:0 sc1
  ds_read_b128 v[80:83], v5 offset:256
  ds_read_b128 v[84:87], v5 offset:20736
  ds_read_b128 v[88:91], v5 offset:41216
  ds_read_b128 v[92:95], v5 offset:61696
  s_waitcnt vmcnt(6) lgkmcnt(4)
  v_mfma_f32_16x16x32_bf16 v[16:19], v[96:99], v[56:59], v[16:19]
  v_mfma_f32_16x16x32_bf16 v[20:23], v[100:103], v[56:59], v[20:23]
  v_mfma_f32_16x16x32_bf16 v[24:27], v[104:107], v[56:59], v[24:27]
  v_mfma_f32_16x16x32_bf16 v[28:31], v[108:111], v[56:59], v[28:31]
  v_mfma_f32_16x16x32_bf16 v[32:35], v[96:99], v[60:63], v[32:35]
  v_mfma_f32_16x16x32_bf16 v[36:39], v[100:103], v[60:63], v[36:39]
  v_mfma_f32_16x16x32_bf16 v[40:43], v[104:107], v[60:63], v[40:43]
  v_mfma_f32_16x16x32_bf16 v[44:47], v[108:111], v[60:63], v[44:47]
  buffer_load_dwordx4 v[56:59], v2, s[8:11], s38 offen offset:1024 sc1
  buffer_load_dwordx4 v[60:63], v2, s[8:11], s39 offen offset:1024 sc1
  ds_read_b128 v[96:99], v6 offset:256
  ds_read_b128 v[100:103], v6 offset:20736
  ds_read_b128 v[104:107], v6 offset:41216
  ds_read_b128 v[108:111], v6 offset:61696
  s_waitcnt vmcnt(6) lgkmcnt(4)
  v_mfma_f32_16x16x32_bf16 v[16:19], v[80:83], v[64:67], v[16:19]
  v_mfma_f32_16x16x32_bf16 v[20:23], v[84:87], v[64:67], v[20:23]
  v_mfma_f32_16x16x32_bf16 v[24:27], v[88:91], v[64:67], v[24:27]
  v_mfma_f32_16x16x32_bf16 v[28:31], v[92:95], v[64:67], v[28:31]
  v_mfma_f32_16x16x32_bf16 v[32:35], v[80:83], v[68:71], v[32:35]
  v_mfma_f32_16x16x32_bf16 v[36:39], v[84:87], v[68:71], v[36:39]
  v_mfma_f32_16x16x32_bf16 v[40:43], v[88:91], v[68:71], v[40:43]
  v_mfma_f32_16x16x32_bf16 v[44:47], v[92:95], v[68:71], v[44:47]
  buffer_load_dwordx4 v[64:67], v2, s[8:11], s38 offen offset:2048 sc1
  buffer_load_dwordx4 v[68:71], v2, s[8:11], s39 offen offset:2048 sc1
  ds_read_b128 v[80:83], v3 offset:512
  ds_read_b128 v[84:87], v3 offset:20992
  ds_read_b128 v[88:91], v3 offset:41472
  ds_read_b128 v[92:95], v3 offset:61952
  s_waitcnt vmcnt(6) lgkmcnt(4)
  v_mfma_f32_16x16x32_bf16 v[16:19], v[96:99], v[72:75], v[16:19]
  v_mfma_f32_16x16x32_bf16 v[20:23], v[100:103], v[72:75], v[20:23]
  v_mfma_f32_16x16x32_bf16 v[24:27], v[104:107], v[72:75], v[24:27]
  v_mfma_f32_16x16x32_bf16 v[28:31], v[108:111], v[72:75], v[28:31]
  v_mfma_f32_16x16x32_bf16 v[32:35], v[96:99], v[76:79], v[32:35]
  v_mfma_f32_16x16x32_bf16 v[36:39], v[100:103], v[76:79], v[36:39]
  v_mfma_f32_16x16x32_bf16 v[40:43], v[104:107], v[76:79], v[40:43]
  v_mfma_f32_16x16x32_bf16 v[44:47], v[108:111], v[76:79], v[44:47]
  buffer_load_dwordx4 v[72:75], v2, s[8:11], s38 offen offset:3072 sc1
  buffer_load_dwordx4 v[76:79], v2, s[8:11], s39 offen offset:3072 sc1
  s_add_u32 s38, s38, 4096
  s_add_u32 s39, s39, 4096
  ds_read_b128 v[96:99], v4 offset:512
  ds_read_b128 v[100:103], v4 offset:20992
  ds_read_b128 v[104:107], v4 offset:41472
  ds_read_b128 v[108:111], v4 offset:61952
  s_waitcnt vmcnt(6) lgkmcnt(4)
  v_mfma_f32_16x16x32_bf16 v[16:19], v[80:83], v[48:51], v[16:19]
  v_mfma_f32_16x16x32_bf16 v[20:23], v[84:87], v[48:51], v[20:23]
  v_mfma_f32_16x16x32_bf16 v[24:27], v[88:91], v[48:51], v[24:27]
  v_mfma_f32_16x16x32_bf16 v[28:31], v[92:95], v[48:51], v[28:31]
  v_mfma_f32_16x16x32_bf16 v[32:35], v[80:83], v[52:55], v[32:35]
  v_mfma_f32_16x16x32_bf16 v[36:39], v[84:87], v[52:55], v[36:39]
  v_mfma_f32_16x16x32_bf16 v[40:43], v[88:91], v[52:55], v[40:43]
  v_mfma_f32_16x16x32_bf16 v[44:47], v[92:95], v[52:55], v[44:47]
  buffer_load_dwordx4 v[48:51], v2, s[8:11], s38 offen offset:0 sc1
  buffer_load_dwordx4 v[52:55], v2, s[8:11], s39 offen offset:0 sc1
  ds_read_b128 v[80:83], v5 offset:512
  ds_read_b128 v[84:87], v5 offset:20992
  ds_read_b128 v[88:91], v5 offset:41472
  ds_read_b128 v[92:95], v5 offset:61952
  s_waitcnt vmcnt(6) lgkmcnt(4)
  v_mfma_f32_16x16x32_bf16 v[16:19], v[96:99], v[56:59], v[16:19]
  v_mfma_f32_16x16x32_bf16 v[20:23], v[100:103], v[56:59], v[20:23]
  v_mfma_f32_16x16x32_bf16 v[24:27], v[104:107], v[56:59], v[24:27]
  v_mfma_f32_16x16x32_bf16 v[28:31], v[108:111], v[56:59], v[28:31]
  v_mfma_f32_16x16x32_bf16 v[32:35], v[96:99], v[60:63], v[32:35]
  v_mfma_f32_16x16x32_bf16 v[36:39], v[100:103], v[60:63], v[36:39]
  v_mfma_f32_16x16x32_bf16 v[40:43], v[104:107], v[60:63], v[40:43]
  v_mfma_f32_16x16x32_bf16 v[44:47], v[108:111], v[60:63], v[44:47]
  buffer_load_dwordx4 v[56:59], v2, s[8:11], s38 offen offset:1024 sc1
  buffer_load_dwordx4 v[60:63], v2, s[8:11], s39 offen offset:1024 sc1
  ds_read_b128 v[96:99], v6 offset:512
  ds_read_b128 v[100:103], v6 offset:20992
  ds_read_b128 v[104:107], v6 offset:41472
  ds_read_b128 v[108:111], v6 offset:61952
  s_waitcnt vmcnt(6) lgkmcnt(4)
  v_mfma_f32_16x16x32_bf16 v[16:19], v[80:83], v[64:67], v[16:19]
  v_mfma_f32_16x16x32_bf16 v[20:23], v[84:87], v[64:67], v[20:23]
  v_mfma_f32_16x16x32_bf16 v[24:27], v[88:91], v[64:67], v[24:27]
  v_mfma_f32_16x16x32_bf16 v[28:31], v[92:95], v[64:67], v[28:31]
  v_mfma_f32_16x16x32_bf16 v[32:35], v[80:83], v[68:71], v[32:35]
  v_mfma_f32_16x16x32_bf16 v[36:39], v[84:87], v[68:71], v[36:39]
  v_mfma_f32_16x16x32_bf16 v[40:43], v[88:91], v[68:71], v[40:43]
  v_mfma_f32_16x16x32_bf16 v[44:47], v[92:95], v[68:71], v[44:47]
  buffer_load_dwordx4 v[64:67], v2, s[8:11], s38 offen offset:2048 sc1
  buffer_load_dwordx4 v[68:71], v2, s[8:11], s39 offen offset:2048 sc1
  ds_read_b128 v[80:83], v3 offset:768
  ds_read_b128 v[84:87], v3 offset:21248
  ds_read_b128 v[88:91], v3 offset:41728
  ds_read_b128 v[92:95], v3 offset:62208
  s_waitcnt vmcnt(6) lgkmcnt(4)
  v_mfma_f32_16x16x32_bf16 v[16:19], v[96:99], v[72:75], v[16:19]
  v_mfma_f32_16x16x32_bf16 v[20:23], v[100:103], v[72:75], v[20:23]
  v_mfma_f32_16x16x32_bf16 v[24:27], v[104:107], v[72:75], v[24:27]
  v_mfma_f32_16x16x32_bf16 v[28:31], v[108:111], v[72:75], v[28:31]
  v_mfma_f32_16x16x32_bf16 v[32:35], v[96:99], v[76:79], v[32:35]
  v_mfma_f32_16x16x32_bf16 v[36:39], v[100:103], v[76:79], v[36:39]
  v_mfma_f32_16x16x32_bf16 v[40:43], v[104:107], v[76:79], v[40:43]
  v_mfma_f32_16x16x32_bf16 v[44:47], v[108:111], v[76:79], v[44:47]
  buffer_load_dwordx4 v[72:75], v2, s[8:11], s38 offen offset:3072 sc1
  buffer_load_dwordx4 v[76:79], v2, s[8:11], s39 offen offset:3072 sc1
  s_add_u32 s38, s38, 4096
  s_add_u32 s39, s39, 4096
  ds_read_b128 v[96:99], v4 offset:768
  ds_read_b128 v[100:103], v4 offset:21248
  ds_read_b128 v[104:107], v4 offset:41728
  ds_read_b128 v[108:111], v4 offset:62208
  s_waitcnt vmcnt(6) lgkmcnt(4)
  v_mfma_f32_16x16x32_bf16 v[16:19], v[80:83], v[48:51], v[16:19]
  v_mfma_f32_16x16x32_bf16 v[20:23], v[84:87], v[48:51], v[20:23]
  v_mfma_f32_16x16x32_bf16 v[24:27], v[88:91], v[48:51], v[24:27]
  v_mfma_f32_16x16x32_bf16 v[28:31], v[92:95], v[48:51], v[28:31]
  v_mfma_f32_16x16x32_bf16 v[32:35], v[80:83], v[52:55], v[32:35]
  v_mfma_f32_16x16x32_bf16 v[36:39], v[84:87], v[52:55], v[36:39]
  v_mfma_f32_16x16x32_bf16 v[40:43], v[88:91], v[52:55], v[40:43]
  v_mfma_f32_16x16x32_bf16 v[44:47], v[92:95], v[52:55], v[44:47]
  buffer_load_dwordx4 v[48:51], v2, s[8:11], s38 offen offset:0 sc1
  buffer_load_dwordx4 v[52:55], v2, s[8:11], s39 offen offset:0 sc1
  ds_read_b128 v[80:83], v5 offset:768
  ds_read_b128 v[84:87], v5 offset:21248
  ds_read_b128 v[88:91], v5 offset:41728
  ds_read_b128 v[92:95], v5 offset:62208
  s_waitcnt vmcnt(6) lgkmcnt(4)
  v_mfma_f32_16x16x32_bf16 v[16:19], v[96:99], v[56:59], v[16:19]
  v_mfma_f32_16x16x32_bf16 v[20:23], v[100:103], v[56:59], v[20:23]
  v_mfma_f32_16x16x32_bf16 v[24:27], v[104:107], v[56:59], v[24:27]
  v_mfma_f32_16x16x32_bf16 v[28:31], v[108:111], v[56:59], v[28:31]
  v_mfma_f32_16x16x32_bf16 v[32:35], v[96:99], v[60:63], v[32:35]
  v_mfma_f32_16x16x32_bf16 v[36:39], v[100:103], v[60:63], v[36:39]
  v_mfma_f32_16x16x32_bf16 v[40:43], v[104:107], v[60:63], v[40:43]
  v_mfma_f32_16x16x32_bf16 v[44:47], v[108:111], v[60:63], v[44:47]
  buffer_load_dwordx4 v[56:59], v2, s[8:11], s38 offen offset:1024 sc1
  buffer_load_dwordx4 v[60:63], v2, s[8:11], s39 offen offset:1024 sc1
  ds_read_b128 v[96:99], v6 offset:768
  ds_read_b128 v[100:103], v6 offset:21248
  ds_read_b128 v[104:107], v6 offset:41728
  ds_read_b128 v[108:111], v6 offset:62208
  s_waitcnt vmcnt(6) lgkmcnt(4)
  v_mfma_f32_16x16x32_bf16 v[16:19], v[80:83], v[64:67], v[16:19]
  v_mfma_f32_16x16x32_bf16 v[20:23], v[84:87], v[64:67], v[20:23]
  v_mfma_f32_16x16x32_bf16 v[24:27], v[88:91], v[64:67], v[24:27]
  v_mfma_f32_16x16x32_bf16 v[28:31], v[92:95], v[64:67], v[28:31]
  v_mfma_f32_16x16x32_bf16 v[32:35], v[80:83], v[68:71], v[32:35]
  v_mfma_f32_16x16x32_bf16 v[36:39], v[84:87], v[68:71], v[36:39]
  v_mfma_f32_16x16x32_bf16 v[40:43], v[88:91], v[68:71], v[40:43]
  v_mfma_f32_16x16x32_bf16 v[44:47], v[92:95], v[68:71], v[44:47]
  buffer_load_dwordx4 v[64:67], v2, s[8:11], s38 offen offset:2048 sc1
  buffer_load_dwordx4 v[68:71], v2, s[8:11], s39 offen offset:2048 sc1
  ds_read_b128 v[80:83], v3 offset:1024
  ds_read_b128 v[84:87], v3 offset:21504
  ds_read_b128 v[88:91], v3 offset:41984
  ds_read_b128 v[92:95], v3 offset:62464
  s_waitcnt vmcnt(6) lgkmcnt(4)
  v_mfma_f32_16x16x32_bf16 v[16:19], v[96:99], v[72:75], v[16:19]
  v_mfma_f32_16x16x32_bf16 v[20:23], v[100:103], v[72:75], v[20:23]
  v_mfma_f32_16x16x32_bf16 v[24:27], v[104:107], v[72:75], v[24:27]
  v_mfma_f32_16x16x32_bf16 v[28:31], v[108:111], v[72:75], v[28:31]
  v_mfma_f32_16x16x32_bf16 v[32:35], v[96:99], v[76:79], v[32:35]
  v_mfma_f32_16x16x32_bf16 v[36:39], v[100:103], v[76:79], v[36:39]
  v_mfma_f32_16x16x32_bf16 v[40:43], v[104:107], v[76:79], v[40:43]
  v_mfma_f32_16x16x32_bf16 v[44:47], v[108:111], v[76:79], v[44:47]
  buffer_load_dwordx4 v[72:75], v2, s[8:11], s38 offen offset:3072 sc1
  buffer_load_dwordx4 v[76:79], v2, s[8:11], s39 offen offset:3072 sc1
  s_add_u32 s38, s38, 4096
  s_add_u32 s39, s39, 4096
  ds_read_b128 v[96:99], v4 offset:1024
  ds_read_b128 v[100:103], v4 offset:21504
  ds_read_b128 v[104:107], v4 offset:41984
  ds_read_b128 v[108:111], v4 offset:62464
  s_waitcnt vmcnt(6) lgkmcnt(4)
  v_mfma_f32_16x16x32_bf16 v[16:19], v[80:83], v[48:51], v[16:19]
  v_mfma_f32_16x16x32_bf16 v[20:23], v[84:87], v[48:51], v[20:23]
  v_mfma_f32_16x16x32_bf16 v[24:27], v[88:91], v[48:51], v[24:27]
  v_mfma_f32_16x16x32_bf16 v[28:31], v[92:95], v[48:51], v[28:31]
  v_mfma_f32_16x16x32_bf16 v[32:35], v[80:83], v[52:55], v[32:35]
  v_mfma_f32_16x16x32_bf16 v[36:39], v[84:87], v[52:55], v[36:39]
  v_mfma_f32_16x16x32_bf16 v[40:43], v[88:91], v[52:55], v[40:43]
  v_mfma_f32_16x16x32_bf16 v[44:47], v[92:95], v[52:55], v[44:47]
  ds_read_b128 v[80:83], v5 offset:1024
  ds_read_b128 v[84:87], v5 offset:21504
  ds_read_b128 v[88:91], v5 offset:41984
  ds_read_b128 v[92:95], v5 offset:62464
  s_waitcnt vmcnt(4) lgkmcnt(4)
  v_mfma_f32_16x16x32_bf16 v[16:19], v[96:99], v[56:59], v[16:19]
  v_mfma_f32_16x16x32_bf16 v[20:23], v[100:103], v[56:59], v[20:23]
  v_mfma_f32_16x16x32_bf16 v[24:27], v[104:107], v[56:59], v[24:27]
  v_mfma_f32_16x16x32_bf16 v[28:31], v[108:111], v[56:59], v[28:31]
  v_mfma_f32_16x16x32_bf16 v[32:35], v[96:99], v[60:63], v[32:35]
  v_mfma_f32_16x16x32_bf16 v[36:39], v[100:103], v[60:63], v[36:39]
  v_mfma_f32_16x16x32_bf16 v[40:43], v[104:107], v[60:63], v[40:43]
  v_mfma_f32_16x16x32_bf16 v[44:47], v[108:111], v[60:63], v[44:47]
  ds_read_b128 v[96:99], v6 offset:1024
  ds_read_b128 v[100:103], v6 offset:21504
  ds_read_b128 v[104:107], v6 offset:41984
  ds_read_b128 v[108:111], v6 offset:62464
  s_waitcnt vmcnt(2) lgkmcnt(4)
  v_mfma_f32_16x16x32_bf16 v[16:19], v[80:83], v[64:67], v[16:19]
  v_mfma_f32_16x16x32_bf16 v[20:23], v[84:87], v[64:67], v[20:23]
  v_mfma_f32_16x16x32_bf16 v[24:27], v[88:91], v[64:67], v[24:27]
  v_mfma_f32_16x16x32_bf16 v[28:31], v[92:95], v[64:67], v[28:31]
  v_mfma_f32_16x16x32_bf16 v[32:35], v[80:83], v[68:71], v[32:35]
  v_mfma_f32_16x16x32_bf16 v[36:39], v[84:87], v[68:71], v[36:39]
  v_mfma_f32_16x16x32_bf16 v[40:43], v[88:91], v[68:71], v[40:43]
  v_mfma_f32_16x16x32_bf16 v[44:47], v[92:95], v[68:71], v[44:47]
  s_waitcnt vmcnt(0) lgkmcnt(0)
  v_mfma_f32_16x16x32_bf16 v[16:19], v[96:99], v[72:75], v[16:19]
  v_mfma_f32_16x16x32_bf16 v[20:23], v[100:103], v[72:75], v[20:23]
  v_mfma_f32_16x16x32_bf16 v[24:27], v[104:107], v[72:75], v[24:27]
  v_mfma_f32_16x16x32_bf16 v[28:31], v[108:111], v[72:75], v[28:31]
  v_mfma_f32_16x16x32_bf16 v[32:35], v[96:99], v[76:79], v[32:35]
  v_mfma_f32_16x16x32_bf16 v[36:39], v[100:103], v[76:79], v[36:39]
  v_mfma_f32_16x16x32_bf16 v[40:43], v[104:107], v[76:79], v[40:43]
  v_mfma_f32_16x16x32_bf16 v[44:47], v[108:111], v[76:79], v[44:47]
  s_nop 7
  v_cvt_pk_bf16_f32 v144, v16, v17
  v_cvt_pk_bf16_f32 v145, v18, v19
  v_cvt_pk_bf16_f32 v146, v20, v21
  v_cvt_pk_bf16_f32 v147, v22, v23
  v_cvt_pk_bf16_f32 v148, v24, v25
  v_cvt_pk_bf16_f32 v149, v26, v27
  v_cvt_pk_bf16_f32 v150, v28, v29
  v_cvt_pk_bf16_f32 v151, v30, v31
  s_nop 1
  v_cvt_pk_bf16_f32 v244, v32, v33
  v_lshlrev_b32 v245, 16, v244
  v_and_b32 v246, 0xffff0000, v244
  v_mul_f32 v247, s34, v245
  v_mul_f32 v248, s34, v246
  v_exp_f32 v247, v247
  v_exp_f32 v248, v248
  v_cmp_lt_f32 vcc, 0, v245
  v_add_f32 v245, 1.0, v245
  v_cmp_lt_f32 s[36:37], 0, v246
  v_cndmask_b32 v245, v247, v245, vcc
  v_add_f32 v246, 1.0, v246
  s_nop 0
  v_cndmask_b32 v246, v248, v246, s[36:37]
  v_cvt_pk_bf16_f32 v244, v245, v246
  v_lshlrev_b32 v245, 16, v244
  v_and_b32 v246, 0xffff0000, v244
  v_add_f32 v245, s35, v245
  v_add_f32 v246, s35, v246
  v_cvt_pk_bf16_f32 v160, v245, v246
  v_cvt_pk_bf16_f32 v250, v34, v35
  v_lshlrev_b32 v251, 16, v250
  v_and_b32 v252, 0xffff0000, v250
  v_mul_f32 v253, s34, v251
  v_mul_f32 v254, s34, v252
  v_exp_f32 v253, v253
  v_exp_f32 v254, v254
  v_cmp_lt_f32 vcc, 0, v251
  v_add_f32 v251, 1.0, v251
  v_cmp_lt_f32 s[36:37], 0, v252
  v_cndmask_b32 v251, v253, v251, vcc
  v_add_f32 v252, 1.0, v252
  s_nop 0
  v_cndmask_b32 v252, v254, v252, s[36:37]
  v_cvt_pk_bf16_f32 v250, v251, v252
  v_lshlrev_b32 v251, 16, v250
  v_and_b32 v252, 0xffff0000, v250
  v_add_f32 v251, s35, v251
  v_add_f32 v252, s35, v252
  v_cvt_pk_bf16_f32 v161, v251, v252
  v_cvt_pk_bf16_f32 v244, v36, v37
  v_lshlrev_b32 v245, 16, v244
  v_and_b32 v246, 0xffff0000, v244
  v_mul_f32 v247, s34, v245
  v_mul_f32 v248, s34, v246
  v_exp_f32 v247, v247
  v_exp_f32 v248, v248
  v_cmp_lt_f32 vcc, 0, v245
  v_add_f32 v245, 1.0, v245
  v_cmp_lt_f32 s[36:37], 0, v246
  v_cndmask_b32 v245, v247, v245, vcc
  v_add_f32 v246, 1.0, v246
  s_nop 0
  v_cndmask_b32 v246, v248, v246, s[36:37]
  v_cvt_pk_bf16_f32 v244, v245, v246
  v_lshlrev_b32 v245, 16, v244
  v_and_b32 v246, 0xffff0000, v244
  v_add_f32 v245, s35, v245
  v_add_f32 v246, s35, v246
  v_cvt_pk_bf16_f32 v162, v245, v246
  v_cvt_pk_bf16_f32 v250, v38, v39
  v_lshlrev_b32 v251, 16, v250
  v_and_b32 v252, 0xffff0000, v250
  v_mul_f32 v253, s34, v251
  v_mul_f32 v254, s34, v252
  v_exp_f32 v253, v253
  v_exp_f32 v254, v254
  v_cmp_lt_f32 vcc, 0, v251
  v_add_f32 v251, 1.0, v251
  v_cmp_lt_f32 s[36:37], 0, v252
  v_cndmask_b32 v251, v253, v251, vcc
  v_add_f32 v252, 1.0, v252
  s_nop 0
  v_cndmask_b32 v252, v254, v252, s[36:37]
  v_cvt_pk_bf16_f32 v250, v251, v252
  v_lshlrev_b32 v251, 16, v250
  v_and_b32 v252, 0xffff0000, v250
  v_add_f32 v251, s35, v251
  v_add_f32 v252, s35, v252
  v_cvt_pk_bf16_f32 v163, v251, v252
  v_cvt_pk_bf16_f32 v244, v40, v41
  v_lshlrev_b32 v245, 16, v244
  v_and_b32 v246, 0xffff0000, v244
  v_mul_f32 v247, s34, v245
  v_mul_f32 v248, s34, v246
  v_exp_f32 v247, v247
  v_exp_f32 v248, v248
  v_cmp_lt_f32 vcc, 0, v245
  v_add_f32 v245, 1.0, v245
  v_cmp_lt_f32 s[36:37], 0, v246
  v_cndmask_b32 v245, v247, v245, vcc
  v_add_f32 v246, 1.0, v246
  s_nop 0
  v_cndmask_b32 v246, v248, v246, s[36:37]
  v_cvt_pk_bf16_f32 v244, v245, v246
  v_lshlrev_b32 v245, 16, v244
  v_and_b32 v246, 0xffff0000, v244
  v_add_f32 v245, s35, v245
  v_add_f32 v246, s35, v246
  v_cvt_pk_bf16_f32 v164, v245, v246
  v_cvt_pk_bf16_f32 v250, v42, v43
  v_lshlrev_b32 v251, 16, v250
  v_and_b32 v252, 0xffff0000, v250
  v_mul_f32 v253, s34, v251
  v_mul_f32 v254, s34, v252
  v_exp_f32 v253, v253
  v_exp_f32 v254, v254
  v_cmp_lt_f32 vcc, 0, v251
  v_add_f32 v251, 1.0, v251
  v_cmp_lt_f32 s[36:37], 0, v252
  v_cndmask_b32 v251, v253, v251, vcc
  v_add_f32 v252, 1.0, v252
  s_nop 0
  v_cndmask_b32 v252, v254, v252, s[36:37]
  v_cvt_pk_bf16_f32 v250, v251, v252
  v_lshlrev_b32 v251, 16, v250
  v_and_b32 v252, 0xffff0000, v250
  v_add_f32 v251, s35, v251
  v_add_f32 v252, s35, v252
  v_cvt_pk_bf16_f32 v165, v251, v252
  v_cvt_pk_bf16_f32 v244, v44, v45
  v_lshlrev_b32 v245, 16, v244
  v_and_b32 v246, 0xffff0000, v244
  v_mul_f32 v247, s34, v245
  v_mul_f32 v248, s34, v246
  v_exp_f32 v247, v247
  v_exp_f32 v248, v248
  v_cmp_lt_f32 vcc, 0, v245
  v_add_f32 v245, 1.0, v245
  v_cmp_lt_f32 s[36:37], 0, v246
  v_cndmask_b32 v245, v247, v245, vcc
  v_add_f32 v246, 1.0, v246
  s_nop 0
  v_cndmask_b32 v246, v248, v246, s[36:37]
  v_cvt_pk_bf16_f32 v244, v245, v246
  v_lshlrev_b32 v245, 16, v244
  v_and_b32 v246, 0xffff0000, v244
  v_add_f32 v245, s35, v245
  v_add_f32 v246, s35, v246
  v_cvt_pk_bf16_f32 v166, v245, v246
  v_cvt_pk_bf16_f32 v250, v46, v47
  v_lshlrev_b32 v251, 16, v250
  v_and_b32 v252, 0xffff0000, v250
  v_mul_f32 v253, s34, v251
  v_mul_f32 v254, s34, v252
  v_exp_f32 v253, v253
  v_exp_f32 v254, v254
  v_cmp_lt_f32 vcc, 0, v251
  v_add_f32 v251, 1.0, v251
  v_cmp_lt_f32 s[36:37], 0, v252
  v_cndmask_b32 v251, v253, v251, vcc
  v_add_f32 v252, 1.0, v252
  s_nop 0
  v_cndmask_b32 v252, v254, v252, s[36:37]
  v_cvt_pk_bf16_f32 v250, v251, v252
  v_lshlrev_b32 v251, 16, v250
  v_and_b32 v252, 0xffff0000, v250
  v_add_f32 v251, s35, v251
  v_add_f32 v252, s35, v252
  v_cvt_pk_bf16_f32 v167, v251, v252
  s_nop 1
  v_mfma_f32_16x16x32_bf16 v[168:171], v[160:163], v[112:115], v[168:171]
  v_mfma_f32_16x16x32_bf16 v[172:175], v[160:163], v[120:123], v[172:175]
  v_mfma_f32_16x16x32_bf16 v[220:223], v[160:163], v[240:243], v[220:223]
  v_mfma_f32_16x16x32_bf16 v[168:171], v[164:167], v[116:119], v[168:171]
  v_mfma_f32_16x16x32_bf16 v[172:175], v[164:167], v[124:127], v[172:175]
  v_mfma_f32_16x16x32_bf16 v[220:223], v[164:167], v[240:243], v[220:223]
  s_mul_i32 s38, s3, 102400
  s_add_u32 s38, s38, 84725760
  s_mul_i32 s39, s3, 102400
  s_add_u32 s39, s39, 84746240
  buffer_load_dwordx4 v[48:51], v2, s[8:11], s38 offen offset:0 sc1
  buffer_load_dwordx4 v[52:55], v2, s[8:11], s39 offen offset:0 sc1
  buffer_load_dwordx4 v[56:59], v2, s[8:11], s38 offen offset:1024 sc1
  buffer_load_dwordx4 v[60:63], v2, s[8:11], s39 offen offset:1024 sc1
  buffer_load_dwordx4 v[64:67], v2, s[8:11], s38 offen offset:2048 sc1
  buffer_load_dwordx4 v[68:71], v2, s[8:11], s39 offen offset:2048 sc1
  ds_read_b128 v[80:83], v3 offset:0
  ds_read_b128 v[84:87], v3 offset:20480
  ds_read_b128 v[88:91], v3 offset:40960
  ds_read_b128 v[92:95], v3 offset:61440
  buffer_load_dwordx4 v[72:75], v2, s[8:11], s38 offen offset:3072 sc1
  buffer_load_dwordx4 v[76:79], v2, s[8:11], s39 offen offset:3072 sc1
  s_add_u32 s38, s38, 4096
  s_add_u32 s39, s39, 4096
  ds_read_b128 v[96:99], v4 offset:0
  ds_read_b128 v[100:103], v4 offset:20480
  ds_read_b128 v[104:107], v4 offset:40960
  ds_read_b128 v[108:111], v4 offset:61440
  s_waitcnt vmcnt(6) lgkmcnt(4)
  v_mfma_f32_16x16x32_bf16 v[16:19], v[80:83], v[48:51], 0
  v_mfma_f32_16x16x32_bf16 v[20:23], v[84:87], v[48:51], 0
  v_mfma_f32_16x16x32_bf16 v[24:27], v[88:91], v[48:51], 0
  v_mfma_f32_16x16x32_bf16 v[28:31], v[92:95], v[48:51], 0
  v_mfma_f32_16x16x32_bf16 v[32:35], v[80:83], v[52:55], 0
  v_mfma_f32_16x16x32_bf16 v[36:39], v[84:87], v[52:55], 0
  v_mfma_f32_16x16x32_bf16 v[40:43], v[88:91], v[52:55], 0
  v_mfma_f32_16x16x32_bf16 v[44:47], v[92:95], v[52:55], 0
  buffer_load_dwordx4 v[48:51], v2, s[8:11], s38 offen offset:0 sc1
  buffer_load_dwordx4 v[52:55], v2, s[8:11], s39 offen offset:0 sc1
  ds_read_b128 v[80:83], v5 offset:0
  ds_read_b128 v[84:87], v5 offset:20480
  ds_read_b128 v[88:91], v5 offset:40960
  ds_read_b128 v[92:95], v5 offset:61440
  s_waitcnt vmcnt(6) lgkmcnt(4)
  v_mfma_f32_16x16x32_bf16 v[16:19], v[96:99], v[56:59], v[16:19]
  v_mfma_f32_16x16x32_bf16 v[20:23], v[100:103], v[56:59], v[20:23]
  v_mfma_f32_16x16x32_bf16 v[24:27], v[104:107], v[56:59], v[24:27]
  v_mfma_f32_16x16x32_bf16 v[28:31], v[108:111], v[56:59], v[28:31]
  v_mfma_f32_16x16x32_bf16 v[32:35], v[96:99], v[60:63], v[32:35]
  v_mfma_f32_16x16x32_bf16 v[36:39], v[100:103], v[60:63], v[36:39]
  v_mfma_f32_16x16x32_bf16 v[40:43], v[104:107], v[60:63], v[40:43]
  v_mfma_f32_16x16x32_bf16 v[44:47], v[108:111], v[60:63], v[44:47]
  buffer_load_dwordx4 v[56:59], v2, s[8:11], s38 offen offset:1024 sc1
  buffer_load_dwordx4 v[60:63], v2, s[8:11], s39 offen offset:1024 sc1
  ds_read_b128 v[96:99], v6 offset:0
  ds_read_b128 v[100:103], v6 offset:20480
  ds_read_b128 v[104:107], v6 offset:40960
  ds_read_b128 v[108:111], v6 offset:61440
  s_waitcnt vmcnt(6) lgkmcnt(4)
  v_mfma_f32_16x16x32_bf16 v[16:19], v[80:83], v[64:67], v[16:19]
  v_mfma_f32_16x16x32_bf16 v[20:23], v[84:87], v[64:67], v[20:23]
  v_mfma_f32_16x16x32_bf16 v[24:27], v[88:91], v[64:67], v[24:27]
  v_mfma_f32_16x16x32_bf16 v[28:31], v[92:95], v[64:67], v[28:31]
  v_mfma_f32_16x16x32_bf16 v[32:35], v[80:83], v[68:71], v[32:35]
  v_mfma_f32_16x16x32_bf16 v[36:39], v[84:87], v[68:71], v[36:39]
  v_mfma_f32_16x16x32_bf16 v[40:43], v[88:91], v[68:71], v[40:43]
  v_mfma_f32_16x16x32_bf16 v[44:47], v[92:95], v[68:71], v[44:47]
  buffer_load_dwordx4 v[64:67], v2, s[8:11], s38 offen offset:2048 sc1
  buffer_load_dwordx4 v[68:71], v2, s[8:11], s39 offen offset:2048 sc1
  ds_read_b128 v[80:83], v3 offset:256
  ds_read_b128 v[84:87], v3 offset:20736
  ds_read_b128 v[88:91], v3 offset:41216
  ds_read_b128 v[92:95], v3 offset:61696
  s_waitcnt vmcnt(6) lgkmcnt(4)
  v_mfma_f32_16x16x32_bf16 v[16:19], v[96:99], v[72:75], v[16:19]
  v_mfma_f32_16x16x32_bf16 v[20:23], v[100:103], v[72:75], v[20:23]
  v_mfma_f32_16x16x32_bf16 v[24:27], v[104:107], v[72:75], v[24:27]
  v_mfma_f32_16x16x32_bf16 v[28:31], v[108:111], v[72:75], v[28:31]
  v_mfma_f32_16x16x32_bf16 v[32:35], v[96:99], v[76:79], v[32:35]
  v_mfma_f32_16x16x32_bf16 v[36:39], v[100:103], v[76:79], v[36:39]
  v_mfma_f32_16x16x32_bf16 v[40:43], v[104:107], v[76:79], v[40:43]
  v_mfma_f32_16x16x32_bf16 v[44:47], v[108:111], v[76:79], v[44:47]
  buffer_load_dwordx4 v[72:75], v2, s[8:11], s38 offen offset:3072 sc1
  buffer_load_dwordx4 v[76:79], v2, s[8:11], s39 offen offset:3072 sc1
  s_add_u32 s38, s38, 4096
  s_add_u32 s39, s39, 4096
  ds_read_b128 v[96:99], v4 offset:256
  ds_read_b128 v[100:103], v4 offset:20736
  ds_read_b128 v[104:107], v4 offset:41216
  ds_read_b128 v[108:111], v4 offset:61696
  s_waitcnt vmcnt(6) lgkmcnt(4)
  v_mfma_f32_16x16x32_bf16 v[16:19], v[80:83], v[48:51], v[16:19]
  v_mfma_f32_16x16x32_bf16 v[20:23], v[84:87], v[48:51], v[20:23]
  v_mfma_f32_16x16x32_bf16 v[24:27], v[88:91], v[48:51], v[24:27]
  v_mfma_f32_16x16x32_bf16 v[28:31], v[92:95], v[48:51], v[28:31]
  v_mfma_f32_16x16x32_bf16 v[32:35], v[80:83], v[52:55], v[32:35]
  v_mfma_f32_16x16x32_bf16 v[36:39], v[84:87], v[52:55], v[36:39]
  v_mfma_f32_16x16x32_bf16 v[40:43], v[88:91], v[52:55], v[40:43]
  v_mfma_f32_16x16x32_bf16 v[44:47], v[92:95], v[52:55], v[44:47]
  buffer_load_dwordx4 v[48:51], v2, s[8:11], s38 offen offset:0 sc1
  buffer_load_dwordx4 v[52:55], v2, s[8:11], s39 offen offset:0 sc1
  ds_read_b128 v[80:83], v5 offset:256
  ds_read_b128 v[84:87], v5 offset:20736
  ds_read_b128 v[88:91], v5 offset:41216
  ds_read_b128 v[92:95], v5 offset:61696
  s_waitcnt vmcnt(6) lgkmcnt(4)
  v_mfma_f32_16x16x32_bf16 v[16:19], v[96:99], v[56:59], v[16:19]
  v_mfma_f32_16x16x32_bf16 v[20:23], v[100:103], v[56:59], v[20:23]
  v_mfma_f32_16x16x32_bf16 v[24:27], v[104:107], v[56:59], v[24:27]
  v_mfma_f32_16x16x32_bf16 v[28:31], v[108:111], v[56:59], v[28:31]
  v_mfma_f32_16x16x32_bf16 v[32:35], v[96:99], v[60:63], v[32:35]
  v_mfma_f32_16x16x32_bf16 v[36:39], v[100:103], v[60:63], v[36:39]
  v_mfma_f32_16x16x32_bf16 v[40:43], v[104:107], v[60:63], v[40:43]
  v_mfma_f32_16x16x32_bf16 v[44:47], v[108:111], v[60:63], v[44:47]
  buffer_load_dwordx4 v[56:59], v2, s[8:11], s38 offen offset:1024 sc1
  buffer_load_dwordx4 v[60:63], v2, s[8:11], s39 offen offset:1024 sc1
  ds_read_b128 v[96:99], v6 offset:256
  ds_read_b128 v[100:103], v6 offset:20736
  ds_read_b128 v[104:107], v6 offset:41216
  ds_read_b128 v[108:111], v6 offset:61696
  s_waitcnt vmcnt(6) lgkmcnt(4)
  v_mfma_f32_16x16x32_bf16 v[16:19], v[80:83], v[64:67], v[16:19]
  v_mfma_f32_16x16x32_bf16 v[20:23], v[84:87], v[64:67], v[20:23]
  v_mfma_f32_16x16x32_bf16 v[24:27], v[88:91], v[64:67], v[24:27]
  v_mfma_f32_16x16x32_bf16 v[28:31], v[92:95], v[64:67], v[28:31]
  v_mfma_f32_16x16x32_bf16 v[32:35], v[80:83], v[68:71], v[32:35]
  v_mfma_f32_16x16x32_bf16 v[36:39], v[84:87], v[68:71], v[36:39]
  v_mfma_f32_16x16x32_bf16 v[40:43], v[88:91], v[68:71], v[40:43]
  v_mfma_f32_16x16x32_bf16 v[44:47], v[92:95], v[68:71], v[44:47]
  buffer_load_dwordx4 v[64:67], v2, s[8:11], s38 offen offset:2048 sc1
  buffer_load_dwordx4 v[68:71], v2, s[8:11], s39 offen offset:2048 sc1
  ds_read_b128 v[80:83], v3 offset:512
  ds_read_b128 v[84:87], v3 offset:20992
  ds_read_b128 v[88:91], v3 offset:41472
  ds_read_b128 v[92:95], v3 offset:61952
  s_waitcnt vmcnt(6) lgkmcnt(4)
  v_mfma_f32_16x16x32_bf16 v[16:19], v[96:99], v[72:75], v[16:19]
  v_mfma_f32_16x16x32_bf16 v[20:23], v[100:103], v[72:75], v[20:23]
  v_mfma_f32_16x16x32_bf16 v[24:27], v[104:107], v[72:75], v[24:27]
  v_mfma_f32_16x16x32_bf16 v[28:31], v[108:111], v[72:75], v[28:31]
  v_mfma_f32_16x16x32_bf16 v[32:35], v[96:99], v[76:79], v[32:35]
  v_mfma_f32_16x16x32_bf16 v[36:39], v[100:103], v[76:79], v[36:39]
  v_mfma_f32_16x16x32_bf16 v[40:43], v[104:107], v[76:79], v[40:43]
  v_mfma_f32_16x16x32_bf16 v[44:47], v[108:111], v[76:79], v[44:47]
  buffer_load_dwordx4 v[72:75], v2, s[8:11], s38 offen offset:3072 sc1
  buffer_load_dwordx4 v[76:79], v2, s[8:11], s39 offen offset:3072 sc1
  s_add_u32 s38, s38, 4096
  s_add_u32 s39, s39, 4096
  ds_read_b128 v[96:99], v4 offset:512
  ds_read_b128 v[100:103], v4 offset:20992
  ds_read_b128 v[104:107], v4 offset:41472
  ds_read_b128 v[108:111], v4 offset:61952
  s_waitcnt vmcnt(6) lgkmcnt(4)
  v_mfma_f32_16x16x32_bf16 v[16:19], v[80:83], v[48:51], v[16:19]
  v_mfma_f32_16x16x32_bf16 v[20:23], v[84:87], v[48:51], v[20:23]
  v_mfma_f32_16x16x32_bf16 v[24:27], v[88:91], v[48:51], v[24:27]
  v_mfma_f32_16x16x32_bf16 v[28:31], v[92:95], v[48:51], v[28:31]
  v_mfma_f32_16x16x32_bf16 v[32:35], v[80:83], v[52:55], v[32:35]
  v_mfma_f32_16x16x32_bf16 v[36:39], v[84:87], v[52:55], v[36:39]
  v_mfma_f32_16x16x32_bf16 v[40:43], v[88:91], v[52:55], v[40:43]
  v_mfma_f32_16x16x32_bf16 v[44:47], v[92:95], v[52:55], v[44:47]
  buffer_load_dwordx4 v[48:51], v2, s[8:11], s38 offen offset:0 sc1
  buffer_load_dwordx4 v[52:55], v2, s[8:11], s39 offen offset:0 sc1
  ds_read_b128 v[80:83], v5 offset:512
  ds_read_b128 v[84:87], v5 offset:20992
  ds_read_b128 v[88:91], v5 offset:41472
  ds_read_b128 v[92:95], v5 offset:61952
  s_waitcnt vmcnt(6) lgkmcnt(4)
  v_mfma_f32_16x16x32_bf16 v[16:19], v[96:99], v[56:59], v[16:19]
  v_mfma_f32_16x16x32_bf16 v[20:23], v[100:103], v[56:59], v[20:23]
  v_mfma_f32_16x16x32_bf16 v[24:27], v[104:107], v[56:59], v[24:27]
  v_mfma_f32_16x16x32_bf16 v[28:31], v[108:111], v[56:59], v[28:31]
  v_mfma_f32_16x16x32_bf16 v[32:35], v[96:99], v[60:63], v[32:35]
  v_mfma_f32_16x16x32_bf16 v[36:39], v[100:103], v[60:63], v[36:39]
  v_mfma_f32_16x16x32_bf16 v[40:43], v[104:107], v[60:63], v[40:43]
  v_mfma_f32_16x16x32_bf16 v[44:47], v[108:111], v[60:63], v[44:47]
  buffer_load_dwordx4 v[56:59], v2, s[8:11], s38 offen offset:1024 sc1
  buffer_load_dwordx4 v[60:63], v2, s[8:11], s39 offen offset:1024 sc1
  ds_read_b128 v[96:99], v6 offset:512
  ds_read_b128 v[100:103], v6 offset:20992
  ds_read_b128 v[104:107], v6 offset:41472
  ds_read_b128 v[108:111], v6 offset:61952
  s_waitcnt vmcnt(6) lgkmcnt(4)
  v_mfma_f32_16x16x32_bf16 v[16:19], v[80:83], v[64:67], v[16:19]
  v_mfma_f32_16x16x32_bf16 v[20:23], v[84:87], v[64:67], v[20:23]
  v_mfma_f32_16x16x32_bf16 v[24:27], v[88:91], v[64:67], v[24:27]
  v_mfma_f32_16x16x32_bf16 v[28:31], v[92:95], v[64:67], v[28:31]
  v_mfma_f32_16x16x32_bf16 v[32:35], v[80:83], v[68:71], v[32:35]
  v_mfma_f32_16x16x32_bf16 v[36:39], v[84:87], v[68:71], v[36:39]
  v_mfma_f32_16x16x32_bf16 v[40:43], v[88:91], v[68:71], v[40:43]
  v_mfma_f32_16x16x32_bf16 v[44:47], v[92:95], v[68:71], v[44:47]
  buffer_load_dwordx4 v[64:67], v2, s[8:11], s38 offen offset:2048 sc1
  buffer_load_dwordx4 v[68:71], v2, s[8:11], s39 offen offset:2048 sc1
  ds_read_b128 v[80:83], v3 offset:768
  ds_read_b128 v[84:87], v3 offset:21248
  ds_read_b128 v[88:91], v3 offset:41728
  ds_read_b128 v[92:95], v3 offset:62208
  s_waitcnt vmcnt(6) lgkmcnt(4)
  v_mfma_f32_16x16x32_bf16 v[16:19], v[96:99], v[72:75], v[16:19]
  v_mfma_f32_16x16x32_bf16 v[20:23], v[100:103], v[72:75], v[20:23]
  v_mfma_f32_16x16x32_bf16 v[24:27], v[104:107], v[72:75], v[24:27]
  v_mfma_f32_16x16x32_bf16 v[28:31], v[108:111], v[72:75], v[28:31]
  v_mfma_f32_16x16x32_bf16 v[32:35], v[96:99], v[76:79], v[32:35]
  v_mfma_f32_16x16x32_bf16 v[36:39], v[100:103], v[76:79], v[36:39]
  v_mfma_f32_16x16x32_bf16 v[40:43], v[104:107], v[76:79], v[40:43]
  v_mfma_f32_16x16x32_bf16 v[44:47], v[108:111], v[76:79], v[44:47]
  buffer_load_dwordx4 v[72:75], v2, s[8:11], s38 offen offset:3072 sc1
  buffer_load_dwordx4 v[76:79], v2, s[8:11], s39 offen offset:3072 sc1
  s_add_u32 s38, s38, 4096
  s_add_u32 s39, s39, 4096
  ds_read_b128 v[96:99], v4 offset:768
  ds_read_b128 v[100:103], v4 offset:21248
  ds_read_b128 v[104:107], v4 offset:41728
  ds_read_b128 v[108:111], v4 offset:62208
  s_waitcnt vmcnt(6) lgkmcnt(4)
  v_mfma_f32_16x16x32_bf16 v[16:19], v[80:83], v[48:51], v[16:19]
  v_mfma_f32_16x16x32_bf16 v[20:23], v[84:87], v[48:51], v[20:23]
  v_mfma_f32_16x16x32_bf16 v[24:27], v[88:91], v[48:51], v[24:27]
  v_mfma_f32_16x16x32_bf16 v[28:31], v[92:95], v[48:51], v[28:31]
  v_mfma_f32_16x16x32_bf16 v[32:35], v[80:83], v[52:55], v[32:35]
  v_mfma_f32_16x16x32_bf16 v[36:39], v[84:87], v[52:55], v[36:39]
  v_mfma_f32_16x16x32_bf16 v[40:43], v[88:91], v[52:55], v[40:43]
  v_mfma_f32_16x16x32_bf16 v[44:47], v[92:95], v[52:55], v[44:47]
  buffer_load_dwordx4 v[48:51], v2, s[8:11], s38 offen offset:0 sc1
  buffer_load_dwordx4 v[52:55], v2, s[8:11], s39 offen offset:0 sc1
  ds_read_b128 v[80:83], v5 offset:768
  ds_read_b128 v[84:87], v5 offset:21248
  ds_read_b128 v[88:91], v5 offset:41728
  ds_read_b128 v[92:95], v5 offset:62208
  s_waitcnt vmcnt(6) lgkmcnt(4)
  v_mfma_f32_16x16x32_bf16 v[16:19], v[96:99], v[56:59], v[16:19]
  v_mfma_f32_16x16x32_bf16 v[20:23], v[100:103], v[56:59], v[20:23]
  v_mfma_f32_16x16x32_bf16 v[24:27], v[104:107], v[56:59], v[24:27]
  v_mfma_f32_16x16x32_bf16 v[28:31], v[108:111], v[56:59], v[28:31]
  v_mfma_f32_16x16x32_bf16 v[32:35], v[96:99], v[60:63], v[32:35]
  v_mfma_f32_16x16x32_bf16 v[36:39], v[100:103], v[60:63], v[36:39]
  v_mfma_f32_16x16x32_bf16 v[40:43], v[104:107], v[60:63], v[40:43]
  v_mfma_f32_16x16x32_bf16 v[44:47], v[108:111], v[60:63], v[44:47]
  buffer_load_dwordx4 v[56:59], v2, s[8:11], s38 offen offset:1024 sc1
  buffer_load_dwordx4 v[60:63], v2, s[8:11], s39 offen offset:1024 sc1
  ds_read_b128 v[96:99], v6 offset:768
  ds_read_b128 v[100:103], v6 offset:21248
  ds_read_b128 v[104:107], v6 offset:41728
  ds_read_b128 v[108:111], v6 offset:62208
  s_waitcnt vmcnt(6) lgkmcnt(4)
  v_mfma_f32_16x16x32_bf16 v[16:19], v[80:83], v[64:67], v[16:19]
  v_mfma_f32_16x16x32_bf16 v[20:23], v[84:87], v[64:67], v[20:23]
  v_mfma_f32_16x16x32_bf16 v[24:27], v[88:91], v[64:67], v[24:27]
  v_mfma_f32_16x16x32_bf16 v[28:31], v[92:95], v[64:67], v[28:31]
  v_mfma_f32_16x16x32_bf16 v[32:35], v[80:83], v[68:71], v[32:35]
  v_mfma_f32_16x16x32_bf16 v[36:39], v[84:87], v[68:71], v[36:39]
  v_mfma_f32_16x16x32_bf16 v[40:43], v[88:91], v[68:71], v[40:43]
  v_mfma_f32_16x16x32_bf16 v[44:47], v[92:95], v[68:71], v[44:47]
  buffer_load_dwordx4 v[64:67], v2, s[8:11], s38 offen offset:2048 sc1
  buffer_load_dwordx4 v[68:71], v2, s[8:11], s39 offen offset:2048 sc1
  ds_read_b128 v[80:83], v3 offset:1024
  ds_read_b128 v[84:87], v3 offset:21504
  ds_read_b128 v[88:91], v3 offset:41984
  ds_read_b128 v[92:95], v3 offset:62464
  s_waitcnt vmcnt(6) lgkmcnt(4)
  v_mfma_f32_16x16x32_bf16 v[16:19], v[96:99], v[72:75], v[16:19]
  v_mfma_f32_16x16x32_bf16 v[20:23], v[100:103], v[72:75], v[20:23]
  v_mfma_f32_16x16x32_bf16 v[24:27], v[104:107], v[72:75], v[24:27]
  v_mfma_f32_16x16x32_bf16 v[28:31], v[108:111], v[72:75], v[28:31]
  v_mfma_f32_16x16x32_bf16 v[32:35], v[96:99], v[76:79], v[32:35]
  v_mfma_f32_16x16x32_bf16 v[36:39], v[100:103], v[76:79], v[36:39]
  v_mfma_f32_16x16x32_bf16 v[40:43], v[104:107], v[76:79], v[40:43]
  v_mfma_f32_16x16x32_bf16 v[44:47], v[108:111], v[76:79], v[44:47]
  buffer_load_dwordx4 v[72:75], v2, s[8:11], s38 offen offset:3072 sc1
  buffer_load_dwordx4 v[76:79], v2, s[8:11], s39 offen offset:3072 sc1
  s_add_u32 s38, s38, 4096
  s_add_u32 s39, s39, 4096
  ds_read_b128 v[96:99], v4 offset:1024
  ds_read_b128 v[100:103], v4 offset:21504
  ds_read_b128 v[104:107], v4 offset:41984
  ds_read_b128 v[108:111], v4 offset:62464
  s_waitcnt vmcnt(6) lgkmcnt(4)
  v_mfma_f32_16x16x32_bf16 v[16:19], v[80:83], v[48:51], v[16:19]
  v_mfma_f32_16x16x32_bf16 v[20:23], v[84:87], v[48:51], v[20:23]
  v_mfma_f32_16x16x32_bf16 v[24:27], v[88:91], v[48:51], v[24:27]
  v_mfma_f32_16x16x32_bf16 v[28:31], v[92:95], v[48:51], v[28:31]
  v_mfma_f32_16x16x32_bf16 v[32:35], v[80:83], v[52:55], v[32:35]
  v_mfma_f32_16x16x32_bf16 v[36:39], v[84:87], v[52:55], v[36:39]
  v_mfma_f32_16x16x32_bf16 v[40:43], v[88:91], v[52:55], v[40:43]
  v_mfma_f32_16x16x32_bf16 v[44:47], v[92:95], v[52:55], v[44:47]
  ds_read_b128 v[80:83], v5 offset:1024
  ds_read_b128 v[84:87], v5 offset:21504
  ds_read_b128 v[88:91], v5 offset:41984
  ds_read_b128 v[92:95], v5 offset:62464
  s_waitcnt vmcnt(4) lgkmcnt(4)
  v_mfma_f32_16x16x32_bf16 v[16:19], v[96:99], v[56:59], v[16:19]
  v_mfma_f32_16x16x32_bf16 v[20:23], v[100:103], v[56:59], v[20:23]
  v_mfma_f32_16x16x32_bf16 v[24:27], v[104:107], v[56:59], v[24:27]
  v_mfma_f32_16x16x32_bf16 v[28:31], v[108:111], v[56:59], v[28:31]
  v_mfma_f32_16x16x32_bf16 v[32:35], v[96:99], v[60:63], v[32:35]
  v_mfma_f32_16x16x32_bf16 v[36:39], v[100:103], v[60:63], v[36:39]
  v_mfma_f32_16x16x32_bf16 v[40:43], v[104:107], v[60:63], v[40:43]
  v_mfma_f32_16x16x32_bf16 v[44:47], v[108:111], v[60:63], v[44:47]
  ds_read_b128 v[96:99], v6 offset:1024
  ds_read_b128 v[100:103], v6 offset:21504
  ds_read_b128 v[104:107], v6 offset:41984
  ds_read_b128 v[108:111], v6 offset:62464
  s_waitcnt vmcnt(2) lgkmcnt(4)
  v_mfma_f32_16x16x32_bf16 v[16:19], v[80:83], v[64:67], v[16:19]
  v_mfma_f32_16x16x32_bf16 v[20:23], v[84:87], v[64:67], v[20:23]
  v_mfma_f32_16x16x32_bf16 v[24:27], v[88:91], v[64:67], v[24:27]
  v_mfma_f32_16x16x32_bf16 v[28:31], v[92:95], v[64:67], v[28:31]
  v_mfma_f32_16x16x32_bf16 v[32:35], v[80:83], v[68:71], v[32:35]
  v_mfma_f32_16x16x32_bf16 v[36:39], v[84:87], v[68:71], v[36:39]
  v_mfma_f32_16x16x32_bf16 v[40:43], v[88:91], v[68:71], v[40:43]
  v_mfma_f32_16x16x32_bf16 v[44:47], v[92:95], v[68:71], v[44:47]
  s_waitcnt vmcnt(0) lgkmcnt(0)
  v_mfma_f32_16x16x32_bf16 v[16:19], v[96:99], v[72:75], v[16:19]
  v_mfma_f32_16x16x32_bf16 v[20:23], v[100:103], v[72:75], v[20:23]
  v_mfma_f32_16x16x32_bf16 v[24:27], v[104:107], v[72:75], v[24:27]
  v_mfma_f32_16x16x32_bf16 v[28:31], v[108:111], v[72:75], v[28:31]
  v_mfma_f32_16x16x32_bf16 v[32:35], v[96:99], v[76:79], v[32:35]
  v_mfma_f32_16x16x32_bf16 v[36:39], v[100:103], v[76:79], v[36:39]
  v_mfma_f32_16x16x32_bf16 v[40:43], v[104:107], v[76:79], v[40:43]
  v_mfma_f32_16x16x32_bf16 v[44:47], v[108:111], v[76:79], v[44:47]
  s_nop 7
  s_nop 1
  v_cvt_pk_bf16_f32 v244, v16, v17
  v_lshlrev_b32 v245, 16, v244
  v_and_b32 v246, 0xffff0000, v244
  v_mul_f32 v247, s34, v245
  v_mul_f32 v248, s34, v246
  v_exp_f32 v247, v247
  v_exp_f32 v248, v248
  v_cmp_lt_f32 vcc, 0, v245
  v_add_f32 v245, 1.0, v245
  v_cmp_lt_f32 s[36:37], 0, v246
  v_cndmask_b32 v245, v247, v245, vcc
  v_add_f32 v246, 1.0, v246
  s_nop 0
  v_cndmask_b32 v246, v248, v246, s[36:37]
  v_cvt_pk_bf16_f32 v244, v245, v246
  v_lshlrev_b32 v245, 16, v244
  v_and_b32 v246, 0xffff0000, v244
  v_add_f32 v245, s35, v245
  v_add_f32 v246, s35, v246
  v_cvt_pk_bf16_f32 v152, v245, v246
  v_cvt_pk_bf16_f32 v250, v18, v19
  v_lshlrev_b32 v251, 16, v250
  v_and_b32 v252, 0xffff0000, v250
  v_mul_f32 v253, s34, v251
  v_mul_f32 v254, s34, v252
  v_exp_f32 v253, v253
  v_exp_f32 v254, v254
  v_cmp_lt_f32 vcc, 0, v251
  v_add_f32 v251, 1.0, v251
  v_cmp_lt_f32 s[36:37], 0, v252
  v_cndmask_b32 v251, v253, v251, vcc
  v_add_f32 v252, 1.0, v252
  s_nop 0
  v_cndmask_b32 v252, v254, v252, s[36:37]
  v_cvt_pk_bf16_f32 v250, v251, v252
  v_lshlrev_b32 v251, 16, v250
  v_and_b32 v252, 0xffff0000, v250
  v_add_f32 v251, s35, v251
  v_add_f32 v252, s35, v252
  v_cvt_pk_bf16_f32 v153, v251, v252
  v_cvt_pk_bf16_f32 v244, v20, v21
  v_lshlrev_b32 v245, 16, v244
  v_and_b32 v246, 0xffff0000, v244
  v_mul_f32 v247, s34, v245
  v_mul_f32 v248, s34, v246
  v_exp_f32 v247, v247
  v_exp_f32 v248, v248
  v_cmp_lt_f32 vcc, 0, v245
  v_add_f32 v245, 1.0, v245
  v_cmp_lt_f32 s[36:37], 0, v246
  v_cndmask_b32 v245, v247, v245, vcc
  v_add_f32 v246, 1.0, v246
  s_nop 0
  v_cndmask_b32 v246, v248, v246, s[36:37]
  v_cvt_pk_bf16_f32 v244, v245, v246
  v_lshlrev_b32 v245, 16, v244
  v_and_b32 v246, 0xffff0000, v244
  v_add_f32 v245, s35, v245
  v_add_f32 v246, s35, v246
  v_cvt_pk_bf16_f32 v154, v245, v246
  v_cvt_pk_bf16_f32 v250, v22, v23
  v_lshlrev_b32 v251, 16, v250
  v_and_b32 v252, 0xffff0000, v250
  v_mul_f32 v253, s34, v251
  v_mul_f32 v254, s34, v252
  v_exp_f32 v253, v253
  v_exp_f32 v254, v254
  v_cmp_lt_f32 vcc, 0, v251
  v_add_f32 v251, 1.0, v251
  v_cmp_lt_f32 s[36:37], 0, v252
  v_cndmask_b32 v251, v253, v251, vcc
  v_add_f32 v252, 1.0, v252
  s_nop 0
  v_cndmask_b32 v252, v254, v252, s[36:37]
  v_cvt_pk_bf16_f32 v250, v251, v252
  v_lshlrev_b32 v251, 16, v250
  v_and_b32 v252, 0xffff0000, v250
  v_add_f32 v251, s35, v251
  v_add_f32 v252, s35, v252
  v_cvt_pk_bf16_f32 v155, v251, v252
  v_cvt_pk_bf16_f32 v244, v24, v25
  v_lshlrev_b32 v245, 16, v244
  v_and_b32 v246, 0xffff0000, v244
  v_mul_f32 v247, s34, v245
  v_mul_f32 v248, s34, v246
  v_exp_f32 v247, v247
  v_exp_f32 v248, v248
  v_cmp_lt_f32 vcc, 0, v245
  v_add_f32 v245, 1.0, v245
  v_cmp_lt_f32 s[36:37], 0, v246
  v_cndmask_b32 v245, v247, v245, vcc
  v_add_f32 v246, 1.0, v246
  s_nop 0
  v_cndmask_b32 v246, v248, v246, s[36:37]
  v_cvt_pk_bf16_f32 v244, v245, v246
  v_lshlrev_b32 v245, 16, v244
  v_and_b32 v246, 0xffff0000, v244
  v_add_f32 v245, s35, v245
  v_add_f32 v246, s35, v246
  v_cvt_pk_bf16_f32 v156, v245, v246
  v_cvt_pk_bf16_f32 v250, v26, v27
  v_lshlrev_b32 v251, 16, v250
  v_and_b32 v252, 0xffff0000, v250
  v_mul_f32 v253, s34, v251
  v_mul_f32 v254, s34, v252
  v_exp_f32 v253, v253
  v_exp_f32 v254, v254
  v_cmp_lt_f32 vcc, 0, v251
  v_add_f32 v251, 1.0, v251
  v_cmp_lt_f32 s[36:37], 0, v252
  v_cndmask_b32 v251, v253, v251, vcc
  v_add_f32 v252, 1.0, v252
  s_nop 0
  v_cndmask_b32 v252, v254, v252, s[36:37]
  v_cvt_pk_bf16_f32 v250, v251, v252
  v_lshlrev_b32 v251, 16, v250
  v_and_b32 v252, 0xffff0000, v250
  v_add_f32 v251, s35, v251
  v_add_f32 v252, s35, v252
  v_cvt_pk_bf16_f32 v157, v251, v252
  v_cvt_pk_bf16_f32 v244, v28, v29
  v_lshlrev_b32 v245, 16, v244
  v_and_b32 v246, 0xffff0000, v244
  v_mul_f32 v247, s34, v245
  v_mul_f32 v248, s34, v246
  v_exp_f32 v247, v247
  v_exp_f32 v248, v248
  v_cmp_lt_f32 vcc, 0, v245
  v_add_f32 v245, 1.0, v245
  v_cmp_lt_f32 s[36:37], 0, v246
  v_cndmask_b32 v245, v247, v245, vcc
  v_add_f32 v246, 1.0, v246
  s_nop 0
  v_cndmask_b32 v246, v248, v246, s[36:37]
  v_cvt_pk_bf16_f32 v244, v245, v246
  v_lshlrev_b32 v245, 16, v244
  v_and_b32 v246, 0xffff0000, v244
  v_add_f32 v245, s35, v245
  v_add_f32 v246, s35, v246
  v_cvt_pk_bf16_f32 v158, v245, v246
  v_cvt_pk_bf16_f32 v250, v30, v31
  v_lshlrev_b32 v251, 16, v250
  v_and_b32 v252, 0xffff0000, v250
  v_mul_f32 v253, s34, v251
  v_mul_f32 v254, s34, v252
  v_exp_f32 v253, v253
  v_exp_f32 v254, v254
  v_cmp_lt_f32 vcc, 0, v251
  v_add_f32 v251, 1.0, v251
  v_cmp_lt_f32 s[36:37], 0, v252
  v_cndmask_b32 v251, v253, v251, vcc
  v_add_f32 v252, 1.0, v252
  s_nop 0
  v_cndmask_b32 v252, v254, v252, s[36:37]
  v_cvt_pk_bf16_f32 v250, v251, v252
  v_lshlrev_b32 v251, 16, v250
  v_and_b32 v252, 0xffff0000, v250
  v_add_f32 v251, s35, v251
  v_add_f32 v252, s35, v252
  v_cvt_pk_bf16_f32 v159, v251, v252
  s_nop 1
  v_mfma_f32_16x16x32_bf16 v[176:179], v[152:155], v[112:115], v[176:179]
  v_mfma_f32_16x16x32_bf16 v[180:183], v[152:155], v[120:123], v[180:183]
  v_mfma_f32_16x16x32_bf16 v[184:187], v[152:155], v[128:131], v[184:187]
  v_mfma_f32_16x16x32_bf16 v[224:227], v[152:155], v[240:243], v[224:227]
  v_mfma_f32_16x16x32_bf16 v[176:179], v[156:159], v[116:119], v[176:179]
  v_mfma_f32_16x16x32_bf16 v[180:183], v[156:159], v[124:127], v[180:183]
  v_mfma_f32_16x16x32_bf16 v[184:187], v[156:159], v[132:135], v[184:187]
  v_mfma_f32_16x16x32_bf16 v[224:227], v[156:159], v[240:243], v[224:227]
  v_cvt_pk_bf16_f32 v244, v32, v33
  v_lshlrev_b32 v245, 16, v244
  v_and_b32 v246, 0xffff0000, v244
  v_mul_f32 v247, s34, v245
  v_mul_f32 v248, s34, v246
  v_exp_f32 v247, v247
  v_exp_f32 v248, v248
  v_cmp_lt_f32 vcc, 0, v245
  v_add_f32 v245, 1.0, v245
  v_cmp_lt_f32 s[36:37], 0, v246
  v_cndmask_b32 v245, v247, v245, vcc
  v_add_f32 v246, 1.0, v246
  s_nop 0
  v_cndmask_b32 v246, v248, v246, s[36:37]
  v_cvt_pk_bf16_f32 v244, v245, v246
  v_lshlrev_b32 v245, 16, v244
  v_and_b32 v246, 0xffff0000, v244
  v_add_f32 v245, s35, v245
  v_add_f32 v246, s35, v246
  v_cvt_pk_bf16_f32 v160, v245, v246
  v_cvt_pk_bf16_f32 v250, v34, v35
  v_lshlrev_b32 v251, 16, v250
  v_and_b32 v252, 0xffff0000, v250
  v_mul_f32 v253, s34, v251
  v_mul_f32 v254, s34, v252
  v_exp_f32 v253, v253
  v_exp_f32 v254, v254
  v_cmp_lt_f32 vcc, 0, v251
  v_add_f32 v251, 1.0, v251
  v_cmp_lt_f32 s[36:37], 0, v252
  v_cndmask_b32 v251, v253, v251, vcc
  v_add_f32 v252, 1.0, v252
  s_nop 0
  v_cndmask_b32 v252, v254, v252, s[36:37]
  v_cvt_pk_bf16_f32 v250, v251, v252
  v_lshlrev_b32 v251, 16, v250
  v_and_b32 v252, 0xffff0000, v250
  v_add_f32 v251, s35, v251
  v_add_f32 v252, s35, v252
  v_cvt_pk_bf16_f32 v161, v251, v252
  v_cvt_pk_bf16_f32 v244, v36, v37
  v_lshlrev_b32 v245, 16, v244
  v_and_b32 v246, 0xffff0000, v244
  v_mul_f32 v247, s34, v245
  v_mul_f32 v248, s34, v246
  v_exp_f32 v247, v247
  v_exp_f32 v248, v248
  v_cmp_lt_f32 vcc, 0, v245
  v_add_f32 v245, 1.0, v245
  v_cmp_lt_f32 s[36:37], 0, v246
  v_cndmask_b32 v245, v247, v245, vcc
  v_add_f32 v246, 1.0, v246
  s_nop 0
  v_cndmask_b32 v246, v248, v246, s[36:37]
  v_cvt_pk_bf16_f32 v244, v245, v246
  v_lshlrev_b32 v245, 16, v244
  v_and_b32 v246, 0xffff0000, v244
  v_add_f32 v245, s35, v245
  v_add_f32 v246, s35, v246
  v_cvt_pk_bf16_f32 v162, v245, v246
  v_cvt_pk_bf16_f32 v250, v38, v39
  v_lshlrev_b32 v251, 16, v250
  v_and_b32 v252, 0xffff0000, v250
  v_mul_f32 v253, s34, v251
  v_mul_f32 v254, s34, v252
  v_exp_f32 v253, v253
  v_exp_f32 v254, v254
  v_cmp_lt_f32 vcc, 0, v251
  v_add_f32 v251, 1.0, v251
  v_cmp_lt_f32 s[36:37], 0, v252
  v_cndmask_b32 v251, v253, v251, vcc
  v_add_f32 v252, 1.0, v252
  s_nop 0
  v_cndmask_b32 v252, v254, v252, s[36:37]
  v_cvt_pk_bf16_f32 v250, v251, v252
  v_lshlrev_b32 v251, 16, v250
  v_and_b32 v252, 0xffff0000, v250
  v_add_f32 v251, s35, v251
  v_add_f32 v252, s35, v252
  v_cvt_pk_bf16_f32 v163, v251, v252
  v_cvt_pk_bf16_f32 v244, v40, v41
  v_lshlrev_b32 v245, 16, v244
  v_and_b32 v246, 0xffff0000, v244
  v_mul_f32 v247, s34, v245
  v_mul_f32 v248, s34, v246
  v_exp_f32 v247, v247
  v_exp_f32 v248, v248
  v_cmp_lt_f32 vcc, 0, v245
  v_add_f32 v245, 1.0, v245
  v_cmp_lt_f32 s[36:37], 0, v246
  v_cndmask_b32 v245, v247, v245, vcc
  v_add_f32 v246, 1.0, v246
  s_nop 0
  v_cndmask_b32 v246, v248, v246, s[36:37]
  v_cvt_pk_bf16_f32 v244, v245, v246
  v_lshlrev_b32 v245, 16, v244
  v_and_b32 v246, 0xffff0000, v244
  v_add_f32 v245, s35, v245
  v_add_f32 v246, s35, v246
  v_cvt_pk_bf16_f32 v164, v245, v246
  v_cvt_pk_bf16_f32 v250, v42, v43
  v_lshlrev_b32 v251, 16, v250
  v_and_b32 v252, 0xffff0000, v250
  v_mul_f32 v253, s34, v251
  v_mul_f32 v254, s34, v252
  v_exp_f32 v253, v253
  v_exp_f32 v254, v254
  v_cmp_lt_f32 vcc, 0, v251
  v_add_f32 v251, 1.0, v251
  v_cmp_lt_f32 s[36:37], 0, v252
  v_cndmask_b32 v251, v253, v251, vcc
  v_add_f32 v252, 1.0, v252
  s_nop 0
  v_cndmask_b32 v252, v254, v252, s[36:37]
  v_cvt_pk_bf16_f32 v250, v251, v252
  v_lshlrev_b32 v251, 16, v250
  v_and_b32 v252, 0xffff0000, v250
  v_add_f32 v251, s35, v251
  v_add_f32 v252, s35, v252
  v_cvt_pk_bf16_f32 v165, v251, v252
  v_cvt_pk_bf16_f32 v244, v44, v45
  v_lshlrev_b32 v245, 16, v244
  v_and_b32 v246, 0xffff0000, v244
  v_mul_f32 v247, s34, v245
  v_mul_f32 v248, s34, v246
  v_exp_f32 v247, v247
  v_exp_f32 v248, v248
  v_cmp_lt_f32 vcc, 0, v245
  v_add_f32 v245, 1.0, v245
  v_cmp_lt_f32 s[36:37], 0, v246
  v_cndmask_b32 v245, v247, v245, vcc
  v_add_f32 v246, 1.0, v246
  s_nop 0
  v_cndmask_b32 v246, v248, v246, s[36:37]
  v_cvt_pk_bf16_f32 v244, v245, v246
  v_lshlrev_b32 v245, 16, v244
  v_and_b32 v246, 0xffff0000, v244
  v_add_f32 v245, s35, v245
  v_add_f32 v246, s35, v246
  v_cvt_pk_bf16_f32 v166, v245, v246
  v_cvt_pk_bf16_f32 v250, v46, v47
  v_lshlrev_b32 v251, 16, v250
  v_and_b32 v252, 0xffff0000, v250
  v_mul_f32 v253, s34, v251
  v_mul_f32 v254, s34, v252
  v_exp_f32 v253, v253
  v_exp_f32 v254, v254
  v_cmp_lt_f32 vcc, 0, v251
  v_add_f32 v251, 1.0, v251
  v_cmp_lt_f32 s[36:37], 0, v252
  v_cndmask_b32 v251, v253, v251, vcc
  v_add_f32 v252, 1.0, v252
  s_nop 0
  v_cndmask_b32 v252, v254, v252, s[36:37]
  v_cvt_pk_bf16_f32 v250, v251, v252
  v_lshlrev_b32 v251, 16, v250
  v_and_b32 v252, 0xffff0000, v250
  v_add_f32 v251, s35, v251
  v_add_f32 v252, s35, v252
  v_cvt_pk_bf16_f32 v167, v251, v252
  s_nop 1
  v_mfma_f32_16x16x32_bf16 v[188:191], v[160:163], v[120:123], v[188:191]
  v_mfma_f32_16x16x32_bf16 v[192:195], v[160:163], v[128:131], v[192:195]
  v_mfma_f32_16x16x32_bf16 v[196:199], v[160:163], v[136:139], v[196:199]
  v_mfma_f32_16x16x32_bf16 v[228:231], v[160:163], v[240:243], v[228:231]
  v_mfma_f32_16x16x32_bf16 v[188:191], v[164:167], v[124:127], v[188:191]
  v_mfma_f32_16x16x32_bf16 v[192:195], v[164:167], v[132:135], v[192:195]
  v_mfma_f32_16x16x32_bf16 v[196:199], v[164:167], v[140:143], v[196:199]
  v_mfma_f32_16x16x32_bf16 v[228:231], v[164:167], v[240:243], v[228:231]
  s_mul_i32 s38, s3, 102400
  s_add_u32 s38, s38, 84766720
  s_mul_i32 s39, s3, 102400
  s_add_u32 s39, s39, 84787200
  buffer_load_dwordx4 v[48:51], v2, s[8:11], s38 offen offset:0 sc1
  buffer_load_dwordx4 v[52:55], v2, s[8:11], s39 offen offset:0 sc1
  buffer_load_dwordx4 v[56:59], v2, s[8:11], s38 offen offset:1024 sc1
  buffer_load_dwordx4 v[60:63], v2, s[8:11], s39 offen offset:1024 sc1
  buffer_load_dwordx4 v[64:67], v2, s[8:11], s38 offen offset:2048 sc1
  buffer_load_dwordx4 v[68:71], v2, s[8:11], s39 offen offset:2048 sc1
  ds_read_b128 v[80:83], v3 offset:0
  ds_read_b128 v[84:87], v3 offset:20480
  ds_read_b128 v[88:91], v3 offset:40960
  ds_read_b128 v[92:95], v3 offset:61440
  buffer_load_dwordx4 v[72:75], v2, s[8:11], s38 offen offset:3072 sc1
  buffer_load_dwordx4 v[76:79], v2, s[8:11], s39 offen offset:3072 sc1
  s_add_u32 s38, s38, 4096
  s_add_u32 s39, s39, 4096
  ds_read_b128 v[96:99], v4 offset:0
  ds_read_b128 v[100:103], v4 offset:20480
  ds_read_b128 v[104:107], v4 offset:40960
  ds_read_b128 v[108:111], v4 offset:61440
  s_waitcnt vmcnt(6) lgkmcnt(4)
  v_mfma_f32_16x16x32_bf16 v[16:19], v[80:83], v[48:51], 0
  v_mfma_f32_16x16x32_bf16 v[20:23], v[84:87], v[48:51], 0
  v_mfma_f32_16x16x32_bf16 v[24:27], v[88:91], v[48:51], 0
  v_mfma_f32_16x16x32_bf16 v[28:31], v[92:95], v[48:51], 0
  v_mfma_f32_16x16x32_bf16 v[32:35], v[80:83], v[52:55], 0
  v_mfma_f32_16x16x32_bf16 v[36:39], v[84:87], v[52:55], 0
  v_mfma_f32_16x16x32_bf16 v[40:43], v[88:91], v[52:55], 0
  v_mfma_f32_16x16x32_bf16 v[44:47], v[92:95], v[52:55], 0
  buffer_load_dwordx4 v[48:51], v2, s[8:11], s38 offen offset:0 sc1
  buffer_load_dwordx4 v[52:55], v2, s[8:11], s39 offen offset:0 sc1
  ds_read_b128 v[80:83], v5 offset:0
  ds_read_b128 v[84:87], v5 offset:20480
  ds_read_b128 v[88:91], v5 offset:40960
  ds_read_b128 v[92:95], v5 offset:61440
  s_waitcnt vmcnt(6) lgkmcnt(4)
  v_mfma_f32_16x16x32_bf16 v[16:19], v[96:99], v[56:59], v[16:19]
  v_mfma_f32_16x16x32_bf16 v[20:23], v[100:103], v[56:59], v[20:23]
  v_mfma_f32_16x16x32_bf16 v[24:27], v[104:107], v[56:59], v[24:27]
  v_mfma_f32_16x16x32_bf16 v[28:31], v[108:111], v[56:59], v[28:31]
  v_mfma_f32_16x16x32_bf16 v[32:35], v[96:99], v[60:63], v[32:35]
  v_mfma_f32_16x16x32_bf16 v[36:39], v[100:103], v[60:63], v[36:39]
  v_mfma_f32_16x16x32_bf16 v[40:43], v[104:107], v[60:63], v[40:43]
  v_mfma_f32_16x16x32_bf16 v[44:47], v[108:111], v[60:63], v[44:47]
  buffer_load_dwordx4 v[56:59], v2, s[8:11], s38 offen offset:1024 sc1
  buffer_load_dwordx4 v[60:63], v2, s[8:11], s39 offen offset:1024 sc1
  ds_read_b128 v[96:99], v6 offset:0
  ds_read_b128 v[100:103], v6 offset:20480
  ds_read_b128 v[104:107], v6 offset:40960
  ds_read_b128 v[108:111], v6 offset:61440
  s_waitcnt vmcnt(6) lgkmcnt(4)
  v_mfma_f32_16x16x32_bf16 v[16:19], v[80:83], v[64:67], v[16:19]
  v_mfma_f32_16x16x32_bf16 v[20:23], v[84:87], v[64:67], v[20:23]
  v_mfma_f32_16x16x32_bf16 v[24:27], v[88:91], v[64:67], v[24:27]
  v_mfma_f32_16x16x32_bf16 v[28:31], v[92:95], v[64:67], v[28:31]
  v_mfma_f32_16x16x32_bf16 v[32:35], v[80:83], v[68:71], v[32:35]
  v_mfma_f32_16x16x32_bf16 v[36:39], v[84:87], v[68:71], v[36:39]
  v_mfma_f32_16x16x32_bf16 v[40:43], v[88:91], v[68:71], v[40:43]
  v_mfma_f32_16x16x32_bf16 v[44:47], v[92:95], v[68:71], v[44:47]
  buffer_load_dwordx4 v[64:67], v2, s[8:11], s38 offen offset:2048 sc1
  buffer_load_dwordx4 v[68:71], v2, s[8:11], s39 offen offset:2048 sc1
  ds_read_b128 v[80:83], v3 offset:256
  ds_read_b128 v[84:87], v3 offset:20736
  ds_read_b128 v[88:91], v3 offset:41216
  ds_read_b128 v[92:95], v3 offset:61696
  s_waitcnt vmcnt(6) lgkmcnt(4)
  v_mfma_f32_16x16x32_bf16 v[16:19], v[96:99], v[72:75], v[16:19]
  v_mfma_f32_16x16x32_bf16 v[20:23], v[100:103], v[72:75], v[20:23]
  v_mfma_f32_16x16x32_bf16 v[24:27], v[104:107], v[72:75], v[24:27]
  v_mfma_f32_16x16x32_bf16 v[28:31], v[108:111], v[72:75], v[28:31]
  v_mfma_f32_16x16x32_bf16 v[32:35], v[96:99], v[76:79], v[32:35]
  v_mfma_f32_16x16x32_bf16 v[36:39], v[100:103], v[76:79], v[36:39]
  v_mfma_f32_16x16x32_bf16 v[40:43], v[104:107], v[76:79], v[40:43]
  v_mfma_f32_16x16x32_bf16 v[44:47], v[108:111], v[76:79], v[44:47]
  buffer_load_dwordx4 v[72:75], v2, s[8:11], s38 offen offset:3072 sc1
  buffer_load_dwordx4 v[76:79], v2, s[8:11], s39 offen offset:3072 sc1
  s_add_u32 s38, s38, 4096
  s_add_u32 s39, s39, 4096
  ds_read_b128 v[96:99], v4 offset:256
  ds_read_b128 v[100:103], v4 offset:20736
  ds_read_b128 v[104:107], v4 offset:41216
  ds_read_b128 v[108:111], v4 offset:61696
  s_waitcnt vmcnt(6) lgkmcnt(4)
  v_mfma_f32_16x16x32_bf16 v[16:19], v[80:83], v[48:51], v[16:19]
  v_mfma_f32_16x16x32_bf16 v[20:23], v[84:87], v[48:51], v[20:23]
  v_mfma_f32_16x16x32_bf16 v[24:27], v[88:91], v[48:51], v[24:27]
  v_mfma_f32_16x16x32_bf16 v[28:31], v[92:95], v[48:51], v[28:31]
  v_mfma_f32_16x16x32_bf16 v[32:35], v[80:83], v[52:55], v[32:35]
  v_mfma_f32_16x16x32_bf16 v[36:39], v[84:87], v[52:55], v[36:39]
  v_mfma_f32_16x16x32_bf16 v[40:43], v[88:91], v[52:55], v[40:43]
  v_mfma_f32_16x16x32_bf16 v[44:47], v[92:95], v[52:55], v[44:47]
  buffer_load_dwordx4 v[48:51], v2, s[8:11], s38 offen offset:0 sc1
  buffer_load_dwordx4 v[52:55], v2, s[8:11], s39 offen offset:0 sc1
  ds_read_b128 v[80:83], v5 offset:256
  ds_read_b128 v[84:87], v5 offset:20736
  ds_read_b128 v[88:91], v5 offset:41216
  ds_read_b128 v[92:95], v5 offset:61696
  s_waitcnt vmcnt(6) lgkmcnt(4)
  v_mfma_f32_16x16x32_bf16 v[16:19], v[96:99], v[56:59], v[16:19]
  v_mfma_f32_16x16x32_bf16 v[20:23], v[100:103], v[56:59], v[20:23]
  v_mfma_f32_16x16x32_bf16 v[24:27], v[104:107], v[56:59], v[24:27]
  v_mfma_f32_16x16x32_bf16 v[28:31], v[108:111], v[56:59], v[28:31]
  v_mfma_f32_16x16x32_bf16 v[32:35], v[96:99], v[60:63], v[32:35]
  v_mfma_f32_16x16x32_bf16 v[36:39], v[100:103], v[60:63], v[36:39]
  v_mfma_f32_16x16x32_bf16 v[40:43], v[104:107], v[60:63], v[40:43]
  v_mfma_f32_16x16x32_bf16 v[44:47], v[108:111], v[60:63], v[44:47]
  buffer_load_dwordx4 v[56:59], v2, s[8:11], s38 offen offset:1024 sc1
  buffer_load_dwordx4 v[60:63], v2, s[8:11], s39 offen offset:1024 sc1
  ds_read_b128 v[96:99], v6 offset:256
  ds_read_b128 v[100:103], v6 offset:20736
  ds_read_b128 v[104:107], v6 offset:41216
  ds_read_b128 v[108:111], v6 offset:61696
  s_waitcnt vmcnt(6) lgkmcnt(4)
  v_mfma_f32_16x16x32_bf16 v[16:19], v[80:83], v[64:67], v[16:19]
  v_mfma_f32_16x16x32_bf16 v[20:23], v[84:87], v[64:67], v[20:23]
  v_mfma_f32_16x16x32_bf16 v[24:27], v[88:91], v[64:67], v[24:27]
  v_mfma_f32_16x16x32_bf16 v[28:31], v[92:95], v[64:67], v[28:31]
  v_mfma_f32_16x16x32_bf16 v[32:35], v[80:83], v[68:71], v[32:35]
  v_mfma_f32_16x16x32_bf16 v[36:39], v[84:87], v[68:71], v[36:39]
  v_mfma_f32_16x16x32_bf16 v[40:43], v[88:91], v[68:71], v[40:43]
  v_mfma_f32_16x16x32_bf16 v[44:47], v[92:95], v[68:71], v[44:47]
  buffer_load_dwordx4 v[64:67], v2, s[8:11], s38 offen offset:2048 sc1
  buffer_load_dwordx4 v[68:71], v2, s[8:11], s39 offen offset:2048 sc1
  ds_read_b128 v[80:83], v3 offset:512
  ds_read_b128 v[84:87], v3 offset:20992
  ds_read_b128 v[88:91], v3 offset:41472
  ds_read_b128 v[92:95], v3 offset:61952
  s_waitcnt vmcnt(6) lgkmcnt(4)
  v_mfma_f32_16x16x32_bf16 v[16:19], v[96:99], v[72:75], v[16:19]
  v_mfma_f32_16x16x32_bf16 v[20:23], v[100:103], v[72:75], v[20:23]
  v_mfma_f32_16x16x32_bf16 v[24:27], v[104:107], v[72:75], v[24:27]
  v_mfma_f32_16x16x32_bf16 v[28:31], v[108:111], v[72:75], v[28:31]
  v_mfma_f32_16x16x32_bf16 v[32:35], v[96:99], v[76:79], v[32:35]
  v_mfma_f32_16x16x32_bf16 v[36:39], v[100:103], v[76:79], v[36:39]
  v_mfma_f32_16x16x32_bf16 v[40:43], v[104:107], v[76:79], v[40:43]
  v_mfma_f32_16x16x32_bf16 v[44:47], v[108:111], v[76:79], v[44:47]
  buffer_load_dwordx4 v[72:75], v2, s[8:11], s38 offen offset:3072 sc1
  buffer_load_dwordx4 v[76:79], v2, s[8:11], s39 offen offset:3072 sc1
  s_add_u32 s38, s38, 4096
  s_add_u32 s39, s39, 4096
  ds_read_b128 v[96:99], v4 offset:512
  ds_read_b128 v[100:103], v4 offset:20992
  ds_read_b128 v[104:107], v4 offset:41472
  ds_read_b128 v[108:111], v4 offset:61952
  s_waitcnt vmcnt(6) lgkmcnt(4)
  v_mfma_f32_16x16x32_bf16 v[16:19], v[80:83], v[48:51], v[16:19]
  v_mfma_f32_16x16x32_bf16 v[20:23], v[84:87], v[48:51], v[20:23]
  v_mfma_f32_16x16x32_bf16 v[24:27], v[88:91], v[48:51], v[24:27]
  v_mfma_f32_16x16x32_bf16 v[28:31], v[92:95], v[48:51], v[28:31]
  v_mfma_f32_16x16x32_bf16 v[32:35], v[80:83], v[52:55], v[32:35]
  v_mfma_f32_16x16x32_bf16 v[36:39], v[84:87], v[52:55], v[36:39]
  v_mfma_f32_16x16x32_bf16 v[40:43], v[88:91], v[52:55], v[40:43]
  v_mfma_f32_16x16x32_bf16 v[44:47], v[92:95], v[52:55], v[44:47]
  buffer_load_dwordx4 v[48:51], v2, s[8:11], s38 offen offset:0 sc1
  buffer_load_dwordx4 v[52:55], v2, s[8:11], s39 offen offset:0 sc1
  ds_read_b128 v[80:83], v5 offset:512
  ds_read_b128 v[84:87], v5 offset:20992
  ds_read_b128 v[88:91], v5 offset:41472
  ds_read_b128 v[92:95], v5 offset:61952
  s_waitcnt vmcnt(6) lgkmcnt(4)
  v_mfma_f32_16x16x32_bf16 v[16:19], v[96:99], v[56:59], v[16:19]
  v_mfma_f32_16x16x32_bf16 v[20:23], v[100:103], v[56:59], v[20:23]
  v_mfma_f32_16x16x32_bf16 v[24:27], v[104:107], v[56:59], v[24:27]
  v_mfma_f32_16x16x32_bf16 v[28:31], v[108:111], v[56:59], v[28:31]
  v_mfma_f32_16x16x32_bf16 v[32:35], v[96:99], v[60:63], v[32:35]
  v_mfma_f32_16x16x32_bf16 v[36:39], v[100:103], v[60:63], v[36:39]
  v_mfma_f32_16x16x32_bf16 v[40:43], v[104:107], v[60:63], v[40:43]
  v_mfma_f32_16x16x32_bf16 v[44:47], v[108:111], v[60:63], v[44:47]
  buffer_load_dwordx4 v[56:59], v2, s[8:11], s38 offen offset:1024 sc1
  buffer_load_dwordx4 v[60:63], v2, s[8:11], s39 offen offset:1024 sc1
  ds_read_b128 v[96:99], v6 offset:512
  ds_read_b128 v[100:103], v6 offset:20992
  ds_read_b128 v[104:107], v6 offset:41472
  ds_read_b128 v[108:111], v6 offset:61952
  s_waitcnt vmcnt(6) lgkmcnt(4)
  v_mfma_f32_16x16x32_bf16 v[16:19], v[80:83], v[64:67], v[16:19]
  v_mfma_f32_16x16x32_bf16 v[20:23], v[84:87], v[64:67], v[20:23]
  v_mfma_f32_16x16x32_bf16 v[24:27], v[88:91], v[64:67], v[24:27]
  v_mfma_f32_16x16x32_bf16 v[28:31], v[92:95], v[64:67], v[28:31]
  v_mfma_f32_16x16x32_bf16 v[32:35], v[80:83], v[68:71], v[32:35]
  v_mfma_f32_16x16x32_bf16 v[36:39], v[84:87], v[68:71], v[36:39]
  v_mfma_f32_16x16x32_bf16 v[40:43], v[88:91], v[68:71], v[40:43]
  v_mfma_f32_16x16x32_bf16 v[44:47], v[92:95], v[68:71], v[44:47]
  buffer_load_dwordx4 v[64:67], v2, s[8:11], s38 offen offset:2048 sc1
  buffer_load_dwordx4 v[68:71], v2, s[8:11], s39 offen offset:2048 sc1
  ds_read_b128 v[80:83], v3 offset:768
  ds_read_b128 v[84:87], v3 offset:21248
  ds_read_b128 v[88:91], v3 offset:41728
  ds_read_b128 v[92:95], v3 offset:62208
  s_waitcnt vmcnt(6) lgkmcnt(4)
  v_mfma_f32_16x16x32_bf16 v[16:19], v[96:99], v[72:75], v[16:19]
  v_mfma_f32_16x16x32_bf16 v[20:23], v[100:103], v[72:75], v[20:23]
  v_mfma_f32_16x16x32_bf16 v[24:27], v[104:107], v[72:75], v[24:27]
  v_mfma_f32_16x16x32_bf16 v[28:31], v[108:111], v[72:75], v[28:31]
  v_mfma_f32_16x16x32_bf16 v[32:35], v[96:99], v[76:79], v[32:35]
  v_mfma_f32_16x16x32_bf16 v[36:39], v[100:103], v[76:79], v[36:39]
  v_mfma_f32_16x16x32_bf16 v[40:43], v[104:107], v[76:79], v[40:43]
  v_mfma_f32_16x16x32_bf16 v[44:47], v[108:111], v[76:79], v[44:47]
  buffer_load_dwordx4 v[72:75], v2, s[8:11], s38 offen offset:3072 sc1
  buffer_load_dwordx4 v[76:79], v2, s[8:11], s39 offen offset:3072 sc1
  s_add_u32 s38, s38, 4096
  s_add_u32 s39, s39, 4096
  ds_read_b128 v[96:99], v4 offset:768
  ds_read_b128 v[100:103], v4 offset:21248
  ds_read_b128 v[104:107], v4 offset:41728
  ds_read_b128 v[108:111], v4 offset:62208
  s_waitcnt vmcnt(6) lgkmcnt(4)
  v_mfma_f32_16x16x32_bf16 v[16:19], v[80:83], v[48:51], v[16:19]
  v_mfma_f32_16x16x32_bf16 v[20:23], v[84:87], v[48:51], v[20:23]
  v_mfma_f32_16x16x32_bf16 v[24:27], v[88:91], v[48:51], v[24:27]
  v_mfma_f32_16x16x32_bf16 v[28:31], v[92:95], v[48:51], v[28:31]
  v_mfma_f32_16x16x32_bf16 v[32:35], v[80:83], v[52:55], v[32:35]
  v_mfma_f32_16x16x32_bf16 v[36:39], v[84:87], v[52:55], v[36:39]
  v_mfma_f32_16x16x32_bf16 v[40:43], v[88:91], v[52:55], v[40:43]
  v_mfma_f32_16x16x32_bf16 v[44:47], v[92:95], v[52:55], v[44:47]
  buffer_load_dwordx4 v[48:51], v2, s[8:11], s38 offen offset:0 sc1
  buffer_load_dwordx4 v[52:55], v2, s[8:11], s39 offen offset:0 sc1
  ds_read_b128 v[80:83], v5 offset:768
  ds_read_b128 v[84:87], v5 offset:21248
  ds_read_b128 v[88:91], v5 offset:41728
  ds_read_b128 v[92:95], v5 offset:62208
  s_waitcnt vmcnt(6) lgkmcnt(4)
  v_mfma_f32_16x16x32_bf16 v[16:19], v[96:99], v[56:59], v[16:19]
  v_mfma_f32_16x16x32_bf16 v[20:23], v[100:103], v[56:59], v[20:23]
  v_mfma_f32_16x16x32_bf16 v[24:27], v[104:107], v[56:59], v[24:27]
  v_mfma_f32_16x16x32_bf16 v[28:31], v[108:111], v[56:59], v[28:31]
  v_mfma_f32_16x16x32_bf16 v[32:35], v[96:99], v[60:63], v[32:35]
  v_mfma_f32_16x16x32_bf16 v[36:39], v[100:103], v[60:63], v[36:39]
  v_mfma_f32_16x16x32_bf16 v[40:43], v[104:107], v[60:63], v[40:43]
  v_mfma_f32_16x16x32_bf16 v[44:47], v[108:111], v[60:63], v[44:47]
  buffer_load_dwordx4 v[56:59], v2, s[8:11], s38 offen offset:1024 sc1
  buffer_load_dwordx4 v[60:63], v2, s[8:11], s39 offen offset:1024 sc1
  ds_read_b128 v[96:99], v6 offset:768
  ds_read_b128 v[100:103], v6 offset:21248
  ds_read_b128 v[104:107], v6 offset:41728
  ds_read_b128 v[108:111], v6 offset:62208
  s_waitcnt vmcnt(6) lgkmcnt(4)
  v_mfma_f32_16x16x32_bf16 v[16:19], v[80:83], v[64:67], v[16:19]
  v_mfma_f32_16x16x32_bf16 v[20:23], v[84:87], v[64:67], v[20:23]
  v_mfma_f32_16x16x32_bf16 v[24:27], v[88:91], v[64:67], v[24:27]
  v_mfma_f32_16x16x32_bf16 v[28:31], v[92:95], v[64:67], v[28:31]
  v_mfma_f32_16x16x32_bf16 v[32:35], v[80:83], v[68:71], v[32:35]
  v_mfma_f32_16x16x32_bf16 v[36:39], v[84:87], v[68:71], v[36:39]
  v_mfma_f32_16x16x32_bf16 v[40:43], v[88:91], v[68:71], v[40:43]
  v_mfma_f32_16x16x32_bf16 v[44:47], v[92:95], v[68:71], v[44:47]
  buffer_load_dwordx4 v[64:67], v2, s[8:11], s38 offen offset:2048 sc1
  buffer_load_dwordx4 v[68:71], v2, s[8:11], s39 offen offset:2048 sc1
  ds_read_b128 v[80:83], v3 offset:1024
  ds_read_b128 v[84:87], v3 offset:21504
  ds_read_b128 v[88:91], v3 offset:41984
  ds_read_b128 v[92:95], v3 offset:62464
  s_waitcnt vmcnt(6) lgkmcnt(4)
  v_mfma_f32_16x16x32_bf16 v[16:19], v[96:99], v[72:75], v[16:19]
  v_mfma_f32_16x16x32_bf16 v[20:23], v[100:103], v[72:75], v[20:23]
  v_mfma_f32_16x16x32_bf16 v[24:27], v[104:107], v[72:75], v[24:27]
  v_mfma_f32_16x16x32_bf16 v[28:31], v[108:111], v[72:75], v[28:31]
  v_mfma_f32_16x16x32_bf16 v[32:35], v[96:99], v[76:79], v[32:35]
  v_mfma_f32_16x16x32_bf16 v[36:39], v[100:103], v[76:79], v[36:39]
  v_mfma_f32_16x16x32_bf16 v[40:43], v[104:107], v[76:79], v[40:43]
  v_mfma_f32_16x16x32_bf16 v[44:47], v[108:111], v[76:79], v[44:47]
  buffer_load_dwordx4 v[72:75], v2, s[8:11], s38 offen offset:3072 sc1
  buffer_load_dwordx4 v[76:79], v2, s[8:11], s39 offen offset:3072 sc1
  s_add_u32 s38, s38, 4096
  s_add_u32 s39, s39, 4096
  ds_read_b128 v[96:99], v4 offset:1024
  ds_read_b128 v[100:103], v4 offset:21504
  ds_read_b128 v[104:107], v4 offset:41984
  ds_read_b128 v[108:111], v4 offset:62464
  s_waitcnt vmcnt(6) lgkmcnt(4)
  v_mfma_f32_16x16x32_bf16 v[16:19], v[80:83], v[48:51], v[16:19]
  v_mfma_f32_16x16x32_bf16 v[20:23], v[84:87], v[48:51], v[20:23]
  v_mfma_f32_16x16x32_bf16 v[24:27], v[88:91], v[48:51], v[24:27]
  v_mfma_f32_16x16x32_bf16 v[28:31], v[92:95], v[48:51], v[28:31]
  v_mfma_f32_16x16x32_bf16 v[32:35], v[80:83], v[52:55], v[32:35]
  v_mfma_f32_16x16x32_bf16 v[36:39], v[84:87], v[52:55], v[36:39]
  v_mfma_f32_16x16x32_bf16 v[40:43], v[88:91], v[52:55], v[40:43]
  v_mfma_f32_16x16x32_bf16 v[44:47], v[92:95], v[52:55], v[44:47]
  ds_read_b128 v[80:83], v5 offset:1024
  ds_read_b128 v[84:87], v5 offset:21504
  ds_read_b128 v[88:91], v5 offset:41984
  ds_read_b128 v[92:95], v5 offset:62464
  s_waitcnt vmcnt(4) lgkmcnt(4)
  v_mfma_f32_16x16x32_bf16 v[16:19], v[96:99], v[56:59], v[16:19]
  v_mfma_f32_16x16x32_bf16 v[20:23], v[100:103], v[56:59], v[20:23]
  v_mfma_f32_16x16x32_bf16 v[24:27], v[104:107], v[56:59], v[24:27]
  v_mfma_f32_16x16x32_bf16 v[28:31], v[108:111], v[56:59], v[28:31]
  v_mfma_f32_16x16x32_bf16 v[32:35], v[96:99], v[60:63], v[32:35]
  v_mfma_f32_16x16x32_bf16 v[36:39], v[100:103], v[60:63], v[36:39]
  v_mfma_f32_16x16x32_bf16 v[40:43], v[104:107], v[60:63], v[40:43]
  v_mfma_f32_16x16x32_bf16 v[44:47], v[108:111], v[60:63], v[44:47]
  ds_read_b128 v[96:99], v6 offset:1024
  ds_read_b128 v[100:103], v6 offset:21504
  ds_read_b128 v[104:107], v6 offset:41984
  ds_read_b128 v[108:111], v6 offset:62464
  s_waitcnt vmcnt(2) lgkmcnt(4)
  v_mfma_f32_16x16x32_bf16 v[16:19], v[80:83], v[64:67], v[16:19]
  v_mfma_f32_16x16x32_bf16 v[20:23], v[84:87], v[64:67], v[20:23]
  v_mfma_f32_16x16x32_bf16 v[24:27], v[88:91], v[64:67], v[24:27]
  v_mfma_f32_16x16x32_bf16 v[28:31], v[92:95], v[64:67], v[28:31]
  v_mfma_f32_16x16x32_bf16 v[32:35], v[80:83], v[68:71], v[32:35]
  v_mfma_f32_16x16x32_bf16 v[36:39], v[84:87], v[68:71], v[36:39]
  v_mfma_f32_16x16x32_bf16 v[40:43], v[88:91], v[68:71], v[40:43]
  v_mfma_f32_16x16x32_bf16 v[44:47], v[92:95], v[68:71], v[44:47]
  s_waitcnt vmcnt(0) lgkmcnt(0)
  v_mfma_f32_16x16x32_bf16 v[16:19], v[96:99], v[72:75], v[16:19]
  v_mfma_f32_16x16x32_bf16 v[20:23], v[100:103], v[72:75], v[20:23]
  v_mfma_f32_16x16x32_bf16 v[24:27], v[104:107], v[72:75], v[24:27]
  v_mfma_f32_16x16x32_bf16 v[28:31], v[108:111], v[72:75], v[28:31]
  v_mfma_f32_16x16x32_bf16 v[32:35], v[96:99], v[76:79], v[32:35]
  v_mfma_f32_16x16x32_bf16 v[36:39], v[100:103], v[76:79], v[36:39]
  v_mfma_f32_16x16x32_bf16 v[40:43], v[104:107], v[76:79], v[40:43]
  v_mfma_f32_16x16x32_bf16 v[44:47], v[108:111], v[76:79], v[44:47]
  s_nop 7
  s_nop 1
  v_cvt_pk_bf16_f32 v244, v16, v17
  v_lshlrev_b32 v245, 16, v244
  v_and_b32 v246, 0xffff0000, v244
  v_mul_f32 v247, s34, v245
  v_mul_f32 v248, s34, v246
  v_exp_f32 v247, v247
  v_exp_f32 v248, v248
  v_cmp_lt_f32 vcc, 0, v245
  v_add_f32 v245, 1.0, v245
  v_cmp_lt_f32 s[36:37], 0, v246
  v_cndmask_b32 v245, v247, v245, vcc
  v_add_f32 v246, 1.0, v246
  s_nop 0
  v_cndmask_b32 v246, v248, v246, s[36:37]
  v_cvt_pk_bf16_f32 v244, v245, v246
  v_lshlrev_b32 v245, 16, v244
  v_and_b32 v246, 0xffff0000, v244
  v_add_f32 v245, s35, v245
  v_add_f32 v246, s35, v246
  v_cvt_pk_bf16_f32 v152, v245, v246
  v_cvt_pk_bf16_f32 v250, v18, v19
  v_lshlrev_b32 v251, 16, v250
  v_and_b32 v252, 0xffff0000, v250
  v_mul_f32 v253, s34, v251
  v_mul_f32 v254, s34, v252
  v_exp_f32 v253, v253
  v_exp_f32 v254, v254
  v_cmp_lt_f32 vcc, 0, v251
  v_add_f32 v251, 1.0, v251
  v_cmp_lt_f32 s[36:37], 0, v252
  v_cndmask_b32 v251, v253, v251, vcc
  v_add_f32 v252, 1.0, v252
  s_nop 0
  v_cndmask_b32 v252, v254, v252, s[36:37]
  v_cvt_pk_bf16_f32 v250, v251, v252
  v_lshlrev_b32 v251, 16, v250
  v_and_b32 v252, 0xffff0000, v250
  v_add_f32 v251, s35, v251
  v_add_f32 v252, s35, v252
  v_cvt_pk_bf16_f32 v153, v251, v252
  v_cvt_pk_bf16_f32 v244, v20, v21
  v_lshlrev_b32 v245, 16, v244
  v_and_b32 v246, 0xffff0000, v244
  v_mul_f32 v247, s34, v245
  v_mul_f32 v248, s34, v246
  v_exp_f32 v247, v247
  v_exp_f32 v248, v248
  v_cmp_lt_f32 vcc, 0, v245
  v_add_f32 v245, 1.0, v245
  v_cmp_lt_f32 s[36:37], 0, v246
  v_cndmask_b32 v245, v247, v245, vcc
  v_add_f32 v246, 1.0, v246
  s_nop 0
  v_cndmask_b32 v246, v248, v246, s[36:37]
  v_cvt_pk_bf16_f32 v244, v245, v246
  v_lshlrev_b32 v245, 16, v244
  v_and_b32 v246, 0xffff0000, v244
  v_add_f32 v245, s35, v245
  v_add_f32 v246, s35, v246
  v_cvt_pk_bf16_f32 v154, v245, v246
  v_cvt_pk_bf16_f32 v250, v22, v23
  v_lshlrev_b32 v251, 16, v250
  v_and_b32 v252, 0xffff0000, v250
  v_mul_f32 v253, s34, v251
  v_mul_f32 v254, s34, v252
  v_exp_f32 v253, v253
  v_exp_f32 v254, v254
  v_cmp_lt_f32 vcc, 0, v251
  v_add_f32 v251, 1.0, v251
  v_cmp_lt_f32 s[36:37], 0, v252
  v_cndmask_b32 v251, v253, v251, vcc
  v_add_f32 v252, 1.0, v252
  s_nop 0
  v_cndmask_b32 v252, v254, v252, s[36:37]
  v_cvt_pk_bf16_f32 v250, v251, v252
  v_lshlrev_b32 v251, 16, v250
  v_and_b32 v252, 0xffff0000, v250
  v_add_f32 v251, s35, v251
  v_add_f32 v252, s35, v252
  v_cvt_pk_bf16_f32 v155, v251, v252
  v_cvt_pk_bf16_f32 v244, v24, v25
  v_lshlrev_b32 v245, 16, v244
  v_and_b32 v246, 0xffff0000, v244
  v_mul_f32 v247, s34, v245
  v_mul_f32 v248, s34, v246
  v_exp_f32 v247, v247
  v_exp_f32 v248, v248
  v_cmp_lt_f32 vcc, 0, v245
  v_add_f32 v245, 1.0, v245
  v_cmp_lt_f32 s[36:37], 0, v246
  v_cndmask_b32 v245, v247, v245, vcc
  v_add_f32 v246, 1.0, v246
  s_nop 0
  v_cndmask_b32 v246, v248, v246, s[36:37]
  v_cvt_pk_bf16_f32 v244, v245, v246
  v_lshlrev_b32 v245, 16, v244
  v_and_b32 v246, 0xffff0000, v244
  v_add_f32 v245, s35, v245
  v_add_f32 v246, s35, v246
  v_cvt_pk_bf16_f32 v156, v245, v246
  v_cvt_pk_bf16_f32 v250, v26, v27
  v_lshlrev_b32 v251, 16, v250
  v_and_b32 v252, 0xffff0000, v250
  v_mul_f32 v253, s34, v251
  v_mul_f32 v254, s34, v252
  v_exp_f32 v253, v253
  v_exp_f32 v254, v254
  v_cmp_lt_f32 vcc, 0, v251
  v_add_f32 v251, 1.0, v251
  v_cmp_lt_f32 s[36:37], 0, v252
  v_cndmask_b32 v251, v253, v251, vcc
  v_add_f32 v252, 1.0, v252
  s_nop 0
  v_cndmask_b32 v252, v254, v252, s[36:37]
  v_cvt_pk_bf16_f32 v250, v251, v252
  v_lshlrev_b32 v251, 16, v250
  v_and_b32 v252, 0xffff0000, v250
  v_add_f32 v251, s35, v251
  v_add_f32 v252, s35, v252
  v_cvt_pk_bf16_f32 v157, v251, v252
  v_cvt_pk_bf16_f32 v244, v28, v29
  v_lshlrev_b32 v245, 16, v244
  v_and_b32 v246, 0xffff0000, v244
  v_mul_f32 v247, s34, v245
  v_mul_f32 v248, s34, v246
  v_exp_f32 v247, v247
  v_exp_f32 v248, v248
  v_cmp_lt_f32 vcc, 0, v245
  v_add_f32 v245, 1.0, v245
  v_cmp_lt_f32 s[36:37], 0, v246
  v_cndmask_b32 v245, v247, v245, vcc
  v_add_f32 v246, 1.0, v246
  s_nop 0
  v_cndmask_b32 v246, v248, v246, s[36:37]
  v_cvt_pk_bf16_f32 v244, v245, v246
  v_lshlrev_b32 v245, 16, v244
  v_and_b32 v246, 0xffff0000, v244
  v_add_f32 v245, s35, v245
  v_add_f32 v246, s35, v246
  v_cvt_pk_bf16_f32 v158, v245, v246
  v_cvt_pk_bf16_f32 v250, v30, v31
  v_lshlrev_b32 v251, 16, v250
  v_and_b32 v252, 0xffff0000, v250
  v_mul_f32 v253, s34, v251
  v_mul_f32 v254, s34, v252
  v_exp_f32 v253, v253
  v_exp_f32 v254, v254
  v_cmp_lt_f32 vcc, 0, v251
  v_add_f32 v251, 1.0, v251
  v_cmp_lt_f32 s[36:37], 0, v252
  v_cndmask_b32 v251, v253, v251, vcc
  v_add_f32 v252, 1.0, v252
  s_nop 0
  v_cndmask_b32 v252, v254, v252, s[36:37]
  v_cvt_pk_bf16_f32 v250, v251, v252
  v_lshlrev_b32 v251, 16, v250
  v_and_b32 v252, 0xffff0000, v250
  v_add_f32 v251, s35, v251
  v_add_f32 v252, s35, v252
  v_cvt_pk_bf16_f32 v159, v251, v252
  s_nop 1
  v_mfma_f32_16x16x32_bf16 v[200:203], v[152:155], v[128:131], v[200:203]
  v_mfma_f32_16x16x32_bf16 v[204:207], v[152:155], v[136:139], v[204:207]
  v_mfma_f32_16x16x32_bf16 v[208:211], v[152:155], v[144:147], v[208:211]
  v_mfma_f32_16x16x32_bf16 v[232:235], v[152:155], v[240:243], v[232:235]
  v_mfma_f32_16x16x32_bf16 v[200:203], v[156:159], v[132:135], v[200:203]
  v_mfma_f32_16x16x32_bf16 v[204:207], v[156:159], v[140:143], v[204:207]
  v_mfma_f32_16x16x32_bf16 v[208:211], v[156:159], v[148:151], v[208:211]
  v_mfma_f32_16x16x32_bf16 v[232:235], v[156:159], v[240:243], v[232:235]
  v_cvt_pk_bf16_f32 v244, v32, v33
  v_lshlrev_b32 v245, 16, v244
  v_and_b32 v246, 0xffff0000, v244
  v_mul_f32 v247, s34, v245
  v_mul_f32 v248, s34, v246
  v_exp_f32 v247, v247
  v_exp_f32 v248, v248
  v_cmp_lt_f32 vcc, 0, v245
  v_add_f32 v245, 1.0, v245
  v_cmp_lt_f32 s[36:37], 0, v246
  v_cndmask_b32 v245, v247, v245, vcc
  v_add_f32 v246, 1.0, v246
  s_nop 0
  v_cndmask_b32 v246, v248, v246, s[36:37]
  v_cvt_pk_bf16_f32 v244, v245, v246
  v_lshlrev_b32 v245, 16, v244
  v_and_b32 v246, 0xffff0000, v244
  v_add_f32 v245, s35, v245
  v_add_f32 v246, s35, v246
  v_cvt_pk_bf16_f32 v160, v245, v246
  v_cvt_pk_bf16_f32 v250, v34, v35
  v_lshlrev_b32 v251, 16, v250
  v_and_b32 v252, 0xffff0000, v250
  v_mul_f32 v253, s34, v251
  v_mul_f32 v254, s34, v252
  v_exp_f32 v253, v253
  v_exp_f32 v254, v254
  v_cmp_lt_f32 vcc, 0, v251
  v_add_f32 v251, 1.0, v251
  v_cmp_lt_f32 s[36:37], 0, v252
  v_cndmask_b32 v251, v253, v251, vcc
  v_add_f32 v252, 1.0, v252
  s_nop 0
  v_cndmask_b32 v252, v254, v252, s[36:37]
  v_cvt_pk_bf16_f32 v250, v251, v252
  v_lshlrev_b32 v251, 16, v250
  v_and_b32 v252, 0xffff0000, v250
  v_add_f32 v251, s35, v251
  v_add_f32 v252, s35, v252
  v_cvt_pk_bf16_f32 v161, v251, v252
  v_cvt_pk_bf16_f32 v244, v36, v37
  v_lshlrev_b32 v245, 16, v244
  v_and_b32 v246, 0xffff0000, v244
  v_mul_f32 v247, s34, v245
  v_mul_f32 v248, s34, v246
  v_exp_f32 v247, v247
  v_exp_f32 v248, v248
  v_cmp_lt_f32 vcc, 0, v245
  v_add_f32 v245, 1.0, v245
  v_cmp_lt_f32 s[36:37], 0, v246
  v_cndmask_b32 v245, v247, v245, vcc
  v_add_f32 v246, 1.0, v246
  s_nop 0
  v_cndmask_b32 v246, v248, v246, s[36:37]
  v_cvt_pk_bf16_f32 v244, v245, v246
  v_lshlrev_b32 v245, 16, v244
  v_and_b32 v246, 0xffff0000, v244
  v_add_f32 v245, s35, v245
  v_add_f32 v246, s35, v246
  v_cvt_pk_bf16_f32 v162, v245, v246
  v_cvt_pk_bf16_f32 v250, v38, v39
  v_lshlrev_b32 v251, 16, v250
  v_and_b32 v252, 0xffff0000, v250
  v_mul_f32 v253, s34, v251
  v_mul_f32 v254, s34, v252
  v_exp_f32 v253, v253
  v_exp_f32 v254, v254
  v_cmp_lt_f32 vcc, 0, v251
  v_add_f32 v251, 1.0, v251
  v_cmp_lt_f32 s[36:37], 0, v252
  v_cndmask_b32 v251, v253, v251, vcc
  v_add_f32 v252, 1.0, v252
  s_nop 0
  v_cndmask_b32 v252, v254, v252, s[36:37]
  v_cvt_pk_bf16_f32 v250, v251, v252
  v_lshlrev_b32 v251, 16, v250
  v_and_b32 v252, 0xffff0000, v250
  v_add_f32 v251, s35, v251
  v_add_f32 v252, s35, v252
  v_cvt_pk_bf16_f32 v163, v251, v252
  v_cvt_pk_bf16_f32 v244, v40, v41
  v_lshlrev_b32 v245, 16, v244
  v_and_b32 v246, 0xffff0000, v244
  v_mul_f32 v247, s34, v245
  v_mul_f32 v248, s34, v246
  v_exp_f32 v247, v247
  v_exp_f32 v248, v248
  v_cmp_lt_f32 vcc, 0, v245
  v_add_f32 v245, 1.0, v245
  v_cmp_lt_f32 s[36:37], 0, v246
  v_cndmask_b32 v245, v247, v245, vcc
  v_add_f32 v246, 1.0, v246
  s_nop 0
  v_cndmask_b32 v246, v248, v246, s[36:37]
  v_cvt_pk_bf16_f32 v244, v245, v246
  v_lshlrev_b32 v245, 16, v244
  v_and_b32 v246, 0xffff0000, v244
  v_add_f32 v245, s35, v245
  v_add_f32 v246, s35, v246
  v_cvt_pk_bf16_f32 v164, v245, v246
  v_cvt_pk_bf16_f32 v250, v42, v43
  v_lshlrev_b32 v251, 16, v250
  v_and_b32 v252, 0xffff0000, v250
  v_mul_f32 v253, s34, v251
  v_mul_f32 v254, s34, v252
  v_exp_f32 v253, v253
  v_exp_f32 v254, v254
  v_cmp_lt_f32 vcc, 0, v251
  v_add_f32 v251, 1.0, v251
  v_cmp_lt_f32 s[36:37], 0, v252
  v_cndmask_b32 v251, v253, v251, vcc
  v_add_f32 v252, 1.0, v252
  s_nop 0
  v_cndmask_b32 v252, v254, v252, s[36:37]
  v_cvt_pk_bf16_f32 v250, v251, v252
  v_lshlrev_b32 v251, 16, v250
  v_and_b32 v252, 0xffff0000, v250
  v_add_f32 v251, s35, v251
  v_add_f32 v252, s35, v252
  v_cvt_pk_bf16_f32 v165, v251, v252
  v_cvt_pk_bf16_f32 v244, v44, v45
  v_lshlrev_b32 v245, 16, v244
  v_and_b32 v246, 0xffff0000, v244
  v_mul_f32 v247, s34, v245
  v_mul_f32 v248, s34, v246
  v_exp_f32 v247, v247
  v_exp_f32 v248, v248
  v_cmp_lt_f32 vcc, 0, v245
  v_add_f32 v245, 1.0, v245
  v_cmp_lt_f32 s[36:37], 0, v246
  v_cndmask_b32 v245, v247, v245, vcc
  v_add_f32 v246, 1.0, v246
  s_nop 0
  v_cndmask_b32 v246, v248, v246, s[36:37]
  v_cvt_pk_bf16_f32 v244, v245, v246
  v_lshlrev_b32 v245, 16, v244
  v_and_b32 v246, 0xffff0000, v244
  v_add_f32 v245, s35, v245
  v_add_f32 v246, s35, v246
  v_cvt_pk_bf16_f32 v166, v245, v246
  v_cvt_pk_bf16_f32 v250, v46, v47
  v_lshlrev_b32 v251, 16, v250
  v_and_b32 v252, 0xffff0000, v250
  v_mul_f32 v253, s34, v251
  v_mul_f32 v254, s34, v252
  v_exp_f32 v253, v253
  v_exp_f32 v254, v254
  v_cmp_lt_f32 vcc, 0, v251
  v_add_f32 v251, 1.0, v251
  v_cmp_lt_f32 s[36:37], 0, v252
  v_cndmask_b32 v251, v253, v251, vcc
  v_add_f32 v252, 1.0, v252
  s_nop 0
  v_cndmask_b32 v252, v254, v252, s[36:37]
  v_cvt_pk_bf16_f32 v250, v251, v252
  v_lshlrev_b32 v251, 16, v250
  v_and_b32 v252, 0xffff0000, v250
  v_add_f32 v251, s35, v251
  v_add_f32 v252, s35, v252
  v_cvt_pk_bf16_f32 v167, v251, v252
  s_nop 1
  v_mfma_f32_16x16x32_bf16 v[212:215], v[160:163], v[136:139], v[212:215]
  v_mfma_f32_16x16x32_bf16 v[216:219], v[160:163], v[144:147], v[216:219]
  v_mfma_f32_16x16x32_bf16 v[236:239], v[160:163], v[240:243], v[236:239]
  v_mfma_f32_16x16x32_bf16 v[212:215], v[164:167], v[140:143], v[212:215]
  v_mfma_f32_16x16x32_bf16 v[216:219], v[164:167], v[148:151], v[216:219]
  v_mfma_f32_16x16x32_bf16 v[236:239], v[164:167], v[240:243], v[236:239]
  s_mul_i32 s25, s29, 18432
  s_add_u32 s25, s25, 87162880
  s_nop 7
  buffer_store_dwordx4 v[168:171], v2, s[8:11], s25 offen offset:0 sc1
  buffer_store_dwordx4 v[172:175], v2, s[8:11], s25 offen offset:1024 sc1
  buffer_store_dwordx4 v[176:179], v2, s[8:11], s25 offen offset:2048 sc1
  buffer_store_dwordx4 v[180:183], v2, s[8:11], s25 offen offset:3072 sc1
  s_add_u32 s25, s25, 4096
  buffer_store_dwordx4 v[184:187], v2, s[8:11], s25 offen offset:0 sc1
  buffer_store_dwordx4 v[188:191], v2, s[8:11], s25 offen offset:1024 sc1
  buffer_store_dwordx4 v[192:195], v2, s[8:11], s25 offen offset:2048 sc1
  buffer_store_dwordx4 v[196:199], v2, s[8:11], s25 offen offset:3072 sc1
  s_add_u32 s25, s25, 4096
  buffer_store_dwordx4 v[200:203], v2, s[8:11], s25 offen offset:0 sc1
  buffer_store_dwordx4 v[204:207], v2, s[8:11], s25 offen offset:1024 sc1
  buffer_store_dwordx4 v[208:211], v2, s[8:11], s25 offen offset:2048 sc1
  buffer_store_dwordx4 v[212:215], v2, s[8:11], s25 offen offset:3072 sc1
  s_add_u32 s25, s25, 4096
  buffer_store_dwordx4 v[216:219], v2, s[8:11], s25 offen offset:0 sc1
  buffer_store_dwordx4 v[220:223], v2, s[8:11], s25 offen offset:1024 sc1
  buffer_store_dwordx4 v[224:227], v2, s[8:11], s25 offen offset:2048 sc1
  buffer_store_dwordx4 v[228:231], v2, s[8:11], s25 offen offset:3072 sc1
  s_add_u32 s25, s25, 4096
  buffer_store_dwordx4 v[232:235], v2, s[8:11], s25 offen offset:0 sc1
  buffer_store_dwordx4 v[236:239], v2, s[8:11], s25 offen offset:1024 sc1
  s_waitcnt vmcnt(0) lgkmcnt(0)
  s_barrier
  s_cmp_eq_u32 s3, 0
  s_cbranch_scc0 L_b_sync1_w
  v_mov_b32 v9, 1
  v_mov_b32 v10, 16448
  s_mov_b64 exec, 1
  buffer_atomic_add v9, v10, s[8:11], 0 offen
  s_mov_b64 exec, -1
L_b_sync1:
  buffer_load_dword v9, v10, s[8:11], 0 offen sc1
  s_waitcnt vmcnt(0)
  v_readfirstlane_b32 s25, v9
  s_nop 0
  s_cmp_ge_u32 s25, 32
  s_cbranch_scc1 L_b_sync1_w
  s_sleep 8
  s_add_u32 s24, s24, 1
  s_cmp_lt_u32 s24, 262144
  s_cbranch_scc1 L_b_sync1
L_b_sync1_w:
  s_barrier
  s_cmp_ge_u32 s29, 104
  s_cbranch_scc1 L_b_nored
  s_mul_i32 s25, s29, 5042
  s_lshr_b32 s25, s25, 16
  s_mul_i32 s26, s25, 13
  s_sub_u32 s26, s29, s26
  s_mov_b32 s40, 0x22211100
  s_mov_b32 s41, 0x44333
  s_mov_b32 s42, 0x32121010
  s_mov_b32 s43, 0x43432
  s_lshl_b32 s27, s26, 2
  s_lshr_b64 s[40:41], s[40:41], s27
  s_lshr_b64 s[42:43], s[42:43], s27
  s_and_b32 s40, s40, 15
  s_and_b32 s42, s42, 15
  s_mul_i32 s27, s25, 18
  s_add_u32 s28, s27, s26
  s_lshl_b32 s28, s28, 10
  s_add_u32 s44, s28, 87162880
  s_add_u32 s28, s27, s40
  s_add_u32 s28, s28, 13
  s_lshl_b32 s28, s28, 10
  s_add_u32 s45, s28, 87162880
  buffer_load_dwordx4 v[112:115], v2, s[8:11], s44 offen sc1
  s_add_u32 s44, s44, 147456
  buffer_load_dwordx4 v[116:119], v2, s[8:11], s44 offen sc1
  s_add_u32 s44, s44, 147456
  buffer_load_dwordx4 v[120:123], v2, s[8:11], s44 offen sc1
  s_add_u32 s44, s44, 147456
  buffer_load_dwordx4 v[124:127], v2, s[8:11], s44 offen sc1
  s_add_u32 s44, s44, 147456
  buffer_load_dwordx4 v[128:131], v2, s[8:11], s44 offen sc1
  s_add_u32 s44, s44, 147456
  buffer_load_dwordx4 v[132:135], v2, s[8:11], s44 offen sc1
  s_add_u32 s44, s44, 147456
  buffer_load_dwordx4 v[136:139], v2, s[8:11], s44 offen sc1
  s_add_u32 s44, s44, 147456
  buffer_load_dwordx4 v[140:143], v2, s[8:11], s44 offen sc1
  s_add_u32 s44, s44, 147456
  buffer_load_dwordx4 v[144:147], v2, s[8:11], s44 offen sc1
  s_add_u32 s44, s44, 147456
  buffer_load_dwordx4 v[148:151], v2, s[8:11], s44 offen sc1
  s_add_u32 s44, s44, 147456
  buffer_load_dwordx4 v[152:155], v2, s[8:11], s44 offen sc1
  s_add_u32 s44, s44, 147456
  buffer_load_dwordx4 v[156:159], v2, s[8:11], s44 offen sc1
  s_add_u32 s44, s44, 147456
  buffer_load_dwordx4 v[160:163], v2, s[8:11], s44 offen sc1
  s_add_u32 s44, s44, 147456
  buffer_load_dwordx4 v[164:167], v2, s[8:11], s44 offen sc1
  s_add_u32 s44, s44, 147456
  buffer_load_dwordx4 v[168:171], v2, s[8:11], s44 offen sc1
  s_add_u32 s44, s44, 147456
  buffer_load_dwordx4 v[172:175], v2, s[8:11], s44 offen sc1
  s_add_u32 s44, s44, 147456
  buffer_load_dwordx4 v[176:179], v2, s[8:11], s44 offen sc1
  s_add_u32 s44, s44, 147456
  buffer_load_dwordx4 v[180:183], v2, s[8:11], s44 offen sc1
  s_add_u32 s44, s44, 147456
  buffer_load_dwordx4 v[184:187], v2, s[8:11], s44 offen sc1
  s_add_u32 s44, s44, 147456
  buffer_load_dwordx4 v[188:191], v2, s[8:11], s44 offen sc1
  s_add_u32 s44, s44, 147456
  buffer_load_dwordx4 v[192:195], v2, s[8:11], s44 offen sc1
  s_add_u32 s44, s44, 147456
  buffer_load_dwordx4 v[196:199], v2, s[8:11], s44 offen sc1
  s_add_u32 s44, s44, 147456
  buffer_load_dwordx4 v[200:203], v2, s[8:11], s44 offen sc1
  s_add_u32 s44, s44, 147456
  buffer_load_dwordx4 v[204:207], v2, s[8:11], s44 offen sc1
  s_add_u32 s44, s44, 147456
  buffer_load_dwordx4 v[208:211], v2, s[8:11], s44 offen sc1
  s_add_u32 s44, s44, 147456
  buffer_load_dwordx4 v[212:215], v2, s[8:11], s44 offen sc1
  s_add_u32 s44, s44, 147456
  buffer_load_dwordx4 v[216:219], v2, s[8:11], s44 offen sc1
  s_add_u32 s44, s44, 147456
  buffer_load_dwordx4 v[220:223], v2, s[8:11], s44 offen sc1
  s_add_u32 s44, s44, 147456
  buffer_load_dwordx4 v[224:227], v2, s[8:11], s44 offen sc1
  s_add_u32 s44, s44, 147456
  buffer_load_dwordx4 v[228:231], v2, s[8:11], s44 offen sc1
  s_add_u32 s44, s44, 147456
  buffer_load_dwordx4 v[232:235], v2, s[8:11], s44 offen sc1
  s_add_u32 s44, s44, 147456
  buffer_load_dwordx4 v[236:239], v2, s[8:11], s44 offen sc1
  s_waitcnt vmcnt(31)
  v_mov_b32 v16, v112
  v_mov_b32 v17, v113
  v_mov_b32 v18, v114
  v_mov_b32 v19, v115
  s_waitcnt vmcnt(30)
  v_add_f32 v16, v16, v116
  v_add_f32 v17, v17, v117
  v_add_f32 v18, v18, v118
  v_add_f32 v19, v19, v119
  s_waitcnt vmcnt(29)
  v_add_f32 v16, v16, v120
  v_add_f32 v17, v17, v121
  v_add_f32 v18, v18, v122
  v_add_f32 v19, v19, v123
  s_waitcnt vmcnt(28)
  v_add_f32 v16, v16, v124
  v_add_f32 v17, v17, v125
  v_add_f32 v18, v18, v126
  v_add_f32 v19, v19, v127
  s_waitcnt vmcnt(27)
  v_add_f32 v16, v16, v128
  v_add_f32 v17, v17, v129
  v_add_f32 v18, v18, v130
  v_add_f32 v19, v19, v131
  s_waitcnt vmcnt(26)
  v_add_f32 v16, v16, v132
  v_add_f32 v17, v17, v133
  v_add_f32 v18, v18, v134
  v_add_f32 v19, v19, v135
  s_waitcnt vmcnt(25)
  v_add_f32 v16, v16, v136
  v_add_f32 v17, v17, v137
  v_add_f32 v18, v18, v138
  v_add_f32 v19, v19, v139
  s_waitcnt vmcnt(24)
  v_add_f32 v16, v16, v140
  v_add_f32 v17, v17, v141
  v_add_f32 v18, v18, v142
  v_add_f32 v19, v19, v143
  s_waitcnt vmcnt(23)
  v_add_f32 v16, v16, v144
  v_add_f32 v17, v17, v145
  v_add_f32 v18, v18, v146
  v_add_f32 v19, v19, v147
  s_waitcnt vmcnt(22)
  v_add_f32 v16, v16, v148
  v_add_f32 v17, v17, v149
  v_add_f32 v18, v18, v150
  v_add_f32 v19, v19, v151
  s_waitcnt vmcnt(21)
  v_add_f32 v16, v16, v152
  v_add_f32 v17, v17, v153
  v_add_f32 v18, v18, v154
  v_add_f32 v19, v19, v155
  s_waitcnt vmcnt(20)
  v_add_f32 v16, v16, v156
  v_add_f32 v17, v17, v157
  v_add_f32 v18, v18, v158
  v_add_f32 v19, v19, v159
  s_waitcnt vmcnt(19)
  v_add_f32 v16, v16, v160
  v_add_f32 v17, v17, v161
  v_add_f32 v18, v18, v162
  v_add_f32 v19, v19, v163
  s_waitcnt vmcnt(18)
  v_add_f32 v16, v16, v164
  v_add_f32 v17, v17, v165
  v_add_f32 v18, v18, v166
  v_add_f32 v19, v19, v167
  s_waitcnt vmcnt(17)
  v_add_f32 v16, v16, v168
  v_add_f32 v17, v17, v169
  v_add_f32 v18, v18, v170
  v_add_f32 v19, v19, v171
  s_waitcnt vmcnt(16)
  v_add_f32 v16, v16, v172
  v_add_f32 v17, v17, v173
  v_add_f32 v18, v18, v174
  v_add_f32 v19, v19, v175
  s_waitcnt vmcnt(15)
  v_add_f32 v16, v16, v176
  v_add_f32 v17, v17, v177
  v_add_f32 v18, v18, v178
  v_add_f32 v19, v19, v179
  s_waitcnt vmcnt(14)
  v_add_f32 v16, v16, v180
  v_add_f32 v17, v17, v181
  v_add_f32 v18, v18, v182
  v_add_f32 v19, v19, v183
  s_waitcnt vmcnt(13)
  v_add_f32 v16, v16, v184
  v_add_f32 v17, v17, v185
  v_add_f32 v18, v18, v186
  v_add_f32 v19, v19, v187
  s_waitcnt vmcnt(12)
  v_add_f32 v16, v16, v188
  v_add_f32 v17, v17, v189
  v_add_f32 v18, v18, v190
  v_add_f32 v19, v19, v191
  s_waitcnt vmcnt(11)
  v_add_f32 v16, v16, v192
  v_add_f32 v17, v17, v193
  v_add_f32 v18, v18, v194
  v_add_f32 v19, v19, v195
  s_waitcnt vmcnt(10)
  v_add_f32 v16, v16, v196
  v_add_f32 v17, v17, v197
  v_add_f32 v18, v18, v198
  v_add_f32 v19, v19, v199
  s_waitcnt vmcnt(9)
  v_add_f32 v16, v16, v200
  v_add_f32 v17, v17, v201
  v_add_f32 v18, v18, v202
  v_add_f32 v19, v19, v203
  s_waitcnt vmcnt(8)
  v_add_f32 v16, v16, v204
  v_add_f32 v17, v17, v205
  v_add_f32 v18, v18, v206
  v_add_f32 v19, v19, v207
  s_waitcnt vmcnt(7)
  v_add_f32 v16, v16, v208
  v_add_f32 v17, v17, v209
  v_add_f32 v18, v18, v210
  v_add_f32 v19, v19, v211
  s_waitcnt vmcnt(6)
  v_add_f32 v16, v16, v212
  v_add_f32 v17, v17, v213
  v_add_f32 v18, v18, v214
  v_add_f32 v19, v19, v215
  s_waitcnt vmcnt(5)
  v_add_f32 v16, v16, v216
  v_add_f32 v17, v17, v217
  v_add_f32 v18, v18, v218
  v_add_f32 v19, v19, v219
  s_waitcnt vmcnt(4)
  v_add_f32 v16, v16, v220
  v_add_f32 v17, v17, v221
  v_add_f32 v18, v18, v222
  v_add_f32 v19, v19, v223
  s_waitcnt vmcnt(3)
  v_add_f32 v16, v16, v224
  v_add_f32 v17, v17, v225
  v_add_f32 v18, v18, v226
  v_add_f32 v19, v19, v227
  s_waitcnt vmcnt(2)
  v_add_f32 v16, v16, v228
  v_add_f32 v17, v17, v229
  v_add_f32 v18, v18, v230
  v_add_f32 v19, v19, v231
  s_waitcnt vmcnt(1)
  v_add_f32 v16, v16, v232
  v_add_f32 v17, v17, v233
  v_add_f32 v18, v18, v234
  v_add_f32 v19, v19, v235
  s_waitcnt vmcnt(0)
  v_add_f32 v16, v16, v236
  v_add_f32 v17, v17, v237
  v_add_f32 v18, v18, v238
  v_add_f32 v19, v19, v239
  buffer_load_dwordx4 v[112:115], v2, s[8:11], s45 offen sc1
  s_add_u32 s45, s45, 147456
  buffer_load_dwordx4 v[116:119], v2, s[8:11], s45 offen sc1
  s_add_u32 s45, s45, 147456
  buffer_load_dwordx4 v[120:123], v2, s[8:11], s45 offen sc1
  s_add_u32 s45, s45, 147456
  buffer_load_dwordx4 v[124:127], v2, s[8:11], s45 offen sc1
  s_add_u32 s45, s45, 147456
  buffer_load_dwordx4 v[128:131], v2, s[8:11], s45 offen sc1
  s_add_u32 s45, s45, 147456
  buffer_load_dwordx4 v[132:135], v2, s[8:11], s45 offen sc1
  s_add_u32 s45, s45, 147456
  buffer_load_dwordx4 v[136:139], v2, s[8:11], s45 offen sc1
  s_add_u32 s45, s45, 147456
  buffer_load_dwordx4 v[140:143], v2, s[8:11], s45 offen sc1
  s_add_u32 s45, s45, 147456
  buffer_load_dwordx4 v[144:147], v2, s[8:11], s45 offen sc1
  s_add_u32 s45, s45, 147456
  buffer_load_dwordx4 v[148:151], v2, s[8:11], s45 offen sc1
  s_add_u32 s45, s45, 147456
  buffer_load_dwordx4 v[152:155], v2, s[8:11], s45 offen sc1
  s_add_u32 s45, s45, 147456
  buffer_load_dwordx4 v[156:159], v2, s[8:11], s45 offen sc1
  s_add_u32 s45, s45, 147456
  buffer_load_dwordx4 v[160:163], v2, s[8:11], s45 offen sc1
  s_add_u32 s45, s45, 147456
  buffer_load_dwordx4 v[164:167], v2, s[8:11], s45 offen sc1
  s_add_u32 s45, s45, 147456
  buffer_load_dwordx4 v[168:171], v2, s[8:11], s45 offen sc1
  s_add_u32 s45, s45, 147456
  buffer_load_dwordx4 v[172:175], v2, s[8:11], s45 offen sc1
  s_add_u32 s45, s45, 147456
  buffer_load_dwordx4 v[176:179], v2, s[8:11], s45 offen sc1
  s_add_u32 s45, s45, 147456
  buffer_load_dwordx4 v[180:183], v2, s[8:11], s45 offen sc1
  s_add_u32 s45, s45, 147456
  buffer_load_dwordx4 v[184:187], v2, s[8:11], s45 offen sc1
  s_add_u32 s45, s45, 147456
  buffer_load_dwordx4 v[188:191], v2, s[8:11], s45 offen sc1
  s_add_u32 s45, s45, 147456
  buffer_load_dwordx4 v[192:195], v2, s[8:11], s45 offen sc1
  s_add_u32 s45, s45, 147456
  buffer_load_dwordx4 v[196:199], v2, s[8:11], s45 offen sc1
  s_add_u32 s45, s45, 147456
  buffer_load_dwordx4 v[200:203], v2, s[8:11], s45 offen sc1
  s_add_u32 s45, s45, 147456
  buffer_load_dwordx4 v[204:207], v2, s[8:11], s45 offen sc1
  s_add_u32 s45, s45, 147456
  buffer_load_dwordx4 v[208:211], v2, s[8:11], s45 offen sc1
  s_add_u32 s45, s45, 147456
  buffer_load_dwordx4 v[212:215], v2, s[8:11], s45 offen sc1
  s_add_u32 s45, s45, 147456
  buffer_load_dwordx4 v[216:219], v2, s[8:11], s45 offen sc1
  s_add_u32 s45, s45, 147456
  buffer_load_dwordx4 v[220:223], v2, s[8:11], s45 offen sc1
  s_add_u32 s45, s45, 147456
  buffer_load_dwordx4 v[224:227], v2, s[8:11], s45 offen sc1
  s_add_u32 s45, s45, 147456
  buffer_load_dwordx4 v[228:231], v2, s[8:11], s45 offen sc1
  s_add_u32 s45, s45, 147456
  buffer_load_dwordx4 v[232:235], v2, s[8:11], s45 offen sc1
  s_add_u32 s45, s45, 147456
  buffer_load_dwordx4 v[236:239], v2, s[8:11], s45 offen sc1
  s_waitcnt vmcnt(31)
  v_mov_b32 v20, v112
  v_mov_b32 v21, v113
  v_mov_b32 v22, v114
  v_mov_b32 v23, v115
  s_waitcnt vmcnt(30)
  v_add_f32 v20, v20, v116
  v_add_f32 v21, v21, v117
  v_add_f32 v22, v22, v118
  v_add_f32 v23, v23, v119
  s_waitcnt vmcnt(29)
  v_add_f32 v20, v20, v120
  v_add_f32 v21, v21, v121
  v_add_f32 v22, v22, v122
  v_add_f32 v23, v23, v123
  s_waitcnt vmcnt(28)
  v_add_f32 v20, v20, v124
  v_add_f32 v21, v21, v125
  v_add_f32 v22, v22, v126
  v_add_f32 v23, v23, v127
  s_waitcnt vmcnt(27)
  v_add_f32 v20, v20, v128
  v_add_f32 v21, v21, v129
  v_add_f32 v22, v22, v130
  v_add_f32 v23, v23, v131
  s_waitcnt vmcnt(26)
  v_add_f32 v20, v20, v132
  v_add_f32 v21, v21, v133
  v_add_f32 v22, v22, v134
  v_add_f32 v23, v23, v135
  s_waitcnt vmcnt(25)
  v_add_f32 v20, v20, v136
  v_add_f32 v21, v21, v137
  v_add_f32 v22, v22, v138
  v_add_f32 v23, v23, v139
  s_waitcnt vmcnt(24)
  v_add_f32 v20, v20, v140
  v_add_f32 v21, v21, v141
  v_add_f32 v22, v22, v142
  v_add_f32 v23, v23, v143
  s_waitcnt vmcnt(23)
  v_add_f32 v20, v20, v144
  v_add_f32 v21, v21, v145
  v_add_f32 v22, v22, v146
  v_add_f32 v23, v23, v147
  s_waitcnt vmcnt(22)
  v_add_f32 v20, v20, v148
  v_add_f32 v21, v21, v149
  v_add_f32 v22, v22, v150
  v_add_f32 v23, v23, v151
  s_waitcnt vmcnt(21)
  v_add_f32 v20, v20, v152
  v_add_f32 v21, v21, v153
  v_add_f32 v22, v22, v154
  v_add_f32 v23, v23, v155
  s_waitcnt vmcnt(20)
  v_add_f32 v20, v20, v156
  v_add_f32 v21, v21, v157
  v_add_f32 v22, v22, v158
  v_add_f32 v23, v23, v159
  s_waitcnt vmcnt(19)
  v_add_f32 v20, v20, v160
  v_add_f32 v21, v21, v161
  v_add_f32 v22, v22, v162
  v_add_f32 v23, v23, v163
  s_waitcnt vmcnt(18)
  v_add_f32 v20, v20, v164
  v_add_f32 v21, v21, v165
  v_add_f32 v22, v22, v166
  v_add_f32 v23, v23, v167
  s_waitcnt vmcnt(17)
  v_add_f32 v20, v20, v168
  v_add_f32 v21, v21, v169
  v_add_f32 v22, v22, v170
  v_add_f32 v23, v23, v171
  s_waitcnt vmcnt(16)
  v_add_f32 v20, v20, v172
  v_add_f32 v21, v21, v173
  v_add_f32 v22, v22, v174
  v_add_f32 v23, v23, v175
  s_waitcnt vmcnt(15)
  v_add_f32 v20, v20, v176
  v_add_f32 v21, v21, v177
  v_add_f32 v22, v22, v178
  v_add_f32 v23, v23, v179
  s_waitcnt vmcnt(14)
  v_add_f32 v20, v20, v180
  v_add_f32 v21, v21, v181
  v_add_f32 v22, v22, v182
  v_add_f32 v23, v23, v183
  s_waitcnt vmcnt(13)
  v_add_f32 v20, v20, v184
  v_add_f32 v21, v21, v185
  v_add_f32 v22, v22, v186
  v_add_f32 v23, v23, v187
  s_waitcnt vmcnt(12)
  v_add_f32 v20, v20, v188
  v_add_f32 v21, v21, v189
  v_add_f32 v22, v22, v190
  v_add_f32 v23, v23, v191
  s_waitcnt vmcnt(11)
  v_add_f32 v20, v20, v192
  v_add_f32 v21, v21, v193
  v_add_f32 v22, v22, v194
  v_add_f32 v23, v23, v195
  s_waitcnt vmcnt(10)
  v_add_f32 v20, v20, v196
  v_add_f32 v21, v21, v197
  v_add_f32 v22, v22, v198
  v_add_f32 v23, v23, v199
  s_waitcnt vmcnt(9)
  v_add_f32 v20, v20, v200
  v_add_f32 v21, v21, v201
  v_add_f32 v22, v22, v202
  v_add_f32 v23, v23, v203
  s_waitcnt vmcnt(8)
  v_add_f32 v20, v20, v204
  v_add_f32 v21, v21, v205
  v_add_f32 v22, v22, v206
  v_add_f32 v23, v23, v207
  s_waitcnt vmcnt(7)
  v_add_f32 v20, v20, v208
  v_add_f32 v21, v21, v209
  v_add_f32 v22, v22, v210
  v_add_f32 v23, v23, v211
  s_waitcnt vmcnt(6)
  v_add_f32 v20, v20, v212
  v_add_f32 v21, v21, v213
  v_add_f32 v22, v22, v214
  v_add_f32 v23, v23, v215
  s_waitcnt vmcnt(5)
  v_add_f32 v20, v20, v216
  v_add_f32 v21, v21, v217
  v_add_f32 v22, v22, v218
  v_add_f32 v23, v23, v219
  s_waitcnt vmcnt(4)
  v_add_f32 v20, v20, v220
  v_add_f32 v21, v21, v221
  v_add_f32 v22, v22, v222
  v_add_f32 v23, v23, v223
  s_waitcnt vmcnt(3)
  v_add_f32 v20, v20, v224
  v_add_f32 v21, v21, v225
  v_add_f32 v22, v22, v226
  v_add_f32 v23, v23, v227
  s_waitcnt vmcnt(2)
  v_add_f32 v20, v20, v228
  v_add_f32 v21, v21, v229
  v_add_f32 v22, v22, v230
  v_add_f32 v23, v23, v231
  s_waitcnt vmcnt(1)
  v_add_f32 v20, v20, v232
  v_add_f32 v21, v21, v233
  v_add_f32 v22, v22, v234
  v_add_f32 v23, v23, v235
  s_waitcnt vmcnt(0)
  v_add_f32 v20, v20, v236
  v_add_f32 v21, v21, v237
  v_add_f32 v22, v22, v238
  v_add_f32 v23, v23, v239
  v_and_b32 v9, 15, v1
  s_lshl_b32 s42, s42, 4
  v_add_u32 v9, s42, v9
  v_mul_u32_u24 v9, 205, v9
  v_lshrrev_b32 v9, 12, v9
  v_lshrrev_b32 v10, 4, v1
  s_lshl_b32 s40, s40, 4
  v_lshl_add_u32 v10, v10, 2, s40
  v_add_u32 v11, 0, v10
  v_mul_u32_u24 v11, 205, v11
  v_lshrrev_b32 v11, 12, v11
  v_cmp_eq_u32 vcc, v11, v9
  s_nop 1
  v_cndmask_b32 v16, 0, v16, vcc
  v_cndmask_b32 v20, 0, v20, vcc
  v_add_u32 v11, 1, v10
  v_mul_u32_u24 v11, 205, v11
  v_lshrrev_b32 v11, 12, v11
  v_cmp_eq_u32 vcc, v11, v9
  s_nop 1
  v_cndmask_b32 v17, 0, v17, vcc
  v_cndmask_b32 v21, 0, v21, vcc
  v_add_u32 v11, 2, v10
  v_mul_u32_u24 v11, 205, v11
  v_lshrrev_b32 v11, 12, v11
  v_cmp_eq_u32 vcc, v11, v9
  s_nop 1
  v_cndmask_b32 v18, 0, v18, vcc
  v_cndmask_b32 v22, 0, v22, vcc
  v_add_u32 v11, 3, v10
  v_mul_u32_u24 v11, 205, v11
  v_lshrrev_b32 v11, 12, v11
  v_cmp_eq_u32 vcc, v11, v9
  s_nop 1
  v_cndmask_b32 v19, 0, v19, vcc
  v_cndmask_b32 v23, 0, v23, vcc
  v_cvt_pk_bf16_f32 v24, v16, v17
  v_cvt_pk_bf16_f32 v25, v18, v19
  v_cvt_pk_bf16_f32 v26, v20, v21
  v_cvt_pk_bf16_f32 v27, v22, v23
  s_lshl_b32 s25, s29, 10
  s_add_u32 s25, s25, 91881472
  buffer_store_dwordx4 v[24:27], v2, s[8:11], s25 offen sc1
L_b_nored:
  s_waitcnt vmcnt(0) lgkmcnt(0)
  s_barrier
  s_cmp_eq_u32 s3, 0
  s_cbranch_scc0 L_b_sync2_w
  v_mov_b32 v9, 1
  v_mov_b32 v10, 16512
  s_mov_b64 exec, 1
  buffer_atomic_add v9, v10, s[8:11], 0 offen
  s_mov_b64 exec, -1
L_b_sync2:
  buffer_load_dword v9, v10, s[8:11], 0 offen sc1
  s_waitcnt vmcnt(0)
  v_readfirstlane_b32 s25, v9
  s_nop 0
  s_cmp_ge_u32 s25, 32
  s_cbranch_scc1 L_b_sync2_w
  s_sleep 8
  s_add_u32 s24, s24, 1
  s_cmp_lt_u32 s24, 262144
  s_cbranch_scc1 L_b_sync2
L_b_sync2_w:
  s_barrier
  s_mul_i32 s25, s3, 13312
  s_add_u32 s25, s25, 91881472
  buffer_load_dwordx4 v[168:171], v2, s[8:11], s25 offen offset:0 sc1
  buffer_load_dwordx4 v[172:175], v2, s[8:11], s25 offen offset:1024 sc1
  buffer_load_dwordx4 v[176:179], v2, s[8:11], s25 offen offset:2048 sc1
  buffer_load_dwordx4 v[180:183], v2, s[8:11], s25 offen offset:3072 sc1
  s_add_u32 s25, s25, 4096
  buffer_load_dwordx4 v[184:187], v2, s[8:11], s25 offen offset:0 sc1
  buffer_load_dwordx4 v[188:191], v2, s[8:11], s25 offen offset:1024 sc1
  buffer_load_dwordx4 v[192:195], v2, s[8:11], s25 offen offset:2048 sc1
  buffer_load_dwordx4 v[196:199], v2, s[8:11], s25 offen offset:3072 sc1
  s_add_u32 s25, s25, 4096
  buffer_load_dwordx4 v[200:203], v2, s[8:11], s25 offen offset:0 sc1
  buffer_load_dwordx4 v[204:207], v2, s[8:11], s25 offen offset:1024 sc1
  buffer_load_dwordx4 v[208:211], v2, s[8:11], s25 offen offset:2048 sc1
  buffer_load_dwordx4 v[212:215], v2, s[8:11], s25 offen offset:3072 sc1
  s_add_u32 s25, s25, 4096
  buffer_load_dwordx4 v[216:219], v2, s[8:11], s25 offen offset:0 sc1
  s_mul_i32 s38, s3, 102400
  s_add_u32 s38, s38, 83886080
  s_mul_i32 s39, s3, 102400
  s_add_u32 s39, s39, 83906560
  buffer_load_dwordx4 v[48:51], v2, s[8:11], s38 offen offset:0 sc1
  buffer_load_dwordx4 v[52:55], v2, s[8:11], s39 offen offset:0 sc1
  buffer_load_dwordx4 v[56:59], v2, s[8:11], s38 offen offset:1024 sc1
  buffer_load_dwordx4 v[60:63], v2, s[8:11], s39 offen offset:1024 sc1
  buffer_load_dwordx4 v[64:67], v2, s[8:11], s38 offen offset:2048 sc1
  buffer_load_dwordx4 v[68:71], v2, s[8:11], s39 offen offset:2048 sc1
  ds_read_b128 v[80:83], v3 offset:0
  ds_read_b128 v[84:87], v3 offset:20480
  ds_read_b128 v[88:91], v3 offset:40960
  ds_read_b128 v[92:95], v3 offset:61440
  buffer_load_dwordx4 v[72:75], v2, s[8:11], s38 offen offset:3072 sc1
  buffer_load_dwordx4 v[76:79], v2, s[8:11], s39 offen offset:3072 sc1
  s_add_u32 s38, s38, 4096
  s_add_u32 s39, s39, 4096
  ds_read_b128 v[96:99], v4 offset:0
  ds_read_b128 v[100:103], v4 offset:20480
  ds_read_b128 v[104:107], v4 offset:40960
  ds_read_b128 v[108:111], v4 offset:61440
  s_waitcnt vmcnt(6) lgkmcnt(4)
  v_mfma_f32_16x16x32_bf16 v[16:19], v[48:51], v[80:83], 0
  v_mfma_f32_16x16x32_bf16 v[20:23], v[48:51], v[84:87], 0
  v_mfma_f32_16x16x32_bf16 v[24:27], v[48:51], v[88:91], 0
  v_mfma_f32_16x16x32_bf16 v[28:31], v[48:51], v[92:95], 0
  v_mfma_f32_16x16x32_bf16 v[32:35], v[52:55], v[80:83], 0
  v_mfma_f32_16x16x32_bf16 v[36:39], v[52:55], v[84:87], 0
  v_mfma_f32_16x16x32_bf16 v[40:43], v[52:55], v[88:91], 0
  v_mfma_f32_16x16x32_bf16 v[44:47], v[52:55], v[92:95], 0
  buffer_load_dwordx4 v[48:51], v2, s[8:11], s38 offen offset:0 sc1
  buffer_load_dwordx4 v[52:55], v2, s[8:11], s39 offen offset:0 sc1
  ds_read_b128 v[80:83], v5 offset:0
  ds_read_b128 v[84:87], v5 offset:20480
  ds_read_b128 v[88:91], v5 offset:40960
  ds_read_b128 v[92:95], v5 offset:61440
  s_waitcnt vmcnt(6) lgkmcnt(4)
  v_mfma_f32_16x16x32_bf16 v[16:19], v[56:59], v[96:99], v[16:19]
  v_mfma_f32_16x16x32_bf16 v[20:23], v[56:59], v[100:103], v[20:23]
  v_mfma_f32_16x16x32_bf16 v[24:27], v[56:59], v[104:107], v[24:27]
  v_mfma_f32_16x16x32_bf16 v[28:31], v[56:59], v[108:111], v[28:31]
  v_mfma_f32_16x16x32_bf16 v[32:35], v[60:63], v[96:99], v[32:35]
  v_mfma_f32_16x16x32_bf16 v[36:39], v[60:63], v[100:103], v[36:39]
  v_mfma_f32_16x16x32_bf16 v[40:43], v[60:63], v[104:107], v[40:43]
  v_mfma_f32_16x16x32_bf16 v[44:47], v[60:63], v[108:111], v[44:47]
  buffer_load_dwordx4 v[56:59], v2, s[8:11], s38 offen offset:1024 sc1
  buffer_load_dwordx4 v[60:63], v2, s[8:11], s39 offen offset:1024 sc1
  ds_read_b128 v[96:99], v6 offset:0
  ds_read_b128 v[100:103], v6 offset:20480
  ds_read_b128 v[104:107], v6 offset:40960
  ds_read_b128 v[108:111], v6 offset:61440
  s_waitcnt vmcnt(6) lgkmcnt(4)
  v_mfma_f32_16x16x32_bf16 v[16:19], v[64:67], v[80:83], v[16:19]
  v_mfma_f32_16x16x32_bf16 v[20:23], v[64:67], v[84:87], v[20:23]
  v_mfma_f32_16x16x32_bf16 v[24:27], v[64:67], v[88:91], v[24:27]
  v_mfma_f32_16x16x32_bf16 v[28:31], v[64:67], v[92:95], v[28:31]
  v_mfma_f32_16x16x32_bf16 v[32:35], v[68:71], v[80:83], v[32:35]
  v_mfma_f32_16x16x32_bf16 v[36:39], v[68:71], v[84:87], v[36:39]
  v_mfma_f32_16x16x32_bf16 v[40:43], v[68:71], v[88:91], v[40:43]
  v_mfma_f32_16x16x32_bf16 v[44:47], v[68:71], v[92:95], v[44:47]
  buffer_load_dwordx4 v[64:67], v2, s[8:11], s38 offen offset:2048 sc1
  buffer_load_dwordx4 v[68:71], v2, s[8:11], s39 offen offset:2048 sc1
  ds_read_b128 v[80:83], v3 offset:256
  ds_read_b128 v[84:87], v3 offset:20736
  ds_read_b128 v[88:91], v3 offset:41216
  ds_read_b128 v[92:95], v3 offset:61696
  s_waitcnt vmcnt(6) lgkmcnt(4)
  v_mfma_f32_16x16x32_bf16 v[16:19], v[72:75], v[96:99], v[16:19]
  v_mfma_f32_16x16x32_bf16 v[20:23], v[72:75], v[100:103], v[20:23]
  v_mfma_f32_16x16x32_bf16 v[24:27], v[72:75], v[104:107], v[24:27]
  v_mfma_f32_16x16x32_bf16 v[28:31], v[72:75], v[108:111], v[28:31]
  v_mfma_f32_16x16x32_bf16 v[32:35], v[76:79], v[96:99], v[32:35]
  v_mfma_f32_16x16x32_bf16 v[36:39], v[76:79], v[100:103], v[36:39]
  v_mfma_f32_16x16x32_bf16 v[40:43], v[76:79], v[104:107], v[40:43]
  v_mfma_f32_16x16x32_bf16 v[44:47], v[76:79], v[108:111], v[44:47]
  buffer_load_dwordx4 v[72:75], v2, s[8:11], s38 offen offset:3072 sc1
  buffer_load_dwordx4 v[76:79], v2, s[8:11], s39 offen offset:3072 sc1
  s_add_u32 s38, s38, 4096
  s_add_u32 s39, s39, 4096
  ds_read_b128 v[96:99], v4 offset:256
  ds_read_b128 v[100:103], v4 offset:20736
  ds_read_b128 v[104:107], v4 offset:41216
  ds_read_b128 v[108:111], v4 offset:61696
  s_waitcnt vmcnt(6) lgkmcnt(4)
  v_mfma_f32_16x16x32_bf16 v[16:19], v[48:51], v[80:83], v[16:19]
  v_mfma_f32_16x16x32_bf16 v[20:23], v[48:51], v[84:87], v[20:23]
  v_mfma_f32_16x16x32_bf16 v[24:27], v[48:51], v[88:91], v[24:27]
  v_mfma_f32_16x16x32_bf16 v[28:31], v[48:51], v[92:95], v[28:31]
  v_mfma_f32_16x16x32_bf16 v[32:35], v[52:55], v[80:83], v[32:35]
  v_mfma_f32_16x16x32_bf16 v[36:39], v[52:55], v[84:87], v[36:39]
  v_mfma_f32_16x16x32_bf16 v[40:43], v[52:55], v[88:91], v[40:43]
  v_mfma_f32_16x16x32_bf16 v[44:47], v[52:55], v[92:95], v[44:47]
  buffer_load_dwordx4 v[48:51], v2, s[8:11], s38 offen offset:0 sc1
  buffer_load_dwordx4 v[52:55], v2, s[8:11], s39 offen offset:0 sc1
  ds_read_b128 v[80:83], v5 offset:256
  ds_read_b128 v[84:87], v5 offset:20736
  ds_read_b128 v[88:91], v5 offset:41216
  ds_read_b128 v[92:95], v5 offset:61696
  s_waitcnt vmcnt(6) lgkmcnt(4)
  v_mfma_f32_16x16x32_bf16 v[16:19], v[56:59], v[96:99], v[16:19]
  v_mfma_f32_16x16x32_bf16 v[20:23], v[56:59], v[100:103], v[20:23]
  v_mfma_f32_16x16x32_bf16 v[24:27], v[56:59], v[104:107], v[24:27]
  v_mfma_f32_16x16x32_bf16 v[28:31], v[56:59], v[108:111], v[28:31]
  v_mfma_f32_16x16x32_bf16 v[32:35], v[60:63], v[96:99], v[32:35]
  v_mfma_f32_16x16x32_bf16 v[36:39], v[60:63], v[100:103], v[36:39]
  v_mfma_f32_16x16x32_bf16 v[40:43], v[60:63], v[104:107], v[40:43]
  v_mfma_f32_16x16x32_bf16 v[44:47], v[60:63], v[108:111], v[44:47]
  buffer_load_dwordx4 v[56:59], v2, s[8:11], s38 offen offset:1024 sc1
  buffer_load_dwordx4 v[60:63], v2, s[8:11], s39 offen offset:1024 sc1
  ds_read_b128 v[96:99], v6 offset:256
  ds_read_b128 v[100:103], v6 offset:20736
  ds_read_b128 v[104:107], v6 offset:41216
  ds_read_b128 v[108:111], v6 offset:61696
  s_waitcnt vmcnt(6) lgkmcnt(4)
  v_mfma_f32_16x16x32_bf16 v[16:19], v[64:67], v[80:83], v[16:19]
  v_mfma_f32_16x16x32_bf16 v[20:23], v[64:67], v[84:87], v[20:23]
  v_mfma_f32_16x16x32_bf16 v[24:27], v[64:67], v[88:91], v[24:27]
  v_mfma_f32_16x16x32_bf16 v[28:31], v[64:67], v[92:95], v[28:31]
  v_mfma_f32_16x16x32_bf16 v[32:35], v[68:71], v[80:83], v[32:35]
  v_mfma_f32_16x16x32_bf16 v[36:39], v[68:71], v[84:87], v[36:39]
  v_mfma_f32_16x16x32_bf16 v[40:43], v[68:71], v[88:91], v[40:43]
  v_mfma_f32_16x16x32_bf16 v[44:47], v[68:71], v[92:95], v[44:47]
  buffer_load_dwordx4 v[64:67], v2, s[8:11], s38 offen offset:2048 sc1
  buffer_load_dwordx4 v[68:71], v2, s[8:11], s39 offen offset:2048 sc1
  ds_read_b128 v[80:83], v3 offset:512
  ds_read_b128 v[84:87], v3 offset:20992
  ds_read_b128 v[88:91], v3 offset:41472
  ds_read_b128 v[92:95], v3 offset:61952
  s_waitcnt vmcnt(6) lgkmcnt(4)
  v_mfma_f32_16x16x32_bf16 v[16:19], v[72:75], v[96:99], v[16:19]
  v_mfma_f32_16x16x32_bf16 v[20:23], v[72:75], v[100:103], v[20:23]
  v_mfma_f32_16x16x32_bf16 v[24:27], v[72:75], v[104:107], v[24:27]
  v_mfma_f32_16x16x32_bf16 v[28:31], v[72:75], v[108:111], v[28:31]
  v_mfma_f32_16x16x32_bf16 v[32:35], v[76:79], v[96:99], v[32:35]
  v_mfma_f32_16x16x32_bf16 v[36:39], v[76:79], v[100:103], v[36:39]
  v_mfma_f32_16x16x32_bf16 v[40:43], v[76:79], v[104:107], v[40:43]
  v_mfma_f32_16x16x32_bf16 v[44:47], v[76:79], v[108:111], v[44:47]
  buffer_load_dwordx4 v[72:75], v2, s[8:11], s38 offen offset:3072 sc1
  buffer_load_dwordx4 v[76:79], v2, s[8:11], s39 offen offset:3072 sc1
  s_add_u32 s38, s38, 4096
  s_add_u32 s39, s39, 4096
  ds_read_b128 v[96:99], v4 offset:512
  ds_read_b128 v[100:103], v4 offset:20992
  ds_read_b128 v[104:107], v4 offset:41472
  ds_read_b128 v[108:111], v4 offset:61952
  s_waitcnt vmcnt(6) lgkmcnt(4)
  v_mfma_f32_16x16x32_bf16 v[16:19], v[48:51], v[80:83], v[16:19]
  v_mfma_f32_16x16x32_bf16 v[20:23], v[48:51], v[84:87], v[20:23]
  v_mfma_f32_16x16x32_bf16 v[24:27], v[48:51], v[88:91], v[24:27]
  v_mfma_f32_16x16x32_bf16 v[28:31], v[48:51], v[92:95], v[28:31]
  v_mfma_f32_16x16x32_bf16 v[32:35], v[52:55], v[80:83], v[32:35]
  v_mfma_f32_16x16x32_bf16 v[36:39], v[52:55], v[84:87], v[36:39]
  v_mfma_f32_16x16x32_bf16 v[40:43], v[52:55], v[88:91], v[40:43]
  v_mfma_f32_16x16x32_bf16 v[44:47], v[52:55], v[92:95], v[44:47]
  buffer_load_dwordx4 v[48:51], v2, s[8:11], s38 offen offset:0 sc1
  buffer_load_dwordx4 v[52:55], v2, s[8:11], s39 offen offset:0 sc1
  ds_read_b128 v[80:83], v5 offset:512
  ds_read_b128 v[84:87], v5 offset:20992
  ds_read_b128 v[88:91], v5 offset:41472
  ds_read_b128 v[92:95], v5 offset:61952
  s_waitcnt vmcnt(6) lgkmcnt(4)
  v_mfma_f32_16x16x32_bf16 v[16:19], v[56:59], v[96:99], v[16:19]
  v_mfma_f32_16x16x32_bf16 v[20:23], v[56:59], v[100:103], v[20:23]
  v_mfma_f32_16x16x32_bf16 v[24:27], v[56:59], v[104:107], v[24:27]
  v_mfma_f32_16x16x32_bf16 v[28:31], v[56:59], v[108:111], v[28:31]
  v_mfma_f32_16x16x32_bf16 v[32:35], v[60:63], v[96:99], v[32:35]
  v_mfma_f32_16x16x32_bf16 v[36:39], v[60:63], v[100:103], v[36:39]
  v_mfma_f32_16x16x32_bf16 v[40:43], v[60:63], v[104:107], v[40:43]
  v_mfma_f32_16x16x32_bf16 v[44:47], v[60:63], v[108:111], v[44:47]
  buffer_load_dwordx4 v[56:59], v2, s[8:11], s38 offen offset:1024 sc1
  buffer_load_dwordx4 v[60:63], v2, s[8:11], s39 offen offset:1024 sc1
  ds_read_b128 v[96:99], v6 offset:512
  ds_read_b128 v[100:103], v6 offset:20992
  ds_read_b128 v[104:107], v6 offset:41472
  ds_read_b128 v[108:111], v6 offset:61952
  s_waitcnt vmcnt(6) lgkmcnt(4)
  v_mfma_f32_16x16x32_bf16 v[16:19], v[64:67], v[80:83], v[16:19]
  v_mfma_f32_16x16x32_bf16 v[20:23], v[64:67], v[84:87], v[20:23]
  v_mfma_f32_16x16x32_bf16 v[24:27], v[64:67], v[88:91], v[24:27]
  v_mfma_f32_16x16x32_bf16 v[28:31], v[64:67], v[92:95], v[28:31]
  v_mfma_f32_16x16x32_bf16 v[32:35], v[68:71], v[80:83], v[32:35]
  v_mfma_f32_16x16x32_bf16 v[36:39], v[68:71], v[84:87], v[36:39]
  v_mfma_f32_16x16x32_bf16 v[40:43], v[68:71], v[88:91], v[40:43]
  v_mfma_f32_16x16x32_bf16 v[44:47], v[68:71], v[92:95], v[44:47]
  buffer_load_dwordx4 v[64:67], v2, s[8:11], s38 offen offset:2048 sc1
  buffer_load_dwordx4 v[68:71], v2, s[8:11], s39 offen offset:2048 sc1
  ds_read_b128 v[80:83], v3 offset:768
  ds_read_b128 v[84:87], v3 offset:21248
  ds_read_b128 v[88:91], v3 offset:41728
  ds_read_b128 v[92:95], v3 offset:62208
  s_waitcnt vmcnt(6) lgkmcnt(4)
  v_mfma_f32_16x16x32_bf16 v[16:19], v[72:75], v[96:99], v[16:19]
  v_mfma_f32_16x16x32_bf16 v[20:23], v[72:75], v[100:103], v[20:23]
  v_mfma_f32_16x16x32_bf16 v[24:27], v[72:75], v[104:107], v[24:27]
  v_mfma_f32_16x16x32_bf16 v[28:31], v[72:75], v[108:111], v[28:31]
  v_mfma_f32_16x16x32_bf16 v[32:35], v[76:79], v[96:99], v[32:35]
  v_mfma_f32_16x16x32_bf16 v[36:39], v[76:79], v[100:103], v[36:39]
  v_mfma_f32_16x16x32_bf16 v[40:43], v[76:79], v[104:107], v[40:43]
  v_mfma_f32_16x16x32_bf16 v[44:47], v[76:79], v[108:111], v[44:47]
  buffer_load_dwordx4 v[72:75], v2, s[8:11], s38 offen offset:3072 sc1
  buffer_load_dwordx4 v[76:79], v2, s[8:11], s39 offen offset:3072 sc1
  s_add_u32 s38, s38, 4096
  s_add_u32 s39, s39, 4096
  ds_read_b128 v[96:99], v4 offset:768
  ds_read_b128 v[100:103], v4 offset:21248
  ds_read_b128 v[104:107], v4 offset:41728
  ds_read_b128 v[108:111], v4 offset:62208
  s_waitcnt vmcnt(6) lgkmcnt(4)
  v_mfma_f32_16x16x32_bf16 v[16:19], v[48:51], v[80:83], v[16:19]
  v_mfma_f32_16x16x32_bf16 v[20:23], v[48:51], v[84:87], v[20:23]
  v_mfma_f32_16x16x32_bf16 v[24:27], v[48:51], v[88:91], v[24:27]
  v_mfma_f32_16x16x32_bf16 v[28:31], v[48:51], v[92:95], v[28:31]
  v_mfma_f32_16x16x32_bf16 v[32:35], v[52:55], v[80:83], v[32:35]
  v_mfma_f32_16x16x32_bf16 v[36:39], v[52:55], v[84:87], v[36:39]
  v_mfma_f32_16x16x32_bf16 v[40:43], v[52:55], v[88:91], v[40:43]
  v_mfma_f32_16x16x32_bf16 v[44:47], v[52:55], v[92:95], v[44:47]
  buffer_load_dwordx4 v[48:51], v2, s[8:11], s38 offen offset:0 sc1
  buffer_load_dwordx4 v[52:55], v2, s[8:11], s39 offen offset:0 sc1
  ds_read_b128 v[80:83], v5 offset:768
  ds_read_b128 v[84:87], v5 offset:21248
  ds_read_b128 v[88:91], v5 offset:41728
  ds_read_b128 v[92:95], v5 offset:62208
  s_waitcnt vmcnt(6) lgkmcnt(4)
  v_mfma_f32_16x16x32_bf16 v[16:19], v[56:59], v[96:99], v[16:19]
  v_mfma_f32_16x16x32_bf16 v[20:23], v[56:59], v[100:103], v[20:23]
  v_mfma_f32_16x16x32_bf16 v[24:27], v[56:59], v[104:107], v[24:27]
  v_mfma_f32_16x16x32_bf16 v[28:31], v[56:59], v[108:111], v[28:31]
  v_mfma_f32_16x16x32_bf16 v[32:35], v[60:63], v[96:99], v[32:35]
  v_mfma_f32_16x16x32_bf16 v[36:39], v[60:63], v[100:103], v[36:39]
  v_mfma_f32_16x16x32_bf16 v[40:43], v[60:63], v[104:107], v[40:43]
  v_mfma_f32_16x16x32_bf16 v[44:47], v[60:63], v[108:111], v[44:47]
  buffer_load_dwordx4 v[56:59], v2, s[8:11], s38 offen offset:1024 sc1
  buffer_load_dwordx4 v[60:63], v2, s[8:11], s39 offen offset:1024 sc1
  ds_read_b128 v[96:99], v6 offset:768
  ds_read_b128 v[100:103], v6 offset:21248
  ds_read_b128 v[104:107], v6 offset:41728
  ds_read_b128 v[108:111], v6 offset:62208
  s_waitcnt vmcnt(6) lgkmcnt(4)
  v_mfma_f32_16x16x32_bf16 v[16:19], v[64:67], v[80:83], v[16:19]
  v_mfma_f32_16x16x32_bf16 v[20:23], v[64:67], v[84:87], v[20:23]
  v_mfma_f32_16x16x32_bf16 v[24:27], v[64:67], v[88:91], v[24:27]
  v_mfma_f32_16x16x32_bf16 v[28:31], v[64:67], v[92:95], v[28:31]
  v_mfma_f32_16x16x32_bf16 v[32:35], v[68:71], v[80:83], v[32:35]
  v_mfma_f32_16x16x32_bf16 v[36:39], v[68:71], v[84:87], v[36:39]
  v_mfma_f32_16x16x32_bf16 v[40:43], v[68:71], v[88:91], v[40:43]
  v_mfma_f32_16x16x32_bf16 v[44:47], v[68:71], v[92:95], v[44:47]
  buffer_load_dwordx4 v[64:67], v2, s[8:11], s38 offen offset:2048 sc1
  buffer_load_dwordx4 v[68:71], v2, s[8:11], s39 offen offset:2048 sc1
  ds_read_b128 v[80:83], v3 offset:1024
  ds_read_b128 v[84:87], v3 offset:21504
  ds_read_b128 v[88:91], v3 offset:41984
  ds_read_b128 v[92:95], v3 offset:62464
  s_waitcnt vmcnt(6) lgkmcnt(4)
  v_mfma_f32_16x16x32_bf16 v[16:19], v[72:75], v[96:99], v[16:19]
  v_mfma_f32_16x16x32_bf16 v[20:23], v[72:75], v[100:103], v[20:23]
  v_mfma_f32_16x16x32_bf16 v[24:27], v[72:75], v[104:107], v[24:27]
  v_mfma_f32_16x16x32_bf16 v[28:31], v[72:75], v[108:111], v[28:31]
  v_mfma_f32_16x16x32_bf16 v[32:35], v[76:79], v[96:99], v[32:35]
  v_mfma_f32_16x16x32_bf16 v[36:39], v[76:79], v[100:103], v[36:39]
  v_mfma_f32_16x16x32_bf16 v[40:43], v[76:79], v[104:107], v[40:43]
  v_mfma_f32_16x16x32_bf16 v[44:47], v[76:79], v[108:111], v[44:47]
  buffer_load_dwordx4 v[72:75], v2, s[8:11], s38 offen offset:3072 sc1
  buffer_load_dwordx4 v[76:79], v2, s[8:11], s39 offen offset:3072 sc1
  s_add_u32 s38, s38, 4096
  s_add_u32 s39, s39, 4096
  ds_read_b128 v[96:99], v4 offset:1024
  ds_read_b128 v[100:103], v4 offset:21504
  ds_read_b128 v[104:107], v4 offset:41984
  ds_read_b128 v[108:111], v4 offset:62464
  s_waitcnt vmcnt(6) lgkmcnt(4)
  v_mfma_f32_16x16x32_bf16 v[16:19], v[48:51], v[80:83], v[16:19]
  v_mfma_f32_16x16x32_bf16 v[20:23], v[48:51], v[84:87], v[20:23]
  v_mfma_f32_16x16x32_bf16 v[24:27], v[48:51], v[88:91], v[24:27]
  v_mfma_f32_16x16x32_bf16 v[28:31], v[48:51], v[92:95], v[28:31]
  v_mfma_f32_16x16x32_bf16 v[32:35], v[52:55], v[80:83], v[32:35]
  v_mfma_f32_16x16x32_bf16 v[36:39], v[52:55], v[84:87], v[36:39]
  v_mfma_f32_16x16x32_bf16 v[40:43], v[52:55], v[88:91], v[40:43]
  v_mfma_f32_16x16x32_bf16 v[44:47], v[52:55], v[92:95], v[44:47]
  ds_read_b128 v[80:83], v5 offset:1024
  ds_read_b128 v[84:87], v5 offset:21504
  ds_read_b128 v[88:91], v5 offset:41984
  ds_read_b128 v[92:95], v5 offset:62464
  s_waitcnt vmcnt(4) lgkmcnt(4)
  v_mfma_f32_16x16x32_bf16 v[16:19], v[56:59], v[96:99], v[16:19]
  v_mfma_f32_16x16x32_bf16 v[20:23], v[56:59], v[100:103], v[20:23]
  v_mfma_f32_16x16x32_bf16 v[24:27], v[56:59], v[104:107], v[24:27]
  v_mfma_f32_16x16x32_bf16 v[28:31], v[56:59], v[108:111], v[28:31]
  v_mfma_f32_16x16x32_bf16 v[32:35], v[60:63], v[96:99], v[32:35]
  v_mfma_f32_16x16x32_bf16 v[36:39], v[60:63], v[100:103], v[36:39]
  v_mfma_f32_16x16x32_bf16 v[40:43], v[60:63], v[104:107], v[40:43]
  v_mfma_f32_16x16x32_bf16 v[44:47], v[60:63], v[108:111], v[44:47]
  ds_read_b128 v[96:99], v6 offset:1024
  ds_read_b128 v[100:103], v6 offset:21504
  ds_read_b128 v[104:107], v6 offset:41984
  ds_read_b128 v[108:111], v6 offset:62464
  s_waitcnt vmcnt(2) lgkmcnt(4)
  v_mfma_f32_16x16x32_bf16 v[16:19], v[64:67], v[80:83], v[16:19]
  v_mfma_f32_16x16x32_bf16 v[20:23], v[64:67], v[84:87], v[20:23]
  v_mfma_f32_16x16x32_bf16 v[24:27], v[64:67], v[88:91], v[24:27]
  v_mfma_f32_16x16x32_bf16 v[28:31], v[64:67], v[92:95], v[28:31]
  v_mfma_f32_16x16x32_bf16 v[32:35], v[68:71], v[80:83], v[32:35]
  v_mfma_f32_16x16x32_bf16 v[36:39], v[68:71], v[84:87], v[36:39]
  v_mfma_f32_16x16x32_bf16 v[40:43], v[68:71], v[88:91], v[40:43]
  v_mfma_f32_16x16x32_bf16 v[44:47], v[68:71], v[92:95], v[44:47]
  s_waitcnt vmcnt(0) lgkmcnt(0)
  v_mfma_f32_16x16x32_bf16 v[16:19], v[72:75], v[96:99], v[16:19]
  v_mfma_f32_16x16x32_bf16 v[20:23], v[72:75], v[100:103], v[20:23]
  v_mfma_f32_16x16x32_bf16 v[24:27], v[72:75], v[104:107], v[24:27]
  v_mfma_f32_16x16x32_bf16 v[28:31], v[72:75], v[108:111], v[28:31]
  v_mfma_f32_16x16x32_bf16 v[32:35], v[76:79], v[96:99], v[32:35]
  v_mfma_f32_16x16x32_bf16 v[36:39], v[76:79], v[100:103], v[36:39]
  v_mfma_f32_16x16x32_bf16 v[40:43], v[76:79], v[104:107], v[40:43]
  v_mfma_f32_16x16x32_bf16 v[44:47], v[76:79], v[108:111], v[44:47]
  s_nop 7
  v_cvt_pk_bf16_f32 v244, v16, v17
  v_lshlrev_b32 v245, 16, v244
  v_and_b32 v246, 0xffff0000, v244
  v_mul_f32 v247, s34, v245
  v_mul_f32 v248, s34, v246
  v_exp_f32 v247, v247
  v_exp_f32 v248, v248
  v_cmp_lt_f32 vcc, 0, v245
  v_add_f32 v245, 1.0, v245
  v_cmp_lt_f32 s[36:37], 0, v246
  v_cndmask_b32 v245, v247, v245, vcc
  v_add_f32 v246, 1.0, v246
  s_nop 0
  v_cndmask_b32 v246, v248, v246, s[36:37]
  v_cvt_pk_bf16_f32 v244, v245, v246
  v_lshlrev_b32 v245, 16, v244
  v_and_b32 v246, 0xffff0000, v244
  v_add_f32 v245, s35, v245
  v_add_f32 v246, s35, v246
  v_cvt_pk_bf16_f32 v112, v245, v246
  v_cvt_pk_bf16_f32 v250, v18, v19
  v_lshlrev_b32 v251, 16, v250
  v_and_b32 v252, 0xffff0000, v250
  v_mul_f32 v253, s34, v251
  v_mul_f32 v254, s34, v252
  v_exp_f32 v253, v253
  v_exp_f32 v254, v254
  v_cmp_lt_f32 vcc, 0, v251
  v_add_f32 v251, 1.0, v251
  v_cmp_lt_f32 s[36:37], 0, v252
  v_cndmask_b32 v251, v253, v251, vcc
  v_add_f32 v252, 1.0, v252
  s_nop 0
  v_cndmask_b32 v252, v254, v252, s[36:37]
  v_cvt_pk_bf16_f32 v250, v251, v252
  v_lshlrev_b32 v251, 16, v250
  v_and_b32 v252, 0xffff0000, v250
  v_add_f32 v251, s35, v251
  v_add_f32 v252, s35, v252
  v_cvt_pk_bf16_f32 v113, v251, v252
  v_cvt_pk_bf16_f32 v244, v20, v21
  v_lshlrev_b32 v245, 16, v244
  v_and_b32 v246, 0xffff0000, v244
  v_mul_f32 v247, s34, v245
  v_mul_f32 v248, s34, v246
  v_exp_f32 v247, v247
  v_exp_f32 v248, v248
  v_cmp_lt_f32 vcc, 0, v245
  v_add_f32 v245, 1.0, v245
  v_cmp_lt_f32 s[36:37], 0, v246
  v_cndmask_b32 v245, v247, v245, vcc
  v_add_f32 v246, 1.0, v246
  s_nop 0
  v_cndmask_b32 v246, v248, v246, s[36:37]
  v_cvt_pk_bf16_f32 v244, v245, v246
  v_lshlrev_b32 v245, 16, v244
  v_and_b32 v246, 0xffff0000, v244
  v_add_f32 v245, s35, v245
  v_add_f32 v246, s35, v246
  v_cvt_pk_bf16_f32 v114, v245, v246
  v_cvt_pk_bf16_f32 v250, v22, v23
  v_lshlrev_b32 v251, 16, v250
  v_and_b32 v252, 0xffff0000, v250
  v_mul_f32 v253, s34, v251
  v_mul_f32 v254, s34, v252
  v_exp_f32 v253, v253
  v_exp_f32 v254, v254
  v_cmp_lt_f32 vcc, 0, v251
  v_add_f32 v251, 1.0, v251
  v_cmp_lt_f32 s[36:37], 0, v252
  v_cndmask_b32 v251, v253, v251, vcc
  v_add_f32 v252, 1.0, v252
  s_nop 0
  v_cndmask_b32 v252, v254, v252, s[36:37]
  v_cvt_pk_bf16_f32 v250, v251, v252
  v_lshlrev_b32 v251, 16, v250
  v_and_b32 v252, 0xffff0000, v250
  v_add_f32 v251, s35, v251
  v_add_f32 v252, s35, v252
  v_cvt_pk_bf16_f32 v115, v251, v252
  v_cvt_pk_bf16_f32 v244, v24, v25
  v_lshlrev_b32 v245, 16, v244
  v_and_b32 v246, 0xffff0000, v244
  v_mul_f32 v247, s34, v245
  v_mul_f32 v248, s34, v246
  v_exp_f32 v247, v247
  v_exp_f32 v248, v248
  v_cmp_lt_f32 vcc, 0, v245
  v_add_f32 v245, 1.0, v245
  v_cmp_lt_f32 s[36:37], 0, v246
  v_cndmask_b32 v245, v247, v245, vcc
  v_add_f32 v246, 1.0, v246
  s_nop 0
  v_cndmask_b32 v246, v248, v246, s[36:37]
  v_cvt_pk_bf16_f32 v244, v245, v246
  v_lshlrev_b32 v245, 16, v244
  v_and_b32 v246, 0xffff0000, v244
  v_add_f32 v245, s35, v245
  v_add_f32 v246, s35, v246
  v_cvt_pk_bf16_f32 v116, v245, v246
  v_cvt_pk_bf16_f32 v250, v26, v27
  v_lshlrev_b32 v251, 16, v250
  v_and_b32 v252, 0xffff0000, v250
  v_mul_f32 v253, s34, v251
  v_mul_f32 v254, s34, v252
  v_exp_f32 v253, v253
  v_exp_f32 v254, v254
  v_cmp_lt_f32 vcc, 0, v251
  v_add_f32 v251, 1.0, v251
  v_cmp_lt_f32 s[36:37], 0, v252
  v_cndmask_b32 v251, v253, v251, vcc
  v_add_f32 v252, 1.0, v252
  s_nop 0
  v_cndmask_b32 v252, v254, v252, s[36:37]
  v_cvt_pk_bf16_f32 v250, v251, v252
  v_lshlrev_b32 v251, 16, v250
  v_and_b32 v252, 0xffff0000, v250
  v_add_f32 v251, s35, v251
  v_add_f32 v252, s35, v252
  v_cvt_pk_bf16_f32 v117, v251, v252
  v_cvt_pk_bf16_f32 v244, v28, v29
  v_lshlrev_b32 v245, 16, v244
  v_and_b32 v246, 0xffff0000, v244
  v_mul_f32 v247, s34, v245
  v_mul_f32 v248, s34, v246
  v_exp_f32 v247, v247
  v_exp_f32 v248, v248
  v_cmp_lt_f32 vcc, 0, v245
  v_add_f32 v245, 1.0, v245
  v_cmp_lt_f32 s[36:37], 0, v246
  v_cndmask_b32 v245, v247, v245, vcc
  v_add_f32 v246, 1.0, v246
  s_nop 0
  v_cndmask_b32 v246, v248, v246, s[36:37]
  v_cvt_pk_bf16_f32 v244, v245, v246
  v_lshlrev_b32 v245, 16, v244
  v_and_b32 v246, 0xffff0000, v244
  v_add_f32 v245, s35, v245
  v_add_f32 v246, s35, v246
  v_cvt_pk_bf16_f32 v118, v245, v246
  v_cvt_pk_bf16_f32 v250, v30, v31
  v_lshlrev_b32 v251, 16, v250
  v_and_b32 v252, 0xffff0000, v250
  v_mul_f32 v253, s34, v251
  v_mul_f32 v254, s34, v252
  v_exp_f32 v253, v253
  v_exp_f32 v254, v254
  v_cmp_lt_f32 vcc, 0, v251
  v_add_f32 v251, 1.0, v251
  v_cmp_lt_f32 s[36:37], 0, v252
  v_cndmask_b32 v251, v253, v251, vcc
  v_add_f32 v252, 1.0, v252
  s_nop 0
  v_cndmask_b32 v252, v254, v252, s[36:37]
  v_cvt_pk_bf16_f32 v250, v251, v252
  v_lshlrev_b32 v251, 16, v250
  v_and_b32 v252, 0xffff0000, v250
  v_add_f32 v251, s35, v251
  v_add_f32 v252, s35, v252
  v_cvt_pk_bf16_f32 v119, v251, v252
  v_cvt_pk_bf16_f32 v244, v32, v33
  v_lshlrev_b32 v245, 16, v244
  v_and_b32 v246, 0xffff0000, v244
  v_mul_f32 v247, s34, v245
  v_mul_f32 v248, s34, v246
  v_exp_f32 v247, v247
  v_exp_f32 v248, v248
  v_cmp_lt_f32 vcc, 0, v245
  v_add_f32 v245, 1.0, v245
  v_cmp_lt_f32 s[36:37], 0, v246
  v_cndmask_b32 v245, v247, v245, vcc
  v_add_f32 v246, 1.0, v246
  s_nop 0
  v_cndmask_b32 v246, v248, v246, s[36:37]
  v_cvt_pk_bf16_f32 v244, v245, v246
  v_lshlrev_b32 v245, 16, v244
  v_and_b32 v246, 0xffff0000, v244
  v_add_f32 v245, s35, v245
  v_add_f32 v246, s35, v246
  v_cvt_pk_bf16_f32 v120, v245, v246
  v_cvt_pk_bf16_f32 v250, v34, v35
  v_lshlrev_b32 v251, 16, v250
  v_and_b32 v252, 0xffff0000, v250
  v_mul_f32 v253, s34, v251
  v_mul_f32 v254, s34, v252
  v_exp_f32 v253, v253
  v_exp_f32 v254, v254
  v_cmp_lt_f32 vcc, 0, v251
  v_add_f32 v251, 1.0, v251
  v_cmp_lt_f32 s[36:37], 0, v252
  v_cndmask_b32 v251, v253, v251, vcc
  v_add_f32 v252, 1.0, v252
  s_nop 0
  v_cndmask_b32 v252, v254, v252, s[36:37]
  v_cvt_pk_bf16_f32 v250, v251, v252
  v_lshlrev_b32 v251, 16, v250
  v_and_b32 v252, 0xffff0000, v250
  v_add_f32 v251, s35, v251
  v_add_f32 v252, s35, v252
  v_cvt_pk_bf16_f32 v121, v251, v252
  v_cvt_pk_bf16_f32 v244, v36, v37
  v_lshlrev_b32 v245, 16, v244
  v_and_b32 v246, 0xffff0000, v244
  v_mul_f32 v247, s34, v245
  v_mul_f32 v248, s34, v246
  v_exp_f32 v247, v247
  v_exp_f32 v248, v248
  v_cmp_lt_f32 vcc, 0, v245
  v_add_f32 v245, 1.0, v245
  v_cmp_lt_f32 s[36:37], 0, v246
  v_cndmask_b32 v245, v247, v245, vcc
  v_add_f32 v246, 1.0, v246
  s_nop 0
  v_cndmask_b32 v246, v248, v246, s[36:37]
  v_cvt_pk_bf16_f32 v244, v245, v246
  v_lshlrev_b32 v245, 16, v244
  v_and_b32 v246, 0xffff0000, v244
  v_add_f32 v245, s35, v245
  v_add_f32 v246, s35, v246
  v_cvt_pk_bf16_f32 v122, v245, v246
  v_cvt_pk_bf16_f32 v250, v38, v39
  v_lshlrev_b32 v251, 16, v250
  v_and_b32 v252, 0xffff0000, v250
  v_mul_f32 v253, s34, v251
  v_mul_f32 v254, s34, v252
  v_exp_f32 v253, v253
  v_exp_f32 v254, v254
  v_cmp_lt_f32 vcc, 0, v251
  v_add_f32 v251, 1.0, v251
  v_cmp_lt_f32 s[36:37], 0, v252
  v_cndmask_b32 v251, v253, v251, vcc
  v_add_f32 v252, 1.0, v252
  s_nop 0
  v_cndmask_b32 v252, v254, v252, s[36:37]
  v_cvt_pk_bf16_f32 v250, v251, v252
  v_lshlrev_b32 v251, 16, v250
  v_and_b32 v252, 0xffff0000, v250
  v_add_f32 v251, s35, v251
  v_add_f32 v252, s35, v252
  v_cvt_pk_bf16_f32 v123, v251, v252
  v_cvt_pk_bf16_f32 v244, v40, v41
  v_lshlrev_b32 v245, 16, v244
  v_and_b32 v246, 0xffff0000, v244
  v_mul_f32 v247, s34, v245
  v_mul_f32 v248, s34, v246
  v_exp_f32 v247, v247
  v_exp_f32 v248, v248
  v_cmp_lt_f32 vcc, 0, v245
  v_add_f32 v245, 1.0, v245
  v_cmp_lt_f32 s[36:37], 0, v246
  v_cndmask_b32 v245, v247, v245, vcc
  v_add_f32 v246, 1.0, v246
  s_nop 0
  v_cndmask_b32 v246, v248, v246, s[36:37]
  v_cvt_pk_bf16_f32 v244, v245, v246
  v_lshlrev_b32 v245, 16, v244
  v_and_b32 v246, 0xffff0000, v244
  v_add_f32 v245, s35, v245
  v_add_f32 v246, s35, v246
  v_cvt_pk_bf16_f32 v124, v245, v246
  v_cvt_pk_bf16_f32 v250, v42, v43
  v_lshlrev_b32 v251, 16, v250
  v_and_b32 v252, 0xffff0000, v250
  v_mul_f32 v253, s34, v251
  v_mul_f32 v254, s34, v252
  v_exp_f32 v253, v253
  v_exp_f32 v254, v254
  v_cmp_lt_f32 vcc, 0, v251
  v_add_f32 v251, 1.0, v251
  v_cmp_lt_f32 s[36:37], 0, v252
  v_cndmask_b32 v251, v253, v251, vcc
  v_add_f32 v252, 1.0, v252
  s_nop 0
  v_cndmask_b32 v252, v254, v252, s[36:37]
  v_cvt_pk_bf16_f32 v250, v251, v252
  v_lshlrev_b32 v251, 16, v250
  v_and_b32 v252, 0xffff0000, v250
  v_add_f32 v251, s35, v251
  v_add_f32 v252, s35, v252
  v_cvt_pk_bf16_f32 v125, v251, v252
  v_cvt_pk_bf16_f32 v244, v44, v45
  v_lshlrev_b32 v245, 16, v244
  v_and_b32 v246, 0xffff0000, v244
  v_mul_f32 v247, s34, v245
  v_mul_f32 v248, s34, v246
  v_exp_f32 v247, v247
  v_exp_f32 v248, v248
  v_cmp_lt_f32 vcc, 0, v245
  v_add_f32 v245, 1.0, v245
  v_cmp_lt_f32 s[36:37], 0, v246
  v_cndmask_b32 v245, v247, v245, vcc
  v_add_f32 v246, 1.0, v246
  s_nop 0
  v_cndmask_b32 v246, v248, v246, s[36:37]
  v_cvt_pk_bf16_f32 v244, v245, v246
  v_lshlrev_b32 v245, 16, v244
  v_and_b32 v246, 0xffff0000, v244
  v_add_f32 v245, s35, v245
  v_add_f32 v246, s35, v246
  v_cvt_pk_bf16_f32 v126, v245, v246
  v_cvt_pk_bf16_f32 v250, v46, v47
  v_lshlrev_b32 v251, 16, v250
  v_and_b32 v252, 0xffff0000, v250
  v_mul_f32 v253, s34, v251
  v_mul_f32 v254, s34, v252
  v_exp_f32 v253, v253
  v_exp_f32 v254, v254
  v_cmp_lt_f32 vcc, 0, v251
  v_add_f32 v251, 1.0, v251
  v_cmp_lt_f32 s[36:37], 0, v252
  v_cndmask_b32 v251, v253, v251, vcc
  v_add_f32 v252, 1.0, v252
  s_nop 0
  v_cndmask_b32 v252, v254, v252, s[36:37]
  v_cvt_pk_bf16_f32 v250, v251, v252
  v_lshlrev_b32 v251, 16, v250
  v_and_b32 v252, 0xffff0000, v250
  v_add_f32 v251, s35, v251
  v_add_f32 v252, s35, v252
  v_cvt_pk_bf16_f32 v127, v251, v252
  s_mul_i32 s38, s3, 102400
  s_add_u32 s38, s38, 83927040
  s_mul_i32 s39, s3, 102400
  s_add_u32 s39, s39, 83947520
  buffer_load_dwordx4 v[48:51], v2, s[8:11], s38 offen offset:0 sc1
  buffer_load_dwordx4 v[52:55], v2, s[8:11], s39 offen offset:0 sc1
  buffer_load_dwordx4 v[56:59], v2, s[8:11], s38 offen offset:1024 sc1
  buffer_load_dwordx4 v[60:63], v2, s[8:11], s39 offen offset:1024 sc1
  buffer_load_dwordx4 v[64:67], v2, s[8:11], s38 offen offset:2048 sc1
  buffer_load_dwordx4 v[68:71], v2, s[8:11], s39 offen offset:2048 sc1
  ds_read_b128 v[80:83], v3 offset:0
  ds_read_b128 v[84:87], v3 offset:20480
  ds_read_b128 v[88:91], v3 offset:40960
  ds_read_b128 v[92:95], v3 offset:61440
  buffer_load_dwordx4 v[72:75], v2, s[8:11], s38 offen offset:3072 sc1
  buffer_load_dwordx4 v[76:79], v2, s[8:11], s39 offen offset:3072 sc1
  s_add_u32 s38, s38, 4096
  s_add_u32 s39, s39, 4096
  ds_read_b128 v[96:99], v4 offset:0
  ds_read_b128 v[100:103], v4 offset:20480
  ds_read_b128 v[104:107], v4 offset:40960
  ds_read_b128 v[108:111], v4 offset:61440
  s_waitcnt vmcnt(6) lgkmcnt(4)
  v_mfma_f32_16x16x32_bf16 v[16:19], v[48:51], v[80:83], 0
  v_mfma_f32_16x16x32_bf16 v[20:23], v[48:51], v[84:87], 0
  v_mfma_f32_16x16x32_bf16 v[24:27], v[48:51], v[88:91], 0
  v_mfma_f32_16x16x32_bf16 v[28:31], v[48:51], v[92:95], 0
  v_mfma_f32_16x16x32_bf16 v[32:35], v[52:55], v[80:83], 0
  v_mfma_f32_16x16x32_bf16 v[36:39], v[52:55], v[84:87], 0
  v_mfma_f32_16x16x32_bf16 v[40:43], v[52:55], v[88:91], 0
  v_mfma_f32_16x16x32_bf16 v[44:47], v[52:55], v[92:95], 0
  buffer_load_dwordx4 v[48:51], v2, s[8:11], s38 offen offset:0 sc1
  buffer_load_dwordx4 v[52:55], v2, s[8:11], s39 offen offset:0 sc1
  ds_read_b128 v[80:83], v5 offset:0
  ds_read_b128 v[84:87], v5 offset:20480
  ds_read_b128 v[88:91], v5 offset:40960
  ds_read_b128 v[92:95], v5 offset:61440
  s_waitcnt vmcnt(6) lgkmcnt(4)
  v_mfma_f32_16x16x32_bf16 v[16:19], v[56:59], v[96:99], v[16:19]
  v_mfma_f32_16x16x32_bf16 v[20:23], v[56:59], v[100:103], v[20:23]
  v_mfma_f32_16x16x32_bf16 v[24:27], v[56:59], v[104:107], v[24:27]
  v_mfma_f32_16x16x32_bf16 v[28:31], v[56:59], v[108:111], v[28:31]
  v_mfma_f32_16x16x32_bf16 v[32:35], v[60:63], v[96:99], v[32:35]
  v_mfma_f32_16x16x32_bf16 v[36:39], v[60:63], v[100:103], v[36:39]
  v_mfma_f32_16x16x32_bf16 v[40:43], v[60:63], v[104:107], v[40:43]
  v_mfma_f32_16x16x32_bf16 v[44:47], v[60:63], v[108:111], v[44:47]
  buffer_load_dwordx4 v[56:59], v2, s[8:11], s38 offen offset:1024 sc1
  buffer_load_dwordx4 v[60:63], v2, s[8:11], s39 offen offset:1024 sc1
  ds_read_b128 v[96:99], v6 offset:0
  ds_read_b128 v[100:103], v6 offset:20480
  ds_read_b128 v[104:107], v6 offset:40960
  ds_read_b128 v[108:111], v6 offset:61440
  s_waitcnt vmcnt(6) lgkmcnt(4)
  v_mfma_f32_16x16x32_bf16 v[16:19], v[64:67], v[80:83], v[16:19]
  v_mfma_f32_16x16x32_bf16 v[20:23], v[64:67], v[84:87], v[20:23]
  v_mfma_f32_16x16x32_bf16 v[24:27], v[64:67], v[88:91], v[24:27]
  v_mfma_f32_16x16x32_bf16 v[28:31], v[64:67], v[92:95], v[28:31]
  v_mfma_f32_16x16x32_bf16 v[32:35], v[68:71], v[80:83], v[32:35]
  v_mfma_f32_16x16x32_bf16 v[36:39], v[68:71], v[84:87], v[36:39]
  v_mfma_f32_16x16x32_bf16 v[40:43], v[68:71], v[88:91], v[40:43]
  v_mfma_f32_16x16x32_bf16 v[44:47], v[68:71], v[92:95], v[44:47]
  buffer_load_dwordx4 v[64:67], v2, s[8:11], s38 offen offset:2048 sc1
  buffer_load_dwordx4 v[68:71], v2, s[8:11], s39 offen offset:2048 sc1
  ds_read_b128 v[80:83], v3 offset:256
  ds_read_b128 v[84:87], v3 offset:20736
  ds_read_b128 v[88:91], v3 offset:41216
  ds_read_b128 v[92:95], v3 offset:61696
  s_waitcnt vmcnt(6) lgkmcnt(4)
  v_mfma_f32_16x16x32_bf16 v[16:19], v[72:75], v[96:99], v[16:19]
  v_mfma_f32_16x16x32_bf16 v[20:23], v[72:75], v[100:103], v[20:23]
  v_mfma_f32_16x16x32_bf16 v[24:27], v[72:75], v[104:107], v[24:27]
  v_mfma_f32_16x16x32_bf16 v[28:31], v[72:75], v[108:111], v[28:31]
  v_mfma_f32_16x16x32_bf16 v[32:35], v[76:79], v[96:99], v[32:35]
  v_mfma_f32_16x16x32_bf16 v[36:39], v[76:79], v[100:103], v[36:39]
  v_mfma_f32_16x16x32_bf16 v[40:43], v[76:79], v[104:107], v[40:43]
  v_mfma_f32_16x16x32_bf16 v[44:47], v[76:79], v[108:111], v[44:47]
  buffer_load_dwordx4 v[72:75], v2, s[8:11], s38 offen offset:3072 sc1
  buffer_load_dwordx4 v[76:79], v2, s[8:11], s39 offen offset:3072 sc1
  s_add_u32 s38, s38, 4096
  s_add_u32 s39, s39, 4096
  ds_read_b128 v[96:99], v4 offset:256
  ds_read_b128 v[100:103], v4 offset:20736
  ds_read_b128 v[104:107], v4 offset:41216
  ds_read_b128 v[108:111], v4 offset:61696
  s_waitcnt vmcnt(6) lgkmcnt(4)
  v_mfma_f32_16x16x32_bf16 v[16:19], v[48:51], v[80:83], v[16:19]
  v_mfma_f32_16x16x32_bf16 v[20:23], v[48:51], v[84:87], v[20:23]
  v_mfma_f32_16x16x32_bf16 v[24:27], v[48:51], v[88:91], v[24:27]
  v_mfma_f32_16x16x32_bf16 v[28:31], v[48:51], v[92:95], v[28:31]
  v_mfma_f32_16x16x32_bf16 v[32:35], v[52:55], v[80:83], v[32:35]
  v_mfma_f32_16x16x32_bf16 v[36:39], v[52:55], v[84:87], v[36:39]
  v_mfma_f32_16x16x32_bf16 v[40:43], v[52:55], v[88:91], v[40:43]
  v_mfma_f32_16x16x32_bf16 v[44:47], v[52:55], v[92:95], v[44:47]
  buffer_load_dwordx4 v[48:51], v2, s[8:11], s38 offen offset:0 sc1
  buffer_load_dwordx4 v[52:55], v2, s[8:11], s39 offen offset:0 sc1
  ds_read_b128 v[80:83], v5 offset:256
  ds_read_b128 v[84:87], v5 offset:20736
  ds_read_b128 v[88:91], v5 offset:41216
  ds_read_b128 v[92:95], v5 offset:61696
  s_waitcnt vmcnt(6) lgkmcnt(4)
  v_mfma_f32_16x16x32_bf16 v[16:19], v[56:59], v[96:99], v[16:19]
  v_mfma_f32_16x16x32_bf16 v[20:23], v[56:59], v[100:103], v[20:23]
  v_mfma_f32_16x16x32_bf16 v[24:27], v[56:59], v[104:107], v[24:27]
  v_mfma_f32_16x16x32_bf16 v[28:31], v[56:59], v[108:111], v[28:31]
  v_mfma_f32_16x16x32_bf16 v[32:35], v[60:63], v[96:99], v[32:35]
  v_mfma_f32_16x16x32_bf16 v[36:39], v[60:63], v[100:103], v[36:39]
  v_mfma_f32_16x16x32_bf16 v[40:43], v[60:63], v[104:107], v[40:43]
  v_mfma_f32_16x16x32_bf16 v[44:47], v[60:63], v[108:111], v[44:47]
  buffer_load_dwordx4 v[56:59], v2, s[8:11], s38 offen offset:1024 sc1
  buffer_load_dwordx4 v[60:63], v2, s[8:11], s39 offen offset:1024 sc1
  ds_read_b128 v[96:99], v6 offset:256
  ds_read_b128 v[100:103], v6 offset:20736
  ds_read_b128 v[104:107], v6 offset:41216
  ds_read_b128 v[108:111], v6 offset:61696
  s_waitcnt vmcnt(6) lgkmcnt(4)
  v_mfma_f32_16x16x32_bf16 v[16:19], v[64:67], v[80:83], v[16:19]
  v_mfma_f32_16x16x32_bf16 v[20:23], v[64:67], v[84:87], v[20:23]
  v_mfma_f32_16x16x32_bf16 v[24:27], v[64:67], v[88:91], v[24:27]
  v_mfma_f32_16x16x32_bf16 v[28:31], v[64:67], v[92:95], v[28:31]
  v_mfma_f32_16x16x32_bf16 v[32:35], v[68:71], v[80:83], v[32:35]
  v_mfma_f32_16x16x32_bf16 v[36:39], v[68:71], v[84:87], v[36:39]
  v_mfma_f32_16x16x32_bf16 v[40:43], v[68:71], v[88:91], v[40:43]
  v_mfma_f32_16x16x32_bf16 v[44:47], v[68:71], v[92:95], v[44:47]
  buffer_load_dwordx4 v[64:67], v2, s[8:11], s38 offen offset:2048 sc1
  buffer_load_dwordx4 v[68:71], v2, s[8:11], s39 offen offset:2048 sc1
  ds_read_b128 v[80:83], v3 offset:512
  ds_read_b128 v[84:87], v3 offset:20992
  ds_read_b128 v[88:91], v3 offset:41472
  ds_read_b128 v[92:95], v3 offset:61952
  s_waitcnt vmcnt(6) lgkmcnt(4)
  v_mfma_f32_16x16x32_bf16 v[16:19], v[72:75], v[96:99], v[16:19]
  v_mfma_f32_16x16x32_bf16 v[20:23], v[72:75], v[100:103], v[20:23]
  v_mfma_f32_16x16x32_bf16 v[24:27], v[72:75], v[104:107], v[24:27]
  v_mfma_f32_16x16x32_bf16 v[28:31], v[72:75], v[108:111], v[28:31]
  v_mfma_f32_16x16x32_bf16 v[32:35], v[76:79], v[96:99], v[32:35]
  v_mfma_f32_16x16x32_bf16 v[36:39], v[76:79], v[100:103], v[36:39]
  v_mfma_f32_16x16x32_bf16 v[40:43], v[76:79], v[104:107], v[40:43]
  v_mfma_f32_16x16x32_bf16 v[44:47], v[76:79], v[108:111], v[44:47]
  buffer_load_dwordx4 v[72:75], v2, s[8:11], s38 offen offset:3072 sc1
  buffer_load_dwordx4 v[76:79], v2, s[8:11], s39 offen offset:3072 sc1
  s_add_u32 s38, s38, 4096
  s_add_u32 s39, s39, 4096
  ds_read_b128 v[96:99], v4 offset:512
  ds_read_b128 v[100:103], v4 offset:20992
  ds_read_b128 v[104:107], v4 offset:41472
  ds_read_b128 v[108:111], v4 offset:61952
  s_waitcnt vmcnt(6) lgkmcnt(4)
  v_mfma_f32_16x16x32_bf16 v[16:19], v[48:51], v[80:83], v[16:19]
  v_mfma_f32_16x16x32_bf16 v[20:23], v[48:51], v[84:87], v[20:23]
  v_mfma_f32_16x16x32_bf16 v[24:27], v[48:51], v[88:91], v[24:27]
  v_mfma_f32_16x16x32_bf16 v[28:31], v[48:51], v[92:95], v[28:31]
  v_mfma_f32_16x16x32_bf16 v[32:35], v[52:55], v[80:83], v[32:35]
  v_mfma_f32_16x16x32_bf16 v[36:39], v[52:55], v[84:87], v[36:39]
  v_mfma_f32_16x16x32_bf16 v[40:43], v[52:55], v[88:91], v[40:43]
  v_mfma_f32_16x16x32_bf16 v[44:47], v[52:55], v[92:95], v[44:47]
  buffer_load_dwordx4 v[48:51], v2, s[8:11], s38 offen offset:0 sc1
  buffer_load_dwordx4 v[52:55], v2, s[8:11], s39 offen offset:0 sc1
  ds_read_b128 v[80:83], v5 offset:512
  ds_read_b128 v[84:87], v5 offset:20992
  ds_read_b128 v[88:91], v5 offset:41472
  ds_read_b128 v[92:95], v5 offset:61952
  s_waitcnt vmcnt(6) lgkmcnt(4)
  v_mfma_f32_16x16x32_bf16 v[16:19], v[56:59], v[96:99], v[16:19]
  v_mfma_f32_16x16x32_bf16 v[20:23], v[56:59], v[100:103], v[20:23]
  v_mfma_f32_16x16x32_bf16 v[24:27], v[56:59], v[104:107], v[24:27]
  v_mfma_f32_16x16x32_bf16 v[28:31], v[56:59], v[108:111], v[28:31]
  v_mfma_f32_16x16x32_bf16 v[32:35], v[60:63], v[96:99], v[32:35]
  v_mfma_f32_16x16x32_bf16 v[36:39], v[60:63], v[100:103], v[36:39]
  v_mfma_f32_16x16x32_bf16 v[40:43], v[60:63], v[104:107], v[40:43]
  v_mfma_f32_16x16x32_bf16 v[44:47], v[60:63], v[108:111], v[44:47]
  buffer_load_dwordx4 v[56:59], v2, s[8:11], s38 offen offset:1024 sc1
  buffer_load_dwordx4 v[60:63], v2, s[8:11], s39 offen offset:1024 sc1
  ds_read_b128 v[96:99], v6 offset:512
  ds_read_b128 v[100:103], v6 offset:20992
  ds_read_b128 v[104:107], v6 offset:41472
  ds_read_b128 v[108:111], v6 offset:61952
  s_waitcnt vmcnt(6) lgkmcnt(4)
  v_mfma_f32_16x16x32_bf16 v[16:19], v[64:67], v[80:83], v[16:19]
  v_mfma_f32_16x16x32_bf16 v[20:23], v[64:67], v[84:87], v[20:23]
  v_mfma_f32_16x16x32_bf16 v[24:27], v[64:67], v[88:91], v[24:27]
  v_mfma_f32_16x16x32_bf16 v[28:31], v[64:67], v[92:95], v[28:31]
  v_mfma_f32_16x16x32_bf16 v[32:35], v[68:71], v[80:83], v[32:35]
  v_mfma_f32_16x16x32_bf16 v[36:39], v[68:71], v[84:87], v[36:39]
  v_mfma_f32_16x16x32_bf16 v[40:43], v[68:71], v[88:91], v[40:43]
  v_mfma_f32_16x16x32_bf16 v[44:47], v[68:71], v[92:95], v[44:47]
  buffer_load_dwordx4 v[64:67], v2, s[8:11], s38 offen offset:2048 sc1
  buffer_load_dwordx4 v[68:71], v2, s[8:11], s39 offen offset:2048 sc1
  ds_read_b128 v[80:83], v3 offset:768
  ds_read_b128 v[84:87], v3 offset:21248
  ds_read_b128 v[88:91], v3 offset:41728
  ds_read_b128 v[92:95], v3 offset:62208
  s_waitcnt vmcnt(6) lgkmcnt(4)
  v_mfma_f32_16x16x32_bf16 v[16:19], v[72:75], v[96:99], v[16:19]
  v_mfma_f32_16x16x32_bf16 v[20:23], v[72:75], v[100:103], v[20:23]
  v_mfma_f32_16x16x32_bf16 v[24:27], v[72:75], v[104:107], v[24:27]
  v_mfma_f32_16x16x32_bf16 v[28:31], v[72:75], v[108:111], v[28:31]
  v_mfma_f32_16x16x32_bf16 v[32:35], v[76:79], v[96:99], v[32:35]
  v_mfma_f32_16x16x32_bf16 v[36:39], v[76:79], v[100:103], v[36:39]
  v_mfma_f32_16x16x32_bf16 v[40:43], v[76:79], v[104:107], v[40:43]
  v_mfma_f32_16x16x32_bf16 v[44:47], v[76:79], v[108:111], v[44:47]
  buffer_load_dwordx4 v[72:75], v2, s[8:11], s38 offen offset:3072 sc1
  buffer_load_dwordx4 v[76:79], v2, s[8:11], s39 offen offset:3072 sc1
  s_add_u32 s38, s38, 4096
  s_add_u32 s39, s39, 4096
  ds_read_b128 v[96:99], v4 offset:768
  ds_read_b128 v[100:103], v4 offset:21248
  ds_read_b128 v[104:107], v4 offset:41728
  ds_read_b128 v[108:111], v4 offset:62208
  s_waitcnt vmcnt(6) lgkmcnt(4)
  v_mfma_f32_16x16x32_bf16 v[16:19], v[48:51], v[80:83], v[16:19]
  v_mfma_f32_16x16x32_bf16 v[20:23], v[48:51], v[84:87], v[20:23]
  v_mfma_f32_16x16x32_bf16 v[24:27], v[48:51], v[88:91], v[24:27]
  v_mfma_f32_16x16x32_bf16 v[28:31], v[48:51], v[92:95], v[28:31]
  v_mfma_f32_16x16x32_bf16 v[32:35], v[52:55], v[80:83], v[32:35]
  v_mfma_f32_16x16x32_bf16 v[36:39], v[52:55], v[84:87], v[36:39]
  v_mfma_f32_16x16x32_bf16 v[40:43], v[52:55], v[88:91], v[40:43]
  v_mfma_f32_16x16x32_bf16 v[44:47], v[52:55], v[92:95], v[44:47]
  buffer_load_dwordx4 v[48:51], v2, s[8:11], s38 offen offset:0 sc1
  buffer_load_dwordx4 v[52:55], v2, s[8:11], s39 offen offset:0 sc1
  ds_read_b128 v[80:83], v5 offset:768
  ds_read_b128 v[84:87], v5 offset:21248
  ds_read_b128 v[88:91], v5 offset:41728
  ds_read_b128 v[92:95], v5 offset:62208
  s_waitcnt vmcnt(6) lgkmcnt(4)
  v_mfma_f32_16x16x32_bf16 v[16:19], v[56:59], v[96:99], v[16:19]
  v_mfma_f32_16x16x32_bf16 v[20:23], v[56:59], v[100:103], v[20:23]
  v_mfma_f32_16x16x32_bf16 v[24:27], v[56:59], v[104:107], v[24:27]
  v_mfma_f32_16x16x32_bf16 v[28:31], v[56:59], v[108:111], v[28:31]
  v_mfma_f32_16x16x32_bf16 v[32:35], v[60:63], v[96:99], v[32:35]
  v_mfma_f32_16x16x32_bf16 v[36:39], v[60:63], v[100:103], v[36:39]
  v_mfma_f32_16x16x32_bf16 v[40:43], v[60:63], v[104:107], v[40:43]
  v_mfma_f32_16x16x32_bf16 v[44:47], v[60:63], v[108:111], v[44:47]
  buffer_load_dwordx4 v[56:59], v2, s[8:11], s38 offen offset:1024 sc1
  buffer_load_dwordx4 v[60:63], v2, s[8:11], s39 offen offset:1024 sc1
  ds_read_b128 v[96:99], v6 offset:768
  ds_read_b128 v[100:103], v6 offset:21248
  ds_read_b128 v[104:107], v6 offset:41728
  ds_read_b128 v[108:111], v6 offset:62208
  s_waitcnt vmcnt(6) lgkmcnt(4)
  v_mfma_f32_16x16x32_bf16 v[16:19], v[64:67], v[80:83], v[16:19]
  v_mfma_f32_16x16x32_bf16 v[20:23], v[64:67], v[84:87], v[20:23]
  v_mfma_f32_16x16x32_bf16 v[24:27], v[64:67], v[88:91], v[24:27]
  v_mfma_f32_16x16x32_bf16 v[28:31], v[64:67], v[92:95], v[28:31]
  v_mfma_f32_16x16x32_bf16 v[32:35], v[68:71], v[80:83], v[32:35]
  v_mfma_f32_16x16x32_bf16 v[36:39], v[68:71], v[84:87], v[36:39]
  v_mfma_f32_16x16x32_bf16 v[40:43], v[68:71], v[88:91], v[40:43]
  v_mfma_f32_16x16x32_bf16 v[44:47], v[68:71], v[92:95], v[44:47]
  buffer_load_dwordx4 v[64:67], v2, s[8:11], s38 offen offset:2048 sc1
  buffer_load_dwordx4 v[68:71], v2, s[8:11], s39 offen offset:2048 sc1
  ds_read_b128 v[80:83], v3 offset:1024
  ds_read_b128 v[84:87], v3 offset:21504
  ds_read_b128 v[88:91], v3 offset:41984
  ds_read_b128 v[92:95], v3 offset:62464
  s_waitcnt vmcnt(6) lgkmcnt(4)
  v_mfma_f32_16x16x32_bf16 v[16:19], v[72:75], v[96:99], v[16:19]
  v_mfma_f32_16x16x32_bf16 v[20:23], v[72:75], v[100:103], v[20:23]
  v_mfma_f32_16x16x32_bf16 v[24:27], v[72:75], v[104:107], v[24:27]
  v_mfma_f32_16x16x32_bf16 v[28:31], v[72:75], v[108:111], v[28:31]
  v_mfma_f32_16x16x32_bf16 v[32:35], v[76:79], v[96:99], v[32:35]
  v_mfma_f32_16x16x32_bf16 v[36:39], v[76:79], v[100:103], v[36:39]
  v_mfma_f32_16x16x32_bf16 v[40:43], v[76:79], v[104:107], v[40:43]
  v_mfma_f32_16x16x32_bf16 v[44:47], v[76:79], v[108:111], v[44:47]
  buffer_load_dwordx4 v[72:75], v2, s[8:11], s38 offen offset:3072 sc1
  buffer_load_dwordx4 v[76:79], v2, s[8:11], s39 offen offset:3072 sc1
  s_add_u32 s38, s38, 4096
  s_add_u32 s39, s39, 4096
  ds_read_b128 v[96:99], v4 offset:1024
  ds_read_b128 v[100:103], v4 offset:21504
  ds_read_b128 v[104:107], v4 offset:41984
  ds_read_b128 v[108:111], v4 offset:62464
  s_waitcnt vmcnt(6) lgkmcnt(4)
  v_mfma_f32_16x16x32_bf16 v[16:19], v[48:51], v[80:83], v[16:19]
  v_mfma_f32_16x16x32_bf16 v[20:23], v[48:51], v[84:87], v[20:23]
  v_mfma_f32_16x16x32_bf16 v[24:27], v[48:51], v[88:91], v[24:27]
  v_mfma_f32_16x16x32_bf16 v[28:31], v[48:51], v[92:95], v[28:31]
  v_mfma_f32_16x16x32_bf16 v[32:35], v[52:55], v[80:83], v[32:35]
  v_mfma_f32_16x16x32_bf16 v[36:39], v[52:55], v[84:87], v[36:39]
  v_mfma_f32_16x16x32_bf16 v[40:43], v[52:55], v[88:91], v[40:43]
  v_mfma_f32_16x16x32_bf16 v[44:47], v[52:55], v[92:95], v[44:47]
  ds_read_b128 v[80:83], v5 offset:1024
  ds_read_b128 v[84:87], v5 offset:21504
  ds_read_b128 v[88:91], v5 offset:41984
  ds_read_b128 v[92:95], v5 offset:62464
  s_waitcnt vmcnt(4) lgkmcnt(4)
  v_mfma_f32_16x16x32_bf16 v[16:19], v[56:59], v[96:99], v[16:19]
  v_mfma_f32_16x16x32_bf16 v[20:23], v[56:59], v[100:103], v[20:23]
  v_mfma_f32_16x16x32_bf16 v[24:27], v[56:59], v[104:107], v[24:27]
  v_mfma_f32_16x16x32_bf16 v[28:31], v[56:59], v[108:111], v[28:31]
  v_mfma_f32_16x16x32_bf16 v[32:35], v[60:63], v[96:99], v[32:35]
  v_mfma_f32_16x16x32_bf16 v[36:39], v[60:63], v[100:103], v[36:39]
  v_mfma_f32_16x16x32_bf16 v[40:43], v[60:63], v[104:107], v[40:43]
  v_mfma_f32_16x16x32_bf16 v[44:47], v[60:63], v[108:111], v[44:47]
  ds_read_b128 v[96:99], v6 offset:1024
  ds_read_b128 v[100:103], v6 offset:21504
  ds_read_b128 v[104:107], v6 offset:41984
  ds_read_b128 v[108:111], v6 offset:62464
  s_waitcnt vmcnt(2) lgkmcnt(4)
  v_mfma_f32_16x16x32_bf16 v[16:19], v[64:67], v[80:83], v[16:19]
  v_mfma_f32_16x16x32_bf16 v[20:23], v[64:67], v[84:87], v[20:23]
  v_mfma_f32_16x16x32_bf16 v[24:27], v[64:67], v[88:91], v[24:27]
  v_mfma_f32_16x16x32_bf16 v[28:31], v[64:67], v[92:95], v[28:31]
  v_mfma_f32_16x16x32_bf16 v[32:35], v[68:71], v[80:83], v[32:35]
  v_mfma_f32_16x16x32_bf16 v[36:39], v[68:71], v[84:87], v[36:39]
  v_mfma_f32_16x16x32_bf16 v[40:43], v[68:71], v[88:91], v[40:43]
  v_mfma_f32_16x16x32_bf16 v[44:47], v[68:71], v[92:95], v[44:47]
  s_waitcnt vmcnt(0) lgkmcnt(0)
  v_mfma_f32_16x16x32_bf16 v[16:19], v[72:75], v[96:99], v[16:19]
  v_mfma_f32_16x16x32_bf16 v[20:23], v[72:75], v[100:103], v[20:23]
  v_mfma_f32_16x16x32_bf16 v[24:27], v[72:75], v[104:107], v[24:27]
  v_mfma_f32_16x16x32_bf16 v[28:31], v[72:75], v[108:111], v[28:31]
  v_mfma_f32_16x16x32_bf16 v[32:35], v[76:79], v[96:99], v[32:35]
  v_mfma_f32_16x16x32_bf16 v[36:39], v[76:79], v[100:103], v[36:39]
  v_mfma_f32_16x16x32_bf16 v[40:43], v[76:79], v[104:107], v[40:43]
  v_mfma_f32_16x16x32_bf16 v[44:47], v[76:79], v[108:111], v[44:47]
  s_nop 7
  v_cvt_pk_bf16_f32 v244, v16, v17
  v_lshlrev_b32 v245, 16, v244
  v_and_b32 v246, 0xffff0000, v244
  v_mul_f32 v247, s34, v245
  v_mul_f32 v248, s34, v246
  v_exp_f32 v247, v247
  v_exp_f32 v248, v248
  v_cmp_lt_f32 vcc, 0, v245
  v_add_f32 v245, 1.0, v245
  v_cmp_lt_f32 s[36:37], 0, v246
  v_cndmask_b32 v245, v247, v245, vcc
  v_add_f32 v246, 1.0, v246
  s_nop 0
  v_cndmask_b32 v246, v248, v246, s[36:37]
  v_cvt_pk_bf16_f32 v244, v245, v246
  v_lshlrev_b32 v245, 16, v244
  v_and_b32 v246, 0xffff0000, v244
  v_add_f32 v245, s35, v245
  v_add_f32 v246, s35, v246
  v_cvt_pk_bf16_f32 v128, v245, v246
  v_cvt_pk_bf16_f32 v250, v18, v19
  v_lshlrev_b32 v251, 16, v250
  v_and_b32 v252, 0xffff0000, v250
  v_mul_f32 v253, s34, v251
  v_mul_f32 v254, s34, v252
  v_exp_f32 v253, v253
  v_exp_f32 v254, v254
  v_cmp_lt_f32 vcc, 0, v251
  v_add_f32 v251, 1.0, v251
  v_cmp_lt_f32 s[36:37], 0, v252
  v_cndmask_b32 v251, v253, v251, vcc
  v_add_f32 v252, 1.0, v252
  s_nop 0
  v_cndmask_b32 v252, v254, v252, s[36:37]
  v_cvt_pk_bf16_f32 v250, v251, v252
  v_lshlrev_b32 v251, 16, v250
  v_and_b32 v252, 0xffff0000, v250
  v_add_f32 v251, s35, v251
  v_add_f32 v252, s35, v252
  v_cvt_pk_bf16_f32 v129, v251, v252
  v_cvt_pk_bf16_f32 v244, v20, v21
  v_lshlrev_b32 v245, 16, v244
  v_and_b32 v246, 0xffff0000, v244
  v_mul_f32 v247, s34, v245
  v_mul_f32 v248, s34, v246
  v_exp_f32 v247, v247
  v_exp_f32 v248, v248
  v_cmp_lt_f32 vcc, 0, v245
  v_add_f32 v245, 1.0, v245
  v_cmp_lt_f32 s[36:37], 0, v246
  v_cndmask_b32 v245, v247, v245, vcc
  v_add_f32 v246, 1.0, v246
  s_nop 0
  v_cndmask_b32 v246, v248, v246, s[36:37]
  v_cvt_pk_bf16_f32 v244, v245, v246
  v_lshlrev_b32 v245, 16, v244
  v_and_b32 v246, 0xffff0000, v244
  v_add_f32 v245, s35, v245
  v_add_f32 v246, s35, v246
  v_cvt_pk_bf16_f32 v130, v245, v246
  v_cvt_pk_bf16_f32 v250, v22, v23
  v_lshlrev_b32 v251, 16, v250
  v_and_b32 v252, 0xffff0000, v250
  v_mul_f32 v253, s34, v251
  v_mul_f32 v254, s34, v252
  v_exp_f32 v253, v253
  v_exp_f32 v254, v254
  v_cmp_lt_f32 vcc, 0, v251
  v_add_f32 v251, 1.0, v251
  v_cmp_lt_f32 s[36:37], 0, v252
  v_cndmask_b32 v251, v253, v251, vcc
  v_add_f32 v252, 1.0, v252
  s_nop 0
  v_cndmask_b32 v252, v254, v252, s[36:37]
  v_cvt_pk_bf16_f32 v250, v251, v252
  v_lshlrev_b32 v251, 16, v250
  v_and_b32 v252, 0xffff0000, v250
  v_add_f32 v251, s35, v251
  v_add_f32 v252, s35, v252
  v_cvt_pk_bf16_f32 v131, v251, v252
  v_cvt_pk_bf16_f32 v244, v24, v25
  v_lshlrev_b32 v245, 16, v244
  v_and_b32 v246, 0xffff0000, v244
  v_mul_f32 v247, s34, v245
  v_mul_f32 v248, s34, v246
  v_exp_f32 v247, v247
  v_exp_f32 v248, v248
  v_cmp_lt_f32 vcc, 0, v245
  v_add_f32 v245, 1.0, v245
  v_cmp_lt_f32 s[36:37], 0, v246
  v_cndmask_b32 v245, v247, v245, vcc
  v_add_f32 v246, 1.0, v246
  s_nop 0
  v_cndmask_b32 v246, v248, v246, s[36:37]
  v_cvt_pk_bf16_f32 v244, v245, v246
  v_lshlrev_b32 v245, 16, v244
  v_and_b32 v246, 0xffff0000, v244
  v_add_f32 v245, s35, v245
  v_add_f32 v246, s35, v246
  v_cvt_pk_bf16_f32 v132, v245, v246
  v_cvt_pk_bf16_f32 v250, v26, v27
  v_lshlrev_b32 v251, 16, v250
  v_and_b32 v252, 0xffff0000, v250
  v_mul_f32 v253, s34, v251
  v_mul_f32 v254, s34, v252
  v_exp_f32 v253, v253
  v_exp_f32 v254, v254
  v_cmp_lt_f32 vcc, 0, v251
  v_add_f32 v251, 1.0, v251
  v_cmp_lt_f32 s[36:37], 0, v252
  v_cndmask_b32 v251, v253, v251, vcc
  v_add_f32 v252, 1.0, v252
  s_nop 0
  v_cndmask_b32 v252, v254, v252, s[36:37]
  v_cvt_pk_bf16_f32 v250, v251, v252
  v_lshlrev_b32 v251, 16, v250
  v_and_b32 v252, 0xffff0000, v250
  v_add_f32 v251, s35, v251
  v_add_f32 v252, s35, v252
  v_cvt_pk_bf16_f32 v133, v251, v252
  v_cvt_pk_bf16_f32 v244, v28, v29
  v_lshlrev_b32 v245, 16, v244
  v_and_b32 v246, 0xffff0000, v244
  v_mul_f32 v247, s34, v245
  v_mul_f32 v248, s34, v246
  v_exp_f32 v247, v247
  v_exp_f32 v248, v248
  v_cmp_lt_f32 vcc, 0, v245
  v_add_f32 v245, 1.0, v245
  v_cmp_lt_f32 s[36:37], 0, v246
  v_cndmask_b32 v245, v247, v245, vcc
  v_add_f32 v246, 1.0, v246
  s_nop 0
  v_cndmask_b32 v246, v248, v246, s[36:37]
  v_cvt_pk_bf16_f32 v244, v245, v246
  v_lshlrev_b32 v245, 16, v244
  v_and_b32 v246, 0xffff0000, v244
  v_add_f32 v245, s35, v245
  v_add_f32 v246, s35, v246
  v_cvt_pk_bf16_f32 v134, v245, v246
  v_cvt_pk_bf16_f32 v250, v30, v31
  v_lshlrev_b32 v251, 16, v250
  v_and_b32 v252, 0xffff0000, v250
  v_mul_f32 v253, s34, v251
  v_mul_f32 v254, s34, v252
  v_exp_f32 v253, v253
  v_exp_f32 v254, v254
  v_cmp_lt_f32 vcc, 0, v251
  v_add_f32 v251, 1.0, v251
  v_cmp_lt_f32 s[36:37], 0, v252
  v_cndmask_b32 v251, v253, v251, vcc
  v_add_f32 v252, 1.0, v252
  s_nop 0
  v_cndmask_b32 v252, v254, v252, s[36:37]
  v_cvt_pk_bf16_f32 v250, v251, v252
  v_lshlrev_b32 v251, 16, v250
  v_and_b32 v252, 0xffff0000, v250
  v_add_f32 v251, s35, v251
  v_add_f32 v252, s35, v252
  v_cvt_pk_bf16_f32 v135, v251, v252
  v_cvt_pk_bf16_f32 v244, v32, v33
  v_lshlrev_b32 v245, 16, v244
  v_and_b32 v246, 0xffff0000, v244
  v_mul_f32 v247, s34, v245
  v_mul_f32 v248, s34, v246
  v_exp_f32 v247, v247
  v_exp_f32 v248, v248
  v_cmp_lt_f32 vcc, 0, v245
  v_add_f32 v245, 1.0, v245
  v_cmp_lt_f32 s[36:37], 0, v246
  v_cndmask_b32 v245, v247, v245, vcc
  v_add_f32 v246, 1.0, v246
  s_nop 0
  v_cndmask_b32 v246, v248, v246, s[36:37]
  v_cvt_pk_bf16_f32 v244, v245, v246
  v_lshlrev_b32 v245, 16, v244
  v_and_b32 v246, 0xffff0000, v244
  v_add_f32 v245, s35, v245
  v_add_f32 v246, s35, v246
  v_cvt_pk_bf16_f32 v136, v245, v246
  v_cvt_pk_bf16_f32 v250, v34, v35
  v_lshlrev_b32 v251, 16, v250
  v_and_b32 v252, 0xffff0000, v250
  v_mul_f32 v253, s34, v251
  v_mul_f32 v254, s34, v252
  v_exp_f32 v253, v253
  v_exp_f32 v254, v254
  v_cmp_lt_f32 vcc, 0, v251
  v_add_f32 v251, 1.0, v251
  v_cmp_lt_f32 s[36:37], 0, v252
  v_cndmask_b32 v251, v253, v251, vcc
  v_add_f32 v252, 1.0, v252
  s_nop 0
  v_cndmask_b32 v252, v254, v252, s[36:37]
  v_cvt_pk_bf16_f32 v250, v251, v252
  v_lshlrev_b32 v251, 16, v250
  v_and_b32 v252, 0xffff0000, v250
  v_add_f32 v251, s35, v251
  v_add_f32 v252, s35, v252
  v_cvt_pk_bf16_f32 v137, v251, v252
  v_cvt_pk_bf16_f32 v244, v36, v37
  v_lshlrev_b32 v245, 16, v244
  v_and_b32 v246, 0xffff0000, v244
  v_mul_f32 v247, s34, v245
  v_mul_f32 v248, s34, v246
  v_exp_f32 v247, v247
  v_exp_f32 v248, v248
  v_cmp_lt_f32 vcc, 0, v245
  v_add_f32 v245, 1.0, v245
  v_cmp_lt_f32 s[36:37], 0, v246
  v_cndmask_b32 v245, v247, v245, vcc
  v_add_f32 v246, 1.0, v246
  s_nop 0
  v_cndmask_b32 v246, v248, v246, s[36:37]
  v_cvt_pk_bf16_f32 v244, v245, v246
  v_lshlrev_b32 v245, 16, v244
  v_and_b32 v246, 0xffff0000, v244
  v_add_f32 v245, s35, v245
  v_add_f32 v246, s35, v246
  v_cvt_pk_bf16_f32 v138, v245, v246
  v_cvt_pk_bf16_f32 v250, v38, v39
  v_lshlrev_b32 v251, 16, v250
  v_and_b32 v252, 0xffff0000, v250
  v_mul_f32 v253, s34, v251
  v_mul_f32 v254, s34, v252
  v_exp_f32 v253, v253
  v_exp_f32 v254, v254
  v_cmp_lt_f32 vcc, 0, v251
  v_add_f32 v251, 1.0, v251
  v_cmp_lt_f32 s[36:37], 0, v252
  v_cndmask_b32 v251, v253, v251, vcc
  v_add_f32 v252, 1.0, v252
  s_nop 0
  v_cndmask_b32 v252, v254, v252, s[36:37]
  v_cvt_pk_bf16_f32 v250, v251, v252
  v_lshlrev_b32 v251, 16, v250
  v_and_b32 v252, 0xffff0000, v250
  v_add_f32 v251, s35, v251
  v_add_f32 v252, s35, v252
  v_cvt_pk_bf16_f32 v139, v251, v252
  v_cvt_pk_bf16_f32 v244, v40, v41
  v_lshlrev_b32 v245, 16, v244
  v_and_b32 v246, 0xffff0000, v244
  v_mul_f32 v247, s34, v245
  v_mul_f32 v248, s34, v246
  v_exp_f32 v247, v247
  v_exp_f32 v248, v248
  v_cmp_lt_f32 vcc, 0, v245
  v_add_f32 v245, 1.0, v245
  v_cmp_lt_f32 s[36:37], 0, v246
  v_cndmask_b32 v245, v247, v245, vcc
  v_add_f32 v246, 1.0, v246
  s_nop 0
  v_cndmask_b32 v246, v248, v246, s[36:37]
  v_cvt_pk_bf16_f32 v244, v245, v246
  v_lshlrev_b32 v245, 16, v244
  v_and_b32 v246, 0xffff0000, v244
  v_add_f32 v245, s35, v245
  v_add_f32 v246, s35, v246
  v_cvt_pk_bf16_f32 v140, v245, v246
  v_cvt_pk_bf16_f32 v250, v42, v43
  v_lshlrev_b32 v251, 16, v250
  v_and_b32 v252, 0xffff0000, v250
  v_mul_f32 v253, s34, v251
  v_mul_f32 v254, s34, v252
  v_exp_f32 v253, v253
  v_exp_f32 v254, v254
  v_cmp_lt_f32 vcc, 0, v251
  v_add_f32 v251, 1.0, v251
  v_cmp_lt_f32 s[36:37], 0, v252
  v_cndmask_b32 v251, v253, v251, vcc
  v_add_f32 v252, 1.0, v252
  s_nop 0
  v_cndmask_b32 v252, v254, v252, s[36:37]
  v_cvt_pk_bf16_f32 v250, v251, v252
  v_lshlrev_b32 v251, 16, v250
  v_and_b32 v252, 0xffff0000, v250
  v_add_f32 v251, s35, v251
  v_add_f32 v252, s35, v252
  v_cvt_pk_bf16_f32 v141, v251, v252
  v_cvt_pk_bf16_f32 v244, v44, v45
  v_lshlrev_b32 v245, 16, v244
  v_and_b32 v246, 0xffff0000, v244
  v_mul_f32 v247, s34, v245
  v_mul_f32 v248, s34, v246
  v_exp_f32 v247, v247
  v_exp_f32 v248, v248
  v_cmp_lt_f32 vcc, 0, v245
  v_add_f32 v245, 1.0, v245
  v_cmp_lt_f32 s[36:37], 0, v246
  v_cndmask_b32 v245, v247, v245, vcc
  v_add_f32 v246, 1.0, v246
  s_nop 0
  v_cndmask_b32 v246, v248, v246, s[36:37]
  v_cvt_pk_bf16_f32 v244, v245, v246
  v_lshlrev_b32 v245, 16, v244
  v_and_b32 v246, 0xffff0000, v244
  v_add_f32 v245, s35, v245
  v_add_f32 v246, s35, v246
  v_cvt_pk_bf16_f32 v142, v245, v246
  v_cvt_pk_bf16_f32 v250, v46, v47
  v_lshlrev_b32 v251, 16, v250
  v_and_b32 v252, 0xffff0000, v250
  v_mul_f32 v253, s34, v251
  v_mul_f32 v254, s34, v252
  v_exp_f32 v253, v253
  v_exp_f32 v254, v254
  v_cmp_lt_f32 vcc, 0, v251
  v_add_f32 v251, 1.0, v251
  v_cmp_lt_f32 s[36:37], 0, v252
  v_cndmask_b32 v251, v253, v251, vcc
  v_add_f32 v252, 1.0, v252
  s_nop 0
  v_cndmask_b32 v252, v254, v252, s[36:37]
  v_cvt_pk_bf16_f32 v250, v251, v252
  v_lshlrev_b32 v251, 16, v250
  v_and_b32 v252, 0xffff0000, v250
  v_add_f32 v251, s35, v251
  v_add_f32 v252, s35, v252
  v_cvt_pk_bf16_f32 v143, v251, v252
  s_mul_i32 s38, s3, 102400
  s_add_u32 s38, s38, 83968000
  buffer_load_dwordx4 v[48:51], v2, s[8:11], s38 offen offset:0 sc1
  buffer_load_dwordx4 v[56:59], v2, s[8:11], s38 offen offset:1024 sc1
  buffer_load_dwordx4 v[64:67], v2, s[8:11], s38 offen offset:2048 sc1
  ds_read_b128 v[80:83], v3 offset:0
  ds_read_b128 v[84:87], v3 offset:20480
  ds_read_b128 v[88:91], v3 offset:40960
  ds_read_b128 v[92:95], v3 offset:61440
  buffer_load_dwordx4 v[72:75], v2, s[8:11], s38 offen offset:3072 sc1
  s_add_u32 s38, s38, 4096
  ds_read_b128 v[96:99], v4 offset:0
  ds_read_b128 v[100:103], v4 offset:20480
  ds_read_b128 v[104:107], v4 offset:40960
  ds_read_b128 v[108:111], v4 offset:61440
  s_waitcnt vmcnt(3) lgkmcnt(4)
  v_mfma_f32_16x16x32_bf16 v[16:19], v[48:51], v[80:83], 0
  v_mfma_f32_16x16x32_bf16 v[20:23], v[48:51], v[84:87], 0
  v_mfma_f32_16x16x32_bf16 v[24:27], v[48:51], v[88:91], 0
  v_mfma_f32_16x16x32_bf16 v[28:31], v[48:51], v[92:95], 0
  buffer_load_dwordx4 v[48:51], v2, s[8:11], s38 offen offset:0 sc1
  ds_read_b128 v[80:83], v5 offset:0
  ds_read_b128 v[84:87], v5 offset:20480
  ds_read_b128 v[88:91], v5 offset:40960
  ds_read_b128 v[92:95], v5 offset:61440
  s_waitcnt vmcnt(3) lgkmcnt(4)
  v_mfma_f32_16x16x32_bf16 v[16:19], v[56:59], v[96:99], v[16:19]
  v_mfma_f32_16x16x32_bf16 v[20:23], v[56:59], v[100:103], v[20:23]
  v_mfma_f32_16x16x32_bf16 v[24:27], v[56:59], v[104:107], v[24:27]
  v_mfma_f32_16x16x32_bf16 v[28:31], v[56:59], v[108:111], v[28:31]
  buffer_load_dwordx4 v[56:59], v2, s[8:11], s38 offen offset:1024 sc1
  ds_read_b128 v[96:99], v6 offset:0
  ds_read_b128 v[100:103], v6 offset:20480
  ds_read_b128 v[104:107], v6 offset:40960
  ds_read_b128 v[108:111], v6 offset:61440
  s_waitcnt vmcnt(3) lgkmcnt(4)
  v_mfma_f32_16x16x32_bf16 v[16:19], v[64:67], v[80:83], v[16:19]
  v_mfma_f32_16x16x32_bf16 v[20:23], v[64:67], v[84:87], v[20:23]
  v_mfma_f32_16x16x32_bf16 v[24:27], v[64:67], v[88:91], v[24:27]
  v_mfma_f32_16x16x32_bf16 v[28:31], v[64:67], v[92:95], v[28:31]
  buffer_load_dwordx4 v[64:67], v2, s[8:11], s38 offen offset:2048 sc1
  ds_read_b128 v[80:83], v3 offset:256
  ds_read_b128 v[84:87], v3 offset:20736
  ds_read_b128 v[88:91], v3 offset:41216
  ds_read_b128 v[92:95], v3 offset:61696
  s_waitcnt vmcnt(3) lgkmcnt(4)
  v_mfma_f32_16x16x32_bf16 v[16:19], v[72:75], v[96:99], v[16:19]
  v_mfma_f32_16x16x32_bf16 v[20:23], v[72:75], v[100:103], v[20:23]
  v_mfma_f32_16x16x32_bf16 v[24:27], v[72:75], v[104:107], v[24:27]
  v_mfma_f32_16x16x32_bf16 v[28:31], v[72:75], v[108:111], v[28:31]
  buffer_load_dwordx4 v[72:75], v2, s[8:11], s38 offen offset:3072 sc1
  s_add_u32 s38, s38, 4096
  ds_read_b128 v[96:99], v4 offset:256
  ds_read_b128 v[100:103], v4 offset:20736
  ds_read_b128 v[104:107], v4 offset:41216
  ds_read_b128 v[108:111], v4 offset:61696
  s_waitcnt vmcnt(3) lgkmcnt(4)
  v_mfma_f32_16x16x32_bf16 v[16:19], v[48:51], v[80:83], v[16:19]
  v_mfma_f32_16x16x32_bf16 v[20:23], v[48:51], v[84:87], v[20:23]
  v_mfma_f32_16x16x32_bf16 v[24:27], v[48:51], v[88:91], v[24:27]
  v_mfma_f32_16x16x32_bf16 v[28:31], v[48:51], v[92:95], v[28:31]
  buffer_load_dwordx4 v[48:51], v2, s[8:11], s38 offen offset:0 sc1
  ds_read_b128 v[80:83], v5 offset:256
  ds_read_b128 v[84:87], v5 offset:20736
  ds_read_b128 v[88:91], v5 offset:41216
  ds_read_b128 v[92:95], v5 offset:61696
  s_waitcnt vmcnt(3) lgkmcnt(4)
  v_mfma_f32_16x16x32_bf16 v[16:19], v[56:59], v[96:99], v[16:19]
  v_mfma_f32_16x16x32_bf16 v[20:23], v[56:59], v[100:103], v[20:23]
  v_mfma_f32_16x16x32_bf16 v[24:27], v[56:59], v[104:107], v[24:27]
  v_mfma_f32_16x16x32_bf16 v[28:31], v[56:59], v[108:111], v[28:31]
  buffer_load_dwordx4 v[56:59], v2, s[8:11], s38 offen offset:1024 sc1
  ds_read_b128 v[96:99], v6 offset:256
  ds_read_b128 v[100:103], v6 offset:20736
  ds_read_b128 v[104:107], v6 offset:41216
  ds_read_b128 v[108:111], v6 offset:61696
  s_waitcnt vmcnt(3) lgkmcnt(4)
  v_mfma_f32_16x16x32_bf16 v[16:19], v[64:67], v[80:83], v[16:19]
  v_mfma_f32_16x16x32_bf16 v[20:23], v[64:67], v[84:87], v[20:23]
  v_mfma_f32_16x16x32_bf16 v[24:27], v[64:67], v[88:91], v[24:27]
  v_mfma_f32_16x16x32_bf16 v[28:31], v[64:67], v[92:95], v[28:31]
  buffer_load_dwordx4 v[64:67], v2, s[8:11], s38 offen offset:2048 sc1
  ds_read_b128 v[80:83], v3 offset:512
  ds_read_b128 v[84:87], v3 offset:20992
  ds_read_b128 v[88:91], v3 offset:41472
  ds_read_b128 v[92:95], v3 offset:61952
  s_waitcnt vmcnt(3) lgkmcnt(4)
  v_mfma_f32_16x16x32_bf16 v[16:19], v[72:75], v[96:99], v[16:19]
  v_mfma_f32_16x16x32_bf16 v[20:23], v[72:75], v[100:103], v[20:23]
  v_mfma_f32_16x16x32_bf16 v[24:27], v[72:75], v[104:107], v[24:27]
  v_mfma_f32_16x16x32_bf16 v[28:31], v[72:75], v[108:111], v[28:31]
  buffer_load_dwordx4 v[72:75], v2, s[8:11], s38 offen offset:3072 sc1
  s_add_u32 s38, s38, 4096
  ds_read_b128 v[96:99], v4 offset:512
  ds_read_b128 v[100:103], v4 offset:20992
  ds_read_b128 v[104:107], v4 offset:41472
  ds_read_b128 v[108:111], v4 offset:61952
  s_waitcnt vmcnt(3) lgkmcnt(4)
  v_mfma_f32_16x16x32_bf16 v[16:19], v[48:51], v[80:83], v[16:19]
  v_mfma_f32_16x16x32_bf16 v[20:23], v[48:51], v[84:87], v[20:23]
  v_mfma_f32_16x16x32_bf16 v[24:27], v[48:51], v[88:91], v[24:27]
  v_mfma_f32_16x16x32_bf16 v[28:31], v[48:51], v[92:95], v[28:31]
  buffer_load_dwordx4 v[48:51], v2, s[8:11], s38 offen offset:0 sc1
  ds_read_b128 v[80:83], v5 offset:512
  ds_read_b128 v[84:87], v5 offset:20992
  ds_read_b128 v[88:91], v5 offset:41472
  ds_read_b128 v[92:95], v5 offset:61952
  s_waitcnt vmcnt(3) lgkmcnt(4)
  v_mfma_f32_16x16x32_bf16 v[16:19], v[56:59], v[96:99], v[16:19]
  v_mfma_f32_16x16x32_bf16 v[20:23], v[56:59], v[100:103], v[20:23]
  v_mfma_f32_16x16x32_bf16 v[24:27], v[56:59], v[104:107], v[24:27]
  v_mfma_f32_16x16x32_bf16 v[28:31], v[56:59], v[108:111], v[28:31]
  buffer_load_dwordx4 v[56:59], v2, s[8:11], s38 offen offset:1024 sc1
  ds_read_b128 v[96:99], v6 offset:512
  ds_read_b128 v[100:103], v6 offset:20992
  ds_read_b128 v[104:107], v6 offset:41472
  ds_read_b128 v[108:111], v6 offset:61952
  s_waitcnt vmcnt(3) lgkmcnt(4)
  v_mfma_f32_16x16x32_bf16 v[16:19], v[64:67], v[80:83], v[16:19]
  v_mfma_f32_16x16x32_bf16 v[20:23], v[64:67], v[84:87], v[20:23]
  v_mfma_f32_16x16x32_bf16 v[24:27], v[64:67], v[88:91], v[24:27]
  v_mfma_f32_16x16x32_bf16 v[28:31], v[64:67], v[92:95], v[28:31]
  buffer_load_dwordx4 v[64:67], v2, s[8:11], s38 offen offset:2048 sc1
  ds_read_b128 v[80:83], v3 offset:768
  ds_read_b128 v[84:87], v3 offset:21248
  ds_read_b128 v[88:91], v3 offset:41728
  ds_read_b128 v[92:95], v3 offset:62208
  s_waitcnt vmcnt(3) lgkmcnt(4)
  v_mfma_f32_16x16x32_bf16 v[16:19], v[72:75], v[96:99], v[16:19]
  v_mfma_f32_16x16x32_bf16 v[20:23], v[72:75], v[100:103], v[20:23]
  v_mfma_f32_16x16x32_bf16 v[24:27], v[72:75], v[104:107], v[24:27]
  v_mfma_f32_16x16x32_bf16 v[28:31], v[72:75], v[108:111], v[28:31]
  buffer_load_dwordx4 v[72:75], v2, s[8:11], s38 offen offset:3072 sc1
  s_add_u32 s38, s38, 4096
  ds_read_b128 v[96:99], v4 offset:768
  ds_read_b128 v[100:103], v4 offset:21248
  ds_read_b128 v[104:107], v4 offset:41728
  ds_read_b128 v[108:111], v4 offset:62208
  s_waitcnt vmcnt(3) lgkmcnt(4)
  v_mfma_f32_16x16x32_bf16 v[16:19], v[48:51], v[80:83], v[16:19]
  v_mfma_f32_16x16x32_bf16 v[20:23], v[48:51], v[84:87], v[20:23]
  v_mfma_f32_16x16x32_bf16 v[24:27], v[48:51], v[88:91], v[24:27]
  v_mfma_f32_16x16x32_bf16 v[28:31], v[48:51], v[92:95], v[28:31]
  buffer_load_dwordx4 v[48:51], v2, s[8:11], s38 offen offset:0 sc1
  ds_read_b128 v[80:83], v5 offset:768
  ds_read_b128 v[84:87], v5 offset:21248
  ds_read_b128 v[88:91], v5 offset:41728
  ds_read_b128 v[92:95], v5 offset:62208
  s_waitcnt vmcnt(3) lgkmcnt(4)
  v_mfma_f32_16x16x32_bf16 v[16:19], v[56:59], v[96:99], v[16:19]
  v_mfma_f32_16x16x32_bf16 v[20:23], v[56:59], v[100:103], v[20:23]
  v_mfma_f32_16x16x32_bf16 v[24:27], v[56:59], v[104:107], v[24:27]
  v_mfma_f32_16x16x32_bf16 v[28:31], v[56:59], v[108:111], v[28:31]
  buffer_load_dwordx4 v[56:59], v2, s[8:11], s38 offen offset:1024 sc1
  ds_read_b128 v[96:99], v6 offset:768
  ds_read_b128 v[100:103], v6 offset:21248
  ds_read_b128 v[104:107], v6 offset:41728
  ds_read_b128 v[108:111], v6 offset:62208
  s_waitcnt vmcnt(3) lgkmcnt(4)
  v_mfma_f32_16x16x32_bf16 v[16:19], v[64:67], v[80:83], v[16:19]
  v_mfma_f32_16x16x32_bf16 v[20:23], v[64:67], v[84:87], v[20:23]
  v_mfma_f32_16x16x32_bf16 v[24:27], v[64:67], v[88:91], v[24:27]
  v_mfma_f32_16x16x32_bf16 v[28:31], v[64:67], v[92:95], v[28:31]
  buffer_load_dwordx4 v[64:67], v2, s[8:11], s38 offen offset:2048 sc1
  ds_read_b128 v[80:83], v3 offset:1024
  ds_read_b128 v[84:87], v3 offset:21504
  ds_read_b128 v[88:91], v3 offset:41984
  ds_read_b128 v[92:95], v3 offset:62464
  s_waitcnt vmcnt(3) lgkmcnt(4)
  v_mfma_f32_16x16x32_bf16 v[16:19], v[72:75], v[96:99], v[16:19]
  v_mfma_f32_16x16x32_bf16 v[20:23], v[72:75], v[100:103], v[20:23]
  v_mfma_f32_16x16x32_bf16 v[24:27], v[72:75], v[104:107], v[24:27]
  v_mfma_f32_16x16x32_bf16 v[28:31], v[72:75], v[108:111], v[28:31]
  buffer_load_dwordx4 v[72:75], v2, s[8:11], s38 offen offset:3072 sc1
  s_add_u32 s38, s38, 4096
  ds_read_b128 v[96:99], v4 offset:1024
  ds_read_b128 v[100:103], v4 offset:21504
  ds_read_b128 v[104:107], v4 offset:41984
  ds_read_b128 v[108:111], v4 offset:62464
  s_waitcnt vmcnt(3) lgkmcnt(4)
  v_mfma_f32_16x16x32_bf16 v[16:19], v[48:51], v[80:83], v[16:19]
  v_mfma_f32_16x16x32_bf16 v[20:23], v[48:51], v[84:87], v[20:23]
  v_mfma_f32_16x16x32_bf16 v[24:27], v[48:51], v[88:91], v[24:27]
  v_mfma_f32_16x16x32_bf16 v[28:31], v[48:51], v[92:95], v[28:31]
  ds_read_b128 v[80:83], v5 offset:1024
  ds_read_b128 v[84:87], v5 offset:21504
  ds_read_b128 v[88:91], v5 offset:41984
  ds_read_b128 v[92:95], v5 offset:62464
  s_waitcnt vmcnt(2) lgkmcnt(4)
  v_mfma_f32_16x16x32_bf16 v[16:19], v[56:59], v[96:99], v[16:19]
  v_mfma_f32_16x16x32_bf16 v[20:23], v[56:59], v[100:103], v[20:23]
  v_mfma_f32_16x16x32_bf16 v[24:27], v[56:59], v[104:107], v[24:27]
  v_mfma_f32_16x16x32_bf16 v[28:31], v[56:59], v[108:111], v[28:31]
  ds_read_b128 v[96:99], v6 offset:1024
  ds_read_b128 v[100:103], v6 offset:21504
  ds_read_b128 v[104:107], v6 offset:41984
  ds_read_b128 v[108:111], v6 offset:62464
  s_waitcnt vmcnt(1) lgkmcnt(4)
  v_mfma_f32_16x16x32_bf16 v[16:19], v[64:67], v[80:83], v[16:19]
  v_mfma_f32_16x16x32_bf16 v[20:23], v[64:67], v[84:87], v[20:23]
  v_mfma_f32_16x16x32_bf16 v[24:27], v[64:67], v[88:91], v[24:27]
  v_mfma_f32_16x16x32_bf16 v[28:31], v[64:67], v[92:95], v[28:31]
  s_waitcnt vmcnt(0) lgkmcnt(0)
  v_mfma_f32_16x16x32_bf16 v[16:19], v[72:75], v[96:99], v[16:19]
  v_mfma_f32_16x16x32_bf16 v[20:23], v[72:75], v[100:103], v[20:23]
  v_mfma_f32_16x16x32_bf16 v[24:27], v[72:75], v[104:107], v[24:27]
  v_mfma_f32_16x16x32_bf16 v[28:31], v[72:75], v[108:111], v[28:31]
  s_nop 7
  v_cvt_pk_bf16_f32 v244, v16, v17
  v_lshlrev_b32 v245, 16, v244
  v_and_b32 v246, 0xffff0000, v244
  v_mul_f32 v247, s34, v245
  v_mul_f32 v248, s34, v246
  v_exp_f32 v247, v247
  v_exp_f32 v248, v248
  v_cmp_lt_f32 vcc, 0, v245
  v_add_f32 v245, 1.0, v245
  v_cmp_lt_f32 s[36:37], 0, v246
  v_cndmask_b32 v245, v247, v245, vcc
  v_add_f32 v246, 1.0, v246
  s_nop 0
  v_cndmask_b32 v246, v248, v246, s[36:37]
  v_cvt_pk_bf16_f32 v244, v245, v246
  v_lshlrev_b32 v245, 16, v244
  v_and_b32 v246, 0xffff0000, v244
  v_add_f32 v245, s35, v245
  v_add_f32 v246, s35, v246
  v_cvt_pk_bf16_f32 v144, v245, v246
  v_cvt_pk_bf16_f32 v250, v18, v19
  v_lshlrev_b32 v251, 16, v250
  v_and_b32 v252, 0xffff0000, v250
  v_mul_f32 v253, s34, v251
  v_mul_f32 v254, s34, v252
  v_exp_f32 v253, v253
  v_exp_f32 v254, v254
  v_cmp_lt_f32 vcc, 0, v251
  v_add_f32 v251, 1.0, v251
  v_cmp_lt_f32 s[36:37], 0, v252
  v_cndmask_b32 v251, v253, v251, vcc
  v_add_f32 v252, 1.0, v252
  s_nop 0
  v_cndmask_b32 v252, v254, v252, s[36:37]
  v_cvt_pk_bf16_f32 v250, v251, v252
  v_lshlrev_b32 v251, 16, v250
  v_and_b32 v252, 0xffff0000, v250
  v_add_f32 v251, s35, v251
  v_add_f32 v252, s35, v252
  v_cvt_pk_bf16_f32 v145, v251, v252
  v_cvt_pk_bf16_f32 v244, v20, v21
  v_lshlrev_b32 v245, 16, v244
  v_and_b32 v246, 0xffff0000, v244
  v_mul_f32 v247, s34, v245
  v_mul_f32 v248, s34, v246
  v_exp_f32 v247, v247
  v_exp_f32 v248, v248
  v_cmp_lt_f32 vcc, 0, v245
  v_add_f32 v245, 1.0, v245
  v_cmp_lt_f32 s[36:37], 0, v246
  v_cndmask_b32 v245, v247, v245, vcc
  v_add_f32 v246, 1.0, v246
  s_nop 0
  v_cndmask_b32 v246, v248, v246, s[36:37]
  v_cvt_pk_bf16_f32 v244, v245, v246
  v_lshlrev_b32 v245, 16, v244
  v_and_b32 v246, 0xffff0000, v244
  v_add_f32 v245, s35, v245
  v_add_f32 v246, s35, v246
  v_cvt_pk_bf16_f32 v146, v245, v246
  v_cvt_pk_bf16_f32 v250, v22, v23
  v_lshlrev_b32 v251, 16, v250
  v_and_b32 v252, 0xffff0000, v250
  v_mul_f32 v253, s34, v251
  v_mul_f32 v254, s34, v252
  v_exp_f32 v253, v253
  v_exp_f32 v254, v254
  v_cmp_lt_f32 vcc, 0, v251
  v_add_f32 v251, 1.0, v251
  v_cmp_lt_f32 s[36:37], 0, v252
  v_cndmask_b32 v251, v253, v251, vcc
  v_add_f32 v252, 1.0, v252
  s_nop 0
  v_cndmask_b32 v252, v254, v252, s[36:37]
  v_cvt_pk_bf16_f32 v250, v251, v252
  v_lshlrev_b32 v251, 16, v250
  v_and_b32 v252, 0xffff0000, v250
  v_add_f32 v251, s35, v251
  v_add_f32 v252, s35, v252
  v_cvt_pk_bf16_f32 v147, v251, v252
  v_cvt_pk_bf16_f32 v244, v24, v25
  v_lshlrev_b32 v245, 16, v244
  v_and_b32 v246, 0xffff0000, v244
  v_mul_f32 v247, s34, v245
  v_mul_f32 v248, s34, v246
  v_exp_f32 v247, v247
  v_exp_f32 v248, v248
  v_cmp_lt_f32 vcc, 0, v245
  v_add_f32 v245, 1.0, v245
  v_cmp_lt_f32 s[36:37], 0, v246
  v_cndmask_b32 v245, v247, v245, vcc
  v_add_f32 v246, 1.0, v246
  s_nop 0
  v_cndmask_b32 v246, v248, v246, s[36:37]
  v_cvt_pk_bf16_f32 v244, v245, v246
  v_lshlrev_b32 v245, 16, v244
  v_and_b32 v246, 0xffff0000, v244
  v_add_f32 v245, s35, v245
  v_add_f32 v246, s35, v246
  v_cvt_pk_bf16_f32 v148, v245, v246
  v_cvt_pk_bf16_f32 v250, v26, v27
  v_lshlrev_b32 v251, 16, v250
  v_and_b32 v252, 0xffff0000, v250
  v_mul_f32 v253, s34, v251
  v_mul_f32 v254, s34, v252
  v_exp_f32 v253, v253
  v_exp_f32 v254, v254
  v_cmp_lt_f32 vcc, 0, v251
  v_add_f32 v251, 1.0, v251
  v_cmp_lt_f32 s[36:37], 0, v252
  v_cndmask_b32 v251, v253, v251, vcc
  v_add_f32 v252, 1.0, v252
  s_nop 0
  v_cndmask_b32 v252, v254, v252, s[36:37]
  v_cvt_pk_bf16_f32 v250, v251, v252
  v_lshlrev_b32 v251, 16, v250
  v_and_b32 v252, 0xffff0000, v250
  v_add_f32 v251, s35, v251
  v_add_f32 v252, s35, v252
  v_cvt_pk_bf16_f32 v149, v251, v252
  v_cvt_pk_bf16_f32 v244, v28, v29
  v_lshlrev_b32 v245, 16, v244
  v_and_b32 v246, 0xffff0000, v244
  v_mul_f32 v247, s34, v245
  v_mul_f32 v248, s34, v246
  v_exp_f32 v247, v247
  v_exp_f32 v248, v248
  v_cmp_lt_f32 vcc, 0, v245
  v_add_f32 v245, 1.0, v245
  v_cmp_lt_f32 s[36:37], 0, v246
  v_cndmask_b32 v245, v247, v245, vcc
  v_add_f32 v246, 1.0, v246
  s_nop 0
  v_cndmask_b32 v246, v248, v246, s[36:37]
  v_cvt_pk_bf16_f32 v244, v245, v246
  v_lshlrev_b32 v245, 16, v244
  v_and_b32 v246, 0xffff0000, v244
  v_add_f32 v245, s35, v245
  v_add_f32 v246, s35, v246
  v_cvt_pk_bf16_f32 v150, v245, v246
  v_cvt_pk_bf16_f32 v250, v30, v31
  v_lshlrev_b32 v251, 16, v250
  v_and_b32 v252, 0xffff0000, v250
  v_mul_f32 v253, s34, v251
  v_mul_f32 v254, s34, v252
  v_exp_f32 v253, v253
  v_exp_f32 v254, v254
  v_cmp_lt_f32 vcc, 0, v251
  v_add_f32 v251, 1.0, v251
  v_cmp_lt_f32 s[36:37], 0, v252
  v_cndmask_b32 v251, v253, v251, vcc
  v_add_f32 v252, 1.0, v252
  s_nop 0
  v_cndmask_b32 v252, v254, v252, s[36:37]
  v_cvt_pk_bf16_f32 v250, v251, v252
  v_lshlrev_b32 v251, 16, v250
  v_and_b32 v252, 0xffff0000, v250
  v_add_f32 v251, s35, v251
  v_add_f32 v252, s35, v252
  v_cvt_pk_bf16_f32 v151, v251, v252
  s_waitcnt vmcnt(0)
  s_mul_i32 s25, s3, 5
  s_add_u32 s25, s25, 0
  s_and_b32 s26, s25, 1
  s_lshl_b32 s26, s26, 3
  s_lshr_b32 s25, s25, 1
  s_lshl_b32 s25, s25, 12
  s_add_u32 s25, s25, s26
  s_add_u32 s25, s25, 81920
  v_add_u32 v9, s25, v2
  v_mfma_f32_16x16x16_bf16 v[16:19], v[168:169], v[112:113], 0
  v_mfma_f32_16x16x16_bf16 v[16:19], v[176:177], v[120:121], v[16:19]
  v_mfma_f32_16x16x16_bf16 v[20:23], v[170:171], v[112:113], 0
  v_mfma_f32_16x16x16_bf16 v[20:23], v[178:179], v[120:121], v[20:23]
  v_mfma_f32_16x16x16_bf16 v[24:27], v[168:169], v[114:115], 0
  v_mfma_f32_16x16x16_bf16 v[24:27], v[176:177], v[122:123], v[24:27]
  v_mfma_f32_16x16x16_bf16 v[28:31], v[170:171], v[114:115], 0
  v_mfma_f32_16x16x16_bf16 v[28:31], v[178:179], v[122:123], v[28:31]
  v_mfma_f32_16x16x16_bf16 v[32:35], v[168:169], v[116:117], 0
  v_mfma_f32_16x16x16_bf16 v[32:35], v[176:177], v[124:125], v[32:35]
  v_mfma_f32_16x16x16_bf16 v[36:39], v[170:171], v[116:117], 0
  v_mfma_f32_16x16x16_bf16 v[36:39], v[178:179], v[124:125], v[36:39]
  v_mfma_f32_16x16x16_bf16 v[40:43], v[168:169], v[118:119], 0
  v_mfma_f32_16x16x16_bf16 v[40:43], v[176:177], v[126:127], v[40:43]
  v_mfma_f32_16x16x16_bf16 v[44:47], v[170:171], v[118:119], 0
  v_mfma_f32_16x16x16_bf16 v[44:47], v[178:179], v[126:127], v[44:47]
  s_nop 7
  v_cvt_pk_bf16_f32 v244, v16, v17
  v_cvt_pk_bf16_f32 v245, v20, v21
  v_lshlrev_b32 v246, 16, v245
  v_and_b32 v247, 0xffff0000, v245
  v_add_f32 v246, s35, v246
  v_add_f32 v247, s35, v247
  v_cvt_pk_bf16_f32 v245, v246, v247
  v_lshlrev_b32 v246, 16, v245
  v_and_b32 v247, 0xffff0000, v245
  v_rcp_f32 v246, v246
  v_rcp_f32 v247, v247
  v_lshlrev_b32 v248, 16, v244
  v_and_b32 v249, 0xffff0000, v244
  v_mul_f32 v248, v248, v246
  v_mul_f32 v249, v249, v247
  v_cvt_pk_bf16_f32 v250, v248, v249
  v_cvt_pk_bf16_f32 v244, v18, v19
  v_cvt_pk_bf16_f32 v245, v22, v23
  v_lshlrev_b32 v246, 16, v245
  v_and_b32 v247, 0xffff0000, v245
  v_add_f32 v246, s35, v246
  v_add_f32 v247, s35, v247
  v_cvt_pk_bf16_f32 v245, v246, v247
  v_lshlrev_b32 v246, 16, v245
  v_and_b32 v247, 0xffff0000, v245
  v_rcp_f32 v246, v246
  v_rcp_f32 v247, v247
  v_lshlrev_b32 v248, 16, v244
  v_and_b32 v249, 0xffff0000, v244
  v_mul_f32 v248, v248, v246
  v_mul_f32 v249, v249, v247
  v_cvt_pk_bf16_f32 v251, v248, v249
  ds_write_b64 v9, v[250:251] offset:0
  v_cvt_pk_bf16_f32 v244, v24, v25
  v_cvt_pk_bf16_f32 v245, v28, v29
  v_lshlrev_b32 v246, 16, v245
  v_and_b32 v247, 0xffff0000, v245
  v_add_f32 v246, s35, v246
  v_add_f32 v247, s35, v247
  v_cvt_pk_bf16_f32 v245, v246, v247
  v_lshlrev_b32 v246, 16, v245
  v_and_b32 v247, 0xffff0000, v245
  v_rcp_f32 v246, v246
  v_rcp_f32 v247, v247
  v_lshlrev_b32 v248, 16, v244
  v_and_b32 v249, 0xffff0000, v244
  v_mul_f32 v248, v248, v246
  v_mul_f32 v249, v249, v247
  v_cvt_pk_bf16_f32 v250, v248, v249
  v_cvt_pk_bf16_f32 v244, v26, v27
  v_cvt_pk_bf16_f32 v245, v30, v31
  v_lshlrev_b32 v246, 16, v245
  v_and_b32 v247, 0xffff0000, v245
  v_add_f32 v246, s35, v246
  v_add_f32 v247, s35, v247
  v_cvt_pk_bf16_f32 v245, v246, v247
  v_lshlrev_b32 v246, 16, v245
  v_and_b32 v247, 0xffff0000, v245
  v_rcp_f32 v246, v246
  v_rcp_f32 v247, v247
  v_lshlrev_b32 v248, 16, v244
  v_and_b32 v249, 0xffff0000, v244
  v_mul_f32 v248, v248, v246
  v_mul_f32 v249, v249, v247
  v_cvt_pk_bf16_f32 v251, v248, v249
  ds_write_b64 v9, v[250:251] offset:1024
  v_cvt_pk_bf16_f32 v244, v32, v33
  v_cvt_pk_bf16_f32 v245, v36, v37
  v_lshlrev_b32 v246, 16, v245
  v_and_b32 v247, 0xffff0000, v245
  v_add_f32 v246, s35, v246
  v_add_f32 v247, s35, v247
  v_cvt_pk_bf16_f32 v245, v246, v247
  v_lshlrev_b32 v246, 16, v245
  v_and_b32 v247, 0xffff0000, v245
  v_rcp_f32 v246, v246
  v_rcp_f32 v247, v247
  v_lshlrev_b32 v248, 16, v244
  v_and_b32 v249, 0xffff0000, v244
  v_mul_f32 v248, v248, v246
  v_mul_f32 v249, v249, v247
  v_cvt_pk_bf16_f32 v250, v248, v249
  v_cvt_pk_bf16_f32 v244, v34, v35
  v_cvt_pk_bf16_f32 v245, v38, v39
  v_lshlrev_b32 v246, 16, v245
  v_and_b32 v247, 0xffff0000, v245
  v_add_f32 v246, s35, v246
  v_add_f32 v247, s35, v247
  v_cvt_pk_bf16_f32 v245, v246, v247
  v_lshlrev_b32 v246, 16, v245
  v_and_b32 v247, 0xffff0000, v245
  v_rcp_f32 v246, v246
  v_rcp_f32 v247, v247
  v_lshlrev_b32 v248, 16, v244
  v_and_b32 v249, 0xffff0000, v244
  v_mul_f32 v248, v248, v246
  v_mul_f32 v249, v249, v247
  v_cvt_pk_bf16_f32 v251, v248, v249
  ds_write_b64 v9, v[250:251] offset:2048
  v_cvt_pk_bf16_f32 v244, v40, v41
  v_cvt_pk_bf16_f32 v245, v44, v45
  v_lshlrev_b32 v246, 16, v245
  v_and_b32 v247, 0xffff0000, v245
  v_add_f32 v246, s35, v246
  v_add_f32 v247, s35, v247
  v_cvt_pk_bf16_f32 v245, v246, v247
  v_lshlrev_b32 v246, 16, v245
  v_and_b32 v247, 0xffff0000, v245
  v_rcp_f32 v246, v246
  v_rcp_f32 v247, v247
  v_lshlrev_b32 v248, 16, v244
  v_and_b32 v249, 0xffff0000, v244
  v_mul_f32 v248, v248, v246
  v_mul_f32 v249, v249, v247
  v_cvt_pk_bf16_f32 v250, v248, v249
  v_cvt_pk_bf16_f32 v244, v42, v43
  v_cvt_pk_bf16_f32 v245, v46, v47
  v_lshlrev_b32 v246, 16, v245
  v_and_b32 v247, 0xffff0000, v245
  v_add_f32 v246, s35, v246
  v_add_f32 v247, s35, v247
  v_cvt_pk_bf16_f32 v245, v246, v247
  v_lshlrev_b32 v246, 16, v245
  v_and_b32 v247, 0xffff0000, v245
  v_rcp_f32 v246, v246
  v_rcp_f32 v247, v247
  v_lshlrev_b32 v248, 16, v244
  v_and_b32 v249, 0xffff0000, v244
  v_mul_f32 v248, v248, v246
  v_mul_f32 v249, v249, v247
  v_cvt_pk_bf16_f32 v251, v248, v249
  ds_write_b64 v9, v[250:251] offset:3072
  s_mul_i32 s25, s3, 5
  s_add_u32 s25, s25, 1
  s_and_b32 s26, s25, 1
  s_lshl_b32 s26, s26, 3
  s_lshr_b32 s25, s25, 1
  s_lshl_b32 s25, s25, 12
  s_add_u32 s25, s25, s26
  s_add_u32 s25, s25, 81920
  v_add_u32 v9, s25, v2
  v_mfma_f32_16x16x16_bf16 v[16:19], v[172:173], v[112:113], 0
  v_mfma_f32_16x16x16_bf16 v[16:19], v[180:181], v[120:121], v[16:19]
  v_mfma_f32_16x16x16_bf16 v[16:19], v[188:189], v[128:129], v[16:19]
  v_mfma_f32_16x16x16_bf16 v[20:23], v[174:175], v[112:113], 0
  v_mfma_f32_16x16x16_bf16 v[20:23], v[182:183], v[120:121], v[20:23]
  v_mfma_f32_16x16x16_bf16 v[20:23], v[190:191], v[128:129], v[20:23]
  v_mfma_f32_16x16x16_bf16 v[24:27], v[172:173], v[114:115], 0
  v_mfma_f32_16x16x16_bf16 v[24:27], v[180:181], v[122:123], v[24:27]
  v_mfma_f32_16x16x16_bf16 v[24:27], v[188:189], v[130:131], v[24:27]
  v_mfma_f32_16x16x16_bf16 v[28:31], v[174:175], v[114:115], 0
  v_mfma_f32_16x16x16_bf16 v[28:31], v[182:183], v[122:123], v[28:31]
  v_mfma_f32_16x16x16_bf16 v[28:31], v[190:191], v[130:131], v[28:31]
  v_mfma_f32_16x16x16_bf16 v[32:35], v[172:173], v[116:117], 0
  v_mfma_f32_16x16x16_bf16 v[32:35], v[180:181], v[124:125], v[32:35]
  v_mfma_f32_16x16x16_bf16 v[32:35], v[188:189], v[132:133], v[32:35]
  v_mfma_f32_16x16x16_bf16 v[36:39], v[174:175], v[116:117], 0
  v_mfma_f32_16x16x16_bf16 v[36:39], v[182:183], v[124:125], v[36:39]
  v_mfma_f32_16x16x16_bf16 v[36:39], v[190:191], v[132:133], v[36:39]
  v_mfma_f32_16x16x16_bf16 v[40:43], v[172:173], v[118:119], 0
  v_mfma_f32_16x16x16_bf16 v[40:43], v[180:181], v[126:127], v[40:43]
  v_mfma_f32_16x16x16_bf16 v[40:43], v[188:189], v[134:135], v[40:43]
  v_mfma_f32_16x16x16_bf16 v[44:47], v[174:175], v[118:119], 0
  v_mfma_f32_16x16x16_bf16 v[44:47], v[182:183], v[126:127], v[44:47]
  v_mfma_f32_16x16x16_bf16 v[44:47], v[190:191], v[134:135], v[44:47]
  s_nop 7
  v_cvt_pk_bf16_f32 v244, v16, v17
  v_cvt_pk_bf16_f32 v245, v20, v21
  v_lshlrev_b32 v246, 16, v245
  v_and_b32 v247, 0xffff0000, v245
  v_add_f32 v246, s35, v246
  v_add_f32 v247, s35, v247
  v_cvt_pk_bf16_f32 v245, v246, v247
  v_lshlrev_b32 v246, 16, v245
  v_and_b32 v247, 0xffff0000, v245
  v_rcp_f32 v246, v246
  v_rcp_f32 v247, v247
  v_lshlrev_b32 v248, 16, v244
  v_and_b32 v249, 0xffff0000, v244
  v_mul_f32 v248, v248, v246
  v_mul_f32 v249, v249, v247
  v_cvt_pk_bf16_f32 v250, v248, v249
  v_cvt_pk_bf16_f32 v244, v18, v19
  v_cvt_pk_bf16_f32 v245, v22, v23
  v_lshlrev_b32 v246, 16, v245
  v_and_b32 v247, 0xffff0000, v245
  v_add_f32 v246, s35, v246
  v_add_f32 v247, s35, v247
  v_cvt_pk_bf16_f32 v245, v246, v247
  v_lshlrev_b32 v246, 16, v245
  v_and_b32 v247, 0xffff0000, v245
  v_rcp_f32 v246, v246
  v_rcp_f32 v247, v247
  v_lshlrev_b32 v248, 16, v244
  v_and_b32 v249, 0xffff0000, v244
  v_mul_f32 v248, v248, v246
  v_mul_f32 v249, v249, v247
  v_cvt_pk_bf16_f32 v251, v248, v249
  ds_write_b64 v9, v[250:251] offset:0
  v_cvt_pk_bf16_f32 v244, v24, v25
  v_cvt_pk_bf16_f32 v245, v28, v29
  v_lshlrev_b32 v246, 16, v245
  v_and_b32 v247, 0xffff0000, v245
  v_add_f32 v246, s35, v246
  v_add_f32 v247, s35, v247
  v_cvt_pk_bf16_f32 v245, v246, v247
  v_lshlrev_b32 v246, 16, v245
  v_and_b32 v247, 0xffff0000, v245
  v_rcp_f32 v246, v246
  v_rcp_f32 v247, v247
  v_lshlrev_b32 v248, 16, v244
  v_and_b32 v249, 0xffff0000, v244
  v_mul_f32 v248, v248, v246
  v_mul_f32 v249, v249, v247
  v_cvt_pk_bf16_f32 v250, v248, v249
  v_cvt_pk_bf16_f32 v244, v26, v27
  v_cvt_pk_bf16_f32 v245, v30, v31
  v_lshlrev_b32 v246, 16, v245
  v_and_b32 v247, 0xffff0000, v245
  v_add_f32 v246, s35, v246
  v_add_f32 v247, s35, v247
  v_cvt_pk_bf16_f32 v245, v246, v247
  v_lshlrev_b32 v246, 16, v245
  v_and_b32 v247, 0xffff0000, v245
  v_rcp_f32 v246, v246
  v_rcp_f32 v247, v247
  v_lshlrev_b32 v248, 16, v244
  v_and_b32 v249, 0xffff0000, v244
  v_mul_f32 v248, v248, v246
  v_mul_f32 v249, v249, v247
  v_cvt_pk_bf16_f32 v251, v248, v249
  ds_write_b64 v9, v[250:251] offset:1024
  v_cvt_pk_bf16_f32 v244, v32, v33
  v_cvt_pk_bf16_f32 v245, v36, v37
  v_lshlrev_b32 v246, 16, v245
  v_and_b32 v247, 0xffff0000, v245
  v_add_f32 v246, s35, v246
  v_add_f32 v247, s35, v247
  v_cvt_pk_bf16_f32 v245, v246, v247
  v_lshlrev_b32 v246, 16, v245
  v_and_b32 v247, 0xffff0000, v245
  v_rcp_f32 v246, v246
  v_rcp_f32 v247, v247
  v_lshlrev_b32 v248, 16, v244
  v_and_b32 v249, 0xffff0000, v244
  v_mul_f32 v248, v248, v246
  v_mul_f32 v249, v249, v247
  v_cvt_pk_bf16_f32 v250, v248, v249
  v_cvt_pk_bf16_f32 v244, v34, v35
  v_cvt_pk_bf16_f32 v245, v38, v39
  v_lshlrev_b32 v246, 16, v245
  v_and_b32 v247, 0xffff0000, v245
  v_add_f32 v246, s35, v246
  v_add_f32 v247, s35, v247
  v_cvt_pk_bf16_f32 v245, v246, v247
  v_lshlrev_b32 v246, 16, v245
  v_and_b32 v247, 0xffff0000, v245
  v_rcp_f32 v246, v246
  v_rcp_f32 v247, v247
  v_lshlrev_b32 v248, 16, v244
  v_and_b32 v249, 0xffff0000, v244
  v_mul_f32 v248, v248, v246
  v_mul_f32 v249, v249, v247
  v_cvt_pk_bf16_f32 v251, v248, v249
  ds_write_b64 v9, v[250:251] offset:2048
  v_cvt_pk_bf16_f32 v244, v40, v41
  v_cvt_pk_bf16_f32 v245, v44, v45
  v_lshlrev_b32 v246, 16, v245
  v_and_b32 v247, 0xffff0000, v245
  v_add_f32 v246, s35, v246
  v_add_f32 v247, s35, v247
  v_cvt_pk_bf16_f32 v245, v246, v247
  v_lshlrev_b32 v246, 16, v245
  v_and_b32 v247, 0xffff0000, v245
  v_rcp_f32 v246, v246
  v_rcp_f32 v247, v247
  v_lshlrev_b32 v248, 16, v244
  v_and_b32 v249, 0xffff0000, v244
  v_mul_f32 v248, v248, v246
  v_mul_f32 v249, v249, v247
  v_cvt_pk_bf16_f32 v250, v248, v249
  v_cvt_pk_bf16_f32 v244, v42, v43
  v_cvt_pk_bf16_f32 v245, v46, v47
  v_lshlrev_b32 v246, 16, v245
  v_and_b32 v247, 0xffff0000, v245
  v_add_f32 v246, s35, v246
  v_add_f32 v247, s35, v247
  v_cvt_pk_bf16_f32 v245, v246, v247
  v_lshlrev_b32 v246, 16, v245
  v_and_b32 v247, 0xffff0000, v245
  v_rcp_f32 v246, v246
  v_rcp_f32 v247, v247
  v_lshlrev_b32 v248, 16, v244
  v_and_b32 v249, 0xffff0000, v244
  v_mul_f32 v248, v248, v246
  v_mul_f32 v249, v249, v247
  v_cvt_pk_bf16_f32 v251, v248, v249
  ds_write_b64 v9, v[250:251] offset:3072
  s_mul_i32 s25, s3, 5
  s_add_u32 s25, s25, 2
  s_and_b32 s26, s25, 1
  s_lshl_b32 s26, s26, 3
  s_lshr_b32 s25, s25, 1
  s_lshl_b32 s25, s25, 12
  s_add_u32 s25, s25, s26
  s_add_u32 s25, s25, 81920
  v_add_u32 v9, s25, v2
  v_mfma_f32_16x16x16_bf16 v[16:19], v[184:185], v[120:121], 0
  v_mfma_f32_16x16x16_bf16 v[16:19], v[192:193], v[128:129], v[16:19]
  v_mfma_f32_16x16x16_bf16 v[16:19], v[200:201], v[136:137], v[16:19]
  v_mfma_f32_16x16x16_bf16 v[20:23], v[186:187], v[120:121], 0
  v_mfma_f32_16x16x16_bf16 v[20:23], v[194:195], v[128:129], v[20:23]
  v_mfma_f32_16x16x16_bf16 v[20:23], v[202:203], v[136:137], v[20:23]
  v_mfma_f32_16x16x16_bf16 v[24:27], v[184:185], v[122:123], 0
  v_mfma_f32_16x16x16_bf16 v[24:27], v[192:193], v[130:131], v[24:27]
  v_mfma_f32_16x16x16_bf16 v[24:27], v[200:201], v[138:139], v[24:27]
  v_mfma_f32_16x16x16_bf16 v[28:31], v[186:187], v[122:123], 0
  v_mfma_f32_16x16x16_bf16 v[28:31], v[194:195], v[130:131], v[28:31]
  v_mfma_f32_16x16x16_bf16 v[28:31], v[202:203], v[138:139], v[28:31]
  v_mfma_f32_16x16x16_bf16 v[32:35], v[184:185], v[124:125], 0
  v_mfma_f32_16x16x16_bf16 v[32:35], v[192:193], v[132:133], v[32:35]
  v_mfma_f32_16x16x16_bf16 v[32:35], v[200:201], v[140:141], v[32:35]
  v_mfma_f32_16x16x16_bf16 v[36:39], v[186:187], v[124:125], 0
  v_mfma_f32_16x16x16_bf16 v[36:39], v[194:195], v[132:133], v[36:39]
  v_mfma_f32_16x16x16_bf16 v[36:39], v[202:203], v[140:141], v[36:39]
  v_mfma_f32_16x16x16_bf16 v[40:43], v[184:185], v[126:127], 0
  v_mfma_f32_16x16x16_bf16 v[40:43], v[192:193], v[134:135], v[40:43]
  v_mfma_f32_16x16x16_bf16 v[40:43], v[200:201], v[142:143], v[40:43]
  v_mfma_f32_16x16x16_bf16 v[44:47], v[186:187], v[126:127], 0
  v_mfma_f32_16x16x16_bf16 v[44:47], v[194:195], v[134:135], v[44:47]
  v_mfma_f32_16x16x16_bf16 v[44:47], v[202:203], v[142:143], v[44:47]
  s_nop 7
  v_cvt_pk_bf16_f32 v244, v16, v17
  v_cvt_pk_bf16_f32 v245, v20, v21
  v_lshlrev_b32 v246, 16, v245
  v_and_b32 v247, 0xffff0000, v245
  v_add_f32 v246, s35, v246
  v_add_f32 v247, s35, v247
  v_cvt_pk_bf16_f32 v245, v246, v247
  v_lshlrev_b32 v246, 16, v245
  v_and_b32 v247, 0xffff0000, v245
  v_rcp_f32 v246, v246
  v_rcp_f32 v247, v247
  v_lshlrev_b32 v248, 16, v244
  v_and_b32 v249, 0xffff0000, v244
  v_mul_f32 v248, v248, v246
  v_mul_f32 v249, v249, v247
  v_cvt_pk_bf16_f32 v250, v248, v249
  v_cvt_pk_bf16_f32 v244, v18, v19
  v_cvt_pk_bf16_f32 v245, v22, v23
  v_lshlrev_b32 v246, 16, v245
  v_and_b32 v247, 0xffff0000, v245
  v_add_f32 v246, s35, v246
  v_add_f32 v247, s35, v247
  v_cvt_pk_bf16_f32 v245, v246, v247
  v_lshlrev_b32 v246, 16, v245
  v_and_b32 v247, 0xffff0000, v245
  v_rcp_f32 v246, v246
  v_rcp_f32 v247, v247
  v_lshlrev_b32 v248, 16, v244
  v_and_b32 v249, 0xffff0000, v244
  v_mul_f32 v248, v248, v246
  v_mul_f32 v249, v249, v247
  v_cvt_pk_bf16_f32 v251, v248, v249
  ds_write_b64 v9, v[250:251] offset:0
  v_cvt_pk_bf16_f32 v244, v24, v25
  v_cvt_pk_bf16_f32 v245, v28, v29
  v_lshlrev_b32 v246, 16, v245
  v_and_b32 v247, 0xffff0000, v245
  v_add_f32 v246, s35, v246
  v_add_f32 v247, s35, v247
  v_cvt_pk_bf16_f32 v245, v246, v247
  v_lshlrev_b32 v246, 16, v245
  v_and_b32 v247, 0xffff0000, v245
  v_rcp_f32 v246, v246
  v_rcp_f32 v247, v247
  v_lshlrev_b32 v248, 16, v244
  v_and_b32 v249, 0xffff0000, v244
  v_mul_f32 v248, v248, v246
  v_mul_f32 v249, v249, v247
  v_cvt_pk_bf16_f32 v250, v248, v249
  v_cvt_pk_bf16_f32 v244, v26, v27
  v_cvt_pk_bf16_f32 v245, v30, v31
  v_lshlrev_b32 v246, 16, v245
  v_and_b32 v247, 0xffff0000, v245
  v_add_f32 v246, s35, v246
  v_add_f32 v247, s35, v247
  v_cvt_pk_bf16_f32 v245, v246, v247
  v_lshlrev_b32 v246, 16, v245
  v_and_b32 v247, 0xffff0000, v245
  v_rcp_f32 v246, v246
  v_rcp_f32 v247, v247
  v_lshlrev_b32 v248, 16, v244
  v_and_b32 v249, 0xffff0000, v244
  v_mul_f32 v248, v248, v246
  v_mul_f32 v249, v249, v247
  v_cvt_pk_bf16_f32 v251, v248, v249
  ds_write_b64 v9, v[250:251] offset:1024
  v_cvt_pk_bf16_f32 v244, v32, v33
  v_cvt_pk_bf16_f32 v245, v36, v37
  v_lshlrev_b32 v246, 16, v245
  v_and_b32 v247, 0xffff0000, v245
  v_add_f32 v246, s35, v246
  v_add_f32 v247, s35, v247
  v_cvt_pk_bf16_f32 v245, v246, v247
  v_lshlrev_b32 v246, 16, v245
  v_and_b32 v247, 0xffff0000, v245
  v_rcp_f32 v246, v246
  v_rcp_f32 v247, v247
  v_lshlrev_b32 v248, 16, v244
  v_and_b32 v249, 0xffff0000, v244
  v_mul_f32 v248, v248, v246
  v_mul_f32 v249, v249, v247
  v_cvt_pk_bf16_f32 v250, v248, v249
  v_cvt_pk_bf16_f32 v244, v34, v35
  v_cvt_pk_bf16_f32 v245, v38, v39
  v_lshlrev_b32 v246, 16, v245
  v_and_b32 v247, 0xffff0000, v245
  v_add_f32 v246, s35, v246
  v_add_f32 v247, s35, v247
  v_cvt_pk_bf16_f32 v245, v246, v247
  v_lshlrev_b32 v246, 16, v245
  v_and_b32 v247, 0xffff0000, v245
  v_rcp_f32 v246, v246
  v_rcp_f32 v247, v247
  v_lshlrev_b32 v248, 16, v244
  v_and_b32 v249, 0xffff0000, v244
  v_mul_f32 v248, v248, v246
  v_mul_f32 v249, v249, v247
  v_cvt_pk_bf16_f32 v251, v248, v249
  ds_write_b64 v9, v[250:251] offset:2048
  v_cvt_pk_bf16_f32 v244, v40, v41
  v_cvt_pk_bf16_f32 v245, v44, v45
  v_lshlrev_b32 v246, 16, v245
  v_and_b32 v247, 0xffff0000, v245
  v_add_f32 v246, s35, v246
  v_add_f32 v247, s35, v247
  v_cvt_pk_bf16_f32 v245, v246, v247
  v_lshlrev_b32 v246, 16, v245
  v_and_b32 v247, 0xffff0000, v245
  v_rcp_f32 v246, v246
  v_rcp_f32 v247, v247
  v_lshlrev_b32 v248, 16, v244
  v_and_b32 v249, 0xffff0000, v244
  v_mul_f32 v248, v248, v246
  v_mul_f32 v249, v249, v247
  v_cvt_pk_bf16_f32 v250, v248, v249
  v_cvt_pk_bf16_f32 v244, v42, v43
  v_cvt_pk_bf16_f32 v245, v46, v47
  v_lshlrev_b32 v246, 16, v245
  v_and_b32 v247, 0xffff0000, v245
  v_add_f32 v246, s35, v246
  v_add_f32 v247, s35, v247
  v_cvt_pk_bf16_f32 v245, v246, v247
  v_lshlrev_b32 v246, 16, v245
  v_and_b32 v247, 0xffff0000, v245
  v_rcp_f32 v246, v246
  v_rcp_f32 v247, v247
  v_lshlrev_b32 v248, 16, v244
  v_and_b32 v249, 0xffff0000, v244
  v_mul_f32 v248, v248, v246
  v_mul_f32 v249, v249, v247
  v_cvt_pk_bf16_f32 v251, v248, v249
  ds_write_b64 v9, v[250:251] offset:3072
  s_mul_i32 s25, s3, 5
  s_add_u32 s25, s25, 3
  s_and_b32 s26, s25, 1
  s_lshl_b32 s26, s26, 3
  s_lshr_b32 s25, s25, 1
  s_lshl_b32 s25, s25, 12
  s_add_u32 s25, s25, s26
  s_add_u32 s25, s25, 81920
  v_add_u32 v9, s25, v2
  v_mfma_f32_16x16x16_bf16 v[16:19], v[196:197], v[128:129], 0
  v_mfma_f32_16x16x16_bf16 v[16:19], v[204:205], v[136:137], v[16:19]
  v_mfma_f32_16x16x16_bf16 v[16:19], v[212:213], v[144:145], v[16:19]
  v_mfma_f32_16x16x16_bf16 v[20:23], v[198:199], v[128:129], 0
  v_mfma_f32_16x16x16_bf16 v[20:23], v[206:207], v[136:137], v[20:23]
  v_mfma_f32_16x16x16_bf16 v[20:23], v[214:215], v[144:145], v[20:23]
  v_mfma_f32_16x16x16_bf16 v[24:27], v[196:197], v[130:131], 0
  v_mfma_f32_16x16x16_bf16 v[24:27], v[204:205], v[138:139], v[24:27]
  v_mfma_f32_16x16x16_bf16 v[24:27], v[212:213], v[146:147], v[24:27]
  v_mfma_f32_16x16x16_bf16 v[28:31], v[198:199], v[130:131], 0
  v_mfma_f32_16x16x16_bf16 v[28:31], v[206:207], v[138:139], v[28:31]
  v_mfma_f32_16x16x16_bf16 v[28:31], v[214:215], v[146:147], v[28:31]
  v_mfma_f32_16x16x16_bf16 v[32:35], v[196:197], v[132:133], 0
  v_mfma_f32_16x16x16_bf16 v[32:35], v[204:205], v[140:141], v[32:35]
  v_mfma_f32_16x16x16_bf16 v[32:35], v[212:213], v[148:149], v[32:35]
  v_mfma_f32_16x16x16_bf16 v[36:39], v[198:199], v[132:133], 0
  v_mfma_f32_16x16x16_bf16 v[36:39], v[206:207], v[140:141], v[36:39]
  v_mfma_f32_16x16x16_bf16 v[36:39], v[214:215], v[148:149], v[36:39]
  v_mfma_f32_16x16x16_bf16 v[40:43], v[196:197], v[134:135], 0
  v_mfma_f32_16x16x16_bf16 v[40:43], v[204:205], v[142:143], v[40:43]
  v_mfma_f32_16x16x16_bf16 v[40:43], v[212:213], v[150:151], v[40:43]
  v_mfma_f32_16x16x16_bf16 v[44:47], v[198:199], v[134:135], 0
  v_mfma_f32_16x16x16_bf16 v[44:47], v[206:207], v[142:143], v[44:47]
  v_mfma_f32_16x16x16_bf16 v[44:47], v[214:215], v[150:151], v[44:47]
  s_nop 7
  v_cvt_pk_bf16_f32 v244, v16, v17
  v_cvt_pk_bf16_f32 v245, v20, v21
  v_lshlrev_b32 v246, 16, v245
  v_and_b32 v247, 0xffff0000, v245
  v_add_f32 v246, s35, v246
  v_add_f32 v247, s35, v247
  v_cvt_pk_bf16_f32 v245, v246, v247
  v_lshlrev_b32 v246, 16, v245
  v_and_b32 v247, 0xffff0000, v245
  v_rcp_f32 v246, v246
  v_rcp_f32 v247, v247
  v_lshlrev_b32 v248, 16, v244
  v_and_b32 v249, 0xffff0000, v244
  v_mul_f32 v248, v248, v246
  v_mul_f32 v249, v249, v247
  v_cvt_pk_bf16_f32 v250, v248, v249
  v_cvt_pk_bf16_f32 v244, v18, v19
  v_cvt_pk_bf16_f32 v245, v22, v23
  v_lshlrev_b32 v246, 16, v245
  v_and_b32 v247, 0xffff0000, v245
  v_add_f32 v246, s35, v246
  v_add_f32 v247, s35, v247
  v_cvt_pk_bf16_f32 v245, v246, v247
  v_lshlrev_b32 v246, 16, v245
  v_and_b32 v247, 0xffff0000, v245
  v_rcp_f32 v246, v246
  v_rcp_f32 v247, v247
  v_lshlrev_b32 v248, 16, v244
  v_and_b32 v249, 0xffff0000, v244
  v_mul_f32 v248, v248, v246
  v_mul_f32 v249, v249, v247
  v_cvt_pk_bf16_f32 v251, v248, v249
  ds_write_b64 v9, v[250:251] offset:0
  v_cvt_pk_bf16_f32 v244, v24, v25
  v_cvt_pk_bf16_f32 v245, v28, v29
  v_lshlrev_b32 v246, 16, v245
  v_and_b32 v247, 0xffff0000, v245
  v_add_f32 v246, s35, v246
  v_add_f32 v247, s35, v247
  v_cvt_pk_bf16_f32 v245, v246, v247
  v_lshlrev_b32 v246, 16, v245
  v_and_b32 v247, 0xffff0000, v245
  v_rcp_f32 v246, v246
  v_rcp_f32 v247, v247
  v_lshlrev_b32 v248, 16, v244
  v_and_b32 v249, 0xffff0000, v244
  v_mul_f32 v248, v248, v246
  v_mul_f32 v249, v249, v247
  v_cvt_pk_bf16_f32 v250, v248, v249
  v_cvt_pk_bf16_f32 v244, v26, v27
  v_cvt_pk_bf16_f32 v245, v30, v31
  v_lshlrev_b32 v246, 16, v245
  v_and_b32 v247, 0xffff0000, v245
  v_add_f32 v246, s35, v246
  v_add_f32 v247, s35, v247
  v_cvt_pk_bf16_f32 v245, v246, v247
  v_lshlrev_b32 v246, 16, v245
  v_and_b32 v247, 0xffff0000, v245
  v_rcp_f32 v246, v246
  v_rcp_f32 v247, v247
  v_lshlrev_b32 v248, 16, v244
  v_and_b32 v249, 0xffff0000, v244
  v_mul_f32 v248, v248, v246
  v_mul_f32 v249, v249, v247
  v_cvt_pk_bf16_f32 v251, v248, v249
  ds_write_b64 v9, v[250:251] offset:1024
  v_cvt_pk_bf16_f32 v244, v32, v33
  v_cvt_pk_bf16_f32 v245, v36, v37
  v_lshlrev_b32 v246, 16, v245
  v_and_b32 v247, 0xffff0000, v245
  v_add_f32 v246, s35, v246
  v_add_f32 v247, s35, v247
  v_cvt_pk_bf16_f32 v245, v246, v247
  v_lshlrev_b32 v246, 16, v245
  v_and_b32 v247, 0xffff0000, v245
  v_rcp_f32 v246, v246
  v_rcp_f32 v247, v247
  v_lshlrev_b32 v248, 16, v244
  v_and_b32 v249, 0xffff0000, v244
  v_mul_f32 v248, v248, v246
  v_mul_f32 v249, v249, v247
  v_cvt_pk_bf16_f32 v250, v248, v249
  v_cvt_pk_bf16_f32 v244, v34, v35
  v_cvt_pk_bf16_f32 v245, v38, v39
  v_lshlrev_b32 v246, 16, v245
  v_and_b32 v247, 0xffff0000, v245
  v_add_f32 v246, s35, v246
  v_add_f32 v247, s35, v247
  v_cvt_pk_bf16_f32 v245, v246, v247
  v_lshlrev_b32 v246, 16, v245
  v_and_b32 v247, 0xffff0000, v245
  v_rcp_f32 v246, v246
  v_rcp_f32 v247, v247
  v_lshlrev_b32 v248, 16, v244
  v_and_b32 v249, 0xffff0000, v244
  v_mul_f32 v248, v248, v246
  v_mul_f32 v249, v249, v247
  v_cvt_pk_bf16_f32 v251, v248, v249
  ds_write_b64 v9, v[250:251] offset:2048
  v_cvt_pk_bf16_f32 v244, v40, v41
  v_cvt_pk_bf16_f32 v245, v44, v45
  v_lshlrev_b32 v246, 16, v245
  v_and_b32 v247, 0xffff0000, v245
  v_add_f32 v246, s35, v246
  v_add_f32 v247, s35, v247
  v_cvt_pk_bf16_f32 v245, v246, v247
  v_lshlrev_b32 v246, 16, v245
  v_and_b32 v247, 0xffff0000, v245
  v_rcp_f32 v246, v246
  v_rcp_f32 v247, v247
  v_lshlrev_b32 v248, 16, v244
  v_and_b32 v249, 0xffff0000, v244
  v_mul_f32 v248, v248, v246
  v_mul_f32 v249, v249, v247
  v_cvt_pk_bf16_f32 v250, v248, v249
  v_cvt_pk_bf16_f32 v244, v42, v43
  v_cvt_pk_bf16_f32 v245, v46, v47
  v_lshlrev_b32 v246, 16, v245
  v_and_b32 v247, 0xffff0000, v245
  v_add_f32 v246, s35, v246
  v_add_f32 v247, s35, v247
  v_cvt_pk_bf16_f32 v245, v246, v247
  v_lshlrev_b32 v246, 16, v245
  v_and_b32 v247, 0xffff0000, v245
  v_rcp_f32 v246, v246
  v_rcp_f32 v247, v247
  v_lshlrev_b32 v248, 16, v244
  v_and_b32 v249, 0xffff0000, v244
  v_mul_f32 v248, v248, v246
  v_mul_f32 v249, v249, v247
  v_cvt_pk_bf16_f32 v251, v248, v249
  ds_write_b64 v9, v[250:251] offset:3072
  s_mul_i32 s25, s3, 5
  s_add_u32 s25, s25, 4
  s_and_b32 s26, s25, 1
  s_lshl_b32 s26, s26, 3
  s_lshr_b32 s25, s25, 1
  s_lshl_b32 s25, s25, 12
  s_add_u32 s25, s25, s26
  s_add_u32 s25, s25, 81920
  v_add_u32 v9, s25, v2
  v_mfma_f32_16x16x16_bf16 v[16:19], v[208:209], v[136:137], 0
  v_mfma_f32_16x16x16_bf16 v[16:19], v[216:217], v[144:145], v[16:19]
  v_mfma_f32_16x16x16_bf16 v[20:23], v[210:211], v[136:137], 0
  v_mfma_f32_16x16x16_bf16 v[20:23], v[218:219], v[144:145], v[20:23]
  v_mfma_f32_16x16x16_bf16 v[24:27], v[208:209], v[138:139], 0
  v_mfma_f32_16x16x16_bf16 v[24:27], v[216:217], v[146:147], v[24:27]
  v_mfma_f32_16x16x16_bf16 v[28:31], v[210:211], v[138:139], 0
  v_mfma_f32_16x16x16_bf16 v[28:31], v[218:219], v[146:147], v[28:31]
  v_mfma_f32_16x16x16_bf16 v[32:35], v[208:209], v[140:141], 0
  v_mfma_f32_16x16x16_bf16 v[32:35], v[216:217], v[148:149], v[32:35]
  v_mfma_f32_16x16x16_bf16 v[36:39], v[210:211], v[140:141], 0
  v_mfma_f32_16x16x16_bf16 v[36:39], v[218:219], v[148:149], v[36:39]
  v_mfma_f32_16x16x16_bf16 v[40:43], v[208:209], v[142:143], 0
  v_mfma_f32_16x16x16_bf16 v[40:43], v[216:217], v[150:151], v[40:43]
  v_mfma_f32_16x16x16_bf16 v[44:47], v[210:211], v[142:143], 0
  v_mfma_f32_16x16x16_bf16 v[44:47], v[218:219], v[150:151], v[44:47]
  s_nop 7
  v_cvt_pk_bf16_f32 v244, v16, v17
  v_cvt_pk_bf16_f32 v245, v20, v21
  v_lshlrev_b32 v246, 16, v245
  v_and_b32 v247, 0xffff0000, v245
  v_add_f32 v246, s35, v246
  v_add_f32 v247, s35, v247
  v_cvt_pk_bf16_f32 v245, v246, v247
  v_lshlrev_b32 v246, 16, v245
  v_and_b32 v247, 0xffff0000, v245
  v_rcp_f32 v246, v246
  v_rcp_f32 v247, v247
  v_lshlrev_b32 v248, 16, v244
  v_and_b32 v249, 0xffff0000, v244
  v_mul_f32 v248, v248, v246
  v_mul_f32 v249, v249, v247
  v_cvt_pk_bf16_f32 v250, v248, v249
  v_cvt_pk_bf16_f32 v244, v18, v19
  v_cvt_pk_bf16_f32 v245, v22, v23
  v_lshlrev_b32 v246, 16, v245
  v_and_b32 v247, 0xffff0000, v245
  v_add_f32 v246, s35, v246
  v_add_f32 v247, s35, v247
  v_cvt_pk_bf16_f32 v245, v246, v247
  v_lshlrev_b32 v246, 16, v245
  v_and_b32 v247, 0xffff0000, v245
  v_rcp_f32 v246, v246
  v_rcp_f32 v247, v247
  v_lshlrev_b32 v248, 16, v244
  v_and_b32 v249, 0xffff0000, v244
  v_mul_f32 v248, v248, v246
  v_mul_f32 v249, v249, v247
  v_cvt_pk_bf16_f32 v251, v248, v249
  ds_write_b64 v9, v[250:251] offset:0
  v_cvt_pk_bf16_f32 v244, v24, v25
  v_cvt_pk_bf16_f32 v245, v28, v29
  v_lshlrev_b32 v246, 16, v245
  v_and_b32 v247, 0xffff0000, v245
  v_add_f32 v246, s35, v246
  v_add_f32 v247, s35, v247
  v_cvt_pk_bf16_f32 v245, v246, v247
  v_lshlrev_b32 v246, 16, v245
  v_and_b32 v247, 0xffff0000, v245
  v_rcp_f32 v246, v246
  v_rcp_f32 v247, v247
  v_lshlrev_b32 v248, 16, v244
  v_and_b32 v249, 0xffff0000, v244
  v_mul_f32 v248, v248, v246
  v_mul_f32 v249, v249, v247
  v_cvt_pk_bf16_f32 v250, v248, v249
  v_cvt_pk_bf16_f32 v244, v26, v27
  v_cvt_pk_bf16_f32 v245, v30, v31
  v_lshlrev_b32 v246, 16, v245
  v_and_b32 v247, 0xffff0000, v245
  v_add_f32 v246, s35, v246
  v_add_f32 v247, s35, v247
  v_cvt_pk_bf16_f32 v245, v246, v247
  v_lshlrev_b32 v246, 16, v245
  v_and_b32 v247, 0xffff0000, v245
  v_rcp_f32 v246, v246
  v_rcp_f32 v247, v247
  v_lshlrev_b32 v248, 16, v244
  v_and_b32 v249, 0xffff0000, v244
  v_mul_f32 v248, v248, v246
  v_mul_f32 v249, v249, v247
  v_cvt_pk_bf16_f32 v251, v248, v249
  ds_write_b64 v9, v[250:251] offset:1024
  v_cvt_pk_bf16_f32 v244, v32, v33
  v_cvt_pk_bf16_f32 v245, v36, v37
  v_lshlrev_b32 v246, 16, v245
  v_and_b32 v247, 0xffff0000, v245
  v_add_f32 v246, s35, v246
  v_add_f32 v247, s35, v247
  v_cvt_pk_bf16_f32 v245, v246, v247
  v_lshlrev_b32 v246, 16, v245
  v_and_b32 v247, 0xffff0000, v245
  v_rcp_f32 v246, v246
  v_rcp_f32 v247, v247
  v_lshlrev_b32 v248, 16, v244
  v_and_b32 v249, 0xffff0000, v244
  v_mul_f32 v248, v248, v246
  v_mul_f32 v249, v249, v247
  v_cvt_pk_bf16_f32 v250, v248, v249
  v_cvt_pk_bf16_f32 v244, v34, v35
  v_cvt_pk_bf16_f32 v245, v38, v39
  v_lshlrev_b32 v246, 16, v245
  v_and_b32 v247, 0xffff0000, v245
  v_add_f32 v246, s35, v246
  v_add_f32 v247, s35, v247
  v_cvt_pk_bf16_f32 v245, v246, v247
  v_lshlrev_b32 v246, 16, v245
  v_and_b32 v247, 0xffff0000, v245
  v_rcp_f32 v246, v246
  v_rcp_f32 v247, v247
  v_lshlrev_b32 v248, 16, v244
  v_and_b32 v249, 0xffff0000, v244
  v_mul_f32 v248, v248, v246
  v_mul_f32 v249, v249, v247
  v_cvt_pk_bf16_f32 v251, v248, v249
  ds_write_b64 v9, v[250:251] offset:2048
  v_cvt_pk_bf16_f32 v244, v40, v41
  v_cvt_pk_bf16_f32 v245, v44, v45
  v_lshlrev_b32 v246, 16, v245
  v_and_b32 v247, 0xffff0000, v245
  v_add_f32 v246, s35, v246
  v_add_f32 v247, s35, v247
  v_cvt_pk_bf16_f32 v245, v246, v247
  v_lshlrev_b32 v246, 16, v245
  v_and_b32 v247, 0xffff0000, v245
  v_rcp_f32 v246, v246
  v_rcp_f32 v247, v247
  v_lshlrev_b32 v248, 16, v244
  v_and_b32 v249, 0xffff0000, v244
  v_mul_f32 v248, v248, v246
  v_mul_f32 v249, v249, v247
  v_cvt_pk_bf16_f32 v250, v248, v249
  v_cvt_pk_bf16_f32 v244, v42, v43
  v_cvt_pk_bf16_f32 v245, v46, v47
  v_lshlrev_b32 v246, 16, v245
  v_and_b32 v247, 0xffff0000, v245
  v_add_f32 v246, s35, v246
  v_add_f32 v247, s35, v247
  v_cvt_pk_bf16_f32 v245, v246, v247
  v_lshlrev_b32 v246, 16, v245
  v_and_b32 v247, 0xffff0000, v245
  v_rcp_f32 v246, v246
  v_rcp_f32 v247, v247
  v_lshlrev_b32 v248, 16, v244
  v_and_b32 v249, 0xffff0000, v244
  v_mul_f32 v248, v248, v246
  v_mul_f32 v249, v249, v247
  v_cvt_pk_bf16_f32 v251, v248, v249
  ds_write_b64 v9, v[250:251] offset:3072
  s_waitcnt lgkmcnt(0)
  s_barrier
  v_and_b32 v9, 15, v1
  v_mul_u32_u24 v9, 2560, v9
  v_lshrrev_b32 v10, 4, v1
  v_lshl_add_u32 v9, v10, 3, v9
  s_mov_b32 s12, s84
  s_and_b32 s13, s85, 0xffff
  s_mov_b32 s14, 5242880
  s_mov_b32 s15, 0x20000
  s_mul_i32 s38, s3, 102400
  s_add_u32 s38, s38, 86343680
  s_mul_i32 s39, s3, 102400
  s_add_u32 s39, s39, 86364160
  buffer_load_dwordx4 v[48:51], v2, s[8:11], s38 offen offset:0 sc1
  buffer_load_dwordx4 v[52:55], v2, s[8:11], s39 offen offset:0 sc1
  buffer_load_dwordx4 v[56:59], v2, s[8:11], s38 offen offset:1024 sc1
  buffer_load_dwordx4 v[60:63], v2, s[8:11], s39 offen offset:1024 sc1
  buffer_load_dwordx4 v[64:67], v2, s[8:11], s38 offen offset:2048 sc1
  buffer_load_dwordx4 v[68:71], v2, s[8:11], s39 offen offset:2048 sc1
  ds_read_b128 v[80:83], v7 offset:0
  ds_read_b128 v[84:87], v7 offset:1024
  ds_read_b128 v[88:91], v7 offset:2048
  ds_read_b128 v[92:95], v7 offset:3072
  buffer_load_dwordx4 v[72:75], v2, s[8:11], s38 offen offset:3072 sc1
  buffer_load_dwordx4 v[76:79], v2, s[8:11], s39 offen offset:3072 sc1
  s_add_u32 s38, s38, 4096
  s_add_u32 s39, s39, 4096
  ds_read_b128 v[96:99], v7 offset:4096
  ds_read_b128 v[100:103], v7 offset:5120
  ds_read_b128 v[104:107], v7 offset:6144
  ds_read_b128 v[108:111], v7 offset:7168
  s_waitcnt vmcnt(6) lgkmcnt(4)
  v_mfma_f32_16x16x32_bf16 v[16:19], v[48:51], v[80:83], 0
  v_mfma_f32_16x16x32_bf16 v[20:23], v[48:51], v[84:87], 0
  v_mfma_f32_16x16x32_bf16 v[24:27], v[48:51], v[88:91], 0
  v_mfma_f32_16x16x32_bf16 v[28:31], v[48:51], v[92:95], 0
  v_mfma_f32_16x16x32_bf16 v[32:35], v[52:55], v[80:83], 0
  v_mfma_f32_16x16x32_bf16 v[36:39], v[52:55], v[84:87], 0
  v_mfma_f32_16x16x32_bf16 v[40:43], v[52:55], v[88:91], 0
  v_mfma_f32_16x16x32_bf16 v[44:47], v[52:55], v[92:95], 0
  buffer_load_dwordx4 v[48:51], v2, s[8:11], s38 offen offset:0 sc1
  buffer_load_dwordx4 v[52:55], v2, s[8:11], s39 offen offset:0 sc1
  ds_read_b128 v[80:83], v7 offset:8192
  ds_read_b128 v[84:87], v7 offset:9216
  ds_read_b128 v[88:91], v7 offset:10240
  ds_read_b128 v[92:95], v7 offset:11264
  s_waitcnt vmcnt(6) lgkmcnt(4)
  v_mfma_f32_16x16x32_bf16 v[16:19], v[56:59], v[96:99], v[16:19]
  v_mfma_f32_16x16x32_bf16 v[20:23], v[56:59], v[100:103], v[20:23]
  v_mfma_f32_16x16x32_bf16 v[24:27], v[56:59], v[104:107], v[24:27]
  v_mfma_f32_16x16x32_bf16 v[28:31], v[56:59], v[108:111], v[28:31]
  v_mfma_f32_16x16x32_bf16 v[32:35], v[60:63], v[96:99], v[32:35]
  v_mfma_f32_16x16x32_bf16 v[36:39], v[60:63], v[100:103], v[36:39]
  v_mfma_f32_16x16x32_bf16 v[40:43], v[60:63], v[104:107], v[40:43]
  v_mfma_f32_16x16x32_bf16 v[44:47], v[60:63], v[108:111], v[44:47]
  buffer_load_dwordx4 v[56:59], v2, s[8:11], s38 offen offset:1024 sc1
  buffer_load_dwordx4 v[60:63], v2, s[8:11], s39 offen offset:1024 sc1
  ds_read_b128 v[96:99], v7 offset:12288
  ds_read_b128 v[100:103], v7 offset:13312
  ds_read_b128 v[104:107], v7 offset:14336
  ds_read_b128 v[108:111], v7 offset:15360
  s_waitcnt vmcnt(6) lgkmcnt(4)
  v_mfma_f32_16x16x32_bf16 v[16:19], v[64:67], v[80:83], v[16:19]
  v_mfma_f32_16x16x32_bf16 v[20:23], v[64:67], v[84:87], v[20:23]
  v_mfma_f32_16x16x32_bf16 v[24:27], v[64:67], v[88:91], v[24:27]
  v_mfma_f32_16x16x32_bf16 v[28:31], v[64:67], v[92:95], v[28:31]
  v_mfma_f32_16x16x32_bf16 v[32:35], v[68:71], v[80:83], v[32:35]
  v_mfma_f32_16x16x32_bf16 v[36:39], v[68:71], v[84:87], v[36:39]
  v_mfma_f32_16x16x32_bf16 v[40:43], v[68:71], v[88:91], v[40:43]
  v_mfma_f32_16x16x32_bf16 v[44:47], v[68:71], v[92:95], v[44:47]
  buffer_load_dwordx4 v[64:67], v2, s[8:11], s38 offen offset:2048 sc1
  buffer_load_dwordx4 v[68:71], v2, s[8:11], s39 offen offset:2048 sc1
  ds_read_b128 v[80:83], v7 offset:16384
  ds_read_b128 v[84:87], v7 offset:17408
  ds_read_b128 v[88:91], v7 offset:18432
  ds_read_b128 v[92:95], v7 offset:19456
  s_waitcnt vmcnt(6) lgkmcnt(4)
  v_mfma_f32_16x16x32_bf16 v[16:19], v[72:75], v[96:99], v[16:19]
  v_mfma_f32_16x16x32_bf16 v[20:23], v[72:75], v[100:103], v[20:23]
  v_mfma_f32_16x16x32_bf16 v[24:27], v[72:75], v[104:107], v[24:27]
  v_mfma_f32_16x16x32_bf16 v[28:31], v[72:75], v[108:111], v[28:31]
  v_mfma_f32_16x16x32_bf16 v[32:35], v[76:79], v[96:99], v[32:35]
  v_mfma_f32_16x16x32_bf16 v[36:39], v[76:79], v[100:103], v[36:39]
  v_mfma_f32_16x16x32_bf16 v[40:43], v[76:79], v[104:107], v[40:43]
  v_mfma_f32_16x16x32_bf16 v[44:47], v[76:79], v[108:111], v[44:47]
  buffer_load_dwordx4 v[72:75], v2, s[8:11], s38 offen offset:3072 sc1
  buffer_load_dwordx4 v[76:79], v2, s[8:11], s39 offen offset:3072 sc1
  s_add_u32 s38, s38, 4096
  s_add_u32 s39, s39, 4096
  ds_read_b128 v[96:99], v7 offset:20480
  ds_read_b128 v[100:103], v7 offset:21504
  ds_read_b128 v[104:107], v7 offset:22528
  ds_read_b128 v[108:111], v7 offset:23552
  s_waitcnt vmcnt(6) lgkmcnt(4)
  v_mfma_f32_16x16x32_bf16 v[16:19], v[48:51], v[80:83], v[16:19]
  v_mfma_f32_16x16x32_bf16 v[20:23], v[48:51], v[84:87], v[20:23]
  v_mfma_f32_16x16x32_bf16 v[24:27], v[48:51], v[88:91], v[24:27]
  v_mfma_f32_16x16x32_bf16 v[28:31], v[48:51], v[92:95], v[28:31]
  v_mfma_f32_16x16x32_bf16 v[32:35], v[52:55], v[80:83], v[32:35]
  v_mfma_f32_16x16x32_bf16 v[36:39], v[52:55], v[84:87], v[36:39]
  v_mfma_f32_16x16x32_bf16 v[40:43], v[52:55], v[88:91], v[40:43]
  v_mfma_f32_16x16x32_bf16 v[44:47], v[52:55], v[92:95], v[44:47]
  buffer_load_dwordx4 v[48:51], v2, s[8:11], s38 offen offset:0 sc1
  buffer_load_dwordx4 v[52:55], v2, s[8:11], s39 offen offset:0 sc1
  ds_read_b128 v[80:83], v7 offset:24576
  ds_read_b128 v[84:87], v7 offset:25600
  ds_read_b128 v[88:91], v7 offset:26624
  ds_read_b128 v[92:95], v7 offset:27648
  s_waitcnt vmcnt(6) lgkmcnt(4)
  v_mfma_f32_16x16x32_bf16 v[16:19], v[56:59], v[96:99], v[16:19]
  v_mfma_f32_16x16x32_bf16 v[20:23], v[56:59], v[100:103], v[20:23]
  v_mfma_f32_16x16x32_bf16 v[24:27], v[56:59], v[104:107], v[24:27]
  v_mfma_f32_16x16x32_bf16 v[28:31], v[56:59], v[108:111], v[28:31]
  v_mfma_f32_16x16x32_bf16 v[32:35], v[60:63], v[96:99], v[32:35]
  v_mfma_f32_16x16x32_bf16 v[36:39], v[60:63], v[100:103], v[36:39]
  v_mfma_f32_16x16x32_bf16 v[40:43], v[60:63], v[104:107], v[40:43]
  v_mfma_f32_16x16x32_bf16 v[44:47], v[60:63], v[108:111], v[44:47]
  buffer_load_dwordx4 v[56:59], v2, s[8:11], s38 offen offset:1024 sc1
  buffer_load_dwordx4 v[60:63], v2, s[8:11], s39 offen offset:1024 sc1
  ds_read_b128 v[96:99], v7 offset:28672
  ds_read_b128 v[100:103], v7 offset:29696
  ds_read_b128 v[104:107], v7 offset:30720
  ds_read_b128 v[108:111], v7 offset:31744
  s_waitcnt vmcnt(6) lgkmcnt(4)
  v_mfma_f32_16x16x32_bf16 v[16:19], v[64:67], v[80:83], v[16:19]
  v_mfma_f32_16x16x32_bf16 v[20:23], v[64:67], v[84:87], v[20:23]
  v_mfma_f32_16x16x32_bf16 v[24:27], v[64:67], v[88:91], v[24:27]
  v_mfma_f32_16x16x32_bf16 v[28:31], v[64:67], v[92:95], v[28:31]
  v_mfma_f32_16x16x32_bf16 v[32:35], v[68:71], v[80:83], v[32:35]
  v_mfma_f32_16x16x32_bf16 v[36:39], v[68:71], v[84:87], v[36:39]
  v_mfma_f32_16x16x32_bf16 v[40:43], v[68:71], v[88:91], v[40:43]
  v_mfma_f32_16x16x32_bf16 v[44:47], v[68:71], v[92:95], v[44:47]
  buffer_load_dwordx4 v[64:67], v2, s[8:11], s38 offen offset:2048 sc1
  buffer_load_dwordx4 v[68:71], v2, s[8:11], s39 offen offset:2048 sc1
  ds_read_b128 v[80:83], v7 offset:32768
  ds_read_b128 v[84:87], v7 offset:33792
  ds_read_b128 v[88:91], v7 offset:34816
  ds_read_b128 v[92:95], v7 offset:35840
  s_waitcnt vmcnt(6) lgkmcnt(4)
  v_mfma_f32_16x16x32_bf16 v[16:19], v[72:75], v[96:99], v[16:19]
  v_mfma_f32_16x16x32_bf16 v[20:23], v[72:75], v[100:103], v[20:23]
  v_mfma_f32_16x16x32_bf16 v[24:27], v[72:75], v[104:107], v[24:27]
  v_mfma_f32_16x16x32_bf16 v[28:31], v[72:75], v[108:111], v[28:31]
  v_mfma_f32_16x16x32_bf16 v[32:35], v[76:79], v[96:99], v[32:35]
  v_mfma_f32_16x16x32_bf16 v[36:39], v[76:79], v[100:103], v[36:39]
  v_mfma_f32_16x16x32_bf16 v[40:43], v[76:79], v[104:107], v[40:43]
  v_mfma_f32_16x16x32_bf16 v[44:47], v[76:79], v[108:111], v[44:47]
  buffer_load_dwordx4 v[72:75], v2, s[8:11], s38 offen offset:3072 sc1
  buffer_load_dwordx4 v[76:79], v2, s[8:11], s39 offen offset:3072 sc1
  s_add_u32 s38, s38, 4096
  s_add_u32 s39, s39, 4096
  ds_read_b128 v[96:99], v7 offset:36864
  ds_read_b128 v[100:103], v7 offset:37888
  ds_read_b128 v[104:107], v7 offset:38912
  ds_read_b128 v[108:111], v7 offset:39936
  s_waitcnt vmcnt(6) lgkmcnt(4)
  v_mfma_f32_16x16x32_bf16 v[16:19], v[48:51], v[80:83], v[16:19]
  v_mfma_f32_16x16x32_bf16 v[20:23], v[48:51], v[84:87], v[20:23]
  v_mfma_f32_16x16x32_bf16 v[24:27], v[48:51], v[88:91], v[24:27]
  v_mfma_f32_16x16x32_bf16 v[28:31], v[48:51], v[92:95], v[28:31]
  v_mfma_f32_16x16x32_bf16 v[32:35], v[52:55], v[80:83], v[32:35]
  v_mfma_f32_16x16x32_bf16 v[36:39], v[52:55], v[84:87], v[36:39]
  v_mfma_f32_16x16x32_bf16 v[40:43], v[52:55], v[88:91], v[40:43]
  v_mfma_f32_16x16x32_bf16 v[44:47], v[52:55], v[92:95], v[44:47]
  buffer_load_dwordx4 v[48:51], v2, s[8:11], s38 offen offset:0 sc1
  buffer_load_dwordx4 v[52:55], v2, s[8:11], s39 offen offset:0 sc1
  ds_read_b128 v[80:83], v8 offset:0
  ds_read_b128 v[84:87], v8 offset:1024
  ds_read_b128 v[88:91], v8 offset:2048
  ds_read_b128 v[92:95], v8 offset:3072
  s_waitcnt vmcnt(6) lgkmcnt(4)
  v_mfma_f32_16x16x32_bf16 v[16:19], v[56:59], v[96:99], v[16:19]
  v_mfma_f32_16x16x32_bf16 v[20:23], v[56:59], v[100:103], v[20:23]
  v_mfma_f32_16x16x32_bf16 v[24:27], v[56:59], v[104:107], v[24:27]
  v_mfma_f32_16x16x32_bf16 v[28:31], v[56:59], v[108:111], v[28:31]
  v_mfma_f32_16x16x32_bf16 v[32:35], v[60:63], v[96:99], v[32:35]
  v_mfma_f32_16x16x32_bf16 v[36:39], v[60:63], v[100:103], v[36:39]
  v_mfma_f32_16x16x32_bf16 v[40:43], v[60:63], v[104:107], v[40:43]
  v_mfma_f32_16x16x32_bf16 v[44:47], v[60:63], v[108:111], v[44:47]
  buffer_load_dwordx4 v[56:59], v2, s[8:11], s38 offen offset:1024 sc1
  buffer_load_dwordx4 v[60:63], v2, s[8:11], s39 offen offset:1024 sc1
  ds_read_b128 v[96:99], v8 offset:4096
  ds_read_b128 v[100:103], v8 offset:5120
  ds_read_b128 v[104:107], v8 offset:6144
  ds_read_b128 v[108:111], v8 offset:7168
  s_waitcnt vmcnt(6) lgkmcnt(4)
  v_mfma_f32_16x16x32_bf16 v[16:19], v[64:67], v[80:83], v[16:19]
  v_mfma_f32_16x16x32_bf16 v[20:23], v[64:67], v[84:87], v[20:23]
  v_mfma_f32_16x16x32_bf16 v[24:27], v[64:67], v[88:91], v[24:27]
  v_mfma_f32_16x16x32_bf16 v[28:31], v[64:67], v[92:95], v[28:31]
  v_mfma_f32_16x16x32_bf16 v[32:35], v[68:71], v[80:83], v[32:35]
  v_mfma_f32_16x16x32_bf16 v[36:39], v[68:71], v[84:87], v[36:39]
  v_mfma_f32_16x16x32_bf16 v[40:43], v[68:71], v[88:91], v[40:43]
  v_mfma_f32_16x16x32_bf16 v[44:47], v[68:71], v[92:95], v[44:47]
  buffer_load_dwordx4 v[64:67], v2, s[8:11], s38 offen offset:2048 sc1
  buffer_load_dwordx4 v[68:71], v2, s[8:11], s39 offen offset:2048 sc1
  ds_read_b128 v[80:83], v8 offset:8192
  ds_read_b128 v[84:87], v8 offset:9216
  ds_read_b128 v[88:91], v8 offset:10240
  ds_read_b128 v[92:95], v8 offset:11264
  s_waitcnt vmcnt(6) lgkmcnt(4)
  v_mfma_f32_16x16x32_bf16 v[16:19], v[72:75], v[96:99], v[16:19]
  v_mfma_f32_16x16x32_bf16 v[20:23], v[72:75], v[100:103], v[20:23]
  v_mfma_f32_16x16x32_bf16 v[24:27], v[72:75], v[104:107], v[24:27]
  v_mfma_f32_16x16x32_bf16 v[28:31], v[72:75], v[108:111], v[28:31]
  v_mfma_f32_16x16x32_bf16 v[32:35], v[76:79], v[96:99], v[32:35]
  v_mfma_f32_16x16x32_bf16 v[36:39], v[76:79], v[100:103], v[36:39]
  v_mfma_f32_16x16x32_bf16 v[40:43], v[76:79], v[104:107], v[40:43]
  v_mfma_f32_16x16x32_bf16 v[44:47], v[76:79], v[108:111], v[44:47]
  buffer_load_dwordx4 v[72:75], v2, s[8:11], s38 offen offset:3072 sc1
  buffer_load_dwordx4 v[76:79], v2, s[8:11], s39 offen offset:3072 sc1
  s_add_u32 s38, s38, 4096
  s_add_u32 s39, s39, 4096
  ds_read_b128 v[96:99], v8 offset:12288
  ds_read_b128 v[100:103], v8 offset:13312
  ds_read_b128 v[104:107], v8 offset:14336
  ds_read_b128 v[108:111], v8 offset:15360
  s_waitcnt vmcnt(6) lgkmcnt(4)
  v_mfma_f32_16x16x32_bf16 v[16:19], v[48:51], v[80:83], v[16:19]
  v_mfma_f32_16x16x32_bf16 v[20:23], v[48:51], v[84:87], v[20:23]
  v_mfma_f32_16x16x32_bf16 v[24:27], v[48:51], v[88:91], v[24:27]
  v_mfma_f32_16x16x32_bf16 v[28:31], v[48:51], v[92:95], v[28:31]
  v_mfma_f32_16x16x32_bf16 v[32:35], v[52:55], v[80:83], v[32:35]
  v_mfma_f32_16x16x32_bf16 v[36:39], v[52:55], v[84:87], v[36:39]
  v_mfma_f32_16x16x32_bf16 v[40:43], v[52:55], v[88:91], v[40:43]
  v_mfma_f32_16x16x32_bf16 v[44:47], v[52:55], v[92:95], v[44:47]
  buffer_load_dwordx4 v[48:51], v2, s[8:11], s38 offen offset:0 sc1
  buffer_load_dwordx4 v[52:55], v2, s[8:11], s39 offen offset:0 sc1
  ds_read_b128 v[80:83], v8 offset:16384
  ds_read_b128 v[84:87], v8 offset:17408
  ds_read_b128 v[88:91], v8 offset:18432
  ds_read_b128 v[92:95], v8 offset:19456
  s_waitcnt vmcnt(6) lgkmcnt(4)
  v_mfma_f32_16x16x32_bf16 v[16:19], v[56:59], v[96:99], v[16:19]
  v_mfma_f32_16x16x32_bf16 v[20:23], v[56:59], v[100:103], v[20:23]
  v_mfma_f32_16x16x32_bf16 v[24:27], v[56:59], v[104:107], v[24:27]
  v_mfma_f32_16x16x32_bf16 v[28:31], v[56:59], v[108:111], v[28:31]
  v_mfma_f32_16x16x32_bf16 v[32:35], v[60:63], v[96:99], v[32:35]
  v_mfma_f32_16x16x32_bf16 v[36:39], v[60:63], v[100:103], v[36:39]
  v_mfma_f32_16x16x32_bf16 v[40:43], v[60:63], v[104:107], v[40:43]
  v_mfma_f32_16x16x32_bf16 v[44:47], v[60:63], v[108:111], v[44:47]
  buffer_load_dwordx4 v[56:59], v2, s[8:11], s38 offen offset:1024 sc1
  buffer_load_dwordx4 v[60:63], v2, s[8:11], s39 offen offset:1024 sc1
  ds_read_b128 v[96:99], v8 offset:20480
  ds_read_b128 v[100:103], v8 offset:21504
  ds_read_b128 v[104:107], v8 offset:22528
  ds_read_b128 v[108:111], v8 offset:23552
  s_waitcnt vmcnt(6) lgkmcnt(4)
  v_mfma_f32_16x16x32_bf16 v[16:19], v[64:67], v[80:83], v[16:19]
  v_mfma_f32_16x16x32_bf16 v[20:23], v[64:67], v[84:87], v[20:23]
  v_mfma_f32_16x16x32_bf16 v[24:27], v[64:67], v[88:91], v[24:27]
  v_mfma_f32_16x16x32_bf16 v[28:31], v[64:67], v[92:95], v[28:31]
  v_mfma_f32_16x16x32_bf16 v[32:35], v[68:71], v[80:83], v[32:35]
  v_mfma_f32_16x16x32_bf16 v[36:39], v[68:71], v[84:87], v[36:39]
  v_mfma_f32_16x16x32_bf16 v[40:43], v[68:71], v[88:91], v[40:43]
  v_mfma_f32_16x16x32_bf16 v[44:47], v[68:71], v[92:95], v[44:47]
  buffer_load_dwordx4 v[64:67], v2, s[8:11], s38 offen offset:2048 sc1
  buffer_load_dwordx4 v[68:71], v2, s[8:11], s39 offen offset:2048 sc1
  ds_read_b128 v[80:83], v8 offset:24576
  ds_read_b128 v[84:87], v8 offset:25600
  ds_read_b128 v[88:91], v8 offset:26624
  ds_read_b128 v[92:95], v8 offset:27648
  s_waitcnt vmcnt(6) lgkmcnt(4)
  v_mfma_f32_16x16x32_bf16 v[16:19], v[72:75], v[96:99], v[16:19]
  v_mfma_f32_16x16x32_bf16 v[20:23], v[72:75], v[100:103], v[20:23]
  v_mfma_f32_16x16x32_bf16 v[24:27], v[72:75], v[104:107], v[24:27]
  v_mfma_f32_16x16x32_bf16 v[28:31], v[72:75], v[108:111], v[28:31]
  v_mfma_f32_16x16x32_bf16 v[32:35], v[76:79], v[96:99], v[32:35]
  v_mfma_f32_16x16x32_bf16 v[36:39], v[76:79], v[100:103], v[36:39]
  v_mfma_f32_16x16x32_bf16 v[40:43], v[76:79], v[104:107], v[40:43]
  v_mfma_f32_16x16x32_bf16 v[44:47], v[76:79], v[108:111], v[44:47]
  buffer_load_dwordx4 v[72:75], v2, s[8:11], s38 offen offset:3072 sc1
  buffer_load_dwordx4 v[76:79], v2, s[8:11], s39 offen offset:3072 sc1
  s_add_u32 s38, s38, 4096
  s_add_u32 s39, s39, 4096
  ds_read_b128 v[96:99], v8 offset:28672
  ds_read_b128 v[100:103], v8 offset:29696
  ds_read_b128 v[104:107], v8 offset:30720
  ds_read_b128 v[108:111], v8 offset:31744
  s_waitcnt vmcnt(6) lgkmcnt(4)
  v_mfma_f32_16x16x32_bf16 v[16:19], v[48:51], v[80:83], v[16:19]
  v_mfma_f32_16x16x32_bf16 v[20:23], v[48:51], v[84:87], v[20:23]
  v_mfma_f32_16x16x32_bf16 v[24:27], v[48:51], v[88:91], v[24:27]
  v_mfma_f32_16x16x32_bf16 v[28:31], v[48:51], v[92:95], v[28:31]
  v_mfma_f32_16x16x32_bf16 v[32:35], v[52:55], v[80:83], v[32:35]
  v_mfma_f32_16x16x32_bf16 v[36:39], v[52:55], v[84:87], v[36:39]
  v_mfma_f32_16x16x32_bf16 v[40:43], v[52:55], v[88:91], v[40:43]
  v_mfma_f32_16x16x32_bf16 v[44:47], v[52:55], v[92:95], v[44:47]
  ds_read_b128 v[80:83], v8 offset:32768
  ds_read_b128 v[84:87], v8 offset:33792
  ds_read_b128 v[88:91], v8 offset:34816
  ds_read_b128 v[92:95], v8 offset:35840
  s_waitcnt vmcnt(4) lgkmcnt(4)
  v_mfma_f32_16x16x32_bf16 v[16:19], v[56:59], v[96:99], v[16:19]
  v_mfma_f32_16x16x32_bf16 v[20:23], v[56:59], v[100:103], v[20:23]
  v_mfma_f32_16x16x32_bf16 v[24:27], v[56:59], v[104:107], v[24:27]
  v_mfma_f32_16x16x32_bf16 v[28:31], v[56:59], v[108:111], v[28:31]
  v_mfma_f32_16x16x32_bf16 v[32:35], v[60:63], v[96:99], v[32:35]
  v_mfma_f32_16x16x32_bf16 v[36:39], v[60:63], v[100:103], v[36:39]
  v_mfma_f32_16x16x32_bf16 v[40:43], v[60:63], v[104:107], v[40:43]
  v_mfma_f32_16x16x32_bf16 v[44:47], v[60:63], v[108:111], v[44:47]
  ds_read_b128 v[96:99], v8 offset:36864
  ds_read_b128 v[100:103], v8 offset:37888
  ds_read_b128 v[104:107], v8 offset:38912
  ds_read_b128 v[108:111], v8 offset:39936
  s_waitcnt vmcnt(2) lgkmcnt(4)
  v_mfma_f32_16x16x32_bf16 v[16:19], v[64:67], v[80:83], v[16:19]
  v_mfma_f32_16x16x32_bf16 v[20:23], v[64:67], v[84:87], v[20:23]
  v_mfma_f32_16x16x32_bf16 v[24:27], v[64:67], v[88:91], v[24:27]
  v_mfma_f32_16x16x32_bf16 v[28:31], v[64:67], v[92:95], v[28:31]
  v_mfma_f32_16x16x32_bf16 v[32:35], v[68:71], v[80:83], v[32:35]
  v_mfma_f32_16x16x32_bf16 v[36:39], v[68:71], v[84:87], v[36:39]
  v_mfma_f32_16x16x32_bf16 v[40:43], v[68:71], v[88:91], v[40:43]
  v_mfma_f32_16x16x32_bf16 v[44:47], v[68:71], v[92:95], v[44:47]
  s_waitcnt vmcnt(0) lgkmcnt(0)
  v_mfma_f32_16x16x32_bf16 v[16:19], v[72:75], v[96:99], v[16:19]
  v_mfma_f32_16x16x32_bf16 v[20:23], v[72:75], v[100:103], v[20:23]
  v_mfma_f32_16x16x32_bf16 v[24:27], v[72:75], v[104:107], v[24:27]
  v_mfma_f32_16x16x32_bf16 v[28:31], v[72:75], v[108:111], v[28:31]
  v_mfma_f32_16x16x32_bf16 v[32:35], v[76:79], v[96:99], v[32:35]
  v_mfma_f32_16x16x32_bf16 v[36:39], v[76:79], v[100:103], v[36:39]
  v_mfma_f32_16x16x32_bf16 v[40:43], v[76:79], v[104:107], v[40:43]
  v_mfma_f32_16x16x32_bf16 v[44:47], v[76:79], v[108:111], v[44:47]
  s_nop 7
  s_mul_i32 s25, s4, 163840
  s_mul_i32 s26, s3, 160
  s_add_u32 s25, s25, s26
  s_add_u32 s25, s25, 1280
  v_cvt_pk_bf16_f32 v244, v16, v17
  v_cvt_pk_bf16_f32 v245, v18, v19
  buffer_store_dwordx2 v[244:245], v9, s[12:15], s25 offen
  s_add_u32 s25, s25, 40960
  v_cvt_pk_bf16_f32 v246, v20, v21
  v_cvt_pk_bf16_f32 v247, v22, v23
  buffer_store_dwordx2 v[246:247], v9, s[12:15], s25 offen
  s_add_u32 s25, s25, 40960
  v_cvt_pk_bf16_f32 v244, v24, v25
  v_cvt_pk_bf16_f32 v245, v26, v27
  buffer_store_dwordx2 v[244:245], v9, s[12:15], s25 offen
  s_add_u32 s25, s25, 40960
  v_cvt_pk_bf16_f32 v246, v28, v29
  v_cvt_pk_bf16_f32 v247, v30, v31
  buffer_store_dwordx2 v[246:247], v9, s[12:15], s25 offen
  s_mul_i32 s25, s4, 163840
  s_mul_i32 s26, s3, 160
  s_add_u32 s25, s25, s26
  s_add_u32 s25, s25, 1312
  v_cvt_pk_bf16_f32 v248, v32, v33
  v_cvt_pk_bf16_f32 v249, v34, v35
  buffer_store_dwordx2 v[248:249], v9, s[12:15], s25 offen
  s_add_u32 s25, s25, 40960
  v_cvt_pk_bf16_f32 v250, v36, v37
  v_cvt_pk_bf16_f32 v251, v38, v39
  buffer_store_dwordx2 v[250:251], v9, s[12:15], s25 offen
  s_add_u32 s25, s25, 40960
  v_cvt_pk_bf16_f32 v248, v40, v41
  v_cvt_pk_bf16_f32 v249, v42, v43
  buffer_store_dwordx2 v[248:249], v9, s[12:15], s25 offen
  s_add_u32 s25, s25, 40960
  v_cvt_pk_bf16_f32 v250, v44, v45
  v_cvt_pk_bf16_f32 v251, v46, v47
  buffer_store_dwordx2 v[250:251], v9, s[12:15], s25 offen
  s_mul_i32 s38, s3, 102400
  s_add_u32 s38, s38, 86384640
  s_mul_i32 s39, s3, 102400
  s_add_u32 s39, s39, 86405120
  buffer_load_dwordx4 v[48:51], v2, s[8:11], s38 offen offset:0 sc1
  buffer_load_dwordx4 v[52:55], v2, s[8:11], s39 offen offset:0 sc1
  buffer_load_dwordx4 v[56:59], v2, s[8:11], s38 offen offset:1024 sc1
  buffer_load_dwordx4 v[60:63], v2, s[8:11], s39 offen offset:1024 sc1
  buffer_load_dwordx4 v[64:67], v2, s[8:11], s38 offen offset:2048 sc1
  buffer_load_dwordx4 v[68:71], v2, s[8:11], s39 offen offset:2048 sc1
  ds_read_b128 v[80:83], v7 offset:0
  ds_read_b128 v[84:87], v7 offset:1024
  ds_read_b128 v[88:91], v7 offset:2048
  ds_read_b128 v[92:95], v7 offset:3072
  buffer_load_dwordx4 v[72:75], v2, s[8:11], s38 offen offset:3072 sc1
  buffer_load_dwordx4 v[76:79], v2, s[8:11], s39 offen offset:3072 sc1
  s_add_u32 s38, s38, 4096
  s_add_u32 s39, s39, 4096
  ds_read_b128 v[96:99], v7 offset:4096
  ds_read_b128 v[100:103], v7 offset:5120
  ds_read_b128 v[104:107], v7 offset:6144
  ds_read_b128 v[108:111], v7 offset:7168
  s_waitcnt vmcnt(6) lgkmcnt(4)
  v_mfma_f32_16x16x32_bf16 v[16:19], v[48:51], v[80:83], 0
  v_mfma_f32_16x16x32_bf16 v[20:23], v[48:51], v[84:87], 0
  v_mfma_f32_16x16x32_bf16 v[24:27], v[48:51], v[88:91], 0
  v_mfma_f32_16x16x32_bf16 v[28:31], v[48:51], v[92:95], 0
  v_mfma_f32_16x16x32_bf16 v[32:35], v[52:55], v[80:83], 0
  v_mfma_f32_16x16x32_bf16 v[36:39], v[52:55], v[84:87], 0
  v_mfma_f32_16x16x32_bf16 v[40:43], v[52:55], v[88:91], 0
  v_mfma_f32_16x16x32_bf16 v[44:47], v[52:55], v[92:95], 0
  buffer_load_dwordx4 v[48:51], v2, s[8:11], s38 offen offset:0 sc1
  buffer_load_dwordx4 v[52:55], v2, s[8:11], s39 offen offset:0 sc1
  ds_read_b128 v[80:83], v7 offset:8192
  ds_read_b128 v[84:87], v7 offset:9216
  ds_read_b128 v[88:91], v7 offset:10240
  ds_read_b128 v[92:95], v7 offset:11264
  s_waitcnt vmcnt(6) lgkmcnt(4)
  v_mfma_f32_16x16x32_bf16 v[16:19], v[56:59], v[96:99], v[16:19]
  v_mfma_f32_16x16x32_bf16 v[20:23], v[56:59], v[100:103], v[20:23]
  v_mfma_f32_16x16x32_bf16 v[24:27], v[56:59], v[104:107], v[24:27]
  v_mfma_f32_16x16x32_bf16 v[28:31], v[56:59], v[108:111], v[28:31]
  v_mfma_f32_16x16x32_bf16 v[32:35], v[60:63], v[96:99], v[32:35]
  v_mfma_f32_16x16x32_bf16 v[36:39], v[60:63], v[100:103], v[36:39]
  v_mfma_f32_16x16x32_bf16 v[40:43], v[60:63], v[104:107], v[40:43]
  v_mfma_f32_16x16x32_bf16 v[44:47], v[60:63], v[108:111], v[44:47]
  buffer_load_dwordx4 v[56:59], v2, s[8:11], s38 offen offset:1024 sc1
  buffer_load_dwordx4 v[60:63], v2, s[8:11], s39 offen offset:1024 sc1
  ds_read_b128 v[96:99], v7 offset:12288
  ds_read_b128 v[100:103], v7 offset:13312
  ds_read_b128 v[104:107], v7 offset:14336
  ds_read_b128 v[108:111], v7 offset:15360
  s_waitcnt vmcnt(6) lgkmcnt(4)
  v_mfma_f32_16x16x32_bf16 v[16:19], v[64:67], v[80:83], v[16:19]
  v_mfma_f32_16x16x32_bf16 v[20:23], v[64:67], v[84:87], v[20:23]
  v_mfma_f32_16x16x32_bf16 v[24:27], v[64:67], v[88:91], v[24:27]
  v_mfma_f32_16x16x32_bf16 v[28:31], v[64:67], v[92:95], v[28:31]
  v_mfma_f32_16x16x32_bf16 v[32:35], v[68:71], v[80:83], v[32:35]
  v_mfma_f32_16x16x32_bf16 v[36:39], v[68:71], v[84:87], v[36:39]
  v_mfma_f32_16x16x32_bf16 v[40:43], v[68:71], v[88:91], v[40:43]
  v_mfma_f32_16x16x32_bf16 v[44:47], v[68:71], v[92:95], v[44:47]
  buffer_load_dwordx4 v[64:67], v2, s[8:11], s38 offen offset:2048 sc1
  buffer_load_dwordx4 v[68:71], v2, s[8:11], s39 offen offset:2048 sc1
  ds_read_b128 v[80:83], v7 offset:16384
  ds_read_b128 v[84:87], v7 offset:17408
  ds_read_b128 v[88:91], v7 offset:18432
  ds_read_b128 v[92:95], v7 offset:19456
  s_waitcnt vmcnt(6) lgkmcnt(4)
  v_mfma_f32_16x16x32_bf16 v[16:19], v[72:75], v[96:99], v[16:19]
  v_mfma_f32_16x16x32_bf16 v[20:23], v[72:75], v[100:103], v[20:23]
  v_mfma_f32_16x16x32_bf16 v[24:27], v[72:75], v[104:107], v[24:27]
  v_mfma_f32_16x16x32_bf16 v[28:31], v[72:75], v[108:111], v[28:31]
  v_mfma_f32_16x16x32_bf16 v[32:35], v[76:79], v[96:99], v[32:35]
  v_mfma_f32_16x16x32_bf16 v[36:39], v[76:79], v[100:103], v[36:39]
  v_mfma_f32_16x16x32_bf16 v[40:43], v[76:79], v[104:107], v[40:43]
  v_mfma_f32_16x16x32_bf16 v[44:47], v[76:79], v[108:111], v[44:47]
  buffer_load_dwordx4 v[72:75], v2, s[8:11], s38 offen offset:3072 sc1
  buffer_load_dwordx4 v[76:79], v2, s[8:11], s39 offen offset:3072 sc1
  s_add_u32 s38, s38, 4096
  s_add_u32 s39, s39, 4096
  ds_read_b128 v[96:99], v7 offset:20480
  ds_read_b128 v[100:103], v7 offset:21504
  ds_read_b128 v[104:107], v7 offset:22528
  ds_read_b128 v[108:111], v7 offset:23552
  s_waitcnt vmcnt(6) lgkmcnt(4)
  v_mfma_f32_16x16x32_bf16 v[16:19], v[48:51], v[80:83], v[16:19]
  v_mfma_f32_16x16x32_bf16 v[20:23], v[48:51], v[84:87], v[20:23]
  v_mfma_f32_16x16x32_bf16 v[24:27], v[48:51], v[88:91], v[24:27]
  v_mfma_f32_16x16x32_bf16 v[28:31], v[48:51], v[92:95], v[28:31]
  v_mfma_f32_16x16x32_bf16 v[32:35], v[52:55], v[80:83], v[32:35]
  v_mfma_f32_16x16x32_bf16 v[36:39], v[52:55], v[84:87], v[36:39]
  v_mfma_f32_16x16x32_bf16 v[40:43], v[52:55], v[88:91], v[40:43]
  v_mfma_f32_16x16x32_bf16 v[44:47], v[52:55], v[92:95], v[44:47]
  buffer_load_dwordx4 v[48:51], v2, s[8:11], s38 offen offset:0 sc1
  buffer_load_dwordx4 v[52:55], v2, s[8:11], s39 offen offset:0 sc1
  ds_read_b128 v[80:83], v7 offset:24576
  ds_read_b128 v[84:87], v7 offset:25600
  ds_read_b128 v[88:91], v7 offset:26624
  ds_read_b128 v[92:95], v7 offset:27648
  s_waitcnt vmcnt(6) lgkmcnt(4)
  v_mfma_f32_16x16x32_bf16 v[16:19], v[56:59], v[96:99], v[16:19]
  v_mfma_f32_16x16x32_bf16 v[20:23], v[56:59], v[100:103], v[20:23]
  v_mfma_f32_16x16x32_bf16 v[24:27], v[56:59], v[104:107], v[24:27]
  v_mfma_f32_16x16x32_bf16 v[28:31], v[56:59], v[108:111], v[28:31]
  v_mfma_f32_16x16x32_bf16 v[32:35], v[60:63], v[96:99], v[32:35]
  v_mfma_f32_16x16x32_bf16 v[36:39], v[60:63], v[100:103], v[36:39]
  v_mfma_f32_16x16x32_bf16 v[40:43], v[60:63], v[104:107], v[40:43]
  v_mfma_f32_16x16x32_bf16 v[44:47], v[60:63], v[108:111], v[44:47]
  buffer_load_dwordx4 v[56:59], v2, s[8:11], s38 offen offset:1024 sc1
  buffer_load_dwordx4 v[60:63], v2, s[8:11], s39 offen offset:1024 sc1
  ds_read_b128 v[96:99], v7 offset:28672
  ds_read_b128 v[100:103], v7 offset:29696
  ds_read_b128 v[104:107], v7 offset:30720
  ds_read_b128 v[108:111], v7 offset:31744
  s_waitcnt vmcnt(6) lgkmcnt(4)
  v_mfma_f32_16x16x32_bf16 v[16:19], v[64:67], v[80:83], v[16:19]
  v_mfma_f32_16x16x32_bf16 v[20:23], v[64:67], v[84:87], v[20:23]
  v_mfma_f32_16x16x32_bf16 v[24:27], v[64:67], v[88:91], v[24:27]
  v_mfma_f32_16x16x32_bf16 v[28:31], v[64:67], v[92:95], v[28:31]
  v_mfma_f32_16x16x32_bf16 v[32:35], v[68:71], v[80:83], v[32:35]
  v_mfma_f32_16x16x32_bf16 v[36:39], v[68:71], v[84:87], v[36:39]
  v_mfma_f32_16x16x32_bf16 v[40:43], v[68:71], v[88:91], v[40:43]
  v_mfma_f32_16x16x32_bf16 v[44:47], v[68:71], v[92:95], v[44:47]
  buffer_load_dwordx4 v[64:67], v2, s[8:11], s38 offen offset:2048 sc1
  buffer_load_dwordx4 v[68:71], v2, s[8:11], s39 offen offset:2048 sc1
  ds_read_b128 v[80:83], v7 offset:32768
  ds_read_b128 v[84:87], v7 offset:33792
  ds_read_b128 v[88:91], v7 offset:34816
  ds_read_b128 v[92:95], v7 offset:35840
  s_waitcnt vmcnt(6) lgkmcnt(4)
  v_mfma_f32_16x16x32_bf16 v[16:19], v[72:75], v[96:99], v[16:19]
  v_mfma_f32_16x16x32_bf16 v[20:23], v[72:75], v[100:103], v[20:23]
  v_mfma_f32_16x16x32_bf16 v[24:27], v[72:75], v[104:107], v[24:27]
  v_mfma_f32_16x16x32_bf16 v[28:31], v[72:75], v[108:111], v[28:31]
  v_mfma_f32_16x16x32_bf16 v[32:35], v[76:79], v[96:99], v[32:35]
  v_mfma_f32_16x16x32_bf16 v[36:39], v[76:79], v[100:103], v[36:39]
  v_mfma_f32_16x16x32_bf16 v[40:43], v[76:79], v[104:107], v[40:43]
  v_mfma_f32_16x16x32_bf16 v[44:47], v[76:79], v[108:111], v[44:47]
  buffer_load_dwordx4 v[72:75], v2, s[8:11], s38 offen offset:3072 sc1
  buffer_load_dwordx4 v[76:79], v2, s[8:11], s39 offen offset:3072 sc1
  s_add_u32 s38, s38, 4096
  s_add_u32 s39, s39, 4096
  ds_read_b128 v[96:99], v7 offset:36864
  ds_read_b128 v[100:103], v7 offset:37888
  ds_read_b128 v[104:107], v7 offset:38912
  ds_read_b128 v[108:111], v7 offset:39936
  s_waitcnt vmcnt(6) lgkmcnt(4)
  v_mfma_f32_16x16x32_bf16 v[16:19], v[48:51], v[80:83], v[16:19]
  v_mfma_f32_16x16x32_bf16 v[20:23], v[48:51], v[84:87], v[20:23]
  v_mfma_f32_16x16x32_bf16 v[24:27], v[48:51], v[88:91], v[24:27]
  v_mfma_f32_16x16x32_bf16 v[28:31], v[48:51], v[92:95], v[28:31]
  v_mfma_f32_16x16x32_bf16 v[32:35], v[52:55], v[80:83], v[32:35]
  v_mfma_f32_16x16x32_bf16 v[36:39], v[52:55], v[84:87], v[36:39]
  v_mfma_f32_16x16x32_bf16 v[40:43], v[52:55], v[88:91], v[40:43]
  v_mfma_f32_16x16x32_bf16 v[44:47], v[52:55], v[92:95], v[44:47]
  buffer_load_dwordx4 v[48:51], v2, s[8:11], s38 offen offset:0 sc1
  buffer_load_dwordx4 v[52:55], v2, s[8:11], s39 offen offset:0 sc1
  ds_read_b128 v[80:83], v8 offset:0
  ds_read_b128 v[84:87], v8 offset:1024
  ds_read_b128 v[88:91], v8 offset:2048
  ds_read_b128 v[92:95], v8 offset:3072
  s_waitcnt vmcnt(6) lgkmcnt(4)
  v_mfma_f32_16x16x32_bf16 v[16:19], v[56:59], v[96:99], v[16:19]
  v_mfma_f32_16x16x32_bf16 v[20:23], v[56:59], v[100:103], v[20:23]
  v_mfma_f32_16x16x32_bf16 v[24:27], v[56:59], v[104:107], v[24:27]
  v_mfma_f32_16x16x32_bf16 v[28:31], v[56:59], v[108:111], v[28:31]
  v_mfma_f32_16x16x32_bf16 v[32:35], v[60:63], v[96:99], v[32:35]
  v_mfma_f32_16x16x32_bf16 v[36:39], v[60:63], v[100:103], v[36:39]
  v_mfma_f32_16x16x32_bf16 v[40:43], v[60:63], v[104:107], v[40:43]
  v_mfma_f32_16x16x32_bf16 v[44:47], v[60:63], v[108:111], v[44:47]
  buffer_load_dwordx4 v[56:59], v2, s[8:11], s38 offen offset:1024 sc1
  buffer_load_dwordx4 v[60:63], v2, s[8:11], s39 offen offset:1024 sc1
  ds_read_b128 v[96:99], v8 offset:4096
  ds_read_b128 v[100:103], v8 offset:5120
  ds_read_b128 v[104:107], v8 offset:6144
  ds_read_b128 v[108:111], v8 offset:7168
  s_waitcnt vmcnt(6) lgkmcnt(4)
  v_mfma_f32_16x16x32_bf16 v[16:19], v[64:67], v[80:83], v[16:19]
  v_mfma_f32_16x16x32_bf16 v[20:23], v[64:67], v[84:87], v[20:23]
  v_mfma_f32_16x16x32_bf16 v[24:27], v[64:67], v[88:91], v[24:27]
  v_mfma_f32_16x16x32_bf16 v[28:31], v[64:67], v[92:95], v[28:31]
  v_mfma_f32_16x16x32_bf16 v[32:35], v[68:71], v[80:83], v[32:35]
  v_mfma_f32_16x16x32_bf16 v[36:39], v[68:71], v[84:87], v[36:39]
  v_mfma_f32_16x16x32_bf16 v[40:43], v[68:71], v[88:91], v[40:43]
  v_mfma_f32_16x16x32_bf16 v[44:47], v[68:71], v[92:95], v[44:47]
  buffer_load_dwordx4 v[64:67], v2, s[8:11], s38 offen offset:2048 sc1
  buffer_load_dwordx4 v[68:71], v2, s[8:11], s39 offen offset:2048 sc1
  ds_read_b128 v[80:83], v8 offset:8192
  ds_read_b128 v[84:87], v8 offset:9216
  ds_read_b128 v[88:91], v8 offset:10240
  ds_read_b128 v[92:95], v8 offset:11264
  s_waitcnt vmcnt(6) lgkmcnt(4)
  v_mfma_f32_16x16x32_bf16 v[16:19], v[72:75], v[96:99], v[16:19]
  v_mfma_f32_16x16x32_bf16 v[20:23], v[72:75], v[100:103], v[20:23]
  v_mfma_f32_16x16x32_bf16 v[24:27], v[72:75], v[104:107], v[24:27]
  v_mfma_f32_16x16x32_bf16 v[28:31], v[72:75], v[108:111], v[28:31]
  v_mfma_f32_16x16x32_bf16 v[32:35], v[76:79], v[96:99], v[32:35]
  v_mfma_f32_16x16x32_bf16 v[36:39], v[76:79], v[100:103], v[36:39]
  v_mfma_f32_16x16x32_bf16 v[40:43], v[76:79], v[104:107], v[40:43]
  v_mfma_f32_16x16x32_bf16 v[44:47], v[76:79], v[108:111], v[44:47]
  buffer_load_dwordx4 v[72:75], v2, s[8:11], s38 offen offset:3072 sc1
  buffer_load_dwordx4 v[76:79], v2, s[8:11], s39 offen offset:3072 sc1
  s_add_u32 s38, s38, 4096
  s_add_u32 s39, s39, 4096
  ds_read_b128 v[96:99], v8 offset:12288
  ds_read_b128 v[100:103], v8 offset:13312
  ds_read_b128 v[104:107], v8 offset:14336
  ds_read_b128 v[108:111], v8 offset:15360
  s_waitcnt vmcnt(6) lgkmcnt(4)
  v_mfma_f32_16x16x32_bf16 v[16:19], v[48:51], v[80:83], v[16:19]
  v_mfma_f32_16x16x32_bf16 v[20:23], v[48:51], v[84:87], v[20:23]
  v_mfma_f32_16x16x32_bf16 v[24:27], v[48:51], v[88:91], v[24:27]
  v_mfma_f32_16x16x32_bf16 v[28:31], v[48:51], v[92:95], v[28:31]
  v_mfma_f32_16x16x32_bf16 v[32:35], v[52:55], v[80:83], v[32:35]
  v_mfma_f32_16x16x32_bf16 v[36:39], v[52:55], v[84:87], v[36:39]
  v_mfma_f32_16x16x32_bf16 v[40:43], v[52:55], v[88:91], v[40:43]
  v_mfma_f32_16x16x32_bf16 v[44:47], v[52:55], v[92:95], v[44:47]
  buffer_load_dwordx4 v[48:51], v2, s[8:11], s38 offen offset:0 sc1
  buffer_load_dwordx4 v[52:55], v2, s[8:11], s39 offen offset:0 sc1
  ds_read_b128 v[80:83], v8 offset:16384
  ds_read_b128 v[84:87], v8 offset:17408
  ds_read_b128 v[88:91], v8 offset:18432
  ds_read_b128 v[92:95], v8 offset:19456
  s_waitcnt vmcnt(6) lgkmcnt(4)
  v_mfma_f32_16x16x32_bf16 v[16:19], v[56:59], v[96:99], v[16:19]
  v_mfma_f32_16x16x32_bf16 v[20:23], v[56:59], v[100:103], v[20:23]
  v_mfma_f32_16x16x32_bf16 v[24:27], v[56:59], v[104:107], v[24:27]
  v_mfma_f32_16x16x32_bf16 v[28:31], v[56:59], v[108:111], v[28:31]
  v_mfma_f32_16x16x32_bf16 v[32:35], v[60:63], v[96:99], v[32:35]
  v_mfma_f32_16x16x32_bf16 v[36:39], v[60:63], v[100:103], v[36:39]
  v_mfma_f32_16x16x32_bf16 v[40:43], v[60:63], v[104:107], v[40:43]
  v_mfma_f32_16x16x32_bf16 v[44:47], v[60:63], v[108:111], v[44:47]
  buffer_load_dwordx4 v[56:59], v2, s[8:11], s38 offen offset:1024 sc1
  buffer_load_dwordx4 v[60:63], v2, s[8:11], s39 offen offset:1024 sc1
  ds_read_b128 v[96:99], v8 offset:20480
  ds_read_b128 v[100:103], v8 offset:21504
  ds_read_b128 v[104:107], v8 offset:22528
  ds_read_b128 v[108:111], v8 offset:23552
  s_waitcnt vmcnt(6) lgkmcnt(4)
  v_mfma_f32_16x16x32_bf16 v[16:19], v[64:67], v[80:83], v[16:19]
  v_mfma_f32_16x16x32_bf16 v[20:23], v[64:67], v[84:87], v[20:23]
  v_mfma_f32_16x16x32_bf16 v[24:27], v[64:67], v[88:91], v[24:27]
  v_mfma_f32_16x16x32_bf16 v[28:31], v[64:67], v[92:95], v[28:31]
  v_mfma_f32_16x16x32_bf16 v[32:35], v[68:71], v[80:83], v[32:35]
  v_mfma_f32_16x16x32_bf16 v[36:39], v[68:71], v[84:87], v[36:39]
  v_mfma_f32_16x16x32_bf16 v[40:43], v[68:71], v[88:91], v[40:43]
  v_mfma_f32_16x16x32_bf16 v[44:47], v[68:71], v[92:95], v[44:47]
  buffer_load_dwordx4 v[64:67], v2, s[8:11], s38 offen offset:2048 sc1
  buffer_load_dwordx4 v[68:71], v2, s[8:11], s39 offen offset:2048 sc1
  ds_read_b128 v[80:83], v8 offset:24576
  ds_read_b128 v[84:87], v8 offset:25600
  ds_read_b128 v[88:91], v8 offset:26624
  ds_read_b128 v[92:95], v8 offset:27648
  s_waitcnt vmcnt(6) lgkmcnt(4)
  v_mfma_f32_16x16x32_bf16 v[16:19], v[72:75], v[96:99], v[16:19]
  v_mfma_f32_16x16x32_bf16 v[20:23], v[72:75], v[100:103], v[20:23]
  v_mfma_f32_16x16x32_bf16 v[24:27], v[72:75], v[104:107], v[24:27]
  v_mfma_f32_16x16x32_bf16 v[28:31], v[72:75], v[108:111], v[28:31]
  v_mfma_f32_16x16x32_bf16 v[32:35], v[76:79], v[96:99], v[32:35]
  v_mfma_f32_16x16x32_bf16 v[36:39], v[76:79], v[100:103], v[36:39]
  v_mfma_f32_16x16x32_bf16 v[40:43], v[76:79], v[104:107], v[40:43]
  v_mfma_f32_16x16x32_bf16 v[44:47], v[76:79], v[108:111], v[44:47]
  buffer_load_dwordx4 v[72:75], v2, s[8:11], s38 offen offset:3072 sc1
  buffer_load_dwordx4 v[76:79], v2, s[8:11], s39 offen offset:3072 sc1
  s_add_u32 s38, s38, 4096
  s_add_u32 s39, s39, 4096
  ds_read_b128 v[96:99], v8 offset:28672
  ds_read_b128 v[100:103], v8 offset:29696
  ds_read_b128 v[104:107], v8 offset:30720
  ds_read_b128 v[108:111], v8 offset:31744
  s_waitcnt vmcnt(6) lgkmcnt(4)
  v_mfma_f32_16x16x32_bf16 v[16:19], v[48:51], v[80:83], v[16:19]
  v_mfma_f32_16x16x32_bf16 v[20:23], v[48:51], v[84:87], v[20:23]
  v_mfma_f32_16x16x32_bf16 v[24:27], v[48:51], v[88:91], v[24:27]
  v_mfma_f32_16x16x32_bf16 v[28:31], v[48:51], v[92:95], v[28:31]
  v_mfma_f32_16x16x32_bf16 v[32:35], v[52:55], v[80:83], v[32:35]
  v_mfma_f32_16x16x32_bf16 v[36:39], v[52:55], v[84:87], v[36:39]
  v_mfma_f32_16x16x32_bf16 v[40:43], v[52:55], v[88:91], v[40:43]
  v_mfma_f32_16x16x32_bf16 v[44:47], v[52:55], v[92:95], v[44:47]
  ds_read_b128 v[80:83], v8 offset:32768
  ds_read_b128 v[84:87], v8 offset:33792
  ds_read_b128 v[88:91], v8 offset:34816
  ds_read_b128 v[92:95], v8 offset:35840
  s_waitcnt vmcnt(4) lgkmcnt(4)
  v_mfma_f32_16x16x32_bf16 v[16:19], v[56:59], v[96:99], v[16:19]
  v_mfma_f32_16x16x32_bf16 v[20:23], v[56:59], v[100:103], v[20:23]
  v_mfma_f32_16x16x32_bf16 v[24:27], v[56:59], v[104:107], v[24:27]
  v_mfma_f32_16x16x32_bf16 v[28:31], v[56:59], v[108:111], v[28:31]
  v_mfma_f32_16x16x32_bf16 v[32:35], v[60:63], v[96:99], v[32:35]
  v_mfma_f32_16x16x32_bf16 v[36:39], v[60:63], v[100:103], v[36:39]
  v_mfma_f32_16x16x32_bf16 v[40:43], v[60:63], v[104:107], v[40:43]
  v_mfma_f32_16x16x32_bf16 v[44:47], v[60:63], v[108:111], v[44:47]
  ds_read_b128 v[96:99], v8 offset:36864
  ds_read_b128 v[100:103], v8 offset:37888
  ds_read_b128 v[104:107], v8 offset:38912
  ds_read_b128 v[108:111], v8 offset:39936
  s_waitcnt vmcnt(2) lgkmcnt(4)
  v_mfma_f32_16x16x32_bf16 v[16:19], v[64:67], v[80:83], v[16:19]
  v_mfma_f32_16x16x32_bf16 v[20:23], v[64:67], v[84:87], v[20:23]
  v_mfma_f32_16x16x32_bf16 v[24:27], v[64:67], v[88:91], v[24:27]
  v_mfma_f32_16x16x32_bf16 v[28:31], v[64:67], v[92:95], v[28:31]
  v_mfma_f32_16x16x32_bf16 v[32:35], v[68:71], v[80:83], v[32:35]
  v_mfma_f32_16x16x32_bf16 v[36:39], v[68:71], v[84:87], v[36:39]
  v_mfma_f32_16x16x32_bf16 v[40:43], v[68:71], v[88:91], v[40:43]
  v_mfma_f32_16x16x32_bf16 v[44:47], v[68:71], v[92:95], v[44:47]
  s_waitcnt vmcnt(0) lgkmcnt(0)
  v_mfma_f32_16x16x32_bf16 v[16:19], v[72:75], v[96:99], v[16:19]
  v_mfma_f32_16x16x32_bf16 v[20:23], v[72:75], v[100:103], v[20:23]
  v_mfma_f32_16x16x32_bf16 v[24:27], v[72:75], v[104:107], v[24:27]
  v_mfma_f32_16x16x32_bf16 v[28:31], v[72:75], v[108:111], v[28:31]
  v_mfma_f32_16x16x32_bf16 v[32:35], v[76:79], v[96:99], v[32:35]
  v_mfma_f32_16x16x32_bf16 v[36:39], v[76:79], v[100:103], v[36:39]
  v_mfma_f32_16x16x32_bf16 v[40:43], v[76:79], v[104:107], v[40:43]
  v_mfma_f32_16x16x32_bf16 v[44:47], v[76:79], v[108:111], v[44:47]
  s_nop 7
  s_mul_i32 s25, s4, 163840
  s_mul_i32 s26, s3, 160
  s_add_u32 s25, s25, s26
  s_add_u32 s25, s25, 1344
  v_cvt_pk_bf16_f32 v244, v16, v17
  v_cvt_pk_bf16_f32 v245, v18, v19
  buffer_store_dwordx2 v[244:245], v9, s[12:15], s25 offen
  s_add_u32 s25, s25, 40960
  v_cvt_pk_bf16_f32 v246, v20, v21
  v_cvt_pk_bf16_f32 v247, v22, v23
  buffer_store_dwordx2 v[246:247], v9, s[12:15], s25 offen
  s_add_u32 s25, s25, 40960
  v_cvt_pk_bf16_f32 v244, v24, v25
  v_cvt_pk_bf16_f32 v245, v26, v27
  buffer_store_dwordx2 v[244:245], v9, s[12:15], s25 offen
  s_add_u32 s25, s25, 40960
  v_cvt_pk_bf16_f32 v246, v28, v29
  v_cvt_pk_bf16_f32 v247, v30, v31
  buffer_store_dwordx2 v[246:247], v9, s[12:15], s25 offen
  s_mul_i32 s25, s4, 163840
  s_mul_i32 s26, s3, 160
  s_add_u32 s25, s25, s26
  s_add_u32 s25, s25, 1376
  v_cvt_pk_bf16_f32 v248, v32, v33
  v_cvt_pk_bf16_f32 v249, v34, v35
  buffer_store_dwordx2 v[248:249], v9, s[12:15], s25 offen
  s_add_u32 s25, s25, 40960
  v_cvt_pk_bf16_f32 v250, v36, v37
  v_cvt_pk_bf16_f32 v251, v38, v39
  buffer_store_dwordx2 v[250:251], v9, s[12:15], s25 offen
  s_add_u32 s25, s25, 40960
  v_cvt_pk_bf16_f32 v248, v40, v41
  v_cvt_pk_bf16_f32 v249, v42, v43
  buffer_store_dwordx2 v[248:249], v9, s[12:15], s25 offen
  s_add_u32 s25, s25, 40960
  v_cvt_pk_bf16_f32 v250, v44, v45
  v_cvt_pk_bf16_f32 v251, v46, v47
  buffer_store_dwordx2 v[250:251], v9, s[12:15], s25 offen
  s_mul_i32 s38, s3, 102400
  s_add_u32 s38, s38, 86425600
  buffer_load_dwordx4 v[48:51], v2, s[8:11], s38 offen offset:0 sc1
  buffer_load_dwordx4 v[56:59], v2, s[8:11], s38 offen offset:1024 sc1
  buffer_load_dwordx4 v[64:67], v2, s[8:11], s38 offen offset:2048 sc1
  ds_read_b128 v[80:83], v7 offset:0
  ds_read_b128 v[84:87], v7 offset:1024
  ds_read_b128 v[88:91], v7 offset:2048
  ds_read_b128 v[92:95], v7 offset:3072
  buffer_load_dwordx4 v[72:75], v2, s[8:11], s38 offen offset:3072 sc1
  s_add_u32 s38, s38, 4096
  ds_read_b128 v[96:99], v7 offset:4096
  ds_read_b128 v[100:103], v7 offset:5120
  ds_read_b128 v[104:107], v7 offset:6144
  ds_read_b128 v[108:111], v7 offset:7168
  s_waitcnt vmcnt(3) lgkmcnt(4)
  v_mfma_f32_16x16x32_bf16 v[16:19], v[48:51], v[80:83], 0
  v_mfma_f32_16x16x32_bf16 v[20:23], v[48:51], v[84:87], 0
  v_mfma_f32_16x16x32_bf16 v[24:27], v[48:51], v[88:91], 0
  v_mfma_f32_16x16x32_bf16 v[28:31], v[48:51], v[92:95], 0
  buffer_load_dwordx4 v[48:51], v2, s[8:11], s38 offen offset:0 sc1
  ds_read_b128 v[80:83], v7 offset:8192
  ds_read_b128 v[84:87], v7 offset:9216
  ds_read_b128 v[88:91], v7 offset:10240
  ds_read_b128 v[92:95], v7 offset:11264
  s_waitcnt vmcnt(3) lgkmcnt(4)
  v_mfma_f32_16x16x32_bf16 v[16:19], v[56:59], v[96:99], v[16:19]
  v_mfma_f32_16x16x32_bf16 v[20:23], v[56:59], v[100:103], v[20:23]
  v_mfma_f32_16x16x32_bf16 v[24:27], v[56:59], v[104:107], v[24:27]
  v_mfma_f32_16x16x32_bf16 v[28:31], v[56:59], v[108:111], v[28:31]
  buffer_load_dwordx4 v[56:59], v2, s[8:11], s38 offen offset:1024 sc1
  ds_read_b128 v[96:99], v7 offset:12288
  ds_read_b128 v[100:103], v7 offset:13312
  ds_read_b128 v[104:107], v7 offset:14336
  ds_read_b128 v[108:111], v7 offset:15360
  s_waitcnt vmcnt(3) lgkmcnt(4)
  v_mfma_f32_16x16x32_bf16 v[16:19], v[64:67], v[80:83], v[16:19]
  v_mfma_f32_16x16x32_bf16 v[20:23], v[64:67], v[84:87], v[20:23]
  v_mfma_f32_16x16x32_bf16 v[24:27], v[64:67], v[88:91], v[24:27]
  v_mfma_f32_16x16x32_bf16 v[28:31], v[64:67], v[92:95], v[28:31]
  buffer_load_dwordx4 v[64:67], v2, s[8:11], s38 offen offset:2048 sc1
  ds_read_b128 v[80:83], v7 offset:16384
  ds_read_b128 v[84:87], v7 offset:17408
  ds_read_b128 v[88:91], v7 offset:18432
  ds_read_b128 v[92:95], v7 offset:19456
  s_waitcnt vmcnt(3) lgkmcnt(4)
  v_mfma_f32_16x16x32_bf16 v[16:19], v[72:75], v[96:99], v[16:19]
  v_mfma_f32_16x16x32_bf16 v[20:23], v[72:75], v[100:103], v[20:23]
  v_mfma_f32_16x16x32_bf16 v[24:27], v[72:75], v[104:107], v[24:27]
  v_mfma_f32_16x16x32_bf16 v[28:31], v[72:75], v[108:111], v[28:31]
  buffer_load_dwordx4 v[72:75], v2, s[8:11], s38 offen offset:3072 sc1
  s_add_u32 s38, s38, 4096
  ds_read_b128 v[96:99], v7 offset:20480
  ds_read_b128 v[100:103], v7 offset:21504
  ds_read_b128 v[104:107], v7 offset:22528
  ds_read_b128 v[108:111], v7 offset:23552
  s_waitcnt vmcnt(3) lgkmcnt(4)
  v_mfma_f32_16x16x32_bf16 v[16:19], v[48:51], v[80:83], v[16:19]
  v_mfma_f32_16x16x32_bf16 v[20:23], v[48:51], v[84:87], v[20:23]
  v_mfma_f32_16x16x32_bf16 v[24:27], v[48:51], v[88:91], v[24:27]
  v_mfma_f32_16x16x32_bf16 v[28:31], v[48:51], v[92:95], v[28:31]
  buffer_load_dwordx4 v[48:51], v2, s[8:11], s38 offen offset:0 sc1
  ds_read_b128 v[80:83], v7 offset:24576
  ds_read_b128 v[84:87], v7 offset:25600
  ds_read_b128 v[88:91], v7 offset:26624
  ds_read_b128 v[92:95], v7 offset:27648
  s_waitcnt vmcnt(3) lgkmcnt(4)
  v_mfma_f32_16x16x32_bf16 v[16:19], v[56:59], v[96:99], v[16:19]
  v_mfma_f32_16x16x32_bf16 v[20:23], v[56:59], v[100:103], v[20:23]
  v_mfma_f32_16x16x32_bf16 v[24:27], v[56:59], v[104:107], v[24:27]
  v_mfma_f32_16x16x32_bf16 v[28:31], v[56:59], v[108:111], v[28:31]
  buffer_load_dwordx4 v[56:59], v2, s[8:11], s38 offen offset:1024 sc1
  ds_read_b128 v[96:99], v7 offset:28672
  ds_read_b128 v[100:103], v7 offset:29696
  ds_read_b128 v[104:107], v7 offset:30720
  ds_read_b128 v[108:111], v7 offset:31744
  s_waitcnt vmcnt(3) lgkmcnt(4)
  v_mfma_f32_16x16x32_bf16 v[16:19], v[64:67], v[80:83], v[16:19]
  v_mfma_f32_16x16x32_bf16 v[20:23], v[64:67], v[84:87], v[20:23]
  v_mfma_f32_16x16x32_bf16 v[24:27], v[64:67], v[88:91], v[24:27]
  v_mfma_f32_16x16x32_bf16 v[28:31], v[64:67], v[92:95], v[28:31]
  buffer_load_dwordx4 v[64:67], v2, s[8:11], s38 offen offset:2048 sc1
  ds_read_b128 v[80:83], v7 offset:32768
  ds_read_b128 v[84:87], v7 offset:33792
  ds_read_b128 v[88:91], v7 offset:34816
  ds_read_b128 v[92:95], v7 offset:35840
  s_waitcnt vmcnt(3) lgkmcnt(4)
  v_mfma_f32_16x16x32_bf16 v[16:19], v[72:75], v[96:99], v[16:19]
  v_mfma_f32_16x16x32_bf16 v[20:23], v[72:75], v[100:103], v[20:23]
  v_mfma_f32_16x16x32_bf16 v[24:27], v[72:75], v[104:107], v[24:27]
  v_mfma_f32_16x16x32_bf16 v[28:31], v[72:75], v[108:111], v[28:31]
  buffer_load_dwordx4 v[72:75], v2, s[8:11], s38 offen offset:3072 sc1
  s_add_u32 s38, s38, 4096
  ds_read_b128 v[96:99], v7 offset:36864
  ds_read_b128 v[100:103], v7 offset:37888
  ds_read_b128 v[104:107], v7 offset:38912
  ds_read_b128 v[108:111], v7 offset:39936
  s_waitcnt vmcnt(3) lgkmcnt(4)
  v_mfma_f32_16x16x32_bf16 v[16:19], v[48:51], v[80:83], v[16:19]
  v_mfma_f32_16x16x32_bf16 v[20:23], v[48:51], v[84:87], v[20:23]
  v_mfma_f32_16x16x32_bf16 v[24:27], v[48:51], v[88:91], v[24:27]
  v_mfma_f32_16x16x32_bf16 v[28:31], v[48:51], v[92:95], v[28:31]
  buffer_load_dwordx4 v[48:51], v2, s[8:11], s38 offen offset:0 sc1
  ds_read_b128 v[80:83], v8 offset:0
  ds_read_b128 v[84:87], v8 offset:1024
  ds_read_b128 v[88:91], v8 offset:2048
  ds_read_b128 v[92:95], v8 offset:3072
  s_waitcnt vmcnt(3) lgkmcnt(4)
  v_mfma_f32_16x16x32_bf16 v[16:19], v[56:59], v[96:99], v[16:19]
  v_mfma_f32_16x16x32_bf16 v[20:23], v[56:59], v[100:103], v[20:23]
  v_mfma_f32_16x16x32_bf16 v[24:27], v[56:59], v[104:107], v[24:27]
  v_mfma_f32_16x16x32_bf16 v[28:31], v[56:59], v[108:111], v[28:31]
  buffer_load_dwordx4 v[56:59], v2, s[8:11], s38 offen offset:1024 sc1
  ds_read_b128 v[96:99], v8 offset:4096
  ds_read_b128 v[100:103], v8 offset:5120
  ds_read_b128 v[104:107], v8 offset:6144
  ds_read_b128 v[108:111], v8 offset:7168
  s_waitcnt vmcnt(3) lgkmcnt(4)
  v_mfma_f32_16x16x32_bf16 v[16:19], v[64:67], v[80:83], v[16:19]
  v_mfma_f32_16x16x32_bf16 v[20:23], v[64:67], v[84:87], v[20:23]
  v_mfma_f32_16x16x32_bf16 v[24:27], v[64:67], v[88:91], v[24:27]
  v_mfma_f32_16x16x32_bf16 v[28:31], v[64:67], v[92:95], v[28:31]
  buffer_load_dwordx4 v[64:67], v2, s[8:11], s38 offen offset:2048 sc1
  ds_read_b128 v[80:83], v8 offset:8192
  ds_read_b128 v[84:87], v8 offset:9216
  ds_read_b128 v[88:91], v8 offset:10240
  ds_read_b128 v[92:95], v8 offset:11264
  s_waitcnt vmcnt(3) lgkmcnt(4)
  v_mfma_f32_16x16x32_bf16 v[16:19], v[72:75], v[96:99], v[16:19]
  v_mfma_f32_16x16x32_bf16 v[20:23], v[72:75], v[100:103], v[20:23]
  v_mfma_f32_16x16x32_bf16 v[24:27], v[72:75], v[104:107], v[24:27]
  v_mfma_f32_16x16x32_bf16 v[28:31], v[72:75], v[108:111], v[28:31]
  buffer_load_dwordx4 v[72:75], v2, s[8:11], s38 offen offset:3072 sc1
  s_add_u32 s38, s38, 4096
  ds_read_b128 v[96:99], v8 offset:12288
  ds_read_b128 v[100:103], v8 offset:13312
  ds_read_b128 v[104:107], v8 offset:14336
  ds_read_b128 v[108:111], v8 offset:15360
  s_waitcnt vmcnt(3) lgkmcnt(4)
  v_mfma_f32_16x16x32_bf16 v[16:19], v[48:51], v[80:83], v[16:19]
  v_mfma_f32_16x16x32_bf16 v[20:23], v[48:51], v[84:87], v[20:23]
  v_mfma_f32_16x16x32_bf16 v[24:27], v[48:51], v[88:91], v[24:27]
  v_mfma_f32_16x16x32_bf16 v[28:31], v[48:51], v[92:95], v[28:31]
  buffer_load_dwordx4 v[48:51], v2, s[8:11], s38 offen offset:0 sc1
  ds_read_b128 v[80:83], v8 offset:16384
  ds_read_b128 v[84:87], v8 offset:17408
  ds_read_b128 v[88:91], v8 offset:18432
  ds_read_b128 v[92:95], v8 offset:19456
  s_waitcnt vmcnt(3) lgkmcnt(4)
  v_mfma_f32_16x16x32_bf16 v[16:19], v[56:59], v[96:99], v[16:19]
  v_mfma_f32_16x16x32_bf16 v[20:23], v[56:59], v[100:103], v[20:23]
  v_mfma_f32_16x16x32_bf16 v[24:27], v[56:59], v[104:107], v[24:27]
  v_mfma_f32_16x16x32_bf16 v[28:31], v[56:59], v[108:111], v[28:31]
  buffer_load_dwordx4 v[56:59], v2, s[8:11], s38 offen offset:1024 sc1
  ds_read_b128 v[96:99], v8 offset:20480
  ds_read_b128 v[100:103], v8 offset:21504
  ds_read_b128 v[104:107], v8 offset:22528
  ds_read_b128 v[108:111], v8 offset:23552
  s_waitcnt vmcnt(3) lgkmcnt(4)
  v_mfma_f32_16x16x32_bf16 v[16:19], v[64:67], v[80:83], v[16:19]
  v_mfma_f32_16x16x32_bf16 v[20:23], v[64:67], v[84:87], v[20:23]
  v_mfma_f32_16x16x32_bf16 v[24:27], v[64:67], v[88:91], v[24:27]
  v_mfma_f32_16x16x32_bf16 v[28:31], v[64:67], v[92:95], v[28:31]
  buffer_load_dwordx4 v[64:67], v2, s[8:11], s38 offen offset:2048 sc1
  ds_read_b128 v[80:83], v8 offset:24576
  ds_read_b128 v[84:87], v8 offset:25600
  ds_read_b128 v[88:91], v8 offset:26624
  ds_read_b128 v[92:95], v8 offset:27648
  s_waitcnt vmcnt(3) lgkmcnt(4)
  v_mfma_f32_16x16x32_bf16 v[16:19], v[72:75], v[96:99], v[16:19]
  v_mfma_f32_16x16x32_bf16 v[20:23], v[72:75], v[100:103], v[20:23]
  v_mfma_f32_16x16x32_bf16 v[24:27], v[72:75], v[104:107], v[24:27]
  v_mfma_f32_16x16x32_bf16 v[28:31], v[72:75], v[108:111], v[28:31]
  buffer_load_dwordx4 v[72:75], v2, s[8:11], s38 offen offset:3072 sc1
  s_add_u32 s38, s38, 4096
  ds_read_b128 v[96:99], v8 offset:28672
  ds_read_b128 v[100:103], v8 offset:29696
  ds_read_b128 v[104:107], v8 offset:30720
  ds_read_b128 v[108:111], v8 offset:31744
  s_waitcnt vmcnt(3) lgkmcnt(4)
  v_mfma_f32_16x16x32_bf16 v[16:19], v[48:51], v[80:83], v[16:19]
  v_mfma_f32_16x16x32_bf16 v[20:23], v[48:51], v[84:87], v[20:23]
  v_mfma_f32_16x16x32_bf16 v[24:27], v[48:51], v[88:91], v[24:27]
  v_mfma_f32_16x16x32_bf16 v[28:31], v[48:51], v[92:95], v[28:31]
  ds_read_b128 v[80:83], v8 offset:32768
  ds_read_b128 v[84:87], v8 offset:33792
  ds_read_b128 v[88:91], v8 offset:34816
  ds_read_b128 v[92:95], v8 offset:35840
  s_waitcnt vmcnt(2) lgkmcnt(4)
  v_mfma_f32_16x16x32_bf16 v[16:19], v[56:59], v[96:99], v[16:19]
  v_mfma_f32_16x16x32_bf16 v[20:23], v[56:59], v[100:103], v[20:23]
  v_mfma_f32_16x16x32_bf16 v[24:27], v[56:59], v[104:107], v[24:27]
  v_mfma_f32_16x16x32_bf16 v[28:31], v[56:59], v[108:111], v[28:31]
  ds_read_b128 v[96:99], v8 offset:36864
  ds_read_b128 v[100:103], v8 offset:37888
  ds_read_b128 v[104:107], v8 offset:38912
  ds_read_b128 v[108:111], v8 offset:39936
  s_waitcnt vmcnt(1) lgkmcnt(4)
  v_mfma_f32_16x16x32_bf16 v[16:19], v[64:67], v[80:83], v[16:19]
  v_mfma_f32_16x16x32_bf16 v[20:23], v[64:67], v[84:87], v[20:23]
  v_mfma_f32_16x16x32_bf16 v[24:27], v[64:67], v[88:91], v[24:27]
  v_mfma_f32_16x16x32_bf16 v[28:31], v[64:67], v[92:95], v[28:31]
  s_waitcnt vmcnt(0) lgkmcnt(0)
  v_mfma_f32_16x16x32_bf16 v[16:19], v[72:75], v[96:99], v[16:19]
  v_mfma_f32_16x16x32_bf16 v[20:23], v[72:75], v[100:103], v[20:23]
  v_mfma_f32_16x16x32_bf16 v[24:27], v[72:75], v[104:107], v[24:27]
  v_mfma_f32_16x16x32_bf16 v[28:31], v[72:75], v[108:111], v[28:31]
  s_nop 7
  s_mul_i32 s25, s4, 163840
  s_mul_i32 s26, s3, 160
  s_add_u32 s25, s25, s26
  s_add_u32 s25, s25, 1408
  v_cvt_pk_bf16_f32 v244, v16, v17
  v_cvt_pk_bf16_f32 v245, v18, v19
  buffer_store_dwordx2 v[244:245], v9, s[12:15], s25 offen
  s_add_u32 s25, s25, 40960
  v_cvt_pk_bf16_f32 v246, v20, v21
  v_cvt_pk_bf16_f32 v247, v22, v23
  buffer_store_dwordx2 v[246:247], v9, s[12:15], s25 offen
  s_add_u32 s25, s25, 40960
  v_cvt_pk_bf16_f32 v244, v24, v25
  v_cvt_pk_bf16_f32 v245, v26, v27
  buffer_store_dwordx2 v[244:245], v9, s[12:15], s25 offen
  s_add_u32 s25, s25, 40960
  v_cvt_pk_bf16_f32 v246, v28, v29
  v_cvt_pk_bf16_f32 v247, v30, v31
  buffer_store_dwordx2 v[246:247], v9, s[12:15], s25 offen
  s_waitcnt vmcnt(0) lgkmcnt(0)
  s_branch L_attx2
L_boot_entry:
  s_lshr_b32 s34, s33, 5
  s_and_b32 s35, s33, 31
  s_cmp_eq_u32 s34, 0
  s_cselect_b32 s16, s70, s72
  s_cselect_b32 s17, s71, s73
  s_and_b32 s17, s17, 0xffff
  s_mov_b32 s18, 5242880
  s_mov_b32 s19, 0x20000
  s_mov_b32 s12, s64
  s_and_b32 s13, s65, 0xffff
  s_mov_b32 s14, 2621440
  s_mov_b32 s15, 0x20000
  v_lshrrev_b32 v18, 4, v1
  v_lshlrev_b32 v18, 13, v18
  v_and_b32 v19, 15, v1
  v_lshl_or_b32 v18, v19, 4, v18
  s_lshl_b32 s36, s35, 8
  s_lshl_b32 s37, s3, 15
  s_add_u32 s36, s36, s37
  buffer_load_dwordx4 v[96:99], v18, s[16:19], s36 offen
  s_add_u32 s36, s36, 262144
  buffer_load_dwordx4 v[100:103], v18, s[16:19], s36 offen
  s_add_u32 s36, s36, 262144
  buffer_load_dwordx4 v[104:107], v18, s[16:19], s36 offen
  s_add_u32 s36, s36, 262144
  buffer_load_dwordx4 v[108:111], v18, s[16:19], s36 offen
  s_add_u32 s36, s36, 262144
  buffer_load_dwordx4 v[112:115], v18, s[16:19], s36 offen
  s_add_u32 s36, s36, 262144
  buffer_load_dwordx4 v[116:119], v18, s[16:19], s36 offen
  s_add_u32 s36, s36, 262144
  buffer_load_dwordx4 v[120:123], v18, s[16:19], s36 offen
  s_add_u32 s36, s36, 262144
  buffer_load_dwordx4 v[124:127], v18, s[16:19], s36 offen
  s_add_u32 s36, s36, 262144
  buffer_load_dwordx4 v[128:131], v18, s[16:19], s36 offen
  s_add_u32 s36, s36, 262144
  buffer_load_dwordx4 v[132:135], v18, s[16:19], s36 offen
  s_add_u32 s36, s36, 262144
  buffer_load_dwordx4 v[136:139], v18, s[16:19], s36 offen
  s_add_u32 s36, s36, 262144
  buffer_load_dwordx4 v[140:143], v18, s[16:19], s36 offen
  s_add_u32 s36, s36, 262144
  buffer_load_dwordx4 v[144:147], v18, s[16:19], s36 offen
  s_add_u32 s36, s36, 262144
  buffer_load_dwordx4 v[148:151], v18, s[16:19], s36 offen
  s_add_u32 s36, s36, 262144
  buffer_load_dwordx4 v[152:155], v18, s[16:19], s36 offen
  s_add_u32 s36, s36, 262144
  buffer_load_dwordx4 v[156:159], v18, s[16:19], s36 offen
  s_add_u32 s36, s36, 262144
  buffer_load_dwordx4 v[160:163], v18, s[16:19], s36 offen
  s_add_u32 s36, s36, 262144
  buffer_load_dwordx4 v[164:167], v18, s[16:19], s36 offen
  s_add_u32 s36, s36, 262144
  buffer_load_dwordx4 v[168:171], v18, s[16:19], s36 offen
  s_add_u32 s36, s36, 262144
  buffer_load_dwordx4 v[172:175], v18, s[16:19], s36 offen
  s_mul_i32 s37, s3, 320
  s_add_u32 s37, s37, 0
  v_add_u32 v20, s37, v1
  v_mul_u32_u24 v21, 52429, v20
  v_lshrrev_b32 v21, 22, v21
  v_mul_u32_u24 v22, 80, v21
  v_sub_u32 v22, v20, v22
  v_xor_b32 v23, v22, v21
  v_and_b32 v23, 15, v23
  v_and_b32 v22, 0x70, v22
  v_or_b32 v22, v22, v23
  v_mul_u32_u24 v21, 1280, v21
  v_lshl_add_u32 v2, v22, 4, v21
  s_mul_i32 s37, s3, 320
  s_add_u32 s37, s37, 64
  v_add_u32 v20, s37, v1
  v_mul_u32_u24 v21, 52429, v20
  v_lshrrev_b32 v21, 22, v21
  v_mul_u32_u24 v22, 80, v21
  v_sub_u32 v22, v20, v22
  v_xor_b32 v23, v22, v21
  v_and_b32 v23, 15, v23
  v_and_b32 v22, 0x70, v22
  v_or_b32 v22, v22, v23
  v_mul_u32_u24 v21, 1280, v21
  v_lshl_add_u32 v3, v22, 4, v21
  s_mul_i32 s37, s3, 320
  s_add_u32 s37, s37, 128
  v_add_u32 v20, s37, v1
  v_mul_u32_u24 v21, 52429, v20
  v_lshrrev_b32 v21, 22, v21
  v_mul_u32_u24 v22, 80, v21
  v_sub_u32 v22, v20, v22
  v_xor_b32 v23, v22, v21
  v_and_b32 v23, 15, v23
  v_and_b32 v22, 0x70, v22
  v_or_b32 v22, v22, v23
  v_mul_u32_u24 v21, 1280, v21
  v_lshl_add_u32 v4, v22, 4, v21
  s_mul_i32 s37, s3, 320
  s_add_u32 s37, s37, 192
  v_add_u32 v20, s37, v1
  v_mul_u32_u24 v21, 52429, v20
  v_lshrrev_b32 v21, 22, v21
  v_mul_u32_u24 v22, 80, v21
  v_sub_u32 v22, v20, v22
  v_xor_b32 v23, v22, v21
  v_and_b32 v23, 15, v23
  v_and_b32 v22, 0x70, v22
  v_or_b32 v22, v22, v23
  v_mul_u32_u24 v21, 1280, v21
  v_lshl_add_u32 v5, v22, 4, v21
  s_mul_i32 s37, s3, 320
  s_add_u32 s37, s37, 256
  v_add_u32 v20, s37, v1
  v_mul_u32_u24 v21, 52429, v20
  v_lshrrev_b32 v21, 22, v21
  v_mul_u32_u24 v22, 80, v21
  v_sub_u32 v22, v20, v22
  v_xor_b32 v23, v22, v21
  v_and_b32 v23, 15, v23
  v_and_b32 v22, 0x70, v22
  v_or_b32 v22, v22, v23
  v_mul_u32_u24 v21, 1280, v21
  v_lshl_add_u32 v6, v22, 4, v21
  s_mul_i32 s39, s3, 5120
  s_mov_b32 s38, 0
  s_add_u32 m0, s39, 0
  s_nop 0
  buffer_load_dwordx4 v2, s[12:15], s38 offen lds
  s_add_u32 m0, s39, 1024
  s_nop 0
  buffer_load_dwordx4 v3, s[12:15], s38 offen lds
  s_add_u32 m0, s39, 2048
  s_nop 0
  buffer_load_dwordx4 v4, s[12:15], s38 offen lds
  s_add_u32 m0, s39, 3072
  s_nop 0
  buffer_load_dwordx4 v5, s[12:15], s38 offen lds
  s_add_u32 m0, s39, 4096
  s_nop 0
  buffer_load_dwordx4 v6, s[12:15], s38 offen lds
  s_mov_b32 s38, 40960
  s_add_u32 m0, s39, 40960
  s_nop 0
  buffer_load_dwordx4 v2, s[12:15], s38 offen lds
  s_add_u32 m0, s39, 41984
  s_nop 0
  buffer_load_dwordx4 v3, s[12:15], s38 offen lds
  s_add_u32 m0, s39, 43008
  s_nop 0
  buffer_load_dwordx4 v4, s[12:15], s38 offen lds
  s_add_u32 m0, s39, 44032
  s_nop 0
  buffer_load_dwordx4 v5, s[12:15], s38 offen lds
  s_add_u32 m0, s39, 45056
  s_nop 0
  buffer_load_dwordx4 v6, s[12:15], s38 offen lds
  s_mov_b32 s38, 81920
  s_add_u32 m0, s39, 81920
  s_nop 0
  buffer_load_dwordx4 v2, s[12:15], s38 offen lds
  s_add_u32 m0, s39, 82944
  s_nop 0
  buffer_load_dwordx4 v3, s[12:15], s38 offen lds
  s_add_u32 m0, s39, 83968
  s_nop 0
  buffer_load_dwordx4 v4, s[12:15], s38 offen lds
  s_add_u32 m0, s39, 84992
  s_nop 0
  buffer_load_dwordx4 v5, s[12:15], s38 offen lds
  s_add_u32 m0, s39, 86016
  s_nop 0
  buffer_load_dwordx4 v6, s[12:15], s38 offen lds
  v_and_b32 v20, 15, v1
  v_lshrrev_b32 v21, 4, v1
  v_xor_b32 v21, v21, v20
  v_mul_u32_u24 v20, 1280, v20
  v_xor_b32 v22, 0, v21
  v_lshl_add_u32 v8, v22, 4, v20
  v_add_u32 v12, 81920, v8
  v_xor_b32 v22, 4, v21
  v_lshl_add_u32 v9, v22, 4, v20
  v_add_u32 v13, 81920, v9
  v_xor_b32 v22, 8, v21
  v_lshl_add_u32 v10, v22, 4, v20
  v_add_u32 v14, 81920, v10
  v_xor_b32 v22, 12, v21
  v_lshl_add_u32 v11, v22, 4, v20
  v_add_u32 v15, 81920, v11
  v_lshrrev_b32 v20, 4, v1
  s_bfe_u32 s36, s3, 0x10001
  s_lshl_b32 s36, s36, 2
  v_add_u32 v21, s36, v20
  v_lshlrev_b32 v21, 1, v21
  v_and_b32 v22, 15, v1
  v_xor_b32 v21, v21, v22
  v_lshlrev_b32 v20, 8, v20
  v_lshl_add_u32 v28, v21, 4, v20
  s_lshl_b32 s36, s3, 10
  s_add_u32 s36, s36, 122880
  v_add_u32 v28, s36, v28
  v_lshrrev_b32 v20, 4, v1
  v_bfe_u32 v21, v1, 2, 2
  v_lshl_add_u32 v22, v20, 3, v21
  v_lshlrev_b32 v22, 8, v22
  v_and_b32 v20, 1, v20
  v_lshl_add_u32 v21, v20, 2, v21
  v_lshlrev_b32 v21, 1, v21
  v_bfe_u32 v23, v1, 1, 1
  s_lshl_b32 s36, s3, 1
  v_or_b32 v23, s36, v23
  v_xor_b32 v21, v21, v23
  v_lshl_add_u32 v22, v21, 4, v22
  v_and_b32 v23, 1, v1
  v_lshl_add_u32 v22, v23, 3, v22
  v_add_u32 v29, 122880, v22
  s_waitcnt vmcnt(34)
  ds_write_b128 v28, v[96:99] offset:0
  s_waitcnt lgkmcnt(0)
  s_barrier
  ds_read_b64_tr_b16 v[96:97], v29 offset:0
  ds_read_b64_tr_b16 v[98:99], v29 offset:1024
  s_waitcnt vmcnt(33)
  ds_write_b128 v28, v[100:103] offset:8192
  s_waitcnt lgkmcnt(0)
  s_barrier
  ds_read_b64_tr_b16 v[100:101], v29 offset:8192
  ds_read_b64_tr_b16 v[102:103], v29 offset:9216
  s_waitcnt vmcnt(32)
  ds_write_b128 v28, v[104:107] offset:0
  s_waitcnt lgkmcnt(0)
  s_barrier
  ds_read_b64_tr_b16 v[104:105], v29 offset:0
  ds_read_b64_tr_b16 v[106:107], v29 offset:1024
  s_waitcnt vmcnt(31)
  ds_write_b128 v28, v[108:111] offset:8192
  s_waitcnt lgkmcnt(0)
  s_barrier
  ds_read_b64_tr_b16 v[108:109], v29 offset:8192
  ds_read_b64_tr_b16 v[110:111], v29 offset:9216
  s_waitcnt vmcnt(30)
  ds_write_b128 v28, v[112:115] offset:0
  s_waitcnt lgkmcnt(0)
  s_barrier
  ds_read_b64_tr_b16 v[112:113], v29 offset:0
  ds_read_b64_tr_b16 v[114:115], v29 offset:1024
  s_waitcnt vmcnt(29)
  ds_write_b128 v28, v[116:119] offset:8192
  s_waitcnt lgkmcnt(0)
  s_barrier
  ds_read_b64_tr_b16 v[116:117], v29 offset:8192
  ds_read_b64_tr_b16 v[118:119], v29 offset:9216
  s_waitcnt vmcnt(28)
  ds_write_b128 v28, v[120:123] offset:0
  s_waitcnt lgkmcnt(0)
  s_barrier
  ds_read_b64_tr_b16 v[120:121], v29 offset:0
  ds_read_b64_tr_b16 v[122:123], v29 offset:1024
  s_waitcnt vmcnt(27)
  ds_write_b128 v28, v[124:127] offset:8192
  s_waitcnt lgkmcnt(0)
  s_barrier
  ds_read_b64_tr_b16 v[124:125], v29 offset:8192
  ds_read_b64_tr_b16 v[126:127], v29 offset:9216
  s_waitcnt vmcnt(26)
  ds_write_b128 v28, v[128:131] offset:0
  s_waitcnt lgkmcnt(0)
  s_barrier
  ds_read_b64_tr_b16 v[128:129], v29 offset:0
  ds_read_b64_tr_b16 v[130:131], v29 offset:1024
  s_waitcnt vmcnt(25)
  ds_write_b128 v28, v[132:135] offset:8192
  s_waitcnt lgkmcnt(0)
  s_barrier
  ds_read_b64_tr_b16 v[132:133], v29 offset:8192
  ds_read_b64_tr_b16 v[134:135], v29 offset:9216
  s_waitcnt vmcnt(24)
  ds_write_b128 v28, v[136:139] offset:0
  s_waitcnt lgkmcnt(0)
  s_barrier
  ds_read_b64_tr_b16 v[136:137], v29 offset:0
  ds_read_b64_tr_b16 v[138:139], v29 offset:1024
  s_waitcnt vmcnt(23)
  ds_write_b128 v28, v[140:143] offset:8192
  s_waitcnt lgkmcnt(0)
  s_barrier
  ds_read_b64_tr_b16 v[140:141], v29 offset:8192
  ds_read_b64_tr_b16 v[142:143], v29 offset:9216
  s_waitcnt vmcnt(22)
  ds_write_b128 v28, v[144:147] offset:0
  s_waitcnt lgkmcnt(0)
  s_barrier
  ds_read_b64_tr_b16 v[144:145], v29 offset:0
  ds_read_b64_tr_b16 v[146:147], v29 offset:1024
  s_waitcnt vmcnt(21)
  ds_write_b128 v28, v[148:151] offset:8192
  s_waitcnt lgkmcnt(0)
  s_barrier
  ds_read_b64_tr_b16 v[148:149], v29 offset:8192
  ds_read_b64_tr_b16 v[150:151], v29 offset:9216
  s_waitcnt vmcnt(20)
  ds_write_b128 v28, v[152:155] offset:0
  s_waitcnt lgkmcnt(0)
  s_barrier
  ds_read_b64_tr_b16 v[152:153], v29 offset:0
  ds_read_b64_tr_b16 v[154:155], v29 offset:1024
  s_waitcnt vmcnt(19)
  ds_write_b128 v28, v[156:159] offset:8192
  s_waitcnt lgkmcnt(0)
  s_barrier
  ds_read_b64_tr_b16 v[156:157], v29 offset:8192
  ds_read_b64_tr_b16 v[158:159], v29 offset:9216
  s_waitcnt vmcnt(18)
  ds_write_b128 v28, v[160:163] offset:0
  s_waitcnt lgkmcnt(0)
  s_barrier
  ds_read_b64_tr_b16 v[160:161], v29 offset:0
  ds_read_b64_tr_b16 v[162:163], v29 offset:1024
  s_waitcnt vmcnt(17)
  ds_write_b128 v28, v[164:167] offset:8192
  s_waitcnt lgkmcnt(0)
  s_barrier
  ds_read_b64_tr_b16 v[164:165], v29 offset:8192
  ds_read_b64_tr_b16 v[166:167], v29 offset:9216
  s_waitcnt vmcnt(16)
  ds_write_b128 v28, v[168:171] offset:0
  s_waitcnt lgkmcnt(0)
  s_barrier
  ds_read_b64_tr_b16 v[168:169], v29 offset:0
  ds_read_b64_tr_b16 v[170:171], v29 offset:1024
  s_waitcnt vmcnt(15)
  ds_write_b128 v28, v[172:175] offset:8192
  s_waitcnt lgkmcnt(0)
  s_barrier
  ds_read_b64_tr_b16 v[172:173], v29 offset:8192
  ds_read_b64_tr_b16 v[174:175], v29 offset:9216
  s_mul_i32 s36, s34, 16777216
  s_add_u32 s36, s36, 4194304
  s_lshl_b32 s37, s35, 13
  s_add_u32 s36, s36, s37
  s_lshr_b32 s37, s3, 1
  s_lshl_b32 s37, s37, 11
  s_add_u32 s36, s36, s37
  s_and_b32 s37, s3, 1
  s_cmp_eq_u32 s34, 0
  s_cselect_b32 s40, 3, 10
  s_lshl_b32 s37, s37, s40
  s_add_u32 s36, s36, s37
  v_lshlrev_b32 v16, 4, v1
  v_add_u32 v16, s36, v16
  s_lshl_b32 s36, s34, 5
  s_add_u32 s36, s36, s35
  s_lshl_b32 s36, s36, 6
  s_lshl_b32 s37, s3, 2
  s_add_u32 s36, s36, s37
  s_add_u32 s36, s36, 0
  s_cmp_lt_u32 s3, 4
  s_cselect_b32 s36, s36, 1073741824
  v_mov_b32 v17, 1073741824
  v_cmp_eq_u32 vcc, 0, v1
  v_mov_b32 v20, s36
  s_nop 0
  v_cndmask_b32 v17, v17, v20, vcc
  s_waitcnt vmcnt(0) lgkmcnt(0)
  s_barrier
  s_mov_b32 s56, s86
  s_and_b32 s57, s87, 0xffff
  s_mov_b32 s58, 256
  s_mov_b32 s59, 0x20000
  s_mov_b32 s63, 0
  v_mov_b32 v26, 128
  buffer_load_dword v25, v26, s[56:59], 0 offen sc1
  s_cmp_eq_u32 s34, 0
  s_cbranch_scc0 L_boot_v
  ds_read_b128 v[56:59], v8 offset:0
  ds_read_b128 v[60:63], v8 offset:20480
  ds_read_b128 v[64:67], v9 offset:0
  ds_read_b128 v[68:71], v9 offset:20480
  s_waitcnt lgkmcnt(3)
  v_mfma_f32_16x16x32_bf16 v[80:83], v[96:99], v[56:59], 0
  ds_read_b128 v[72:75], v10 offset:0
  s_waitcnt lgkmcnt(3)
  v_mfma_f32_16x16x32_bf16 v[84:87], v[96:99], v[60:63], 0
  ds_read_b128 v[76:79], v10 offset:20480
  s_waitcnt lgkmcnt(3)
  v_mfma_f32_16x16x32_bf16 v[80:83], v[100:103], v[64:67], v[80:83]
  ds_read_b128 v[56:59], v11 offset:0
  s_waitcnt lgkmcnt(3)
  v_mfma_f32_16x16x32_bf16 v[84:87], v[100:103], v[68:71], v[84:87]
  ds_read_b128 v[60:63], v11 offset:20480
  s_waitcnt lgkmcnt(3)
  v_mfma_f32_16x16x32_bf16 v[80:83], v[104:107], v[72:75], v[80:83]
  ds_read_b128 v[64:67], v8 offset:256
  s_waitcnt lgkmcnt(3)
  v_mfma_f32_16x16x32_bf16 v[84:87], v[104:107], v[76:79], v[84:87]
  ds_read_b128 v[68:71], v8 offset:20736
  s_waitcnt lgkmcnt(3)
  v_mfma_f32_16x16x32_bf16 v[80:83], v[108:111], v[56:59], v[80:83]
  ds_read_b128 v[72:75], v9 offset:256
  s_waitcnt lgkmcnt(3)
  v_mfma_f32_16x16x32_bf16 v[84:87], v[108:111], v[60:63], v[84:87]
  ds_read_b128 v[76:79], v9 offset:20736
  s_waitcnt lgkmcnt(3)
  v_mfma_f32_16x16x32_bf16 v[80:83], v[112:115], v[64:67], v[80:83]
  ds_read_b128 v[56:59], v10 offset:256
  s_waitcnt lgkmcnt(3)
  v_mfma_f32_16x16x32_bf16 v[84:87], v[112:115], v[68:71], v[84:87]
  ds_read_b128 v[60:63], v10 offset:20736
  s_waitcnt lgkmcnt(3)
  v_mfma_f32_16x16x32_bf16 v[80:83], v[116:119], v[72:75], v[80:83]
  ds_read_b128 v[64:67], v11 offset:256
  s_waitcnt lgkmcnt(3)
  v_mfma_f32_16x16x32_bf16 v[84:87], v[116:119], v[76:79], v[84:87]
  ds_read_b128 v[68:71], v11 offset:20736
  s_waitcnt lgkmcnt(3)
  v_mfma_f32_16x16x32_bf16 v[80:83], v[120:123], v[56:59], v[80:83]
  ds_read_b128 v[72:75], v8 offset:512
  s_waitcnt lgkmcnt(3)
  v_mfma_f32_16x16x32_bf16 v[84:87], v[120:123], v[60:63], v[84:87]
  ds_read_b128 v[76:79], v8 offset:20992
  s_waitcnt lgkmcnt(3)
  v_mfma_f32_16x16x32_bf16 v[80:83], v[124:127], v[64:67], v[80:83]
  ds_read_b128 v[56:59], v9 offset:512
  s_waitcnt lgkmcnt(3)
  v_mfma_f32_16x16x32_bf16 v[84:87], v[124:127], v[68:71], v[84:87]
  ds_read_b128 v[60:63], v9 offset:20992
  s_waitcnt lgkmcnt(3)
  v_mfma_f32_16x16x32_bf16 v[80:83], v[128:131], v[72:75], v[80:83]
  ds_read_b128 v[64:67], v10 offset:512
  s_waitcnt lgkmcnt(3)
  v_mfma_f32_16x16x32_bf16 v[84:87], v[128:131], v[76:79], v[84:87]
  ds_read_b128 v[68:71], v10 offset:20992
  s_waitcnt lgkmcnt(3)
  v_mfma_f32_16x16x32_bf16 v[80:83], v[132:135], v[56:59], v[80:83]
  ds_read_b128 v[72:75], v11 offset:512
  s_waitcnt lgkmcnt(3)
  v_mfma_f32_16x16x32_bf16 v[84:87], v[132:135], v[60:63], v[84:87]
  ds_read_b128 v[76:79], v11 offset:20992
  s_waitcnt lgkmcnt(3)
  v_mfma_f32_16x16x32_bf16 v[80:83], v[136:139], v[64:67], v[80:83]
  ds_read_b128 v[56:59], v8 offset:768
  s_waitcnt lgkmcnt(3)
  v_mfma_f32_16x16x32_bf16 v[84:87], v[136:139], v[68:71], v[84:87]
  ds_read_b128 v[60:63], v8 offset:21248
  s_waitcnt lgkmcnt(3)
  v_mfma_f32_16x16x32_bf16 v[80:83], v[140:143], v[72:75], v[80:83]
  ds_read_b128 v[64:67], v9 offset:768
  s_waitcnt lgkmcnt(3)
  v_mfma_f32_16x16x32_bf16 v[84:87], v[140:143], v[76:79], v[84:87]
  ds_read_b128 v[68:71], v9 offset:21248
  s_waitcnt lgkmcnt(3)
  v_mfma_f32_16x16x32_bf16 v[80:83], v[144:147], v[56:59], v[80:83]
  ds_read_b128 v[72:75], v10 offset:768
  s_waitcnt lgkmcnt(3)
  v_mfma_f32_16x16x32_bf16 v[84:87], v[144:147], v[60:63], v[84:87]
  ds_read_b128 v[76:79], v10 offset:21248
  s_waitcnt lgkmcnt(3)
  v_mfma_f32_16x16x32_bf16 v[80:83], v[148:151], v[64:67], v[80:83]
  ds_read_b128 v[56:59], v11 offset:768
  s_waitcnt lgkmcnt(3)
  v_mfma_f32_16x16x32_bf16 v[84:87], v[148:151], v[68:71], v[84:87]
  ds_read_b128 v[60:63], v11 offset:21248
  s_waitcnt lgkmcnt(3)
  v_mfma_f32_16x16x32_bf16 v[80:83], v[152:155], v[72:75], v[80:83]
  ds_read_b128 v[64:67], v8 offset:1024
  s_waitcnt lgkmcnt(3)
  v_mfma_f32_16x16x32_bf16 v[84:87], v[152:155], v[76:79], v[84:87]
  ds_read_b128 v[68:71], v8 offset:21504
  s_waitcnt lgkmcnt(3)
  v_mfma_f32_16x16x32_bf16 v[80:83], v[156:159], v[56:59], v[80:83]
  ds_read_b128 v[72:75], v9 offset:1024
  s_waitcnt lgkmcnt(3)
  v_mfma_f32_16x16x32_bf16 v[84:87], v[156:159], v[60:63], v[84:87]
  ds_read_b128 v[76:79], v9 offset:21504
  s_waitcnt lgkmcnt(3)
  v_mfma_f32_16x16x32_bf16 v[80:83], v[160:163], v[64:67], v[80:83]
  ds_read_b128 v[56:59], v10 offset:1024
  s_waitcnt lgkmcnt(3)
  v_mfma_f32_16x16x32_bf16 v[84:87], v[160:163], v[68:71], v[84:87]
  ds_read_b128 v[60:63], v10 offset:21504
  s_waitcnt lgkmcnt(3)
  v_mfma_f32_16x16x32_bf16 v[80:83], v[164:167], v[72:75], v[80:83]
  ds_read_b128 v[64:67], v11 offset:1024
  s_waitcnt lgkmcnt(3)
  v_mfma_f32_16x16x32_bf16 v[84:87], v[164:167], v[76:79], v[84:87]
  ds_read_b128 v[68:71], v11 offset:21504
  s_waitcnt lgkmcnt(3)
  v_mfma_f32_16x16x32_bf16 v[80:83], v[168:171], v[56:59], v[80:83]
  s_waitcnt lgkmcnt(2)
  v_mfma_f32_16x16x32_bf16 v[84:87], v[168:171], v[60:63], v[84:87]
  s_waitcnt lgkmcnt(1)
  v_mfma_f32_16x16x32_bf16 v[80:83], v[172:175], v[64:67], v[80:83]
  s_waitcnt lgkmcnt(0)
  v_mfma_f32_16x16x32_bf16 v[84:87], v[172:175], v[68:71], v[84:87]
  s_mov_b32 s40, 0
  s_nop 6
  v_cvt_pk_bf16_f32 v48, v80, v81
  v_cvt_pk_bf16_f32 v49, v82, v83
  v_cvt_pk_bf16_f32 v50, v84, v85
  v_cvt_pk_bf16_f32 v51, v86, v87
  buffer_store_dwordx2 v[48:49], v16, s[8:11], s40 offen sc1
  buffer_store_dwordx2 v[50:51], v16, s[8:11], s40 offen offset:1024 sc1
  s_waitcnt vmcnt(0)
  s_cmp_eq_u32 s98, 0
  s_cbranch_scc0 L_boot_nv0
L_boot_vote0:
  v_readfirstlane_b32 s60, v25
  s_nop 0
  s_cmp_eq_u32 s60, 1
  s_cbranch_scc1 L_boot_vote0_all
  s_cmp_eq_u32 s60, 2
  s_cbranch_scc1 L_restart
  s_add_u32 s63, s63, 1
  s_cmp_ge_u32 s63, 0x40000
  s_cbranch_scc1 L_restart
  s_sleep 4
  buffer_load_dword v25, v26, s[56:59], 0 offen sc1
  s_waitcnt vmcnt(0)
  s_branch L_boot_vote0
L_boot_vote0_all:
L_boot_nv0:
  s_barrier
  v_mov_b32 v24, 1
  buffer_store_dword v24, v17, s[8:11], 0 offen sc1
  ds_read_b128 v[56:59], v8 offset:40960
  ds_read_b128 v[60:63], v8 offset:61440
  ds_read_b128 v[64:67], v9 offset:40960
  ds_read_b128 v[68:71], v9 offset:61440
  s_waitcnt lgkmcnt(3)
  v_mfma_f32_16x16x32_bf16 v[80:83], v[96:99], v[56:59], 0
  ds_read_b128 v[72:75], v10 offset:40960
  s_waitcnt lgkmcnt(3)
  v_mfma_f32_16x16x32_bf16 v[84:87], v[96:99], v[60:63], 0
  ds_read_b128 v[76:79], v10 offset:61440
  s_waitcnt lgkmcnt(3)
  v_mfma_f32_16x16x32_bf16 v[80:83], v[100:103], v[64:67], v[80:83]
  ds_read_b128 v[56:59], v11 offset:40960
  s_waitcnt lgkmcnt(3)
  v_mfma_f32_16x16x32_bf16 v[84:87], v[100:103], v[68:71], v[84:87]
  ds_read_b128 v[60:63], v11 offset:61440
  s_waitcnt lgkmcnt(3)
  v_mfma_f32_16x16x32_bf16 v[80:83], v[104:107], v[72:75], v[80:83]
  ds_read_b128 v[64:67], v8 offset:41216
  s_waitcnt lgkmcnt(3)
  v_mfma_f32_16x16x32_bf16 v[84:87], v[104:107], v[76:79], v[84:87]
  ds_read_b128 v[68:71], v8 offset:61696
  s_waitcnt lgkmcnt(3)
  v_mfma_f32_16x16x32_bf16 v[80:83], v[108:111], v[56:59], v[80:83]
  ds_read_b128 v[72:75], v9 offset:41216
  s_waitcnt lgkmcnt(3)
  v_mfma_f32_16x16x32_bf16 v[84:87], v[108:111], v[60:63], v[84:87]
  ds_read_b128 v[76:79], v9 offset:61696
  s_waitcnt lgkmcnt(3)
  v_mfma_f32_16x16x32_bf16 v[80:83], v[112:115], v[64:67], v[80:83]
  ds_read_b128 v[56:59], v10 offset:41216
  s_waitcnt lgkmcnt(3)
  v_mfma_f32_16x16x32_bf16 v[84:87], v[112:115], v[68:71], v[84:87]
  ds_read_b128 v[60:63], v10 offset:61696
  s_waitcnt lgkmcnt(3)
  v_mfma_f32_16x16x32_bf16 v[80:83], v[116:119], v[72:75], v[80:83]
  ds_read_b128 v[64:67], v11 offset:41216
  s_waitcnt lgkmcnt(3)
  v_mfma_f32_16x16x32_bf16 v[84:87], v[116:119], v[76:79], v[84:87]
  ds_read_b128 v[68:71], v11 offset:61696
  s_waitcnt lgkmcnt(3)
  v_mfma_f32_16x16x32_bf16 v[80:83], v[120:123], v[56:59], v[80:83]
  ds_read_b128 v[72:75], v8 offset:41472
  s_waitcnt lgkmcnt(3)
  v_mfma_f32_16x16x32_bf16 v[84:87], v[120:123], v[60:63], v[84:87]
  ds_read_b128 v[76:79], v8 offset:61952
  s_waitcnt lgkmcnt(3)
  v_mfma_f32_16x16x32_bf16 v[80:83], v[124:127], v[64:67], v[80:83]
  ds_read_b128 v[56:59], v9 offset:41472
  s_waitcnt lgkmcnt(3)
  v_mfma_f32_16x16x32_bf16 v[84:87], v[124:127], v[68:71], v[84:87]
  ds_read_b128 v[60:63], v9 offset:61952
  s_waitcnt lgkmcnt(3)
  v_mfma_f32_16x16x32_bf16 v[80:83], v[128:131], v[72:75], v[80:83]
  ds_read_b128 v[64:67], v10 offset:41472
  s_waitcnt lgkmcnt(3)
  v_mfma_f32_16x16x32_bf16 v[84:87], v[128:131], v[76:79], v[84:87]
  ds_read_b128 v[68:71], v10 offset:61952
  s_waitcnt lgkmcnt(3)
  v_mfma_f32_16x16x32_bf16 v[80:83], v[132:135], v[56:59], v[80:83]
  ds_read_b128 v[72:75], v11 offset:41472
  s_waitcnt lgkmcnt(3)
  v_mfma_f32_16x16x32_bf16 v[84:87], v[132:135], v[60:63], v[84:87]
  ds_read_b128 v[76:79], v11 offset:61952
  s_waitcnt lgkmcnt(3)
  v_mfma_f32_16x16x32_bf16 v[80:83], v[136:139], v[64:67], v[80:83]
  ds_read_b128 v[56:59], v8 offset:41728
  s_waitcnt lgkmcnt(3)
  v_mfma_f32_16x16x32_bf16 v[84:87], v[136:139], v[68:71], v[84:87]
  ds_read_b128 v[60:63], v8 offset:62208
  s_waitcnt lgkmcnt(3)
  v_mfma_f32_16x16x32_bf16 v[80:83], v[140:143], v[72:75], v[80:83]
  ds_read_b128 v[64:67], v9 offset:41728
  s_waitcnt lgkmcnt(3)
  v_mfma_f32_16x16x32_bf16 v[84:87], v[140:143], v[76:79], v[84:87]
  ds_read_b128 v[68:71], v9 offset:62208
  s_waitcnt lgkmcnt(3)
  v_mfma_f32_16x16x32_bf16 v[80:83], v[144:147], v[56:59], v[80:83]
  ds_read_b128 v[72:75], v10 offset:41728
  s_waitcnt lgkmcnt(3)
  v_mfma_f32_16x16x32_bf16 v[84:87], v[144:147], v[60:63], v[84:87]
  ds_read_b128 v[76:79], v10 offset:62208
  s_waitcnt lgkmcnt(3)
  v_mfma_f32_16x16x32_bf16 v[80:83], v[148:151], v[64:67], v[80:83]
  ds_read_b128 v[56:59], v11 offset:41728
  s_waitcnt lgkmcnt(3)
  v_mfma_f32_16x16x32_bf16 v[84:87], v[148:151], v[68:71], v[84:87]
  ds_read_b128 v[60:63], v11 offset:62208
  s_waitcnt lgkmcnt(3)
  v_mfma_f32_16x16x32_bf16 v[80:83], v[152:155], v[72:75], v[80:83]
  ds_read_b128 v[64:67], v8 offset:41984
  s_waitcnt lgkmcnt(3)
  v_mfma_f32_16x16x32_bf16 v[84:87], v[152:155], v[76:79], v[84:87]
  ds_read_b128 v[68:71], v8 offset:62464
  s_waitcnt lgkmcnt(3)
  v_mfma_f32_16x16x32_bf16 v[80:83], v[156:159], v[56:59], v[80:83]
  ds_read_b128 v[72:75], v9 offset:41984
  s_waitcnt lgkmcnt(3)
  v_mfma_f32_16x16x32_bf16 v[84:87], v[156:159], v[60:63], v[84:87]
  ds_read_b128 v[76:79], v9 offset:62464
  s_waitcnt lgkmcnt(3)
  v_mfma_f32_16x16x32_bf16 v[80:83], v[160:163], v[64:67], v[80:83]
  ds_read_b128 v[56:59], v10 offset:41984
  s_waitcnt lgkmcnt(3)
  v_mfma_f32_16x16x32_bf16 v[84:87], v[160:163], v[68:71], v[84:87]
  ds_read_b128 v[60:63], v10 offset:62464
  s_waitcnt lgkmcnt(3)
  v_mfma_f32_16x16x32_bf16 v[80:83], v[164:167], v[72:75], v[80:83]
  ds_read_b128 v[64:67], v11 offset:41984
  s_waitcnt lgkmcnt(3)
  v_mfma_f32_16x16x32_bf16 v[84:87], v[164:167], v[76:79], v[84:87]
  ds_read_b128 v[68:71], v11 offset:62464
  s_waitcnt lgkmcnt(3)
  v_mfma_f32_16x16x32_bf16 v[80:83], v[168:171], v[56:59], v[80:83]
  s_waitcnt lgkmcnt(2)
  v_mfma_f32_16x16x32_bf16 v[84:87], v[168:171], v[60:63], v[84:87]
  s_waitcnt lgkmcnt(1)
  v_mfma_f32_16x16x32_bf16 v[80:83], v[172:175], v[64:67], v[80:83]
  s_waitcnt lgkmcnt(0)
  v_mfma_f32_16x16x32_bf16 v[84:87], v[172:175], v[68:71], v[84:87]
  s_waitcnt vmcnt(0)
  s_barrier
  s_mov_b32 s38, 122880
  s_add_u32 m0, s39, 0
  s_nop 0
  buffer_load_dwordx4 v2, s[12:15], s38 offen lds
  s_add_u32 m0, s39, 1024
  s_nop 0
  buffer_load_dwordx4 v3, s[12:15], s38 offen lds
  s_add_u32 m0, s39, 2048
  s_nop 0
  buffer_load_dwordx4 v4, s[12:15], s38 offen lds
  s_add_u32 m0, s39, 3072
  s_nop 0
  buffer_load_dwordx4 v5, s[12:15], s38 offen lds
  s_add_u32 m0, s39, 4096
  s_nop 0
  buffer_load_dwordx4 v6, s[12:15], s38 offen lds
  s_mov_b32 s40, 262144
  s_nop 6
  v_cvt_pk_bf16_f32 v52, v80, v81
  v_cvt_pk_bf16_f32 v53, v82, v83
  v_cvt_pk_bf16_f32 v54, v84, v85
  v_cvt_pk_bf16_f32 v55, v86, v87
  buffer_store_dwordx2 v[52:53], v16, s[8:11], s40 offen sc1
  buffer_store_dwordx2 v[54:55], v16, s[8:11], s40 offen offset:1024 sc1
  ds_read_b128 v[56:59], v12 offset:0
  ds_read_b128 v[60:63], v12 offset:20480
  ds_read_b128 v[64:67], v13 offset:0
  ds_read_b128 v[68:71], v13 offset:20480
  s_waitcnt lgkmcnt(3)
  v_mfma_f32_16x16x32_bf16 v[80:83], v[96:99], v[56:59], 0
  ds_read_b128 v[72:75], v14 offset:0
  s_waitcnt lgkmcnt(3)
  v_mfma_f32_16x16x32_bf16 v[84:87], v[96:99], v[60:63], 0
  ds_read_b128 v[76:79], v14 offset:20480
  s_waitcnt lgkmcnt(3)
  v_mfma_f32_16x16x32_bf16 v[80:83], v[100:103], v[64:67], v[80:83]
  ds_read_b128 v[56:59], v15 offset:0
  s_waitcnt lgkmcnt(3)
  v_mfma_f32_16x16x32_bf16 v[84:87], v[100:103], v[68:71], v[84:87]
  ds_read_b128 v[60:63], v15 offset:20480
  s_waitcnt lgkmcnt(3)
  v_mfma_f32_16x16x32_bf16 v[80:83], v[104:107], v[72:75], v[80:83]
  ds_read_b128 v[64:67], v12 offset:256
  s_waitcnt lgkmcnt(3)
  v_mfma_f32_16x16x32_bf16 v[84:87], v[104:107], v[76:79], v[84:87]
  ds_read_b128 v[68:71], v12 offset:20736
  s_waitcnt lgkmcnt(3)
  v_mfma_f32_16x16x32_bf16 v[80:83], v[108:111], v[56:59], v[80:83]
  ds_read_b128 v[72:75], v13 offset:256
  s_waitcnt lgkmcnt(3)
  v_mfma_f32_16x16x32_bf16 v[84:87], v[108:111], v[60:63], v[84:87]
  ds_read_b128 v[76:79], v13 offset:20736
  s_waitcnt lgkmcnt(3)
  v_mfma_f32_16x16x32_bf16 v[80:83], v[112:115], v[64:67], v[80:83]
  ds_read_b128 v[56:59], v14 offset:256
  s_waitcnt lgkmcnt(3)
  v_mfma_f32_16x16x32_bf16 v[84:87], v[112:115], v[68:71], v[84:87]
  ds_read_b128 v[60:63], v14 offset:20736
  s_waitcnt lgkmcnt(3)
  v_mfma_f32_16x16x32_bf16 v[80:83], v[116:119], v[72:75], v[80:83]
  ds_read_b128 v[64:67], v15 offset:256
  s_waitcnt lgkmcnt(3)
  v_mfma_f32_16x16x32_bf16 v[84:87], v[116:119], v[76:79], v[84:87]
  ds_read_b128 v[68:71], v15 offset:20736
  s_waitcnt lgkmcnt(3)
  v_mfma_f32_16x16x32_bf16 v[80:83], v[120:123], v[56:59], v[80:83]
  ds_read_b128 v[72:75], v12 offset:512
  s_waitcnt lgkmcnt(3)
  v_mfma_f32_16x16x32_bf16 v[84:87], v[120:123], v[60:63], v[84:87]
  ds_read_b128 v[76:79], v12 offset:20992
  s_waitcnt lgkmcnt(3)
  v_mfma_f32_16x16x32_bf16 v[80:83], v[124:127], v[64:67], v[80:83]
  ds_read_b128 v[56:59], v13 offset:512
  s_waitcnt lgkmcnt(3)
  v_mfma_f32_16x16x32_bf16 v[84:87], v[124:127], v[68:71], v[84:87]
  ds_read_b128 v[60:63], v13 offset:20992
  s_waitcnt lgkmcnt(3)
  v_mfma_f32_16x16x32_bf16 v[80:83], v[128:131], v[72:75], v[80:83]
  ds_read_b128 v[64:67], v14 offset:512
  s_waitcnt lgkmcnt(3)
  v_mfma_f32_16x16x32_bf16 v[84:87], v[128:131], v[76:79], v[84:87]
  ds_read_b128 v[68:71], v14 offset:20992
  s_waitcnt lgkmcnt(3)
  v_mfma_f32_16x16x32_bf16 v[80:83], v[132:135], v[56:59], v[80:83]
  ds_read_b128 v[72:75], v15 offset:512
  s_waitcnt lgkmcnt(3)
  v_mfma_f32_16x16x32_bf16 v[84:87], v[132:135], v[60:63], v[84:87]
  ds_read_b128 v[76:79], v15 offset:20992
  s_waitcnt lgkmcnt(3)
  v_mfma_f32_16x16x32_bf16 v[80:83], v[136:139], v[64:67], v[80:83]
  ds_read_b128 v[56:59], v12 offset:768
  s_waitcnt lgkmcnt(3)
  v_mfma_f32_16x16x32_bf16 v[84:87], v[136:139], v[68:71], v[84:87]
  ds_read_b128 v[60:63], v12 offset:21248
  s_waitcnt lgkmcnt(3)
  v_mfma_f32_16x16x32_bf16 v[80:83], v[140:143], v[72:75], v[80:83]
  ds_read_b128 v[64:67], v13 offset:768
  s_waitcnt lgkmcnt(3)
  v_mfma_f32_16x16x32_bf16 v[84:87], v[140:143], v[76:79], v[84:87]
  ds_read_b128 v[68:71], v13 offset:21248
  s_waitcnt lgkmcnt(3)
  v_mfma_f32_16x16x32_bf16 v[80:83], v[144:147], v[56:59], v[80:83]
  ds_read_b128 v[72:75], v14 offset:768
  s_waitcnt lgkmcnt(3)
  v_mfma_f32_16x16x32_bf16 v[84:87], v[144:147], v[60:63], v[84:87]
  ds_read_b128 v[76:79], v14 offset:21248
  s_waitcnt lgkmcnt(3)
  v_mfma_f32_16x16x32_bf16 v[80:83], v[148:151], v[64:67], v[80:83]
  ds_read_b128 v[56:59], v15 offset:768
  s_waitcnt lgkmcnt(3)
  v_mfma_f32_16x16x32_bf16 v[84:87], v[148:151], v[68:71], v[84:87]
  ds_read_b128 v[60:63], v15 offset:21248
  s_waitcnt lgkmcnt(3)
  v_mfma_f32_16x16x32_bf16 v[80:83], v[152:155], v[72:75], v[80:83]
  ds_read_b128 v[64:67], v12 offset:1024
  s_waitcnt lgkmcnt(3)
  v_mfma_f32_16x16x32_bf16 v[84:87], v[152:155], v[76:79], v[84:87]
  ds_read_b128 v[68:71], v12 offset:21504
  s_waitcnt lgkmcnt(3)
  v_mfma_f32_16x16x32_bf16 v[80:83], v[156:159], v[56:59], v[80:83]
  ds_read_b128 v[72:75], v13 offset:1024
  s_waitcnt lgkmcnt(3)
  v_mfma_f32_16x16x32_bf16 v[84:87], v[156:159], v[60:63], v[84:87]
  ds_read_b128 v[76:79], v13 offset:21504
  s_waitcnt lgkmcnt(3)
  v_mfma_f32_16x16x32_bf16 v[80:83], v[160:163], v[64:67], v[80:83]
  ds_read_b128 v[56:59], v14 offset:1024
  s_waitcnt lgkmcnt(3)
  v_mfma_f32_16x16x32_bf16 v[84:87], v[160:163], v[68:71], v[84:87]
  ds_read_b128 v[60:63], v14 offset:21504
  s_waitcnt lgkmcnt(3)
  v_mfma_f32_16x16x32_bf16 v[80:83], v[164:167], v[72:75], v[80:83]
  ds_read_b128 v[64:67], v15 offset:1024
  s_waitcnt lgkmcnt(3)
  v_mfma_f32_16x16x32_bf16 v[84:87], v[164:167], v[76:79], v[84:87]
  ds_read_b128 v[68:71], v15 offset:21504
  s_waitcnt lgkmcnt(3)
  v_mfma_f32_16x16x32_bf16 v[80:83], v[168:171], v[56:59], v[80:83]
  s_waitcnt lgkmcnt(2)
  v_mfma_f32_16x16x32_bf16 v[84:87], v[168:171], v[60:63], v[84:87]
  s_waitcnt lgkmcnt(1)
  v_mfma_f32_16x16x32_bf16 v[80:83], v[172:175], v[64:67], v[80:83]
  s_waitcnt lgkmcnt(0)
  v_mfma_f32_16x16x32_bf16 v[84:87], v[172:175], v[68:71], v[84:87]
  s_waitcnt vmcnt(0)
  s_barrier
  v_mov_b32 v24, 2
  buffer_store_dword v24, v17, s[8:11], 0 offen sc1
  s_mov_b32 s38, 163840
  s_add_u32 m0, s39, 40960
  s_nop 0
  buffer_load_dwordx4 v2, s[12:15], s38 offen lds
  s_add_u32 m0, s39, 41984
  s_nop 0
  buffer_load_dwordx4 v3, s[12:15], s38 offen lds
  s_add_u32 m0, s39, 43008
  s_nop 0
  buffer_load_dwordx4 v4, s[12:15], s38 offen lds
  s_add_u32 m0, s39, 44032
  s_nop 0
  buffer_load_dwordx4 v5, s[12:15], s38 offen lds
  s_add_u32 m0, s39, 45056
  s_nop 0
  buffer_load_dwordx4 v6, s[12:15], s38 offen lds
  s_mov_b32 s40, 524288
  s_nop 6
  v_cvt_pk_bf16_f32 v48, v80, v81
  v_cvt_pk_bf16_f32 v49, v82, v83
  v_cvt_pk_bf16_f32 v50, v84, v85
  v_cvt_pk_bf16_f32 v51, v86, v87
  buffer_store_dwordx2 v[48:49], v16, s[8:11], s40 offen sc1
  buffer_store_dwordx2 v[50:51], v16, s[8:11], s40 offen offset:1024 sc1
  ds_read_b128 v[56:59], v8 offset:0
  ds_read_b128 v[60:63], v8 offset:20480
  ds_read_b128 v[64:67], v9 offset:0
  ds_read_b128 v[68:71], v9 offset:20480
  s_waitcnt lgkmcnt(3)
  v_mfma_f32_16x16x32_bf16 v[80:83], v[96:99], v[56:59], 0
  ds_read_b128 v[72:75], v10 offset:0
  s_waitcnt lgkmcnt(3)
  v_mfma_f32_16x16x32_bf16 v[84:87], v[96:99], v[60:63], 0
  ds_read_b128 v[76:79], v10 offset:20480
  s_waitcnt lgkmcnt(3)
  v_mfma_f32_16x16x32_bf16 v[80:83], v[100:103], v[64:67], v[80:83]
  ds_read_b128 v[56:59], v11 offset:0
  s_waitcnt lgkmcnt(3)
  v_mfma_f32_16x16x32_bf16 v[84:87], v[100:103], v[68:71], v[84:87]
  ds_read_b128 v[60:63], v11 offset:20480
  s_waitcnt lgkmcnt(3)
  v_mfma_f32_16x16x32_bf16 v[80:83], v[104:107], v[72:75], v[80:83]
  ds_read_b128 v[64:67], v8 offset:256
  s_waitcnt lgkmcnt(3)
  v_mfma_f32_16x16x32_bf16 v[84:87], v[104:107], v[76:79], v[84:87]
  ds_read_b128 v[68:71], v8 offset:20736
  s_waitcnt lgkmcnt(3)
  v_mfma_f32_16x16x32_bf16 v[80:83], v[108:111], v[56:59], v[80:83]
  ds_read_b128 v[72:75], v9 offset:256
  s_waitcnt lgkmcnt(3)
  v_mfma_f32_16x16x32_bf16 v[84:87], v[108:111], v[60:63], v[84:87]
  ds_read_b128 v[76:79], v9 offset:20736
  s_waitcnt lgkmcnt(3)
  v_mfma_f32_16x16x32_bf16 v[80:83], v[112:115], v[64:67], v[80:83]
  ds_read_b128 v[56:59], v10 offset:256
  s_waitcnt lgkmcnt(3)
  v_mfma_f32_16x16x32_bf16 v[84:87], v[112:115], v[68:71], v[84:87]
  ds_read_b128 v[60:63], v10 offset:20736
  s_waitcnt lgkmcnt(3)
  v_mfma_f32_16x16x32_bf16 v[80:83], v[116:119], v[72:75], v[80:83]
  ds_read_b128 v[64:67], v11 offset:256
  s_waitcnt lgkmcnt(3)
  v_mfma_f32_16x16x32_bf16 v[84:87], v[116:119], v[76:79], v[84:87]
  ds_read_b128 v[68:71], v11 offset:20736
  s_waitcnt lgkmcnt(3)
  v_mfma_f32_16x16x32_bf16 v[80:83], v[120:123], v[56:59], v[80:83]
  ds_read_b128 v[72:75], v8 offset:512
  s_waitcnt lgkmcnt(3)
  v_mfma_f32_16x16x32_bf16 v[84:87], v[120:123], v[60:63], v[84:87]
  ds_read_b128 v[76:79], v8 offset:20992
  s_waitcnt lgkmcnt(3)
  v_mfma_f32_16x16x32_bf16 v[80:83], v[124:127], v[64:67], v[80:83]
  ds_read_b128 v[56:59], v9 offset:512
  s_waitcnt lgkmcnt(3)
  v_mfma_f32_16x16x32_bf16 v[84:87], v[124:127], v[68:71], v[84:87]
  ds_read_b128 v[60:63], v9 offset:20992
  s_waitcnt lgkmcnt(3)
  v_mfma_f32_16x16x32_bf16 v[80:83], v[128:131], v[72:75], v[80:83]
  ds_read_b128 v[64:67], v10 offset:512
  s_waitcnt lgkmcnt(3)
  v_mfma_f32_16x16x32_bf16 v[84:87], v[128:131], v[76:79], v[84:87]
  ds_read_b128 v[68:71], v10 offset:20992
  s_waitcnt lgkmcnt(3)
  v_mfma_f32_16x16x32_bf16 v[80:83], v[132:135], v[56:59], v[80:83]
  ds_read_b128 v[72:75], v11 offset:512
  s_waitcnt lgkmcnt(3)
  v_mfma_f32_16x16x32_bf16 v[84:87], v[132:135], v[60:63], v[84:87]
  ds_read_b128 v[76:79], v11 offset:20992
  s_waitcnt lgkmcnt(3)
  v_mfma_f32_16x16x32_bf16 v[80:83], v[136:139], v[64:67], v[80:83]
  ds_read_b128 v[56:59], v8 offset:768
  s_waitcnt lgkmcnt(3)
  v_mfma_f32_16x16x32_bf16 v[84:87], v[136:139], v[68:71], v[84:87]
  ds_read_b128 v[60:63], v8 offset:21248
  s_waitcnt lgkmcnt(3)
  v_mfma_f32_16x16x32_bf16 v[80:83], v[140:143], v[72:75], v[80:83]
  ds_read_b128 v[64:67], v9 offset:768
  s_waitcnt lgkmcnt(3)
  v_mfma_f32_16x16x32_bf16 v[84:87], v[140:143], v[76:79], v[84:87]
  ds_read_b128 v[68:71], v9 offset:21248
  s_waitcnt lgkmcnt(3)
  v_mfma_f32_16x16x32_bf16 v[80:83], v[144:147], v[56:59], v[80:83]
  ds_read_b128 v[72:75], v10 offset:768
  s_waitcnt lgkmcnt(3)
  v_mfma_f32_16x16x32_bf16 v[84:87], v[144:147], v[60:63], v[84:87]
  ds_read_b128 v[76:79], v10 offset:21248
  s_waitcnt lgkmcnt(3)
  v_mfma_f32_16x16x32_bf16 v[80:83], v[148:151], v[64:67], v[80:83]
  ds_read_b128 v[56:59], v11 offset:768
  s_waitcnt lgkmcnt(3)
  v_mfma_f32_16x16x32_bf16 v[84:87], v[148:151], v[68:71], v[84:87]
  ds_read_b128 v[60:63], v11 offset:21248
  s_waitcnt lgkmcnt(3)
  v_mfma_f32_16x16x32_bf16 v[80:83], v[152:155], v[72:75], v[80:83]
  ds_read_b128 v[64:67], v8 offset:1024
  s_waitcnt lgkmcnt(3)
  v_mfma_f32_16x16x32_bf16 v[84:87], v[152:155], v[76:79], v[84:87]
  ds_read_b128 v[68:71], v8 offset:21504
  s_waitcnt lgkmcnt(3)
  v_mfma_f32_16x16x32_bf16 v[80:83], v[156:159], v[56:59], v[80:83]
  ds_read_b128 v[72:75], v9 offset:1024
  s_waitcnt lgkmcnt(3)
  v_mfma_f32_16x16x32_bf16 v[84:87], v[156:159], v[60:63], v[84:87]
  ds_read_b128 v[76:79], v9 offset:21504
  s_waitcnt lgkmcnt(3)
  v_mfma_f32_16x16x32_bf16 v[80:83], v[160:163], v[64:67], v[80:83]
  ds_read_b128 v[56:59], v10 offset:1024
  s_waitcnt lgkmcnt(3)
  v_mfma_f32_16x16x32_bf16 v[84:87], v[160:163], v[68:71], v[84:87]
  ds_read_b128 v[60:63], v10 offset:21504
  s_waitcnt lgkmcnt(3)
  v_mfma_f32_16x16x32_bf16 v[80:83], v[164:167], v[72:75], v[80:83]
  ds_read_b128 v[64:67], v11 offset:1024
  s_waitcnt lgkmcnt(3)
  v_mfma_f32_16x16x32_bf16 v[84:87], v[164:167], v[76:79], v[84:87]
  ds_read_b128 v[68:71], v11 offset:21504
  s_waitcnt lgkmcnt(3)
  v_mfma_f32_16x16x32_bf16 v[80:83], v[168:171], v[56:59], v[80:83]
  s_waitcnt lgkmcnt(2)
  v_mfma_f32_16x16x32_bf16 v[84:87], v[168:171], v[60:63], v[84:87]
  s_waitcnt lgkmcnt(1)
  v_mfma_f32_16x16x32_bf16 v[80:83], v[172:175], v[64:67], v[80:83]
  s_waitcnt lgkmcnt(0)
  v_mfma_f32_16x16x32_bf16 v[84:87], v[172:175], v[68:71], v[84:87]
  s_waitcnt vmcnt(0)
  s_barrier
  v_mov_b32 v24, 3
  buffer_store_dword v24, v17, s[8:11], 0 offen sc1
  s_mov_b32 s40, 786432
  s_nop 6
  v_cvt_pk_bf16_f32 v52, v80, v81
  v_cvt_pk_bf16_f32 v53, v82, v83
  v_cvt_pk_bf16_f32 v54, v84, v85
  v_cvt_pk_bf16_f32 v55, v86, v87
  buffer_store_dwordx2 v[52:53], v16, s[8:11], s40 offen sc1
  buffer_store_dwordx2 v[54:55], v16, s[8:11], s40 offen offset:1024 sc1
  ds_read_b128 v[56:59], v8 offset:40960
  ds_read_b128 v[60:63], v8 offset:61440
  ds_read_b128 v[64:67], v9 offset:40960
  ds_read_b128 v[68:71], v9 offset:61440
  s_waitcnt lgkmcnt(3)
  v_mfma_f32_16x16x32_bf16 v[80:83], v[96:99], v[56:59], 0
  ds_read_b128 v[72:75], v10 offset:40960
  s_waitcnt lgkmcnt(3)
  v_mfma_f32_16x16x32_bf16 v[84:87], v[96:99], v[60:63], 0
  ds_read_b128 v[76:79], v10 offset:61440
  s_waitcnt lgkmcnt(3)
  v_mfma_f32_16x16x32_bf16 v[80:83], v[100:103], v[64:67], v[80:83]
  ds_read_b128 v[56:59], v11 offset:40960
  s_waitcnt lgkmcnt(3)
  v_mfma_f32_16x16x32_bf16 v[84:87], v[100:103], v[68:71], v[84:87]
  ds_read_b128 v[60:63], v11 offset:61440
  s_waitcnt lgkmcnt(3)
  v_mfma_f32_16x16x32_bf16 v[80:83], v[104:107], v[72:75], v[80:83]
  ds_read_b128 v[64:67], v8 offset:41216
  s_waitcnt lgkmcnt(3)
  v_mfma_f32_16x16x32_bf16 v[84:87], v[104:107], v[76:79], v[84:87]
  ds_read_b128 v[68:71], v8 offset:61696
  s_waitcnt lgkmcnt(3)
  v_mfma_f32_16x16x32_bf16 v[80:83], v[108:111], v[56:59], v[80:83]
  ds_read_b128 v[72:75], v9 offset:41216
  s_waitcnt lgkmcnt(3)
  v_mfma_f32_16x16x32_bf16 v[84:87], v[108:111], v[60:63], v[84:87]
  ds_read_b128 v[76:79], v9 offset:61696
  s_waitcnt lgkmcnt(3)
  v_mfma_f32_16x16x32_bf16 v[80:83], v[112:115], v[64:67], v[80:83]
  ds_read_b128 v[56:59], v10 offset:41216
  s_waitcnt lgkmcnt(3)
  v_mfma_f32_16x16x32_bf16 v[84:87], v[112:115], v[68:71], v[84:87]
  ds_read_b128 v[60:63], v10 offset:61696
  s_waitcnt lgkmcnt(3)
  v_mfma_f32_16x16x32_bf16 v[80:83], v[116:119], v[72:75], v[80:83]
  ds_read_b128 v[64:67], v11 offset:41216
  s_waitcnt lgkmcnt(3)
  v_mfma_f32_16x16x32_bf16 v[84:87], v[116:119], v[76:79], v[84:87]
  ds_read_b128 v[68:71], v11 offset:61696
  s_waitcnt lgkmcnt(3)
  v_mfma_f32_16x16x32_bf16 v[80:83], v[120:123], v[56:59], v[80:83]
  ds_read_b128 v[72:75], v8 offset:41472
  s_waitcnt lgkmcnt(3)
  v_mfma_f32_16x16x32_bf16 v[84:87], v[120:123], v[60:63], v[84:87]
  ds_read_b128 v[76:79], v8 offset:61952
  s_waitcnt lgkmcnt(3)
  v_mfma_f32_16x16x32_bf16 v[80:83], v[124:127], v[64:67], v[80:83]
  ds_read_b128 v[56:59], v9 offset:41472
  s_waitcnt lgkmcnt(3)
  v_mfma_f32_16x16x32_bf16 v[84:87], v[124:127], v[68:71], v[84:87]
  ds_read_b128 v[60:63], v9 offset:61952
  s_waitcnt lgkmcnt(3)
  v_mfma_f32_16x16x32_bf16 v[80:83], v[128:131], v[72:75], v[80:83]
  ds_read_b128 v[64:67], v10 offset:41472
  s_waitcnt lgkmcnt(3)
  v_mfma_f32_16x16x32_bf16 v[84:87], v[128:131], v[76:79], v[84:87]
  ds_read_b128 v[68:71], v10 offset:61952
  s_waitcnt lgkmcnt(3)
  v_mfma_f32_16x16x32_bf16 v[80:83], v[132:135], v[56:59], v[80:83]
  ds_read_b128 v[72:75], v11 offset:41472
  s_waitcnt lgkmcnt(3)
  v_mfma_f32_16x16x32_bf16 v[84:87], v[132:135], v[60:63], v[84:87]
  ds_read_b128 v[76:79], v11 offset:61952
  s_waitcnt lgkmcnt(3)
  v_mfma_f32_16x16x32_bf16 v[80:83], v[136:139], v[64:67], v[80:83]
  ds_read_b128 v[56:59], v8 offset:41728
  s_waitcnt lgkmcnt(3)
  v_mfma_f32_16x16x32_bf16 v[84:87], v[136:139], v[68:71], v[84:87]
  ds_read_b128 v[60:63], v8 offset:62208
  s_waitcnt lgkmcnt(3)
  v_mfma_f32_16x16x32_bf16 v[80:83], v[140:143], v[72:75], v[80:83]
  ds_read_b128 v[64:67], v9 offset:41728
  s_waitcnt lgkmcnt(3)
  v_mfma_f32_16x16x32_bf16 v[84:87], v[140:143], v[76:79], v[84:87]
  ds_read_b128 v[68:71], v9 offset:62208
  s_waitcnt lgkmcnt(3)
  v_mfma_f32_16x16x32_bf16 v[80:83], v[144:147], v[56:59], v[80:83]
  ds_read_b128 v[72:75], v10 offset:41728
  s_waitcnt lgkmcnt(3)
  v_mfma_f32_16x16x32_bf16 v[84:87], v[144:147], v[60:63], v[84:87]
  ds_read_b128 v[76:79], v10 offset:62208
  s_waitcnt lgkmcnt(3)
  v_mfma_f32_16x16x32_bf16 v[80:83], v[148:151], v[64:67], v[80:83]
  ds_read_b128 v[56:59], v11 offset:41728
  s_waitcnt lgkmcnt(3)
  v_mfma_f32_16x16x32_bf16 v[84:87], v[148:151], v[68:71], v[84:87]
  ds_read_b128 v[60:63], v11 offset:62208
  s_waitcnt lgkmcnt(3)
  v_mfma_f32_16x16x32_bf16 v[80:83], v[152:155], v[72:75], v[80:83]
  ds_read_b128 v[64:67], v8 offset:41984
  s_waitcnt lgkmcnt(3)
  v_mfma_f32_16x16x32_bf16 v[84:87], v[152:155], v[76:79], v[84:87]
  ds_read_b128 v[68:71], v8 offset:62464
  s_waitcnt lgkmcnt(3)
  v_mfma_f32_16x16x32_bf16 v[80:83], v[156:159], v[56:59], v[80:83]
  ds_read_b128 v[72:75], v9 offset:41984
  s_waitcnt lgkmcnt(3)
  v_mfma_f32_16x16x32_bf16 v[84:87], v[156:159], v[60:63], v[84:87]
  ds_read_b128 v[76:79], v9 offset:62464
  s_waitcnt lgkmcnt(3)
  v_mfma_f32_16x16x32_bf16 v[80:83], v[160:163], v[64:67], v[80:83]
  ds_read_b128 v[56:59], v10 offset:41984
  s_waitcnt lgkmcnt(3)
  v_mfma_f32_16x16x32_bf16 v[84:87], v[160:163], v[68:71], v[84:87]
  ds_read_b128 v[60:63], v10 offset:62464
  s_waitcnt lgkmcnt(3)
  v_mfma_f32_16x16x32_bf16 v[80:83], v[164:167], v[72:75], v[80:83]
  ds_read_b128 v[64:67], v11 offset:41984
  s_waitcnt lgkmcnt(3)
  v_mfma_f32_16x16x32_bf16 v[84:87], v[164:167], v[76:79], v[84:87]
  ds_read_b128 v[68:71], v11 offset:62464
  s_waitcnt lgkmcnt(3)
  v_mfma_f32_16x16x32_bf16 v[80:83], v[168:171], v[56:59], v[80:83]
  s_waitcnt lgkmcnt(2)
  v_mfma_f32_16x16x32_bf16 v[84:87], v[168:171], v[60:63], v[84:87]
  s_waitcnt lgkmcnt(1)
  v_mfma_f32_16x16x32_bf16 v[80:83], v[172:175], v[64:67], v[80:83]
  s_waitcnt lgkmcnt(0)
  v_mfma_f32_16x16x32_bf16 v[84:87], v[172:175], v[68:71], v[84:87]
  s_waitcnt vmcnt(0)
  s_barrier
  v_mov_b32 v24, 4
  buffer_store_dword v24, v17, s[8:11], 0 offen sc1
  s_mov_b32 s40, 1048576
  s_nop 6
  v_cvt_pk_bf16_f32 v48, v80, v81
  v_cvt_pk_bf16_f32 v49, v82, v83
  v_cvt_pk_bf16_f32 v50, v84, v85
  v_cvt_pk_bf16_f32 v51, v86, v87
  buffer_store_dwordx2 v[48:49], v16, s[8:11], s40 offen sc1
  buffer_store_dwordx2 v[50:51], v16, s[8:11], s40 offen offset:1024 sc1
  s_waitcnt vmcnt(0)
  s_barrier
  v_mov_b32 v24, 5
  buffer_store_dword v24, v17, s[8:11], 0 offen sc1
  s_branch L_boot_done
L_boot_v:
  ds_read_b128 v[56:59], v8 offset:0
  ds_read_b128 v[60:63], v8 offset:20480
  ds_read_b128 v[64:67], v9 offset:0
  ds_read_b128 v[68:71], v9 offset:20480
  s_waitcnt lgkmcnt(3)
  v_mfma_f32_16x16x32_bf16 v[80:83], v[56:59], v[96:99], 0
  ds_read_b128 v[72:75], v10 offset:0
  s_waitcnt lgkmcnt(3)
  v_mfma_f32_16x16x32_bf16 v[84:87], v[60:63], v[96:99], 0
  ds_read_b128 v[76:79], v10 offset:20480
  s_waitcnt lgkmcnt(3)
  v_mfma_f32_16x16x32_bf16 v[80:83], v[64:67], v[100:103], v[80:83]
  ds_read_b128 v[56:59], v11 offset:0
  s_waitcnt lgkmcnt(3)
  v_mfma_f32_16x16x32_bf16 v[84:87], v[68:71], v[100:103], v[84:87]
  ds_read_b128 v[60:63], v11 offset:20480
  s_waitcnt lgkmcnt(3)
  v_mfma_f32_16x16x32_bf16 v[80:83], v[72:75], v[104:107], v[80:83]
  ds_read_b128 v[64:67], v8 offset:256
  s_waitcnt lgkmcnt(3)
  v_mfma_f32_16x16x32_bf16 v[84:87], v[76:79], v[104:107], v[84:87]
  ds_read_b128 v[68:71], v8 offset:20736
  s_waitcnt lgkmcnt(3)
  v_mfma_f32_16x16x32_bf16 v[80:83], v[56:59], v[108:111], v[80:83]
  ds_read_b128 v[72:75], v9 offset:256
  s_waitcnt lgkmcnt(3)
  v_mfma_f32_16x16x32_bf16 v[84:87], v[60:63], v[108:111], v[84:87]
  ds_read_b128 v[76:79], v9 offset:20736
  s_waitcnt lgkmcnt(3)
  v_mfma_f32_16x16x32_bf16 v[80:83], v[64:67], v[112:115], v[80:83]
  ds_read_b128 v[56:59], v10 offset:256
  s_waitcnt lgkmcnt(3)
  v_mfma_f32_16x16x32_bf16 v[84:87], v[68:71], v[112:115], v[84:87]
  ds_read_b128 v[60:63], v10 offset:20736
  s_waitcnt lgkmcnt(3)
  v_mfma_f32_16x16x32_bf16 v[80:83], v[72:75], v[116:119], v[80:83]
  ds_read_b128 v[64:67], v11 offset:256
  s_waitcnt lgkmcnt(3)
  v_mfma_f32_16x16x32_bf16 v[84:87], v[76:79], v[116:119], v[84:87]
  ds_read_b128 v[68:71], v11 offset:20736
  s_waitcnt lgkmcnt(3)
  v_mfma_f32_16x16x32_bf16 v[80:83], v[56:59], v[120:123], v[80:83]
  ds_read_b128 v[72:75], v8 offset:512
  s_waitcnt lgkmcnt(3)
  v_mfma_f32_16x16x32_bf16 v[84:87], v[60:63], v[120:123], v[84:87]
  ds_read_b128 v[76:79], v8 offset:20992
  s_waitcnt lgkmcnt(3)
  v_mfma_f32_16x16x32_bf16 v[80:83], v[64:67], v[124:127], v[80:83]
  ds_read_b128 v[56:59], v9 offset:512
  s_waitcnt lgkmcnt(3)
  v_mfma_f32_16x16x32_bf16 v[84:87], v[68:71], v[124:127], v[84:87]
  ds_read_b128 v[60:63], v9 offset:20992
  s_waitcnt lgkmcnt(3)
  v_mfma_f32_16x16x32_bf16 v[80:83], v[72:75], v[128:131], v[80:83]
  ds_read_b128 v[64:67], v10 offset:512
  s_waitcnt lgkmcnt(3)
  v_mfma_f32_16x16x32_bf16 v[84:87], v[76:79], v[128:131], v[84:87]
  ds_read_b128 v[68:71], v10 offset:20992
  s_waitcnt lgkmcnt(3)
  v_mfma_f32_16x16x32_bf16 v[80:83], v[56:59], v[132:135], v[80:83]
  ds_read_b128 v[72:75], v11 offset:512
  s_waitcnt lgkmcnt(3)
  v_mfma_f32_16x16x32_bf16 v[84:87], v[60:63], v[132:135], v[84:87]
  ds_read_b128 v[76:79], v11 offset:20992
  s_waitcnt lgkmcnt(3)
  v_mfma_f32_16x16x32_bf16 v[80:83], v[64:67], v[136:139], v[80:83]
  ds_read_b128 v[56:59], v8 offset:768
  s_waitcnt lgkmcnt(3)
  v_mfma_f32_16x16x32_bf16 v[84:87], v[68:71], v[136:139], v[84:87]
  ds_read_b128 v[60:63], v8 offset:21248
  s_waitcnt lgkmcnt(3)
  v_mfma_f32_16x16x32_bf16 v[80:83], v[72:75], v[140:143], v[80:83]
  ds_read_b128 v[64:67], v9 offset:768
  s_waitcnt lgkmcnt(3)
  v_mfma_f32_16x16x32_bf16 v[84:87], v[76:79], v[140:143], v[84:87]
  ds_read_b128 v[68:71], v9 offset:21248
  s_waitcnt lgkmcnt(3)
  v_mfma_f32_16x16x32_bf16 v[80:83], v[56:59], v[144:147], v[80:83]
  ds_read_b128 v[72:75], v10 offset:768
  s_waitcnt lgkmcnt(3)
  v_mfma_f32_16x16x32_bf16 v[84:87], v[60:63], v[144:147], v[84:87]
  ds_read_b128 v[76:79], v10 offset:21248
  s_waitcnt lgkmcnt(3)
  v_mfma_f32_16x16x32_bf16 v[80:83], v[64:67], v[148:151], v[80:83]
  ds_read_b128 v[56:59], v11 offset:768
  s_waitcnt lgkmcnt(3)
  v_mfma_f32_16x16x32_bf16 v[84:87], v[68:71], v[148:151], v[84:87]
  ds_read_b128 v[60:63], v11 offset:21248
  s_waitcnt lgkmcnt(3)
  v_mfma_f32_16x16x32_bf16 v[80:83], v[72:75], v[152:155], v[80:83]
  ds_read_b128 v[64:67], v8 offset:1024
  s_waitcnt lgkmcnt(3)
  v_mfma_f32_16x16x32_bf16 v[84:87], v[76:79], v[152:155], v[84:87]
  ds_read_b128 v[68:71], v8 offset:21504
  s_waitcnt lgkmcnt(3)
  v_mfma_f32_16x16x32_bf16 v[80:83], v[56:59], v[156:159], v[80:83]
  ds_read_b128 v[72:75], v9 offset:1024
  s_waitcnt lgkmcnt(3)
  v_mfma_f32_16x16x32_bf16 v[84:87], v[60:63], v[156:159], v[84:87]
  ds_read_b128 v[76:79], v9 offset:21504
  s_waitcnt lgkmcnt(3)
  v_mfma_f32_16x16x32_bf16 v[80:83], v[64:67], v[160:163], v[80:83]
  ds_read_b128 v[56:59], v10 offset:1024
  s_waitcnt lgkmcnt(3)
  v_mfma_f32_16x16x32_bf16 v[84:87], v[68:71], v[160:163], v[84:87]
  ds_read_b128 v[60:63], v10 offset:21504
  s_waitcnt lgkmcnt(3)
  v_mfma_f32_16x16x32_bf16 v[80:83], v[72:75], v[164:167], v[80:83]
  ds_read_b128 v[64:67], v11 offset:1024
  s_waitcnt lgkmcnt(3)
  v_mfma_f32_16x16x32_bf16 v[84:87], v[76:79], v[164:167], v[84:87]
  ds_read_b128 v[68:71], v11 offset:21504
  s_waitcnt lgkmcnt(3)
  v_mfma_f32_16x16x32_bf16 v[80:83], v[56:59], v[168:171], v[80:83]
  s_waitcnt lgkmcnt(2)
  v_mfma_f32_16x16x32_bf16 v[84:87], v[60:63], v[168:171], v[84:87]
  s_waitcnt lgkmcnt(1)
  v_mfma_f32_16x16x32_bf16 v[80:83], v[64:67], v[172:175], v[80:83]
  s_waitcnt lgkmcnt(0)
  v_mfma_f32_16x16x32_bf16 v[84:87], v[68:71], v[172:175], v[84:87]
  s_mov_b32 s40, 0
  s_nop 6
  v_cvt_pk_bf16_f32 v48, v80, v81
  v_cvt_pk_bf16_f32 v49, v82, v83
  v_cvt_pk_bf16_f32 v50, v84, v85
  v_cvt_pk_bf16_f32 v51, v86, v87
  buffer_store_dwordx4 v[48:51], v16, s[8:11], s40 offen sc1
  s_waitcnt vmcnt(0)
  s_cmp_eq_u32 s98, 0
  s_cbranch_scc0 L_boot_nv1
L_boot_vote1:
  v_readfirstlane_b32 s60, v25
  s_nop 0
  s_cmp_eq_u32 s60, 1
  s_cbranch_scc1 L_boot_vote1_all
  s_cmp_eq_u32 s60, 2
  s_cbranch_scc1 L_restart
  s_add_u32 s63, s63, 1
  s_cmp_ge_u32 s63, 0x40000
  s_cbranch_scc1 L_restart
  s_sleep 4
  buffer_load_dword v25, v26, s[56:59], 0 offen sc1
  s_waitcnt vmcnt(0)
  s_branch L_boot_vote1
L_boot_vote1_all:
L_boot_nv1:
  s_barrier
  v_mov_b32 v24, 1
  buffer_store_dword v24, v17, s[8:11], 0 offen sc1
  ds_read_b128 v[56:59], v8 offset:40960
  ds_read_b128 v[60:63], v8 offset:61440
  ds_read_b128 v[64:67], v9 offset:40960
  ds_read_b128 v[68:71], v9 offset:61440
  s_waitcnt lgkmcnt(3)
  v_mfma_f32_16x16x32_bf16 v[80:83], v[56:59], v[96:99], 0
  ds_read_b128 v[72:75], v10 offset:40960
  s_waitcnt lgkmcnt(3)
  v_mfma_f32_16x16x32_bf16 v[84:87], v[60:63], v[96:99], 0
  ds_read_b128 v[76:79], v10 offset:61440
  s_waitcnt lgkmcnt(3)
  v_mfma_f32_16x16x32_bf16 v[80:83], v[64:67], v[100:103], v[80:83]
  ds_read_b128 v[56:59], v11 offset:40960
  s_waitcnt lgkmcnt(3)
  v_mfma_f32_16x16x32_bf16 v[84:87], v[68:71], v[100:103], v[84:87]
  ds_read_b128 v[60:63], v11 offset:61440
  s_waitcnt lgkmcnt(3)
  v_mfma_f32_16x16x32_bf16 v[80:83], v[72:75], v[104:107], v[80:83]
  ds_read_b128 v[64:67], v8 offset:41216
  s_waitcnt lgkmcnt(3)
  v_mfma_f32_16x16x32_bf16 v[84:87], v[76:79], v[104:107], v[84:87]
  ds_read_b128 v[68:71], v8 offset:61696
  s_waitcnt lgkmcnt(3)
  v_mfma_f32_16x16x32_bf16 v[80:83], v[56:59], v[108:111], v[80:83]
  ds_read_b128 v[72:75], v9 offset:41216
  s_waitcnt lgkmcnt(3)
  v_mfma_f32_16x16x32_bf16 v[84:87], v[60:63], v[108:111], v[84:87]
  ds_read_b128 v[76:79], v9 offset:61696
  s_waitcnt lgkmcnt(3)
  v_mfma_f32_16x16x32_bf16 v[80:83], v[64:67], v[112:115], v[80:83]
  ds_read_b128 v[56:59], v10 offset:41216
  s_waitcnt lgkmcnt(3)
  v_mfma_f32_16x16x32_bf16 v[84:87], v[68:71], v[112:115], v[84:87]
  ds_read_b128 v[60:63], v10 offset:61696
  s_waitcnt lgkmcnt(3)
  v_mfma_f32_16x16x32_bf16 v[80:83], v[72:75], v[116:119], v[80:83]
  ds_read_b128 v[64:67], v11 offset:41216
  s_waitcnt lgkmcnt(3)
  v_mfma_f32_16x16x32_bf16 v[84:87], v[76:79], v[116:119], v[84:87]
  ds_read_b128 v[68:71], v11 offset:61696
  s_waitcnt lgkmcnt(3)
  v_mfma_f32_16x16x32_bf16 v[80:83], v[56:59], v[120:123], v[80:83]
  ds_read_b128 v[72:75], v8 offset:41472
  s_waitcnt lgkmcnt(3)
  v_mfma_f32_16x16x32_bf16 v[84:87], v[60:63], v[120:123], v[84:87]
  ds_read_b128 v[76:79], v8 offset:61952
  s_waitcnt lgkmcnt(3)
  v_mfma_f32_16x16x32_bf16 v[80:83], v[64:67], v[124:127], v[80:83]
  ds_read_b128 v[56:59], v9 offset:41472
  s_waitcnt lgkmcnt(3)
  v_mfma_f32_16x16x32_bf16 v[84:87], v[68:71], v[124:127], v[84:87]
  ds_read_b128 v[60:63], v9 offset:61952
  s_waitcnt lgkmcnt(3)
  v_mfma_f32_16x16x32_bf16 v[80:83], v[72:75], v[128:131], v[80:83]
  ds_read_b128 v[64:67], v10 offset:41472
  s_waitcnt lgkmcnt(3)
  v_mfma_f32_16x16x32_bf16 v[84:87], v[76:79], v[128:131], v[84:87]
  ds_read_b128 v[68:71], v10 offset:61952
  s_waitcnt lgkmcnt(3)
  v_mfma_f32_16x16x32_bf16 v[80:83], v[56:59], v[132:135], v[80:83]
  ds_read_b128 v[72:75], v11 offset:41472
  s_waitcnt lgkmcnt(3)
  v_mfma_f32_16x16x32_bf16 v[84:87], v[60:63], v[132:135], v[84:87]
  ds_read_b128 v[76:79], v11 offset:61952
  s_waitcnt lgkmcnt(3)
  v_mfma_f32_16x16x32_bf16 v[80:83], v[64:67], v[136:139], v[80:83]
  ds_read_b128 v[56:59], v8 offset:41728
  s_waitcnt lgkmcnt(3)
  v_mfma_f32_16x16x32_bf16 v[84:87], v[68:71], v[136:139], v[84:87]
  ds_read_b128 v[60:63], v8 offset:62208
  s_waitcnt lgkmcnt(3)
  v_mfma_f32_16x16x32_bf16 v[80:83], v[72:75], v[140:143], v[80:83]
  ds_read_b128 v[64:67], v9 offset:41728
  s_waitcnt lgkmcnt(3)
  v_mfma_f32_16x16x32_bf16 v[84:87], v[76:79], v[140:143], v[84:87]
  ds_read_b128 v[68:71], v9 offset:62208
  s_waitcnt lgkmcnt(3)
  v_mfma_f32_16x16x32_bf16 v[80:83], v[56:59], v[144:147], v[80:83]
  ds_read_b128 v[72:75], v10 offset:41728
  s_waitcnt lgkmcnt(3)
  v_mfma_f32_16x16x32_bf16 v[84:87], v[60:63], v[144:147], v[84:87]
  ds_read_b128 v[76:79], v10 offset:62208
  s_waitcnt lgkmcnt(3)
  v_mfma_f32_16x16x32_bf16 v[80:83], v[64:67], v[148:151], v[80:83]
  ds_read_b128 v[56:59], v11 offset:41728
  s_waitcnt lgkmcnt(3)
  v_mfma_f32_16x16x32_bf16 v[84:87], v[68:71], v[148:151], v[84:87]
  ds_read_b128 v[60:63], v11 offset:62208
  s_waitcnt lgkmcnt(3)
  v_mfma_f32_16x16x32_bf16 v[80:83], v[72:75], v[152:155], v[80:83]
  ds_read_b128 v[64:67], v8 offset:41984
  s_waitcnt lgkmcnt(3)
  v_mfma_f32_16x16x32_bf16 v[84:87], v[76:79], v[152:155], v[84:87]
  ds_read_b128 v[68:71], v8 offset:62464
  s_waitcnt lgkmcnt(3)
  v_mfma_f32_16x16x32_bf16 v[80:83], v[56:59], v[156:159], v[80:83]
  ds_read_b128 v[72:75], v9 offset:41984
  s_waitcnt lgkmcnt(3)
  v_mfma_f32_16x16x32_bf16 v[84:87], v[60:63], v[156:159], v[84:87]
  ds_read_b128 v[76:79], v9 offset:62464
  s_waitcnt lgkmcnt(3)
  v_mfma_f32_16x16x32_bf16 v[80:83], v[64:67], v[160:163], v[80:83]
  ds_read_b128 v[56:59], v10 offset:41984
  s_waitcnt lgkmcnt(3)
  v_mfma_f32_16x16x32_bf16 v[84:87], v[68:71], v[160:163], v[84:87]
  ds_read_b128 v[60:63], v10 offset:62464
  s_waitcnt lgkmcnt(3)
  v_mfma_f32_16x16x32_bf16 v[80:83], v[72:75], v[164:167], v[80:83]
  ds_read_b128 v[64:67], v11 offset:41984
  s_waitcnt lgkmcnt(3)
  v_mfma_f32_16x16x32_bf16 v[84:87], v[76:79], v[164:167], v[84:87]
  ds_read_b128 v[68:71], v11 offset:62464
  s_waitcnt lgkmcnt(3)
  v_mfma_f32_16x16x32_bf16 v[80:83], v[56:59], v[168:171], v[80:83]
  s_waitcnt lgkmcnt(2)
  v_mfma_f32_16x16x32_bf16 v[84:87], v[60:63], v[168:171], v[84:87]
  s_waitcnt lgkmcnt(1)
  v_mfma_f32_16x16x32_bf16 v[80:83], v[64:67], v[172:175], v[80:83]
  s_waitcnt lgkmcnt(0)
  v_mfma_f32_16x16x32_bf16 v[84:87], v[68:71], v[172:175], v[84:87]
  s_waitcnt vmcnt(0)
  s_barrier
  s_mov_b32 s38, 122880
  s_add_u32 m0, s39, 0
  s_nop 0
  buffer_load_dwordx4 v2, s[12:15], s38 offen lds
  s_add_u32 m0, s39, 1024
  s_nop 0
  buffer_load_dwordx4 v3, s[12:15], s38 offen lds
  s_add_u32 m0, s39, 2048
  s_nop 0
  buffer_load_dwordx4 v4, s[12:15], s38 offen lds
  s_add_u32 m0, s39, 3072
  s_nop 0
  buffer_load_dwordx4 v5, s[12:15], s38 offen lds
  s_add_u32 m0, s39, 4096
  s_nop 0
  buffer_load_dwordx4 v6, s[12:15], s38 offen lds
  s_mov_b32 s40, 262144
  s_nop 6
  v_cvt_pk_bf16_f32 v52, v80, v81
  v_cvt_pk_bf16_f32 v53, v82, v83
  v_cvt_pk_bf16_f32 v54, v84, v85
  v_cvt_pk_bf16_f32 v55, v86, v87
  buffer_store_dwordx4 v[52:55], v16, s[8:11], s40 offen sc1
  ds_read_b128 v[56:59], v12 offset:0
  ds_read_b128 v[60:63], v12 offset:20480
  ds_read_b128 v[64:67], v13 offset:0
  ds_read_b128 v[68:71], v13 offset:20480
  s_waitcnt lgkmcnt(3)
  v_mfma_f32_16x16x32_bf16 v[80:83], v[56:59], v[96:99], 0
  ds_read_b128 v[72:75], v14 offset:0
  s_waitcnt lgkmcnt(3)
  v_mfma_f32_16x16x32_bf16 v[84:87], v[60:63], v[96:99], 0
  ds_read_b128 v[76:79], v14 offset:20480
  s_waitcnt lgkmcnt(3)
  v_mfma_f32_16x16x32_bf16 v[80:83], v[64:67], v[100:103], v[80:83]
  ds_read_b128 v[56:59], v15 offset:0
  s_waitcnt lgkmcnt(3)
  v_mfma_f32_16x16x32_bf16 v[84:87], v[68:71], v[100:103], v[84:87]
  ds_read_b128 v[60:63], v15 offset:20480
  s_waitcnt lgkmcnt(3)
  v_mfma_f32_16x16x32_bf16 v[80:83], v[72:75], v[104:107], v[80:83]
  ds_read_b128 v[64:67], v12 offset:256
  s_waitcnt lgkmcnt(3)
  v_mfma_f32_16x16x32_bf16 v[84:87], v[76:79], v[104:107], v[84:87]
  ds_read_b128 v[68:71], v12 offset:20736
  s_waitcnt lgkmcnt(3)
  v_mfma_f32_16x16x32_bf16 v[80:83], v[56:59], v[108:111], v[80:83]
  ds_read_b128 v[72:75], v13 offset:256
  s_waitcnt lgkmcnt(3)
  v_mfma_f32_16x16x32_bf16 v[84:87], v[60:63], v[108:111], v[84:87]
  ds_read_b128 v[76:79], v13 offset:20736
  s_waitcnt lgkmcnt(3)
  v_mfma_f32_16x16x32_bf16 v[80:83], v[64:67], v[112:115], v[80:83]
  ds_read_b128 v[56:59], v14 offset:256
  s_waitcnt lgkmcnt(3)
  v_mfma_f32_16x16x32_bf16 v[84:87], v[68:71], v[112:115], v[84:87]
  ds_read_b128 v[60:63], v14 offset:20736
  s_waitcnt lgkmcnt(3)
  v_mfma_f32_16x16x32_bf16 v[80:83], v[72:75], v[116:119], v[80:83]
  ds_read_b128 v[64:67], v15 offset:256
  s_waitcnt lgkmcnt(3)
  v_mfma_f32_16x16x32_bf16 v[84:87], v[76:79], v[116:119], v[84:87]
  ds_read_b128 v[68:71], v15 offset:20736
  s_waitcnt lgkmcnt(3)
  v_mfma_f32_16x16x32_bf16 v[80:83], v[56:59], v[120:123], v[80:83]
  ds_read_b128 v[72:75], v12 offset:512
  s_waitcnt lgkmcnt(3)
  v_mfma_f32_16x16x32_bf16 v[84:87], v[60:63], v[120:123], v[84:87]
  ds_read_b128 v[76:79], v12 offset:20992
  s_waitcnt lgkmcnt(3)
  v_mfma_f32_16x16x32_bf16 v[80:83], v[64:67], v[124:127], v[80:83]
  ds_read_b128 v[56:59], v13 offset:512
  s_waitcnt lgkmcnt(3)
  v_mfma_f32_16x16x32_bf16 v[84:87], v[68:71], v[124:127], v[84:87]
  ds_read_b128 v[60:63], v13 offset:20992
  s_waitcnt lgkmcnt(3)
  v_mfma_f32_16x16x32_bf16 v[80:83], v[72:75], v[128:131], v[80:83]
  ds_read_b128 v[64:67], v14 offset:512
  s_waitcnt lgkmcnt(3)
  v_mfma_f32_16x16x32_bf16 v[84:87], v[76:79], v[128:131], v[84:87]
  ds_read_b128 v[68:71], v14 offset:20992
  s_waitcnt lgkmcnt(3)
  v_mfma_f32_16x16x32_bf16 v[80:83], v[56:59], v[132:135], v[80:83]
  ds_read_b128 v[72:75], v15 offset:512
  s_waitcnt lgkmcnt(3)
  v_mfma_f32_16x16x32_bf16 v[84:87], v[60:63], v[132:135], v[84:87]
  ds_read_b128 v[76:79], v15 offset:20992
  s_waitcnt lgkmcnt(3)
  v_mfma_f32_16x16x32_bf16 v[80:83], v[64:67], v[136:139], v[80:83]
  ds_read_b128 v[56:59], v12 offset:768
  s_waitcnt lgkmcnt(3)
  v_mfma_f32_16x16x32_bf16 v[84:87], v[68:71], v[136:139], v[84:87]
  ds_read_b128 v[60:63], v12 offset:21248
  s_waitcnt lgkmcnt(3)
  v_mfma_f32_16x16x32_bf16 v[80:83], v[72:75], v[140:143], v[80:83]
  ds_read_b128 v[64:67], v13 offset:768
  s_waitcnt lgkmcnt(3)
  v_mfma_f32_16x16x32_bf16 v[84:87], v[76:79], v[140:143], v[84:87]
  ds_read_b128 v[68:71], v13 offset:21248
  s_waitcnt lgkmcnt(3)
  v_mfma_f32_16x16x32_bf16 v[80:83], v[56:59], v[144:147], v[80:83]
  ds_read_b128 v[72:75], v14 offset:768
  s_waitcnt lgkmcnt(3)
  v_mfma_f32_16x16x32_bf16 v[84:87], v[60:63], v[144:147], v[84:87]
  ds_read_b128 v[76:79], v14 offset:21248
  s_waitcnt lgkmcnt(3)
  v_mfma_f32_16x16x32_bf16 v[80:83], v[64:67], v[148:151], v[80:83]
  ds_read_b128 v[56:59], v15 offset:768
  s_waitcnt lgkmcnt(3)
  v_mfma_f32_16x16x32_bf16 v[84:87], v[68:71], v[148:151], v[84:87]
  ds_read_b128 v[60:63], v15 offset:21248
  s_waitcnt lgkmcnt(3)
  v_mfma_f32_16x16x32_bf16 v[80:83], v[72:75], v[152:155], v[80:83]
  ds_read_b128 v[64:67], v12 offset:1024
  s_waitcnt lgkmcnt(3)
  v_mfma_f32_16x16x32_bf16 v[84:87], v[76:79], v[152:155], v[84:87]
  ds_read_b128 v[68:71], v12 offset:21504
  s_waitcnt lgkmcnt(3)
  v_mfma_f32_16x16x32_bf16 v[80:83], v[56:59], v[156:159], v[80:83]
  ds_read_b128 v[72:75], v13 offset:1024
  s_waitcnt lgkmcnt(3)
  v_mfma_f32_16x16x32_bf16 v[84:87], v[60:63], v[156:159], v[84:87]
  ds_read_b128 v[76:79], v13 offset:21504
  s_waitcnt lgkmcnt(3)
  v_mfma_f32_16x16x32_bf16 v[80:83], v[64:67], v[160:163], v[80:83]
  ds_read_b128 v[56:59], v14 offset:1024
  s_waitcnt lgkmcnt(3)
  v_mfma_f32_16x16x32_bf16 v[84:87], v[68:71], v[160:163], v[84:87]
  ds_read_b128 v[60:63], v14 offset:21504
  s_waitcnt lgkmcnt(3)
  v_mfma_f32_16x16x32_bf16 v[80:83], v[72:75], v[164:167], v[80:83]
  ds_read_b128 v[64:67], v15 offset:1024
  s_waitcnt lgkmcnt(3)
  v_mfma_f32_16x16x32_bf16 v[84:87], v[76:79], v[164:167], v[84:87]
  ds_read_b128 v[68:71], v15 offset:21504
  s_waitcnt lgkmcnt(3)
  v_mfma_f32_16x16x32_bf16 v[80:83], v[56:59], v[168:171], v[80:83]
  s_waitcnt lgkmcnt(2)
  v_mfma_f32_16x16x32_bf16 v[84:87], v[60:63], v[168:171], v[84:87]
  s_waitcnt lgkmcnt(1)
  v_mfma_f32_16x16x32_bf16 v[80:83], v[64:67], v[172:175], v[80:83]
  s_waitcnt lgkmcnt(0)
  v_mfma_f32_16x16x32_bf16 v[84:87], v[68:71], v[172:175], v[84:87]
  s_waitcnt vmcnt(0)
  s_barrier
  v_mov_b32 v24, 2
  buffer_store_dword v24, v17, s[8:11], 0 offen sc1
  s_mov_b32 s38, 163840
  s_add_u32 m0, s39, 40960
  s_nop 0
  buffer_load_dwordx4 v2, s[12:15], s38 offen lds
  s_add_u32 m0, s39, 41984
  s_nop 0
  buffer_load_dwordx4 v3, s[12:15], s38 offen lds
  s_add_u32 m0, s39, 43008
  s_nop 0
  buffer_load_dwordx4 v4, s[12:15], s38 offen lds
  s_add_u32 m0, s39, 44032
  s_nop 0
  buffer_load_dwordx4 v5, s[12:15], s38 offen lds
  s_add_u32 m0, s39, 45056
  s_nop 0
  buffer_load_dwordx4 v6, s[12:15], s38 offen lds
  s_mov_b32 s40, 524288
  s_nop 6
  v_cvt_pk_bf16_f32 v48, v80, v81
  v_cvt_pk_bf16_f32 v49, v82, v83
  v_cvt_pk_bf16_f32 v50, v84, v85
  v_cvt_pk_bf16_f32 v51, v86, v87
  buffer_store_dwordx4 v[48:51], v16, s[8:11], s40 offen sc1
  ds_read_b128 v[56:59], v8 offset:0
  ds_read_b128 v[60:63], v8 offset:20480
  ds_read_b128 v[64:67], v9 offset:0
  ds_read_b128 v[68:71], v9 offset:20480
  s_waitcnt lgkmcnt(3)
  v_mfma_f32_16x16x32_bf16 v[80:83], v[56:59], v[96:99], 0
  ds_read_b128 v[72:75], v10 offset:0
  s_waitcnt lgkmcnt(3)
  v_mfma_f32_16x16x32_bf16 v[84:87], v[60:63], v[96:99], 0
  ds_read_b128 v[76:79], v10 offset:20480
  s_waitcnt lgkmcnt(3)
  v_mfma_f32_16x16x32_bf16 v[80:83], v[64:67], v[100:103], v[80:83]
  ds_read_b128 v[56:59], v11 offset:0
  s_waitcnt lgkmcnt(3)
  v_mfma_f32_16x16x32_bf16 v[84:87], v[68:71], v[100:103], v[84:87]
  ds_read_b128 v[60:63], v11 offset:20480
  s_waitcnt lgkmcnt(3)
  v_mfma_f32_16x16x32_bf16 v[80:83], v[72:75], v[104:107], v[80:83]
  ds_read_b128 v[64:67], v8 offset:256
  s_waitcnt lgkmcnt(3)
  v_mfma_f32_16x16x32_bf16 v[84:87], v[76:79], v[104:107], v[84:87]
  ds_read_b128 v[68:71], v8 offset:20736
  s_waitcnt lgkmcnt(3)
  v_mfma_f32_16x16x32_bf16 v[80:83], v[56:59], v[108:111], v[80:83]
  ds_read_b128 v[72:75], v9 offset:256
  s_waitcnt lgkmcnt(3)
  v_mfma_f32_16x16x32_bf16 v[84:87], v[60:63], v[108:111], v[84:87]
  ds_read_b128 v[76:79], v9 offset:20736
  s_waitcnt lgkmcnt(3)
  v_mfma_f32_16x16x32_bf16 v[80:83], v[64:67], v[112:115], v[80:83]
  ds_read_b128 v[56:59], v10 offset:256
  s_waitcnt lgkmcnt(3)
  v_mfma_f32_16x16x32_bf16 v[84:87], v[68:71], v[112:115], v[84:87]
  ds_read_b128 v[60:63], v10 offset:20736
  s_waitcnt lgkmcnt(3)
  v_mfma_f32_16x16x32_bf16 v[80:83], v[72:75], v[116:119], v[80:83]
  ds_read_b128 v[64:67], v11 offset:256
  s_waitcnt lgkmcnt(3)
  v_mfma_f32_16x16x32_bf16 v[84:87], v[76:79], v[116:119], v[84:87]
  ds_read_b128 v[68:71], v11 offset:20736
  s_waitcnt lgkmcnt(3)
  v_mfma_f32_16x16x32_bf16 v[80:83], v[56:59], v[120:123], v[80:83]
  ds_read_b128 v[72:75], v8 offset:512
  s_waitcnt lgkmcnt(3)
  v_mfma_f32_16x16x32_bf16 v[84:87], v[60:63], v[120:123], v[84:87]
  ds_read_b128 v[76:79], v8 offset:20992
  s_waitcnt lgkmcnt(3)
  v_mfma_f32_16x16x32_bf16 v[80:83], v[64:67], v[124:127], v[80:83]
  ds_read_b128 v[56:59], v9 offset:512
  s_waitcnt lgkmcnt(3)
  v_mfma_f32_16x16x32_bf16 v[84:87], v[68:71], v[124:127], v[84:87]
  ds_read_b128 v[60:63], v9 offset:20992
  s_waitcnt lgkmcnt(3)
  v_mfma_f32_16x16x32_bf16 v[80:83], v[72:75], v[128:131], v[80:83]
  ds_read_b128 v[64:67], v10 offset:512
  s_waitcnt lgkmcnt(3)
  v_mfma_f32_16x16x32_bf16 v[84:87], v[76:79], v[128:131], v[84:87]
  ds_read_b128 v[68:71], v10 offset:20992
  s_waitcnt lgkmcnt(3)
  v_mfma_f32_16x16x32_bf16 v[80:83], v[56:59], v[132:135], v[80:83]
  ds_read_b128 v[72:75], v11 offset:512
  s_waitcnt lgkmcnt(3)
  v_mfma_f32_16x16x32_bf16 v[84:87], v[60:63], v[132:135], v[84:87]
  ds_read_b128 v[76:79], v11 offset:20992
  s_waitcnt lgkmcnt(3)
  v_mfma_f32_16x16x32_bf16 v[80:83], v[64:67], v[136:139], v[80:83]
  ds_read_b128 v[56:59], v8 offset:768
  s_waitcnt lgkmcnt(3)
  v_mfma_f32_16x16x32_bf16 v[84:87], v[68:71], v[136:139], v[84:87]
  ds_read_b128 v[60:63], v8 offset:21248
  s_waitcnt lgkmcnt(3)
  v_mfma_f32_16x16x32_bf16 v[80:83], v[72:75], v[140:143], v[80:83]
  ds_read_b128 v[64:67], v9 offset:768
  s_waitcnt lgkmcnt(3)
  v_mfma_f32_16x16x32_bf16 v[84:87], v[76:79], v[140:143], v[84:87]
  ds_read_b128 v[68:71], v9 offset:21248
  s_waitcnt lgkmcnt(3)
  v_mfma_f32_16x16x32_bf16 v[80:83], v[56:59], v[144:147], v[80:83]
  ds_read_b128 v[72:75], v10 offset:768
  s_waitcnt lgkmcnt(3)
  v_mfma_f32_16x16x32_bf16 v[84:87], v[60:63], v[144:147], v[84:87]
  ds_read_b128 v[76:79], v10 offset:21248
  s_waitcnt lgkmcnt(3)
  v_mfma_f32_16x16x32_bf16 v[80:83], v[64:67], v[148:151], v[80:83]
  ds_read_b128 v[56:59], v11 offset:768
  s_waitcnt lgkmcnt(3)
  v_mfma_f32_16x16x32_bf16 v[84:87], v[68:71], v[148:151], v[84:87]
  ds_read_b128 v[60:63], v11 offset:21248
  s_waitcnt lgkmcnt(3)
  v_mfma_f32_16x16x32_bf16 v[80:83], v[72:75], v[152:155], v[80:83]
  ds_read_b128 v[64:67], v8 offset:1024
  s_waitcnt lgkmcnt(3)
  v_mfma_f32_16x16x32_bf16 v[84:87], v[76:79], v[152:155], v[84:87]
  ds_read_b128 v[68:71], v8 offset:21504
  s_waitcnt lgkmcnt(3)
  v_mfma_f32_16x16x32_bf16 v[80:83], v[56:59], v[156:159], v[80:83]
  ds_read_b128 v[72:75], v9 offset:1024
  s_waitcnt lgkmcnt(3)
  v_mfma_f32_16x16x32_bf16 v[84:87], v[60:63], v[156:159], v[84:87]
  ds_read_b128 v[76:79], v9 offset:21504
  s_waitcnt lgkmcnt(3)
  v_mfma_f32_16x16x32_bf16 v[80:83], v[64:67], v[160:163], v[80:83]
  ds_read_b128 v[56:59], v10 offset:1024
  s_waitcnt lgkmcnt(3)
  v_mfma_f32_16x16x32_bf16 v[84:87], v[68:71], v[160:163], v[84:87]
  ds_read_b128 v[60:63], v10 offset:21504
  s_waitcnt lgkmcnt(3)
  v_mfma_f32_16x16x32_bf16 v[80:83], v[72:75], v[164:167], v[80:83]
  ds_read_b128 v[64:67], v11 offset:1024
  s_waitcnt lgkmcnt(3)
  v_mfma_f32_16x16x32_bf16 v[84:87], v[76:79], v[164:167], v[84:87]
  ds_read_b128 v[68:71], v11 offset:21504
  s_waitcnt lgkmcnt(3)
  v_mfma_f32_16x16x32_bf16 v[80:83], v[56:59], v[168:171], v[80:83]
  s_waitcnt lgkmcnt(2)
  v_mfma_f32_16x16x32_bf16 v[84:87], v[60:63], v[168:171], v[84:87]
  s_waitcnt lgkmcnt(1)
  v_mfma_f32_16x16x32_bf16 v[80:83], v[64:67], v[172:175], v[80:83]
  s_waitcnt lgkmcnt(0)
  v_mfma_f32_16x16x32_bf16 v[84:87], v[68:71], v[172:175], v[84:87]
  s_waitcnt vmcnt(0)
  s_barrier
  v_mov_b32 v24, 3
  buffer_store_dword v24, v17, s[8:11], 0 offen sc1
  s_mov_b32 s40, 786432
  s_nop 6
  v_cvt_pk_bf16_f32 v52, v80, v81
  v_cvt_pk_bf16_f32 v53, v82, v83
  v_cvt_pk_bf16_f32 v54, v84, v85
  v_cvt_pk_bf16_f32 v55, v86, v87
  buffer_store_dwordx4 v[52:55], v16, s[8:11], s40 offen sc1
  ds_read_b128 v[56:59], v8 offset:40960
  ds_read_b128 v[60:63], v8 offset:61440
  ds_read_b128 v[64:67], v9 offset:40960
  ds_read_b128 v[68:71], v9 offset:61440
  s_waitcnt lgkmcnt(3)
  v_mfma_f32_16x16x32_bf16 v[80:83], v[56:59], v[96:99], 0
  ds_read_b128 v[72:75], v10 offset:40960
  s_waitcnt lgkmcnt(3)
  v_mfma_f32_16x16x32_bf16 v[84:87], v[60:63], v[96:99], 0
  ds_read_b128 v[76:79], v10 offset:61440
  s_waitcnt lgkmcnt(3)
  v_mfma_f32_16x16x32_bf16 v[80:83], v[64:67], v[100:103], v[80:83]
  ds_read_b128 v[56:59], v11 offset:40960
  s_waitcnt lgkmcnt(3)
  v_mfma_f32_16x16x32_bf16 v[84:87], v[68:71], v[100:103], v[84:87]
  ds_read_b128 v[60:63], v11 offset:61440
  s_waitcnt lgkmcnt(3)
  v_mfma_f32_16x16x32_bf16 v[80:83], v[72:75], v[104:107], v[80:83]
  ds_read_b128 v[64:67], v8 offset:41216
  s_waitcnt lgkmcnt(3)
  v_mfma_f32_16x16x32_bf16 v[84:87], v[76:79], v[104:107], v[84:87]
  ds_read_b128 v[68:71], v8 offset:61696
  s_waitcnt lgkmcnt(3)
  v_mfma_f32_16x16x32_bf16 v[80:83], v[56:59], v[108:111], v[80:83]
  ds_read_b128 v[72:75], v9 offset:41216
  s_waitcnt lgkmcnt(3)
  v_mfma_f32_16x16x32_bf16 v[84:87], v[60:63], v[108:111], v[84:87]
  ds_read_b128 v[76:79], v9 offset:61696
  s_waitcnt lgkmcnt(3)
  v_mfma_f32_16x16x32_bf16 v[80:83], v[64:67], v[112:115], v[80:83]
  ds_read_b128 v[56:59], v10 offset:41216
  s_waitcnt lgkmcnt(3)
  v_mfma_f32_16x16x32_bf16 v[84:87], v[68:71], v[112:115], v[84:87]
  ds_read_b128 v[60:63], v10 offset:61696
  s_waitcnt lgkmcnt(3)
  v_mfma_f32_16x16x32_bf16 v[80:83], v[72:75], v[116:119], v[80:83]
  ds_read_b128 v[64:67], v11 offset:41216
  s_waitcnt lgkmcnt(3)
  v_mfma_f32_16x16x32_bf16 v[84:87], v[76:79], v[116:119], v[84:87]
  ds_read_b128 v[68:71], v11 offset:61696
  s_waitcnt lgkmcnt(3)
  v_mfma_f32_16x16x32_bf16 v[80:83], v[56:59], v[120:123], v[80:83]
  ds_read_b128 v[72:75], v8 offset:41472
  s_waitcnt lgkmcnt(3)
  v_mfma_f32_16x16x32_bf16 v[84:87], v[60:63], v[120:123], v[84:87]
  ds_read_b128 v[76:79], v8 offset:61952
  s_waitcnt lgkmcnt(3)
  v_mfma_f32_16x16x32_bf16 v[80:83], v[64:67], v[124:127], v[80:83]
  ds_read_b128 v[56:59], v9 offset:41472
  s_waitcnt lgkmcnt(3)
  v_mfma_f32_16x16x32_bf16 v[84:87], v[68:71], v[124:127], v[84:87]
  ds_read_b128 v[60:63], v9 offset:61952
  s_waitcnt lgkmcnt(3)
  v_mfma_f32_16x16x32_bf16 v[80:83], v[72:75], v[128:131], v[80:83]
  ds_read_b128 v[64:67], v10 offset:41472
  s_waitcnt lgkmcnt(3)
  v_mfma_f32_16x16x32_bf16 v[84:87], v[76:79], v[128:131], v[84:87]
  ds_read_b128 v[68:71], v10 offset:61952
  s_waitcnt lgkmcnt(3)
  v_mfma_f32_16x16x32_bf16 v[80:83], v[56:59], v[132:135], v[80:83]
  ds_read_b128 v[72:75], v11 offset:41472
  s_waitcnt lgkmcnt(3)
  v_mfma_f32_16x16x32_bf16 v[84:87], v[60:63], v[132:135], v[84:87]
  ds_read_b128 v[76:79], v11 offset:61952
  s_waitcnt lgkmcnt(3)
  v_mfma_f32_16x16x32_bf16 v[80:83], v[64:67], v[136:139], v[80:83]
  ds_read_b128 v[56:59], v8 offset:41728
  s_waitcnt lgkmcnt(3)
  v_mfma_f32_16x16x32_bf16 v[84:87], v[68:71], v[136:139], v[84:87]
  ds_read_b128 v[60:63], v8 offset:62208
  s_waitcnt lgkmcnt(3)
  v_mfma_f32_16x16x32_bf16 v[80:83], v[72:75], v[140:143], v[80:83]
  ds_read_b128 v[64:67], v9 offset:41728
  s_waitcnt lgkmcnt(3)
  v_mfma_f32_16x16x32_bf16 v[84:87], v[76:79], v[140:143], v[84:87]
  ds_read_b128 v[68:71], v9 offset:62208
  s_waitcnt lgkmcnt(3)
  v_mfma_f32_16x16x32_bf16 v[80:83], v[56:59], v[144:147], v[80:83]
  ds_read_b128 v[72:75], v10 offset:41728
  s_waitcnt lgkmcnt(3)
  v_mfma_f32_16x16x32_bf16 v[84:87], v[60:63], v[144:147], v[84:87]
  ds_read_b128 v[76:79], v10 offset:62208
  s_waitcnt lgkmcnt(3)
  v_mfma_f32_16x16x32_bf16 v[80:83], v[64:67], v[148:151], v[80:83]
  ds_read_b128 v[56:59], v11 offset:41728
  s_waitcnt lgkmcnt(3)
  v_mfma_f32_16x16x32_bf16 v[84:87], v[68:71], v[148:151], v[84:87]
  ds_read_b128 v[60:63], v11 offset:62208
  s_waitcnt lgkmcnt(3)
  v_mfma_f32_16x16x32_bf16 v[80:83], v[72:75], v[152:155], v[80:83]
  ds_read_b128 v[64:67], v8 offset:41984
  s_waitcnt lgkmcnt(3)
  v_mfma_f32_16x16x32_bf16 v[84:87], v[76:79], v[152:155], v[84:87]
  ds_read_b128 v[68:71], v8 offset:62464
  s_waitcnt lgkmcnt(3)
  v_mfma_f32_16x16x32_bf16 v[80:83], v[56:59], v[156:159], v[80:83]
  ds_read_b128 v[72:75], v9 offset:41984
  s_waitcnt lgkmcnt(3)
  v_mfma_f32_16x16x32_bf16 v[84:87], v[60:63], v[156:159], v[84:87]
  ds_read_b128 v[76:79], v9 offset:62464
  s_waitcnt lgkmcnt(3)
  v_mfma_f32_16x16x32_bf16 v[80:83], v[64:67], v[160:163], v[80:83]
  ds_read_b128 v[56:59], v10 offset:41984
  s_waitcnt lgkmcnt(3)
  v_mfma_f32_16x16x32_bf16 v[84:87], v[68:71], v[160:163], v[84:87]
  ds_read_b128 v[60:63], v10 offset:62464
  s_waitcnt lgkmcnt(3)
  v_mfma_f32_16x16x32_bf16 v[80:83], v[72:75], v[164:167], v[80:83]
  ds_read_b128 v[64:67], v11 offset:41984
  s_waitcnt lgkmcnt(3)
  v_mfma_f32_16x16x32_bf16 v[84:87], v[76:79], v[164:167], v[84:87]
  ds_read_b128 v[68:71], v11 offset:62464
  s_waitcnt lgkmcnt(3)
  v_mfma_f32_16x16x32_bf16 v[80:83], v[56:59], v[168:171], v[80:83]
  s_waitcnt lgkmcnt(2)
  v_mfma_f32_16x16x32_bf16 v[84:87], v[60:63], v[168:171], v[84:87]
  s_waitcnt lgkmcnt(1)
  v_mfma_f32_16x16x32_bf16 v[80:83], v[64:67], v[172:175], v[80:83]
  s_waitcnt lgkmcnt(0)
  v_mfma_f32_16x16x32_bf16 v[84:87], v[68:71], v[172:175], v[84:87]
  s_waitcnt vmcnt(0)
  s_barrier
  v_mov_b32 v24, 4
  buffer_store_dword v24, v17, s[8:11], 0 offen sc1
  s_mov_b32 s40, 1048576
  s_nop 6
  v_cvt_pk_bf16_f32 v48, v80, v81
  v_cvt_pk_bf16_f32 v49, v82, v83
  v_cvt_pk_bf16_f32 v50, v84, v85
  v_cvt_pk_bf16_f32 v51, v86, v87
  buffer_store_dwordx4 v[48:51], v16, s[8:11], s40 offen sc1
  s_waitcnt vmcnt(0)
  s_barrier
  v_mov_b32 v24, 5
  buffer_store_dword v24, v17, s[8:11], 0 offen sc1
L_boot_done:
  s_waitcnt vmcnt(0) lgkmcnt(0)
  s_barrier
  s_cmp_lt_u32 s33, 40
  s_cbranch_scc1 L_out_after_boot
  s_branch L_b_after_boot
L_end:
  s_endpgm
.section .rodata,"a"
.p2align 6
.amdhsa_kernel concat_heads__memory_aug_recurrent_mem_tr__linear_attn_block__prompt_kernel
  .amdhsa_next_free_vgpr 256
  .amdhsa_next_free_sgpr 102
  .amdhsa_accum_offset 256
  .amdhsa_group_segment_fixed_size 0
  .amdhsa_kernarg_size 104
  .amdhsa_user_sgpr_count 2
  .amdhsa_user_sgpr_kernarg_segment_ptr 1
  .amdhsa_system_sgpr_workgroup_id_x 1
  .amdhsa_float_denorm_mode_32 3
.end_amdhsa_kernel
```
